```python
import torch

def _softmax(x, axis=-1):
    return torch.softmax(x, dim=axis)
def _gelu(x):
    return torch.nn.functional.gelu(x, approximate="tanh")
def _silu(x):
    return torch.nn.functional.silu(x)
def _sigmoid(x):
    return torch.sigmoid(x)
def _layernorm(x, axis=-1, eps=1e-5):
    m = x.mean(dim=axis, keepdim=True)
    v = x.var(dim=axis, keepdim=True, unbiased=False)
    return (x - m) / torch.sqrt(v + eps)
def _scatter_add(tgt, idx, src, axis=0):
    return tgt.clone().index_add_(axis, idx, src)
def _segment_sum(src, seg, n):
    out = torch.zeros((n,) + src.shape[1:], dtype=src.dtype)
    return out.index_add_(0, seg, src)
def _pad(x, pw):
    flat = tuple(v for pair in reversed(pw) for v in pair)
    return torch.nn.functional.pad(x, flat)

kernel_name = 'interleave_layers__linear_kernel_hedgehog__mixer_s_mlp__prompt'

def setup_inputs():

    _w = (lambda a: (lambda t: t.to(torch.bfloat16) if t.is_floating_point() else t)(torch.as_tensor(a)))
    def _A_setup():
        B, S, D, H = 1, 2048, 1024, 32
        Dh = D // H
        return {
            "x": _w((lambda *s: torch.randn(*s, dtype=torch.bfloat16) * 0.05)(B, S, D)),
            "wqkv": _w((lambda *s: torch.randn(*s, dtype=torch.bfloat16) * 0.2)(D, 3 * D)),
            "w_phi": _w((lambda *s: torch.randn(*s, dtype=torch.bfloat16) * 0.2)(H, Dh, Dh) * (Dh ** -0.5)),
            "wo": _w((lambda *s: torch.randn(*s, dtype=torch.bfloat16) * 0.05)(D, D)),
        }
    _A_in = _A_setup()

    def _B_setup():
        B, S, D, F = 1, 2048, 1024, 3584
        return {
            "x":  _w((lambda *s: torch.randn(*s, dtype=torch.bfloat16) * 0.05)(B, S, D)),
            "w1": _w((lambda *s: torch.randn(*s, dtype=torch.bfloat16) * 3.2)(D, D) * (D ** -0.5)),
            "w2": _w((lambda *s: torch.randn(*s, dtype=torch.bfloat16) * 3.2)(D, D) * (D ** -0.5)),
            "w3": _w((lambda *s: torch.randn(*s, dtype=torch.bfloat16) * 3.2)(D, F) * (D ** -0.5)),
            "w4": _w((lambda *s: torch.randn(*s, dtype=torch.bfloat16) * 1.6)(F, D) * (F ** -0.5)),
        }
    _B_in = _B_setup()

    return {
        "A_x": _A_in["x"],
        "A_wqkv": _A_in["wqkv"],
        "A_w_phi": _A_in["w_phi"],
        "A_wo": _A_in["wo"],
        "B_x": _B_in["x"],
        "B_w1": _B_in["w1"],
        "B_w2": _B_in["w2"],
        "B_w3": _B_in["w3"],
        "B_w4": _B_in["w4"],
    }

def reference(A_x, A_wqkv, A_w_phi, A_wo, B_x, B_w1, B_w2, B_w3, B_w4):
    def _A_ref(x, wqkv, w_phi, wo):
        B, S, D = x.shape
        H = 32; Dh = D // H
        qkv = (lambda x, *d: x.permute(*d))((x @ wqkv).reshape(B, S, 3, H, Dh), 2, 0, 3, 1, 4)
        q, k, v = qkv[0], qkv[1], qkv[2]
        pq = torch.einsum("bhsd,hdf->bhsf", q, w_phi)
        pk = torch.einsum("bhsd,hdf->bhsf", k, w_phi)
        phi_q = torch.concatenate([_softmax(pq, axis=-1), _softmax(-pq, axis=-1)], axis=-1)
        phi_k = torch.concatenate([_softmax(pk, axis=-1), _softmax(-pk, axis=-1)], axis=-1)
        kv = torch.einsum("bhsf,bhsd->bhfd", phi_k, v)
        z  = torch.einsum("bhsf->bhf", phi_k)
        num = torch.einsum("bhqf,bhfd->bhqd", phi_q, kv)
        den = torch.einsum("bhqf,bhf->bhq", phi_q, z)[..., None] + 1e-6
        o = num / den
        return (lambda x, *d: x.permute(*d))(o, 0, 2, 1, 3).reshape(B, S, D) @ wo

    def _B_ref(x, w1, w2, w3, w4):
        B, S, D = x.shape
        h = _gelu(_layernorm(x, axis=-1) @ w1)
        c = D // 4
        g0 = _pad(h[:, :, 0*c:1*c], ((0, 0), (1, 0), (0, 0)))[:, :S, :]
        g1 = _pad(h[:, :, 1*c:2*c], ((0, 0), (0, 1), (0, 0)))[:, 1:, :]
        g2 = _pad(h[:, :, 2*c:3*c], ((0, 0), (2, 0), (0, 0)))[:, :S, :]
        g3 = _pad(h[:, :, 3*c:   ], ((0, 0), (0, 2), (0, 0)))[:, 2:, :]
        hs = torch.concatenate([g0, g1, g2, g3], axis=-1) @ w2
        x1 = x + hs
        h2 = _gelu(_layernorm(x1, axis=-1) @ w3) @ w4
        return x1 + h2

    x = A_x
    x = x + _A_ref(_layernorm(x, axis=-1), A_wqkv, A_w_phi, A_wo)
    x = x + _B_ref(_layernorm(x, axis=-1), B_w1, B_w2, B_w3, B_w4)
    x = x + _A_ref(_layernorm(x, axis=-1), A_wqkv, A_w_phi, A_wo)
    x = x + _B_ref(_layernorm(x, axis=-1), B_w1, B_w2, B_w3, B_w4)
    return x
```

```asm
; @launch kernel=prep_kernel grid=(496,1,1) block=(256,1,1) lds=2048
; @launch kernel=qkv_kernel grid=(256,1,1) block=(256,1,1) lds=123904
; @launch kernel=a3_kernel grid=(128,1,1) block=(256,1,1) lds=7168
; @launch kernel=wo_kernel grid=(256,1,1) block=(256,1,1) lds=123904
; @launch kernel=w1_kernel grid=(256,1,1) block=(256,1,1) lds=123904
; @launch kernel=w2_kernel grid=(256,1,1) block=(256,1,1) lds=123904
; @launch kernel=w3_kernel grid=(256,1,1) block=(256,1,1) lds=136192
; @launch kernel=w4a_kernel grid=(256,1,1) block=(256,1,1) lds=99328
; @launch kernel=qkv_kernel grid=(256,1,1) block=(256,1,1) lds=123904
; @launch kernel=a3_kernel grid=(128,1,1) block=(256,1,1) lds=7168
; @launch kernel=wo_kernel grid=(256,1,1) block=(256,1,1) lds=123904
; @launch kernel=w1_kernel grid=(256,1,1) block=(256,1,1) lds=123904
; @launch kernel=w2_kernel grid=(256,1,1) block=(256,1,1) lds=123904
; @launch kernel=w3_kernel grid=(256,1,1) block=(256,1,1) lds=136192
; @launch kernel=w4b_kernel grid=(256,1,1) block=(256,1,1) lds=99328
.amdgcn_target "amdgcn-amd-amdhsa--gfx950"
.text
.globl prep_kernel
.p2align 8
.type prep_kernel,@function
prep_kernel:
s_cmp_ge_u32 s2, 496
s_cbranch_scc1 prep_kernel_end
v_and_b32 v1, 63, v0
v_lshrrev_b32 v2, 6, v0
s_cmp_ge_u32 s2, 256
s_cbranch_scc1 prep_kernel_cs
s_load_dwordx2 s[4:5], s[0:1], 0
s_load_dwordx2 s[8:9], s[0:1], 88
s_load_dwordx2 s[12:13], s[0:1], 88
s_waitcnt lgkmcnt(0)
s_mov_b32 s6, 4194304
s_mov_b32 s7, 0x00020000
s_add_u32 s8, s8, 52428800
s_addc_u32 s9, s9, 0
s_mov_b32 s10, 524288
s_mov_b32 s11, 0x00020000
s_mov_b32 s14, 4194304
s_mov_b32 s15, 0x00020000
s_lshl_b32 s20, s2, 3
v_lshl_add_u32 v3, v2, 1, s20
v_add_u32 v4, 0, v3
v_lshlrev_b32 v5, 11, v4
v_lshl_add_u32 v5, v1, 5, v5
buffer_load_dwordx4 v[8:11], v5, s[4:7], 0 offen
buffer_load_dwordx4 v[12:15], v5, s[4:7], 0 offen offset:16
v_mov_b32 v16, 0
v_mov_b32 v17, 0
s_waitcnt vmcnt(0)
buffer_store_dwordx4 v[8:11], v5, s[12:15], 0 offen
buffer_store_dwordx4 v[12:15], v5, s[12:15], 0 offen offset:16
v_lshlrev_b32 v18, 16, v8
v_and_b32 v19, 0xffff0000, v8
v_add_f32 v16, v16, v18
v_fmac_f32 v17, v18, v18
v_add_f32 v16, v16, v19
v_fmac_f32 v17, v19, v19
v_lshlrev_b32 v18, 16, v9
v_and_b32 v19, 0xffff0000, v9
v_add_f32 v16, v16, v18
v_fmac_f32 v17, v18, v18
v_add_f32 v16, v16, v19
v_fmac_f32 v17, v19, v19
v_lshlrev_b32 v18, 16, v10
v_and_b32 v19, 0xffff0000, v10
v_add_f32 v16, v16, v18
v_fmac_f32 v17, v18, v18
v_add_f32 v16, v16, v19
v_fmac_f32 v17, v19, v19
v_lshlrev_b32 v18, 16, v11
v_and_b32 v19, 0xffff0000, v11
v_add_f32 v16, v16, v18
v_fmac_f32 v17, v18, v18
v_add_f32 v16, v16, v19
v_fmac_f32 v17, v19, v19
v_lshlrev_b32 v18, 16, v12
v_and_b32 v19, 0xffff0000, v12
v_add_f32 v16, v16, v18
v_fmac_f32 v17, v18, v18
v_add_f32 v16, v16, v19
v_fmac_f32 v17, v19, v19
v_lshlrev_b32 v18, 16, v13
v_and_b32 v19, 0xffff0000, v13
v_add_f32 v16, v16, v18
v_fmac_f32 v17, v18, v18
v_add_f32 v16, v16, v19
v_fmac_f32 v17, v19, v19
v_lshlrev_b32 v18, 16, v14
v_and_b32 v19, 0xffff0000, v14
v_add_f32 v16, v16, v18
v_fmac_f32 v17, v18, v18
v_add_f32 v16, v16, v19
v_fmac_f32 v17, v19, v19
v_lshlrev_b32 v18, 16, v15
v_and_b32 v19, 0xffff0000, v15
v_add_f32 v16, v16, v18
v_fmac_f32 v17, v18, v18
v_add_f32 v16, v16, v19
v_fmac_f32 v17, v19, v19
s_nop 1
v_add_f32_dpp v16, v16, v16 quad_perm:[1,0,3,2] row_mask:0xf bank_mask:0xf
v_add_f32_dpp v17, v17, v17 quad_perm:[1,0,3,2] row_mask:0xf bank_mask:0xf
v_lshlrev_b32 v5, 8, v4
v_lshrrev_b32 v6, 1, v1
v_lshl_add_u32 v5, v6, 3, v5
buffer_store_dwordx2 v[16:17], v5, s[8:11], 0 offen
s_nop 1
v_add_u32 v4, 1, v3
v_lshlrev_b32 v5, 11, v4
v_lshl_add_u32 v5, v1, 5, v5
buffer_load_dwordx4 v[8:11], v5, s[4:7], 0 offen
buffer_load_dwordx4 v[12:15], v5, s[4:7], 0 offen offset:16
v_mov_b32 v16, 0
v_mov_b32 v17, 0
s_waitcnt vmcnt(0)
buffer_store_dwordx4 v[8:11], v5, s[12:15], 0 offen
buffer_store_dwordx4 v[12:15], v5, s[12:15], 0 offen offset:16
v_lshlrev_b32 v18, 16, v8
v_and_b32 v19, 0xffff0000, v8
v_add_f32 v16, v16, v18
v_fmac_f32 v17, v18, v18
v_add_f32 v16, v16, v19
v_fmac_f32 v17, v19, v19
v_lshlrev_b32 v18, 16, v9
v_and_b32 v19, 0xffff0000, v9
v_add_f32 v16, v16, v18
v_fmac_f32 v17, v18, v18
v_add_f32 v16, v16, v19
v_fmac_f32 v17, v19, v19
v_lshlrev_b32 v18, 16, v10
v_and_b32 v19, 0xffff0000, v10
v_add_f32 v16, v16, v18
v_fmac_f32 v17, v18, v18
v_add_f32 v16, v16, v19
v_fmac_f32 v17, v19, v19
v_lshlrev_b32 v18, 16, v11
v_and_b32 v19, 0xffff0000, v11
v_add_f32 v16, v16, v18
v_fmac_f32 v17, v18, v18
v_add_f32 v16, v16, v19
v_fmac_f32 v17, v19, v19
v_lshlrev_b32 v18, 16, v12
v_and_b32 v19, 0xffff0000, v12
v_add_f32 v16, v16, v18
v_fmac_f32 v17, v18, v18
v_add_f32 v16, v16, v19
v_fmac_f32 v17, v19, v19
v_lshlrev_b32 v18, 16, v13
v_and_b32 v19, 0xffff0000, v13
v_add_f32 v16, v16, v18
v_fmac_f32 v17, v18, v18
v_add_f32 v16, v16, v19
v_fmac_f32 v17, v19, v19
v_lshlrev_b32 v18, 16, v14
v_and_b32 v19, 0xffff0000, v14
v_add_f32 v16, v16, v18
v_fmac_f32 v17, v18, v18
v_add_f32 v16, v16, v19
v_fmac_f32 v17, v19, v19
v_lshlrev_b32 v18, 16, v15
v_and_b32 v19, 0xffff0000, v15
v_add_f32 v16, v16, v18
v_fmac_f32 v17, v18, v18
v_add_f32 v16, v16, v19
v_fmac_f32 v17, v19, v19
s_nop 1
v_add_f32_dpp v16, v16, v16 quad_perm:[1,0,3,2] row_mask:0xf bank_mask:0xf
v_add_f32_dpp v17, v17, v17 quad_perm:[1,0,3,2] row_mask:0xf bank_mask:0xf
v_lshlrev_b32 v5, 8, v4
v_lshrrev_b32 v6, 1, v1
v_lshl_add_u32 v5, v6, 3, v5
buffer_store_dwordx2 v[16:17], v5, s[8:11], 0 offen
s_nop 1
s_branch prep_kernel_end
prep_kernel_cs:
s_sub_u32 s20, s2, 256
s_and_b32 s26, s20, 3
s_lshr_b32 s20, s20, 2
s_load_dwordx2 s[4:5], s[0:1], 8
s_load_dwordx2 s[12:13], s[0:1], 40
s_load_dwordx2 s[14:15], s[0:1], 56
s_load_dwordx2 s[8:9], s[0:1], 88
s_waitcnt lgkmcnt(0)
s_add_u32 s8, s8, 54525952
s_addc_u32 s9, s9, 0
s_mov_b32 s10, 122880
s_mov_b32 s11, 0x00020000
s_mov_b32 s21, s20
s_mov_b32 s22, 6144
s_mov_b32 s6, 6291456
s_cmp_lt_u32 s20, 24
s_cbranch_scc1 prep_kernel_go
s_mov_b64 s[4:5], s[12:13]
s_sub_u32 s21, s20, 24
s_mov_b32 s22, 2048
s_mov_b32 s6, 2097152
s_cmp_lt_u32 s20, 32
s_cbranch_scc1 prep_kernel_go
s_mov_b64 s[4:5], s[14:15]
s_sub_u32 s21, s20, 32
s_mov_b32 s22, 7168
s_mov_b32 s6, 7340032
prep_kernel_go:
s_mov_b32 s7, 0x00020000
s_lshl_b32 s27, s26, 8
v_lshl_add_u32 v3, v2, 6, s27
v_mul_lo_u32 v3, v3, s22
s_lshl_b32 s23, s21, 8
v_add_u32 v3, s23, v3
v_lshl_add_u32 v3, v1, 2, v3
v_mov_b32 v16, 0
v_mov_b32 v17, 0
s_mov_b32 s24, 1
s_mov_b32 s25, 0
prep_kernel_lp:
buffer_load_dword v20, v3, s[4:7], s25 offen
s_add_u32 s25, s25, s22
buffer_load_dword v21, v3, s[4:7], s25 offen
s_add_u32 s25, s25, s22
buffer_load_dword v22, v3, s[4:7], s25 offen
s_add_u32 s25, s25, s22
buffer_load_dword v23, v3, s[4:7], s25 offen
s_add_u32 s25, s25, s22
buffer_load_dword v24, v3, s[4:7], s25 offen
s_add_u32 s25, s25, s22
buffer_load_dword v25, v3, s[4:7], s25 offen
s_add_u32 s25, s25, s22
buffer_load_dword v26, v3, s[4:7], s25 offen
s_add_u32 s25, s25, s22
buffer_load_dword v27, v3, s[4:7], s25 offen
s_add_u32 s25, s25, s22
buffer_load_dword v28, v3, s[4:7], s25 offen
s_add_u32 s25, s25, s22
buffer_load_dword v29, v3, s[4:7], s25 offen
s_add_u32 s25, s25, s22
buffer_load_dword v30, v3, s[4:7], s25 offen
s_add_u32 s25, s25, s22
buffer_load_dword v31, v3, s[4:7], s25 offen
s_add_u32 s25, s25, s22
buffer_load_dword v32, v3, s[4:7], s25 offen
s_add_u32 s25, s25, s22
buffer_load_dword v33, v3, s[4:7], s25 offen
s_add_u32 s25, s25, s22
buffer_load_dword v34, v3, s[4:7], s25 offen
s_add_u32 s25, s25, s22
buffer_load_dword v35, v3, s[4:7], s25 offen
s_add_u32 s25, s25, s22
buffer_load_dword v36, v3, s[4:7], s25 offen
s_add_u32 s25, s25, s22
buffer_load_dword v37, v3, s[4:7], s25 offen
s_add_u32 s25, s25, s22
buffer_load_dword v38, v3, s[4:7], s25 offen
s_add_u32 s25, s25, s22
buffer_load_dword v39, v3, s[4:7], s25 offen
s_add_u32 s25, s25, s22
buffer_load_dword v40, v3, s[4:7], s25 offen
s_add_u32 s25, s25, s22
buffer_load_dword v41, v3, s[4:7], s25 offen
s_add_u32 s25, s25, s22
buffer_load_dword v42, v3, s[4:7], s25 offen
s_add_u32 s25, s25, s22
buffer_load_dword v43, v3, s[4:7], s25 offen
s_add_u32 s25, s25, s22
buffer_load_dword v44, v3, s[4:7], s25 offen
s_add_u32 s25, s25, s22
buffer_load_dword v45, v3, s[4:7], s25 offen
s_add_u32 s25, s25, s22
buffer_load_dword v46, v3, s[4:7], s25 offen
s_add_u32 s25, s25, s22
buffer_load_dword v47, v3, s[4:7], s25 offen
s_add_u32 s25, s25, s22
buffer_load_dword v48, v3, s[4:7], s25 offen
s_add_u32 s25, s25, s22
buffer_load_dword v49, v3, s[4:7], s25 offen
s_add_u32 s25, s25, s22
buffer_load_dword v50, v3, s[4:7], s25 offen
s_add_u32 s25, s25, s22
buffer_load_dword v51, v3, s[4:7], s25 offen
s_add_u32 s25, s25, s22
buffer_load_dword v52, v3, s[4:7], s25 offen
s_add_u32 s25, s25, s22
buffer_load_dword v53, v3, s[4:7], s25 offen
s_add_u32 s25, s25, s22
buffer_load_dword v54, v3, s[4:7], s25 offen
s_add_u32 s25, s25, s22
buffer_load_dword v55, v3, s[4:7], s25 offen
s_add_u32 s25, s25, s22
buffer_load_dword v56, v3, s[4:7], s25 offen
s_add_u32 s25, s25, s22
buffer_load_dword v57, v3, s[4:7], s25 offen
s_add_u32 s25, s25, s22
buffer_load_dword v58, v3, s[4:7], s25 offen
s_add_u32 s25, s25, s22
buffer_load_dword v59, v3, s[4:7], s25 offen
s_add_u32 s25, s25, s22
buffer_load_dword v60, v3, s[4:7], s25 offen
s_add_u32 s25, s25, s22
buffer_load_dword v61, v3, s[4:7], s25 offen
s_add_u32 s25, s25, s22
buffer_load_dword v62, v3, s[4:7], s25 offen
s_add_u32 s25, s25, s22
buffer_load_dword v63, v3, s[4:7], s25 offen
s_add_u32 s25, s25, s22
buffer_load_dword v64, v3, s[4:7], s25 offen
s_add_u32 s25, s25, s22
buffer_load_dword v65, v3, s[4:7], s25 offen
s_add_u32 s25, s25, s22
buffer_load_dword v66, v3, s[4:7], s25 offen
s_add_u32 s25, s25, s22
buffer_load_dword v67, v3, s[4:7], s25 offen
s_add_u32 s25, s25, s22
buffer_load_dword v68, v3, s[4:7], s25 offen
s_add_u32 s25, s25, s22
buffer_load_dword v69, v3, s[4:7], s25 offen
s_add_u32 s25, s25, s22
buffer_load_dword v70, v3, s[4:7], s25 offen
s_add_u32 s25, s25, s22
buffer_load_dword v71, v3, s[4:7], s25 offen
s_add_u32 s25, s25, s22
buffer_load_dword v72, v3, s[4:7], s25 offen
s_add_u32 s25, s25, s22
buffer_load_dword v73, v3, s[4:7], s25 offen
s_add_u32 s25, s25, s22
buffer_load_dword v74, v3, s[4:7], s25 offen
s_add_u32 s25, s25, s22
buffer_load_dword v75, v3, s[4:7], s25 offen
s_add_u32 s25, s25, s22
buffer_load_dword v76, v3, s[4:7], s25 offen
s_add_u32 s25, s25, s22
buffer_load_dword v77, v3, s[4:7], s25 offen
s_add_u32 s25, s25, s22
buffer_load_dword v78, v3, s[4:7], s25 offen
s_add_u32 s25, s25, s22
buffer_load_dword v79, v3, s[4:7], s25 offen
s_add_u32 s25, s25, s22
buffer_load_dword v80, v3, s[4:7], s25 offen
s_add_u32 s25, s25, s22
buffer_load_dword v81, v3, s[4:7], s25 offen
s_add_u32 s25, s25, s22
buffer_load_dword v82, v3, s[4:7], s25 offen
s_add_u32 s25, s25, s22
buffer_load_dword v83, v3, s[4:7], s25 offen
s_add_u32 s25, s25, s22
s_waitcnt vmcnt(0)
v_lshlrev_b32 v18, 16, v20
v_and_b32 v19, 0xffff0000, v20
v_add_f32 v16, v16, v18
v_add_f32 v17, v17, v19
v_lshlrev_b32 v18, 16, v21
v_and_b32 v19, 0xffff0000, v21
v_add_f32 v16, v16, v18
v_add_f32 v17, v17, v19
v_lshlrev_b32 v18, 16, v22
v_and_b32 v19, 0xffff0000, v22
v_add_f32 v16, v16, v18
v_add_f32 v17, v17, v19
v_lshlrev_b32 v18, 16, v23
v_and_b32 v19, 0xffff0000, v23
v_add_f32 v16, v16, v18
v_add_f32 v17, v17, v19
v_lshlrev_b32 v18, 16, v24
v_and_b32 v19, 0xffff0000, v24
v_add_f32 v16, v16, v18
v_add_f32 v17, v17, v19
v_lshlrev_b32 v18, 16, v25
v_and_b32 v19, 0xffff0000, v25
v_add_f32 v16, v16, v18
v_add_f32 v17, v17, v19
v_lshlrev_b32 v18, 16, v26
v_and_b32 v19, 0xffff0000, v26
v_add_f32 v16, v16, v18
v_add_f32 v17, v17, v19
v_lshlrev_b32 v18, 16, v27
v_and_b32 v19, 0xffff0000, v27
v_add_f32 v16, v16, v18
v_add_f32 v17, v17, v19
v_lshlrev_b32 v18, 16, v28
v_and_b32 v19, 0xffff0000, v28
v_add_f32 v16, v16, v18
v_add_f32 v17, v17, v19
v_lshlrev_b32 v18, 16, v29
v_and_b32 v19, 0xffff0000, v29
v_add_f32 v16, v16, v18
v_add_f32 v17, v17, v19
v_lshlrev_b32 v18, 16, v30
v_and_b32 v19, 0xffff0000, v30
v_add_f32 v16, v16, v18
v_add_f32 v17, v17, v19
v_lshlrev_b32 v18, 16, v31
v_and_b32 v19, 0xffff0000, v31
v_add_f32 v16, v16, v18
v_add_f32 v17, v17, v19
v_lshlrev_b32 v18, 16, v32
v_and_b32 v19, 0xffff0000, v32
v_add_f32 v16, v16, v18
v_add_f32 v17, v17, v19
v_lshlrev_b32 v18, 16, v33
v_and_b32 v19, 0xffff0000, v33
v_add_f32 v16, v16, v18
v_add_f32 v17, v17, v19
v_lshlrev_b32 v18, 16, v34
v_and_b32 v19, 0xffff0000, v34
v_add_f32 v16, v16, v18
v_add_f32 v17, v17, v19
v_lshlrev_b32 v18, 16, v35
v_and_b32 v19, 0xffff0000, v35
v_add_f32 v16, v16, v18
v_add_f32 v17, v17, v19
v_lshlrev_b32 v18, 16, v36
v_and_b32 v19, 0xffff0000, v36
v_add_f32 v16, v16, v18
v_add_f32 v17, v17, v19
v_lshlrev_b32 v18, 16, v37
v_and_b32 v19, 0xffff0000, v37
v_add_f32 v16, v16, v18
v_add_f32 v17, v17, v19
v_lshlrev_b32 v18, 16, v38
v_and_b32 v19, 0xffff0000, v38
v_add_f32 v16, v16, v18
v_add_f32 v17, v17, v19
v_lshlrev_b32 v18, 16, v39
v_and_b32 v19, 0xffff0000, v39
v_add_f32 v16, v16, v18
v_add_f32 v17, v17, v19
v_lshlrev_b32 v18, 16, v40
v_and_b32 v19, 0xffff0000, v40
v_add_f32 v16, v16, v18
v_add_f32 v17, v17, v19
v_lshlrev_b32 v18, 16, v41
v_and_b32 v19, 0xffff0000, v41
v_add_f32 v16, v16, v18
v_add_f32 v17, v17, v19
v_lshlrev_b32 v18, 16, v42
v_and_b32 v19, 0xffff0000, v42
v_add_f32 v16, v16, v18
v_add_f32 v17, v17, v19
v_lshlrev_b32 v18, 16, v43
v_and_b32 v19, 0xffff0000, v43
v_add_f32 v16, v16, v18
v_add_f32 v17, v17, v19
v_lshlrev_b32 v18, 16, v44
v_and_b32 v19, 0xffff0000, v44
v_add_f32 v16, v16, v18
v_add_f32 v17, v17, v19
v_lshlrev_b32 v18, 16, v45
v_and_b32 v19, 0xffff0000, v45
v_add_f32 v16, v16, v18
v_add_f32 v17, v17, v19
v_lshlrev_b32 v18, 16, v46
v_and_b32 v19, 0xffff0000, v46
v_add_f32 v16, v16, v18
v_add_f32 v17, v17, v19
v_lshlrev_b32 v18, 16, v47
v_and_b32 v19, 0xffff0000, v47
v_add_f32 v16, v16, v18
v_add_f32 v17, v17, v19
v_lshlrev_b32 v18, 16, v48
v_and_b32 v19, 0xffff0000, v48
v_add_f32 v16, v16, v18
v_add_f32 v17, v17, v19
v_lshlrev_b32 v18, 16, v49
v_and_b32 v19, 0xffff0000, v49
v_add_f32 v16, v16, v18
v_add_f32 v17, v17, v19
v_lshlrev_b32 v18, 16, v50
v_and_b32 v19, 0xffff0000, v50
v_add_f32 v16, v16, v18
v_add_f32 v17, v17, v19
v_lshlrev_b32 v18, 16, v51
v_and_b32 v19, 0xffff0000, v51
v_add_f32 v16, v16, v18
v_add_f32 v17, v17, v19
v_lshlrev_b32 v18, 16, v52
v_and_b32 v19, 0xffff0000, v52
v_add_f32 v16, v16, v18
v_add_f32 v17, v17, v19
v_lshlrev_b32 v18, 16, v53
v_and_b32 v19, 0xffff0000, v53
v_add_f32 v16, v16, v18
v_add_f32 v17, v17, v19
v_lshlrev_b32 v18, 16, v54
v_and_b32 v19, 0xffff0000, v54
v_add_f32 v16, v16, v18
v_add_f32 v17, v17, v19
v_lshlrev_b32 v18, 16, v55
v_and_b32 v19, 0xffff0000, v55
v_add_f32 v16, v16, v18
v_add_f32 v17, v17, v19
v_lshlrev_b32 v18, 16, v56
v_and_b32 v19, 0xffff0000, v56
v_add_f32 v16, v16, v18
v_add_f32 v17, v17, v19
v_lshlrev_b32 v18, 16, v57
v_and_b32 v19, 0xffff0000, v57
v_add_f32 v16, v16, v18
v_add_f32 v17, v17, v19
v_lshlrev_b32 v18, 16, v58
v_and_b32 v19, 0xffff0000, v58
v_add_f32 v16, v16, v18
v_add_f32 v17, v17, v19
v_lshlrev_b32 v18, 16, v59
v_and_b32 v19, 0xffff0000, v59
v_add_f32 v16, v16, v18
v_add_f32 v17, v17, v19
v_lshlrev_b32 v18, 16, v60
v_and_b32 v19, 0xffff0000, v60
v_add_f32 v16, v16, v18
v_add_f32 v17, v17, v19
v_lshlrev_b32 v18, 16, v61
v_and_b32 v19, 0xffff0000, v61
v_add_f32 v16, v16, v18
v_add_f32 v17, v17, v19
v_lshlrev_b32 v18, 16, v62
v_and_b32 v19, 0xffff0000, v62
v_add_f32 v16, v16, v18
v_add_f32 v17, v17, v19
v_lshlrev_b32 v18, 16, v63
v_and_b32 v19, 0xffff0000, v63
v_add_f32 v16, v16, v18
v_add_f32 v17, v17, v19
v_lshlrev_b32 v18, 16, v64
v_and_b32 v19, 0xffff0000, v64
v_add_f32 v16, v16, v18
v_add_f32 v17, v17, v19
v_lshlrev_b32 v18, 16, v65
v_and_b32 v19, 0xffff0000, v65
v_add_f32 v16, v16, v18
v_add_f32 v17, v17, v19
v_lshlrev_b32 v18, 16, v66
v_and_b32 v19, 0xffff0000, v66
v_add_f32 v16, v16, v18
v_add_f32 v17, v17, v19
v_lshlrev_b32 v18, 16, v67
v_and_b32 v19, 0xffff0000, v67
v_add_f32 v16, v16, v18
v_add_f32 v17, v17, v19
v_lshlrev_b32 v18, 16, v68
v_and_b32 v19, 0xffff0000, v68
v_add_f32 v16, v16, v18
v_add_f32 v17, v17, v19
v_lshlrev_b32 v18, 16, v69
v_and_b32 v19, 0xffff0000, v69
v_add_f32 v16, v16, v18
v_add_f32 v17, v17, v19
v_lshlrev_b32 v18, 16, v70
v_and_b32 v19, 0xffff0000, v70
v_add_f32 v16, v16, v18
v_add_f32 v17, v17, v19
v_lshlrev_b32 v18, 16, v71
v_and_b32 v19, 0xffff0000, v71
v_add_f32 v16, v16, v18
v_add_f32 v17, v17, v19
v_lshlrev_b32 v18, 16, v72
v_and_b32 v19, 0xffff0000, v72
v_add_f32 v16, v16, v18
v_add_f32 v17, v17, v19
v_lshlrev_b32 v18, 16, v73
v_and_b32 v19, 0xffff0000, v73
v_add_f32 v16, v16, v18
v_add_f32 v17, v17, v19
v_lshlrev_b32 v18, 16, v74
v_and_b32 v19, 0xffff0000, v74
v_add_f32 v16, v16, v18
v_add_f32 v17, v17, v19
v_lshlrev_b32 v18, 16, v75
v_and_b32 v19, 0xffff0000, v75
v_add_f32 v16, v16, v18
v_add_f32 v17, v17, v19
v_lshlrev_b32 v18, 16, v76
v_and_b32 v19, 0xffff0000, v76
v_add_f32 v16, v16, v18
v_add_f32 v17, v17, v19
v_lshlrev_b32 v18, 16, v77
v_and_b32 v19, 0xffff0000, v77
v_add_f32 v16, v16, v18
v_add_f32 v17, v17, v19
v_lshlrev_b32 v18, 16, v78
v_and_b32 v19, 0xffff0000, v78
v_add_f32 v16, v16, v18
v_add_f32 v17, v17, v19
v_lshlrev_b32 v18, 16, v79
v_and_b32 v19, 0xffff0000, v79
v_add_f32 v16, v16, v18
v_add_f32 v17, v17, v19
v_lshlrev_b32 v18, 16, v80
v_and_b32 v19, 0xffff0000, v80
v_add_f32 v16, v16, v18
v_add_f32 v17, v17, v19
v_lshlrev_b32 v18, 16, v81
v_and_b32 v19, 0xffff0000, v81
v_add_f32 v16, v16, v18
v_add_f32 v17, v17, v19
v_lshlrev_b32 v18, 16, v82
v_and_b32 v19, 0xffff0000, v82
v_add_f32 v16, v16, v18
v_add_f32 v17, v17, v19
v_lshlrev_b32 v18, 16, v83
v_and_b32 v19, 0xffff0000, v83
v_add_f32 v16, v16, v18
v_add_f32 v17, v17, v19
s_sub_u32 s24, s24, 1
s_cmp_lg_u32 s24, 0
s_cbranch_scc1 prep_kernel_lp
v_lshlrev_b32 v4, 3, v0
ds_write_b64 v4, v[16:17]
s_waitcnt lgkmcnt(0)
s_barrier
v_lshlrev_b32 v4, 3, v1
ds_read_b64 v[20:21], v4 offset:0
ds_read_b64 v[22:23], v4 offset:512
ds_read_b64 v[24:25], v4 offset:1024
ds_read_b64 v[26:27], v4 offset:1536
s_waitcnt lgkmcnt(0)
v_add_f32 v20, v20, v22
v_add_f32 v21, v21, v23
v_add_f32 v20, v20, v24
v_add_f32 v21, v21, v25
v_add_f32 v20, v20, v26
v_add_f32 v21, v21, v27
s_lshl_b32 s23, s20, 9
s_mul_i32 s27, s26, 30720
s_add_u32 s23, s23, s27
v_add_u32 v4, s23, v4
buffer_store_dwordx2 v[20:21], v4, s[8:11], 0 offen
prep_kernel_end:
s_endpgm
.globl qkv_kernel
.p2align 8
.type qkv_kernel,@function
qkv_kernel:
s_cmp_ge_u32 s2, 256
s_cbranch_scc1 qkv_kernel_end
s_load_dwordx2 s[4:5], s[0:1], 88
s_load_dwordx2 s[8:9], s[0:1], 8
s_and_b32 s20, s2, 7
s_lshr_b32 s21, s2, 3
s_lshr_b32 s22, s20, 1
s_lshl_b32 s22, s22, 2
s_and_b32 s23, s21, 3
s_add_u32 s22, s22, s23
s_and_b32 s23, s20, 1
s_lshl_b32 s23, s23, 3
s_lshr_b32 s24, s21, 2
s_add_u32 s23, s23, s24
v_and_b32 v1, 63, v0
v_lshrrev_b32 v2, 6, v0
s_waitcnt lgkmcnt(0)
s_mov_b32 s6, 4194304
s_mov_b32 s7, 0x00020000
s_mov_b32 s10, 6291456
s_mov_b32 s11, 0x00020000
v_lshrrev_b32 v3, 3, v1
v_and_b32 v4, 7, v1
v_xor_b32 v4, v4, v3
v_lshlrev_b32 v4, 4, v4
s_lshl_b32 s25, s22, 7
v_lshlrev_b32 v5, 5, v2
v_add_u32 v5, s25, v5
v_add_u32 v5, v5, v3
s_mov_b32 s26, 2048
v_mul_lo_u32 v5, v5, s26
v_add_u32 v10, v5, v4
v_add_u32 v11, 16384, v10
v_add_u32 v12, 32768, v10
v_add_u32 v13, 49152, v10
v_mul_u32_u24 v3, 384, v2
v_add_u32 v3, 0, v3
v_add_u32 v3, v3, v1
v_mul_u32_u24 v4, 2731, v3
v_lshrrev_b32 v4, 16, v4
v_mul_u32_u24 v5, 24, v4
v_sub_u32 v5, v3, v5
v_bfe_u32 v6, v4, 3, 1
v_bfe_u32 v7, v4, 1, 1
v_lshl_or_b32 v6, v7, 1, v6
v_lshlrev_b32 v6, 1, v6
v_xor_b32 v5, v5, v6
v_lshrrev_b32 v6, 1, v5
v_mul_u32_u24 v7, 43, v6
v_lshrrev_b32 v7, 8, v7
v_mul_u32_u24 v8, 12, v7
v_sub_u32 v8, v5, v8
v_lshrrev_b32 v9, 2, v8
v_and_b32 v8, 3, v8
v_lshlrev_b32 v9, 11, v9
v_lshl_add_u32 v9, v7, 6, v9
v_lshl_add_u32 v9, v8, 4, v9
s_lshl_b32 s25, s23, 7
v_add_u32 v9, s25, v9
v_mul_u32_u24 v4, 6144, v4
v_add_u32 v14, v4, v9
v_mul_u32_u24 v3, 384, v2
v_add_u32 v3, 64, v3
v_add_u32 v3, v3, v1
v_mul_u32_u24 v4, 2731, v3
v_lshrrev_b32 v4, 16, v4
v_mul_u32_u24 v5, 24, v4
v_sub_u32 v5, v3, v5
v_bfe_u32 v6, v4, 3, 1
v_bfe_u32 v7, v4, 1, 1
v_lshl_or_b32 v6, v7, 1, v6
v_lshlrev_b32 v6, 1, v6
v_xor_b32 v5, v5, v6
v_lshrrev_b32 v6, 1, v5
v_mul_u32_u24 v7, 43, v6
v_lshrrev_b32 v7, 8, v7
v_mul_u32_u24 v8, 12, v7
v_sub_u32 v8, v5, v8
v_lshrrev_b32 v9, 2, v8
v_and_b32 v8, 3, v8
v_lshlrev_b32 v9, 11, v9
v_lshl_add_u32 v9, v7, 6, v9
v_lshl_add_u32 v9, v8, 4, v9
s_lshl_b32 s25, s23, 7
v_add_u32 v9, s25, v9
v_mul_u32_u24 v4, 6144, v4
v_add_u32 v15, v4, v9
v_mul_u32_u24 v3, 384, v2
v_add_u32 v3, 128, v3
v_add_u32 v3, v3, v1
v_mul_u32_u24 v4, 2731, v3
v_lshrrev_b32 v4, 16, v4
v_mul_u32_u24 v5, 24, v4
v_sub_u32 v5, v3, v5
v_bfe_u32 v6, v4, 3, 1
v_bfe_u32 v7, v4, 1, 1
v_lshl_or_b32 v6, v7, 1, v6
v_lshlrev_b32 v6, 1, v6
v_xor_b32 v5, v5, v6
v_lshrrev_b32 v6, 1, v5
v_mul_u32_u24 v7, 43, v6
v_lshrrev_b32 v7, 8, v7
v_mul_u32_u24 v8, 12, v7
v_sub_u32 v8, v5, v8
v_lshrrev_b32 v9, 2, v8
v_and_b32 v8, 3, v8
v_lshlrev_b32 v9, 11, v9
v_lshl_add_u32 v9, v7, 6, v9
v_lshl_add_u32 v9, v8, 4, v9
s_lshl_b32 s25, s23, 7
v_add_u32 v9, s25, v9
v_mul_u32_u24 v4, 6144, v4
v_add_u32 v16, v4, v9
v_mul_u32_u24 v3, 384, v2
v_add_u32 v3, 192, v3
v_add_u32 v3, v3, v1
v_mul_u32_u24 v4, 2731, v3
v_lshrrev_b32 v4, 16, v4
v_mul_u32_u24 v5, 24, v4
v_sub_u32 v5, v3, v5
v_bfe_u32 v6, v4, 3, 1
v_bfe_u32 v7, v4, 1, 1
v_lshl_or_b32 v6, v7, 1, v6
v_lshlrev_b32 v6, 1, v6
v_xor_b32 v5, v5, v6
v_lshrrev_b32 v6, 1, v5
v_mul_u32_u24 v7, 43, v6
v_lshrrev_b32 v7, 8, v7
v_mul_u32_u24 v8, 12, v7
v_sub_u32 v8, v5, v8
v_lshrrev_b32 v9, 2, v8
v_and_b32 v8, 3, v8
v_lshlrev_b32 v9, 11, v9
v_lshl_add_u32 v9, v7, 6, v9
v_lshl_add_u32 v9, v8, 4, v9
s_lshl_b32 s25, s23, 7
v_add_u32 v9, s25, v9
v_mul_u32_u24 v4, 6144, v4
v_add_u32 v17, v4, v9
v_mul_u32_u24 v3, 384, v2
v_add_u32 v3, 256, v3
v_add_u32 v3, v3, v1
v_mul_u32_u24 v4, 2731, v3
v_lshrrev_b32 v4, 16, v4
v_mul_u32_u24 v5, 24, v4
v_sub_u32 v5, v3, v5
v_bfe_u32 v6, v4, 3, 1
v_bfe_u32 v7, v4, 1, 1
v_lshl_or_b32 v6, v7, 1, v6
v_lshlrev_b32 v6, 1, v6
v_xor_b32 v5, v5, v6
v_lshrrev_b32 v6, 1, v5
v_mul_u32_u24 v7, 43, v6
v_lshrrev_b32 v7, 8, v7
v_mul_u32_u24 v8, 12, v7
v_sub_u32 v8, v5, v8
v_lshrrev_b32 v9, 2, v8
v_and_b32 v8, 3, v8
v_lshlrev_b32 v9, 11, v9
v_lshl_add_u32 v9, v7, 6, v9
v_lshl_add_u32 v9, v8, 4, v9
s_lshl_b32 s25, s23, 7
v_add_u32 v9, s25, v9
v_mul_u32_u24 v4, 6144, v4
v_add_u32 v18, v4, v9
v_mul_u32_u24 v3, 384, v2
v_add_u32 v3, 320, v3
v_add_u32 v3, v3, v1
v_mul_u32_u24 v4, 2731, v3
v_lshrrev_b32 v4, 16, v4
v_mul_u32_u24 v5, 24, v4
v_sub_u32 v5, v3, v5
v_bfe_u32 v6, v4, 3, 1
v_bfe_u32 v7, v4, 1, 1
v_lshl_or_b32 v6, v7, 1, v6
v_lshlrev_b32 v6, 1, v6
v_xor_b32 v5, v5, v6
v_lshrrev_b32 v6, 1, v5
v_mul_u32_u24 v7, 43, v6
v_lshrrev_b32 v7, 8, v7
v_mul_u32_u24 v8, 12, v7
v_sub_u32 v8, v5, v8
v_lshrrev_b32 v9, 2, v8
v_and_b32 v8, 3, v8
v_lshlrev_b32 v9, 11, v9
v_lshl_add_u32 v9, v7, 6, v9
v_lshl_add_u32 v9, v8, 4, v9
s_lshl_b32 s25, s23, 7
v_add_u32 v9, s25, v9
v_mul_u32_u24 v4, 6144, v4
v_add_u32 v19, v4, v9
v_lshrrev_b32 v3, 1, v2
v_lshlrev_b32 v3, 6, v3
v_and_b32 v4, 15, v1
v_add_u32 v3, v3, v4
v_lshlrev_b32 v3, 7, v3
v_lshrrev_b32 v5, 4, v1
v_and_b32 v6, 7, v1
v_xor_b32 v5, v5, v6
v_lshlrev_b32 v5, 4, v5
v_add_u32 v21, v3, v5
v_xor_b32 v22, 64, v21
v_lshrrev_b32 v3, 4, v1
v_bfe_u32 v4, v1, 2, 2
v_lshl_add_u32 v5, v3, 3, v4
v_mul_u32_u24 v5, 384, v5
v_and_b32 v6, 3, v1
v_lshl_add_u32 v5, v6, 3, v5
v_add_u32 v5, 16384, v5
v_and_b32 v6, 1, v3
v_bfe_u32 v7, v1, 3, 1
v_lshl_or_b32 v6, v7, 1, v6
v_and_b32 v7, 1, v2
v_mul_u32_u24 v7, 6, v7
v_add_u32 v8, 0, v7
v_xor_b32 v8, v8, v6
v_lshl_add_u32 v25, v8, 5, v5
v_add_u32 v8, 1, v7
v_xor_b32 v8, v8, v6
v_lshl_add_u32 v26, v8, 5, v5
v_add_u32 v8, 2, v7
v_xor_b32 v8, v8, v6
v_lshl_add_u32 v27, v8, 5, v5
v_add_u32 v8, 3, v7
v_xor_b32 v8, v8, v6
v_lshl_add_u32 v28, v8, 5, v5
v_add_u32 v8, 4, v7
v_xor_b32 v8, v8, v6
v_lshl_add_u32 v29, v8, 5, v5
v_add_u32 v8, 5, v7
v_xor_b32 v8, v8, v6
v_lshl_add_u32 v30, v8, 5, v5
v_accvgpr_write_b32 a0, 0
v_accvgpr_write_b32 a1, 0
v_accvgpr_write_b32 a2, 0
v_accvgpr_write_b32 a3, 0
v_accvgpr_write_b32 a4, 0
v_accvgpr_write_b32 a5, 0
v_accvgpr_write_b32 a6, 0
v_accvgpr_write_b32 a7, 0
v_accvgpr_write_b32 a8, 0
v_accvgpr_write_b32 a9, 0
v_accvgpr_write_b32 a10, 0
v_accvgpr_write_b32 a11, 0
v_accvgpr_write_b32 a12, 0
v_accvgpr_write_b32 a13, 0
v_accvgpr_write_b32 a14, 0
v_accvgpr_write_b32 a15, 0
v_accvgpr_write_b32 a16, 0
v_accvgpr_write_b32 a17, 0
v_accvgpr_write_b32 a18, 0
v_accvgpr_write_b32 a19, 0
v_accvgpr_write_b32 a20, 0
v_accvgpr_write_b32 a21, 0
v_accvgpr_write_b32 a22, 0
v_accvgpr_write_b32 a23, 0
v_accvgpr_write_b32 a24, 0
v_accvgpr_write_b32 a25, 0
v_accvgpr_write_b32 a26, 0
v_accvgpr_write_b32 a27, 0
v_accvgpr_write_b32 a28, 0
v_accvgpr_write_b32 a29, 0
v_accvgpr_write_b32 a30, 0
v_accvgpr_write_b32 a31, 0
v_accvgpr_write_b32 a32, 0
v_accvgpr_write_b32 a33, 0
v_accvgpr_write_b32 a34, 0
v_accvgpr_write_b32 a35, 0
v_accvgpr_write_b32 a36, 0
v_accvgpr_write_b32 a37, 0
v_accvgpr_write_b32 a38, 0
v_accvgpr_write_b32 a39, 0
v_accvgpr_write_b32 a40, 0
v_accvgpr_write_b32 a41, 0
v_accvgpr_write_b32 a42, 0
v_accvgpr_write_b32 a43, 0
v_accvgpr_write_b32 a44, 0
v_accvgpr_write_b32 a45, 0
v_accvgpr_write_b32 a46, 0
v_accvgpr_write_b32 a47, 0
v_accvgpr_write_b32 a48, 0
v_accvgpr_write_b32 a49, 0
v_accvgpr_write_b32 a50, 0
v_accvgpr_write_b32 a51, 0
v_accvgpr_write_b32 a52, 0
v_accvgpr_write_b32 a53, 0
v_accvgpr_write_b32 a54, 0
v_accvgpr_write_b32 a55, 0
v_accvgpr_write_b32 a56, 0
v_accvgpr_write_b32 a57, 0
v_accvgpr_write_b32 a58, 0
v_accvgpr_write_b32 a59, 0
v_accvgpr_write_b32 a60, 0
v_accvgpr_write_b32 a61, 0
v_accvgpr_write_b32 a62, 0
v_accvgpr_write_b32 a63, 0
v_accvgpr_write_b32 a64, 0
v_accvgpr_write_b32 a65, 0
v_accvgpr_write_b32 a66, 0
v_accvgpr_write_b32 a67, 0
v_accvgpr_write_b32 a68, 0
v_accvgpr_write_b32 a69, 0
v_accvgpr_write_b32 a70, 0
v_accvgpr_write_b32 a71, 0
v_accvgpr_write_b32 a72, 0
v_accvgpr_write_b32 a73, 0
v_accvgpr_write_b32 a74, 0
v_accvgpr_write_b32 a75, 0
v_accvgpr_write_b32 a76, 0
v_accvgpr_write_b32 a77, 0
v_accvgpr_write_b32 a78, 0
v_accvgpr_write_b32 a79, 0
v_accvgpr_write_b32 a80, 0
v_accvgpr_write_b32 a81, 0
v_accvgpr_write_b32 a82, 0
v_accvgpr_write_b32 a83, 0
v_accvgpr_write_b32 a84, 0
v_accvgpr_write_b32 a85, 0
v_accvgpr_write_b32 a86, 0
v_accvgpr_write_b32 a87, 0
v_accvgpr_write_b32 a88, 0
v_accvgpr_write_b32 a89, 0
v_accvgpr_write_b32 a90, 0
v_accvgpr_write_b32 a91, 0
v_accvgpr_write_b32 a92, 0
v_accvgpr_write_b32 a93, 0
v_accvgpr_write_b32 a94, 0
v_accvgpr_write_b32 a95, 0
v_readfirstlane_b32 s27, v2
s_nop 3
s_mul_i32 s28, s27, 6144
s_lshl_b32 s27, s27, 12
s_mov_b32 s16, 0
s_mov_b32 s17, 0
s_add_u32 m0, s27, 0
s_nop 0
buffer_load_dwordx4 v10, s[4:7], s16 offen lds
s_add_u32 m0, s27, 1024
s_nop 0
buffer_load_dwordx4 v11, s[4:7], s16 offen lds
s_add_u32 m0, s27, 2048
s_nop 0
buffer_load_dwordx4 v12, s[4:7], s16 offen lds
s_add_u32 m0, s27, 3072
s_nop 0
buffer_load_dwordx4 v13, s[4:7], s16 offen lds
s_add_u32 m0, s28, 16384
s_nop 0
buffer_load_dwordx4 v14, s[8:11], s17 offen lds
s_add_u32 m0, s28, 17408
s_nop 0
buffer_load_dwordx4 v15, s[8:11], s17 offen lds
s_add_u32 m0, s28, 18432
s_nop 0
buffer_load_dwordx4 v16, s[8:11], s17 offen lds
s_add_u32 m0, s28, 19456
s_nop 0
buffer_load_dwordx4 v17, s[8:11], s17 offen lds
s_add_u32 m0, s28, 20480
s_nop 0
buffer_load_dwordx4 v18, s[8:11], s17 offen lds
s_add_u32 m0, s28, 21504
s_nop 0
buffer_load_dwordx4 v19, s[8:11], s17 offen lds
s_mov_b32 s16, 128
s_mov_b32 s17, 393216
s_add_u32 m0, s27, 40960
s_nop 0
buffer_load_dwordx4 v10, s[4:7], s16 offen lds
s_add_u32 m0, s27, 41984
s_nop 0
buffer_load_dwordx4 v11, s[4:7], s16 offen lds
s_add_u32 m0, s27, 43008
s_nop 0
buffer_load_dwordx4 v12, s[4:7], s16 offen lds
s_add_u32 m0, s27, 44032
s_nop 0
buffer_load_dwordx4 v13, s[4:7], s16 offen lds
s_add_u32 m0, s28, 57344
s_nop 0
buffer_load_dwordx4 v14, s[8:11], s17 offen lds
s_add_u32 m0, s28, 58368
s_nop 0
buffer_load_dwordx4 v15, s[8:11], s17 offen lds
s_add_u32 m0, s28, 59392
s_nop 0
buffer_load_dwordx4 v16, s[8:11], s17 offen lds
s_add_u32 m0, s28, 60416
s_nop 0
buffer_load_dwordx4 v17, s[8:11], s17 offen lds
s_add_u32 m0, s28, 61440
s_nop 0
buffer_load_dwordx4 v18, s[8:11], s17 offen lds
s_add_u32 m0, s28, 62464
s_nop 0
buffer_load_dwordx4 v19, s[8:11], s17 offen lds
s_load_dwordx2 s[12:13], s[0:1], 88
s_waitcnt lgkmcnt(0)
s_add_u32 s12, s12, 52428800
s_addc_u32 s13, s13, 0
s_mov_b32 s14, 524288
s_mov_b32 s15, 0x00020000
s_lshl_b32 s25, s22, 15
v_lshlrev_b32 v3, 7, v0
v_add_u32 v3, s25, v3
buffer_load_dwordx4 v[128:131], v3, s[12:15], 0 offen offset:0
buffer_load_dwordx4 v[132:135], v3, s[12:15], 0 offen offset:16
buffer_load_dwordx4 v[136:139], v3, s[12:15], 0 offen offset:32
buffer_load_dwordx4 v[140:143], v3, s[12:15], 0 offen offset:48
buffer_load_dwordx4 v[144:147], v3, s[12:15], 0 offen offset:64
buffer_load_dwordx4 v[148:151], v3, s[12:15], 0 offen offset:80
buffer_load_dwordx4 v[152:155], v3, s[12:15], 0 offen offset:96
buffer_load_dwordx4 v[156:159], v3, s[12:15], 0 offen offset:112
s_waitcnt vmcnt(0)
v_add_f32 v128, v128, v130
v_add_f32 v129, v129, v131
v_add_f32 v128, v128, v132
v_add_f32 v129, v129, v133
v_add_f32 v128, v128, v134
v_add_f32 v129, v129, v135
v_add_f32 v128, v128, v136
v_add_f32 v129, v129, v137
v_add_f32 v128, v128, v138
v_add_f32 v129, v129, v139
v_add_f32 v128, v128, v140
v_add_f32 v129, v129, v141
v_add_f32 v128, v128, v142
v_add_f32 v129, v129, v143
v_add_f32 v128, v128, v144
v_add_f32 v129, v129, v145
v_add_f32 v128, v128, v146
v_add_f32 v129, v129, v147
v_add_f32 v128, v128, v148
v_add_f32 v129, v129, v149
v_add_f32 v128, v128, v150
v_add_f32 v129, v129, v151
v_add_f32 v128, v128, v152
v_add_f32 v129, v129, v153
v_add_f32 v128, v128, v154
v_add_f32 v129, v129, v155
v_add_f32 v128, v128, v156
v_add_f32 v129, v129, v157
v_add_f32 v128, v128, v158
v_add_f32 v129, v129, v159
s_nop 1
v_add_f32_dpp v128, v128, v128 quad_perm:[1,0,3,2] row_mask:0xf bank_mask:0xf
v_add_f32_dpp v129, v129, v129 quad_perm:[1,0,3,2] row_mask:0xf bank_mask:0xf
v_mul_f32 v128, 0x3a800000, v128
v_mul_f32 v129, 0x3a800000, v129
v_fma_f32 v129, -v128, v128, v129
v_max_f32 v129, 0, v129
v_add_f32 v130, 0x3727c5ac, v129
v_rsq_f32 v130, v130
s_nop 0
v_mov_b32 v129, v130
v_lshrrev_b32 v3, 1, v0
v_lshlrev_b32 v3, 3, v3
v_add_u32 v3, 122880, v3
ds_write_b64 v3, v[128:129]
s_waitcnt vmcnt(10) lgkmcnt(0)
s_barrier
v_add_u32 v23, 0, v21
v_add_u32 v32, 0, v25
v_add_u32 v33, 0, v26
v_add_u32 v34, 0, v27
v_add_u32 v35, 0, v28
v_add_u32 v36, 0, v29
v_add_u32 v37, 0, v30
ds_read_b128 v[40:43], v23 offset:0
ds_read_b128 v[44:47], v23 offset:2048
ds_read_b128 v[48:51], v23 offset:4096
ds_read_b128 v[52:55], v23 offset:6144
ds_read_b64_tr_b16 v[56:57], v32 offset:0
ds_read_b64_tr_b16 v[58:59], v32 offset:1536
ds_read_b64_tr_b16 v[60:61], v33 offset:0
ds_read_b64_tr_b16 v[62:63], v33 offset:1536
ds_read_b64_tr_b16 v[64:65], v34 offset:0
ds_read_b64_tr_b16 v[66:67], v34 offset:1536
ds_read_b64_tr_b16 v[68:69], v35 offset:0
ds_read_b64_tr_b16 v[70:71], v35 offset:1536
ds_read_b64_tr_b16 v[72:73], v36 offset:0
ds_read_b64_tr_b16 v[74:75], v36 offset:1536
ds_read_b64_tr_b16 v[76:77], v37 offset:0
ds_read_b64_tr_b16 v[78:79], v37 offset:1536
s_waitcnt lgkmcnt(0)
v_mfma_f32_16x16x32_bf16 a[0:3], v[56:59], v[40:43], a[0:3]
v_mfma_f32_16x16x32_bf16 a[24:27], v[56:59], v[44:47], a[24:27]
v_add_u32 v23, 0, v22
v_mfma_f32_16x16x32_bf16 a[48:51], v[56:59], v[48:51], a[48:51]
v_add_u32 v32, 0, v25
v_mfma_f32_16x16x32_bf16 a[72:75], v[56:59], v[52:55], a[72:75]
v_add_u32 v33, 0, v26
v_mfma_f32_16x16x32_bf16 a[4:7], v[60:63], v[40:43], a[4:7]
v_add_u32 v34, 0, v27
v_mfma_f32_16x16x32_bf16 a[28:31], v[60:63], v[44:47], a[28:31]
v_add_u32 v35, 0, v28
v_mfma_f32_16x16x32_bf16 a[52:55], v[60:63], v[48:51], a[52:55]
v_add_u32 v36, 0, v29
v_mfma_f32_16x16x32_bf16 a[76:79], v[60:63], v[52:55], a[76:79]
v_add_u32 v37, 0, v30
v_mfma_f32_16x16x32_bf16 a[8:11], v[64:67], v[40:43], a[8:11]
ds_read_b128 v[84:87], v23 offset:0
v_mfma_f32_16x16x32_bf16 a[32:35], v[64:67], v[44:47], a[32:35]
ds_read_b128 v[88:91], v23 offset:2048
v_mfma_f32_16x16x32_bf16 a[56:59], v[64:67], v[48:51], a[56:59]
ds_read_b128 v[92:95], v23 offset:4096
v_mfma_f32_16x16x32_bf16 a[80:83], v[64:67], v[52:55], a[80:83]
ds_read_b128 v[96:99], v23 offset:6144
v_mfma_f32_16x16x32_bf16 a[12:15], v[68:71], v[40:43], a[12:15]
ds_read_b64_tr_b16 v[100:101], v32 offset:12288
v_mfma_f32_16x16x32_bf16 a[36:39], v[68:71], v[44:47], a[36:39]
ds_read_b64_tr_b16 v[102:103], v32 offset:13824
v_mfma_f32_16x16x32_bf16 a[60:63], v[68:71], v[48:51], a[60:63]
ds_read_b64_tr_b16 v[104:105], v33 offset:12288
v_mfma_f32_16x16x32_bf16 a[84:87], v[68:71], v[52:55], a[84:87]
ds_read_b64_tr_b16 v[106:107], v33 offset:13824
v_mfma_f32_16x16x32_bf16 a[16:19], v[40:43], v[72:75], a[16:19]
ds_read_b64_tr_b16 v[108:109], v34 offset:12288
v_mfma_f32_16x16x32_bf16 a[40:43], v[44:47], v[72:75], a[40:43]
ds_read_b64_tr_b16 v[110:111], v34 offset:13824
v_mfma_f32_16x16x32_bf16 a[64:67], v[48:51], v[72:75], a[64:67]
ds_read_b64_tr_b16 v[112:113], v35 offset:12288
v_mfma_f32_16x16x32_bf16 a[88:91], v[52:55], v[72:75], a[88:91]
ds_read_b64_tr_b16 v[114:115], v35 offset:13824
v_mfma_f32_16x16x32_bf16 a[20:23], v[40:43], v[76:79], a[20:23]
ds_read_b64_tr_b16 v[116:117], v36 offset:12288
v_mfma_f32_16x16x32_bf16 a[44:47], v[44:47], v[76:79], a[44:47]
ds_read_b64_tr_b16 v[118:119], v36 offset:13824
v_mfma_f32_16x16x32_bf16 a[68:71], v[48:51], v[76:79], a[68:71]
ds_read_b64_tr_b16 v[120:121], v37 offset:12288
v_mfma_f32_16x16x32_bf16 a[92:95], v[52:55], v[76:79], a[92:95]
ds_read_b64_tr_b16 v[122:123], v37 offset:13824
s_waitcnt vmcnt(0)
s_barrier
s_waitcnt lgkmcnt(0)
v_mfma_f32_16x16x32_bf16 a[0:3], v[100:103], v[84:87], a[0:3]
s_mov_b32 s16, 256
s_mov_b32 s17, 786432
v_mfma_f32_16x16x32_bf16 a[24:27], v[100:103], v[88:91], a[24:27]
s_add_u32 m0, s27, 81920
s_nop 0
v_mfma_f32_16x16x32_bf16 a[48:51], v[100:103], v[92:95], a[48:51]
buffer_load_dwordx4 v10, s[4:7], s16 offen lds
s_add_u32 m0, s27, 82944
v_mfma_f32_16x16x32_bf16 a[72:75], v[100:103], v[96:99], a[72:75]
s_nop 0
buffer_load_dwordx4 v11, s[4:7], s16 offen lds
s_add_u32 m0, s27, 83968
v_mfma_f32_16x16x32_bf16 a[4:7], v[104:107], v[84:87], a[4:7]
s_nop 0
buffer_load_dwordx4 v12, s[4:7], s16 offen lds
v_mfma_f32_16x16x32_bf16 a[28:31], v[104:107], v[88:91], a[28:31]
s_add_u32 m0, s27, 84992
s_nop 0
v_mfma_f32_16x16x32_bf16 a[52:55], v[104:107], v[92:95], a[52:55]
buffer_load_dwordx4 v13, s[4:7], s16 offen lds
s_add_u32 m0, s28, 98304
s_nop 0
v_mfma_f32_16x16x32_bf16 a[76:79], v[104:107], v[96:99], a[76:79]
buffer_load_dwordx4 v14, s[8:11], s17 offen lds
s_add_u32 m0, s28, 99328
v_mfma_f32_16x16x32_bf16 a[8:11], v[108:111], v[84:87], a[8:11]
s_nop 0
buffer_load_dwordx4 v15, s[8:11], s17 offen lds
v_mfma_f32_16x16x32_bf16 a[32:35], v[108:111], v[88:91], a[32:35]
s_add_u32 m0, s28, 100352
s_nop 0
v_mfma_f32_16x16x32_bf16 a[56:59], v[108:111], v[92:95], a[56:59]
buffer_load_dwordx4 v16, s[8:11], s17 offen lds
s_add_u32 m0, s28, 101376
s_nop 0
v_mfma_f32_16x16x32_bf16 a[80:83], v[108:111], v[96:99], a[80:83]
buffer_load_dwordx4 v17, s[8:11], s17 offen lds
s_add_u32 m0, s28, 102400
v_mfma_f32_16x16x32_bf16 a[12:15], v[112:115], v[84:87], a[12:15]
s_nop 0
buffer_load_dwordx4 v18, s[8:11], s17 offen lds
v_mfma_f32_16x16x32_bf16 a[36:39], v[112:115], v[88:91], a[36:39]
s_add_u32 m0, s28, 103424
s_nop 0
buffer_load_dwordx4 v19, s[8:11], s17 offen lds
v_mfma_f32_16x16x32_bf16 a[60:63], v[112:115], v[92:95], a[60:63]
v_add_u32 v23, 40960, v21
v_add_u32 v32, 40960, v25
v_mfma_f32_16x16x32_bf16 a[84:87], v[112:115], v[96:99], a[84:87]
v_add_u32 v33, 40960, v26
v_add_u32 v34, 40960, v27
v_mfma_f32_16x16x32_bf16 a[16:19], v[84:87], v[116:119], a[16:19]
v_add_u32 v35, 40960, v28
v_add_u32 v36, 40960, v29
v_mfma_f32_16x16x32_bf16 a[40:43], v[88:91], v[116:119], a[40:43]
v_add_u32 v37, 40960, v30
ds_read_b128 v[40:43], v23 offset:0
ds_read_b128 v[44:47], v23 offset:2048
v_mfma_f32_16x16x32_bf16 a[64:67], v[92:95], v[116:119], a[64:67]
ds_read_b128 v[48:51], v23 offset:4096
ds_read_b128 v[52:55], v23 offset:6144
v_mfma_f32_16x16x32_bf16 a[88:91], v[96:99], v[116:119], a[88:91]
ds_read_b64_tr_b16 v[56:57], v32 offset:0
ds_read_b64_tr_b16 v[58:59], v32 offset:1536
v_mfma_f32_16x16x32_bf16 a[20:23], v[84:87], v[120:123], a[20:23]
ds_read_b64_tr_b16 v[60:61], v33 offset:0
ds_read_b64_tr_b16 v[62:63], v33 offset:1536
ds_read_b64_tr_b16 v[64:65], v34 offset:0
v_mfma_f32_16x16x32_bf16 a[44:47], v[88:91], v[120:123], a[44:47]
ds_read_b64_tr_b16 v[66:67], v34 offset:1536
ds_read_b64_tr_b16 v[68:69], v35 offset:0
v_mfma_f32_16x16x32_bf16 a[68:71], v[92:95], v[120:123], a[68:71]
ds_read_b64_tr_b16 v[70:71], v35 offset:1536
ds_read_b64_tr_b16 v[72:73], v36 offset:0
v_mfma_f32_16x16x32_bf16 a[92:95], v[96:99], v[120:123], a[92:95]
ds_read_b64_tr_b16 v[74:75], v36 offset:1536
ds_read_b64_tr_b16 v[76:77], v37 offset:0
ds_read_b64_tr_b16 v[78:79], v37 offset:1536
s_waitcnt lgkmcnt(0)
v_mfma_f32_16x16x32_bf16 a[0:3], v[56:59], v[40:43], a[0:3]
v_mfma_f32_16x16x32_bf16 a[24:27], v[56:59], v[44:47], a[24:27]
v_add_u32 v23, 40960, v22
v_mfma_f32_16x16x32_bf16 a[48:51], v[56:59], v[48:51], a[48:51]
v_add_u32 v32, 40960, v25
v_mfma_f32_16x16x32_bf16 a[72:75], v[56:59], v[52:55], a[72:75]
v_add_u32 v33, 40960, v26
v_mfma_f32_16x16x32_bf16 a[4:7], v[60:63], v[40:43], a[4:7]
v_add_u32 v34, 40960, v27
v_mfma_f32_16x16x32_bf16 a[28:31], v[60:63], v[44:47], a[28:31]
v_add_u32 v35, 40960, v28
v_mfma_f32_16x16x32_bf16 a[52:55], v[60:63], v[48:51], a[52:55]
v_add_u32 v36, 40960, v29
v_mfma_f32_16x16x32_bf16 a[76:79], v[60:63], v[52:55], a[76:79]
v_add_u32 v37, 40960, v30
v_mfma_f32_16x16x32_bf16 a[8:11], v[64:67], v[40:43], a[8:11]
ds_read_b128 v[84:87], v23 offset:0
v_mfma_f32_16x16x32_bf16 a[32:35], v[64:67], v[44:47], a[32:35]
ds_read_b128 v[88:91], v23 offset:2048
v_mfma_f32_16x16x32_bf16 a[56:59], v[64:67], v[48:51], a[56:59]
ds_read_b128 v[92:95], v23 offset:4096
v_mfma_f32_16x16x32_bf16 a[80:83], v[64:67], v[52:55], a[80:83]
ds_read_b128 v[96:99], v23 offset:6144
v_mfma_f32_16x16x32_bf16 a[12:15], v[68:71], v[40:43], a[12:15]
ds_read_b64_tr_b16 v[100:101], v32 offset:12288
v_mfma_f32_16x16x32_bf16 a[36:39], v[68:71], v[44:47], a[36:39]
ds_read_b64_tr_b16 v[102:103], v32 offset:13824
v_mfma_f32_16x16x32_bf16 a[60:63], v[68:71], v[48:51], a[60:63]
ds_read_b64_tr_b16 v[104:105], v33 offset:12288
v_mfma_f32_16x16x32_bf16 a[84:87], v[68:71], v[52:55], a[84:87]
ds_read_b64_tr_b16 v[106:107], v33 offset:13824
v_mfma_f32_16x16x32_bf16 a[16:19], v[40:43], v[72:75], a[16:19]
ds_read_b64_tr_b16 v[108:109], v34 offset:12288
v_mfma_f32_16x16x32_bf16 a[40:43], v[44:47], v[72:75], a[40:43]
ds_read_b64_tr_b16 v[110:111], v34 offset:13824
v_mfma_f32_16x16x32_bf16 a[64:67], v[48:51], v[72:75], a[64:67]
ds_read_b64_tr_b16 v[112:113], v35 offset:12288
v_mfma_f32_16x16x32_bf16 a[88:91], v[52:55], v[72:75], a[88:91]
ds_read_b64_tr_b16 v[114:115], v35 offset:13824
v_mfma_f32_16x16x32_bf16 a[20:23], v[40:43], v[76:79], a[20:23]
ds_read_b64_tr_b16 v[116:117], v36 offset:12288
v_mfma_f32_16x16x32_bf16 a[44:47], v[44:47], v[76:79], a[44:47]
ds_read_b64_tr_b16 v[118:119], v36 offset:13824
v_mfma_f32_16x16x32_bf16 a[68:71], v[48:51], v[76:79], a[68:71]
ds_read_b64_tr_b16 v[120:121], v37 offset:12288
v_mfma_f32_16x16x32_bf16 a[92:95], v[52:55], v[76:79], a[92:95]
ds_read_b64_tr_b16 v[122:123], v37 offset:13824
s_waitcnt vmcnt(0)
s_barrier
s_waitcnt lgkmcnt(0)
v_mfma_f32_16x16x32_bf16 a[0:3], v[100:103], v[84:87], a[0:3]
s_mov_b32 s16, 384
s_mov_b32 s17, 1179648
v_mfma_f32_16x16x32_bf16 a[24:27], v[100:103], v[88:91], a[24:27]
s_add_u32 m0, s27, 0
s_nop 0
v_mfma_f32_16x16x32_bf16 a[48:51], v[100:103], v[92:95], a[48:51]
buffer_load_dwordx4 v10, s[4:7], s16 offen lds
s_add_u32 m0, s27, 1024
v_mfma_f32_16x16x32_bf16 a[72:75], v[100:103], v[96:99], a[72:75]
s_nop 0
buffer_load_dwordx4 v11, s[4:7], s16 offen lds
s_add_u32 m0, s27, 2048
v_mfma_f32_16x16x32_bf16 a[4:7], v[104:107], v[84:87], a[4:7]
s_nop 0
buffer_load_dwordx4 v12, s[4:7], s16 offen lds
v_mfma_f32_16x16x32_bf16 a[28:31], v[104:107], v[88:91], a[28:31]
s_add_u32 m0, s27, 3072
s_nop 0
v_mfma_f32_16x16x32_bf16 a[52:55], v[104:107], v[92:95], a[52:55]
buffer_load_dwordx4 v13, s[4:7], s16 offen lds
s_add_u32 m0, s28, 16384
s_nop 0
v_mfma_f32_16x16x32_bf16 a[76:79], v[104:107], v[96:99], a[76:79]
buffer_load_dwordx4 v14, s[8:11], s17 offen lds
s_add_u32 m0, s28, 17408
v_mfma_f32_16x16x32_bf16 a[8:11], v[108:111], v[84:87], a[8:11]
s_nop 0
buffer_load_dwordx4 v15, s[8:11], s17 offen lds
v_mfma_f32_16x16x32_bf16 a[32:35], v[108:111], v[88:91], a[32:35]
s_add_u32 m0, s28, 18432
s_nop 0
v_mfma_f32_16x16x32_bf16 a[56:59], v[108:111], v[92:95], a[56:59]
buffer_load_dwordx4 v16, s[8:11], s17 offen lds
s_add_u32 m0, s28, 19456
s_nop 0
v_mfma_f32_16x16x32_bf16 a[80:83], v[108:111], v[96:99], a[80:83]
buffer_load_dwordx4 v17, s[8:11], s17 offen lds
s_add_u32 m0, s28, 20480
v_mfma_f32_16x16x32_bf16 a[12:15], v[112:115], v[84:87], a[12:15]
s_nop 0
buffer_load_dwordx4 v18, s[8:11], s17 offen lds
v_mfma_f32_16x16x32_bf16 a[36:39], v[112:115], v[88:91], a[36:39]
s_add_u32 m0, s28, 21504
s_nop 0
buffer_load_dwordx4 v19, s[8:11], s17 offen lds
v_mfma_f32_16x16x32_bf16 a[60:63], v[112:115], v[92:95], a[60:63]
v_add_u32 v23, 81920, v21
v_add_u32 v32, 81920, v25
v_mfma_f32_16x16x32_bf16 a[84:87], v[112:115], v[96:99], a[84:87]
v_add_u32 v33, 81920, v26
v_add_u32 v34, 81920, v27
v_mfma_f32_16x16x32_bf16 a[16:19], v[84:87], v[116:119], a[16:19]
v_add_u32 v35, 81920, v28
v_add_u32 v36, 81920, v29
v_mfma_f32_16x16x32_bf16 a[40:43], v[88:91], v[116:119], a[40:43]
v_add_u32 v37, 81920, v30
ds_read_b128 v[40:43], v23 offset:0
ds_read_b128 v[44:47], v23 offset:2048
v_mfma_f32_16x16x32_bf16 a[64:67], v[92:95], v[116:119], a[64:67]
ds_read_b128 v[48:51], v23 offset:4096
ds_read_b128 v[52:55], v23 offset:6144
v_mfma_f32_16x16x32_bf16 a[88:91], v[96:99], v[116:119], a[88:91]
ds_read_b64_tr_b16 v[56:57], v32 offset:0
ds_read_b64_tr_b16 v[58:59], v32 offset:1536
v_mfma_f32_16x16x32_bf16 a[20:23], v[84:87], v[120:123], a[20:23]
ds_read_b64_tr_b16 v[60:61], v33 offset:0
ds_read_b64_tr_b16 v[62:63], v33 offset:1536
ds_read_b64_tr_b16 v[64:65], v34 offset:0
v_mfma_f32_16x16x32_bf16 a[44:47], v[88:91], v[120:123], a[44:47]
ds_read_b64_tr_b16 v[66:67], v34 offset:1536
ds_read_b64_tr_b16 v[68:69], v35 offset:0
v_mfma_f32_16x16x32_bf16 a[68:71], v[92:95], v[120:123], a[68:71]
ds_read_b64_tr_b16 v[70:71], v35 offset:1536
ds_read_b64_tr_b16 v[72:73], v36 offset:0
v_mfma_f32_16x16x32_bf16 a[92:95], v[96:99], v[120:123], a[92:95]
ds_read_b64_tr_b16 v[74:75], v36 offset:1536
ds_read_b64_tr_b16 v[76:77], v37 offset:0
ds_read_b64_tr_b16 v[78:79], v37 offset:1536
s_waitcnt lgkmcnt(0)
v_mfma_f32_16x16x32_bf16 a[0:3], v[56:59], v[40:43], a[0:3]
v_mfma_f32_16x16x32_bf16 a[24:27], v[56:59], v[44:47], a[24:27]
v_add_u32 v23, 81920, v22
v_mfma_f32_16x16x32_bf16 a[48:51], v[56:59], v[48:51], a[48:51]
v_add_u32 v32, 81920, v25
v_mfma_f32_16x16x32_bf16 a[72:75], v[56:59], v[52:55], a[72:75]
v_add_u32 v33, 81920, v26
v_mfma_f32_16x16x32_bf16 a[4:7], v[60:63], v[40:43], a[4:7]
v_add_u32 v34, 81920, v27
v_mfma_f32_16x16x32_bf16 a[28:31], v[60:63], v[44:47], a[28:31]
v_add_u32 v35, 81920, v28
v_mfma_f32_16x16x32_bf16 a[52:55], v[60:63], v[48:51], a[52:55]
v_add_u32 v36, 81920, v29
v_mfma_f32_16x16x32_bf16 a[76:79], v[60:63], v[52:55], a[76:79]
v_add_u32 v37, 81920, v30
v_mfma_f32_16x16x32_bf16 a[8:11], v[64:67], v[40:43], a[8:11]
ds_read_b128 v[84:87], v23 offset:0
v_mfma_f32_16x16x32_bf16 a[32:35], v[64:67], v[44:47], a[32:35]
ds_read_b128 v[88:91], v23 offset:2048
v_mfma_f32_16x16x32_bf16 a[56:59], v[64:67], v[48:51], a[56:59]
ds_read_b128 v[92:95], v23 offset:4096
v_mfma_f32_16x16x32_bf16 a[80:83], v[64:67], v[52:55], a[80:83]
ds_read_b128 v[96:99], v23 offset:6144
v_mfma_f32_16x16x32_bf16 a[12:15], v[68:71], v[40:43], a[12:15]
ds_read_b64_tr_b16 v[100:101], v32 offset:12288
v_mfma_f32_16x16x32_bf16 a[36:39], v[68:71], v[44:47], a[36:39]
ds_read_b64_tr_b16 v[102:103], v32 offset:13824
v_mfma_f32_16x16x32_bf16 a[60:63], v[68:71], v[48:51], a[60:63]
ds_read_b64_tr_b16 v[104:105], v33 offset:12288
v_mfma_f32_16x16x32_bf16 a[84:87], v[68:71], v[52:55], a[84:87]
ds_read_b64_tr_b16 v[106:107], v33 offset:13824
v_mfma_f32_16x16x32_bf16 a[16:19], v[40:43], v[72:75], a[16:19]
ds_read_b64_tr_b16 v[108:109], v34 offset:12288
v_mfma_f32_16x16x32_bf16 a[40:43], v[44:47], v[72:75], a[40:43]
ds_read_b64_tr_b16 v[110:111], v34 offset:13824
v_mfma_f32_16x16x32_bf16 a[64:67], v[48:51], v[72:75], a[64:67]
ds_read_b64_tr_b16 v[112:113], v35 offset:12288
v_mfma_f32_16x16x32_bf16 a[88:91], v[52:55], v[72:75], a[88:91]
ds_read_b64_tr_b16 v[114:115], v35 offset:13824
v_mfma_f32_16x16x32_bf16 a[20:23], v[40:43], v[76:79], a[20:23]
ds_read_b64_tr_b16 v[116:117], v36 offset:12288
v_mfma_f32_16x16x32_bf16 a[44:47], v[44:47], v[76:79], a[44:47]
ds_read_b64_tr_b16 v[118:119], v36 offset:13824
v_mfma_f32_16x16x32_bf16 a[68:71], v[48:51], v[76:79], a[68:71]
ds_read_b64_tr_b16 v[120:121], v37 offset:12288
v_mfma_f32_16x16x32_bf16 a[92:95], v[52:55], v[76:79], a[92:95]
ds_read_b64_tr_b16 v[122:123], v37 offset:13824
s_waitcnt vmcnt(0)
s_barrier
s_waitcnt lgkmcnt(0)
v_mfma_f32_16x16x32_bf16 a[0:3], v[100:103], v[84:87], a[0:3]
s_mov_b32 s16, 512
s_mov_b32 s17, 1572864
v_mfma_f32_16x16x32_bf16 a[24:27], v[100:103], v[88:91], a[24:27]
s_add_u32 m0, s27, 40960
s_nop 0
v_mfma_f32_16x16x32_bf16 a[48:51], v[100:103], v[92:95], a[48:51]
buffer_load_dwordx4 v10, s[4:7], s16 offen lds
s_add_u32 m0, s27, 41984
v_mfma_f32_16x16x32_bf16 a[72:75], v[100:103], v[96:99], a[72:75]
s_nop 0
buffer_load_dwordx4 v11, s[4:7], s16 offen lds
s_add_u32 m0, s27, 43008
v_mfma_f32_16x16x32_bf16 a[4:7], v[104:107], v[84:87], a[4:7]
s_nop 0
buffer_load_dwordx4 v12, s[4:7], s16 offen lds
v_mfma_f32_16x16x32_bf16 a[28:31], v[104:107], v[88:91], a[28:31]
s_add_u32 m0, s27, 44032
s_nop 0
v_mfma_f32_16x16x32_bf16 a[52:55], v[104:107], v[92:95], a[52:55]
buffer_load_dwordx4 v13, s[4:7], s16 offen lds
s_add_u32 m0, s28, 57344
s_nop 0
v_mfma_f32_16x16x32_bf16 a[76:79], v[104:107], v[96:99], a[76:79]
buffer_load_dwordx4 v14, s[8:11], s17 offen lds
s_add_u32 m0, s28, 58368
v_mfma_f32_16x16x32_bf16 a[8:11], v[108:111], v[84:87], a[8:11]
s_nop 0
buffer_load_dwordx4 v15, s[8:11], s17 offen lds
v_mfma_f32_16x16x32_bf16 a[32:35], v[108:111], v[88:91], a[32:35]
s_add_u32 m0, s28, 59392
s_nop 0
v_mfma_f32_16x16x32_bf16 a[56:59], v[108:111], v[92:95], a[56:59]
buffer_load_dwordx4 v16, s[8:11], s17 offen lds
s_add_u32 m0, s28, 60416
s_nop 0
v_mfma_f32_16x16x32_bf16 a[80:83], v[108:111], v[96:99], a[80:83]
buffer_load_dwordx4 v17, s[8:11], s17 offen lds
s_add_u32 m0, s28, 61440
v_mfma_f32_16x16x32_bf16 a[12:15], v[112:115], v[84:87], a[12:15]
s_nop 0
buffer_load_dwordx4 v18, s[8:11], s17 offen lds
v_mfma_f32_16x16x32_bf16 a[36:39], v[112:115], v[88:91], a[36:39]
s_add_u32 m0, s28, 62464
s_nop 0
buffer_load_dwordx4 v19, s[8:11], s17 offen lds
v_mfma_f32_16x16x32_bf16 a[60:63], v[112:115], v[92:95], a[60:63]
v_add_u32 v23, 0, v21
v_add_u32 v32, 0, v25
v_mfma_f32_16x16x32_bf16 a[84:87], v[112:115], v[96:99], a[84:87]
v_add_u32 v33, 0, v26
v_add_u32 v34, 0, v27
v_mfma_f32_16x16x32_bf16 a[16:19], v[84:87], v[116:119], a[16:19]
v_add_u32 v35, 0, v28
v_add_u32 v36, 0, v29
v_mfma_f32_16x16x32_bf16 a[40:43], v[88:91], v[116:119], a[40:43]
v_add_u32 v37, 0, v30
ds_read_b128 v[40:43], v23 offset:0
ds_read_b128 v[44:47], v23 offset:2048
v_mfma_f32_16x16x32_bf16 a[64:67], v[92:95], v[116:119], a[64:67]
ds_read_b128 v[48:51], v23 offset:4096
ds_read_b128 v[52:55], v23 offset:6144
v_mfma_f32_16x16x32_bf16 a[88:91], v[96:99], v[116:119], a[88:91]
ds_read_b64_tr_b16 v[56:57], v32 offset:0
ds_read_b64_tr_b16 v[58:59], v32 offset:1536
v_mfma_f32_16x16x32_bf16 a[20:23], v[84:87], v[120:123], a[20:23]
ds_read_b64_tr_b16 v[60:61], v33 offset:0
ds_read_b64_tr_b16 v[62:63], v33 offset:1536
ds_read_b64_tr_b16 v[64:65], v34 offset:0
v_mfma_f32_16x16x32_bf16 a[44:47], v[88:91], v[120:123], a[44:47]
ds_read_b64_tr_b16 v[66:67], v34 offset:1536
ds_read_b64_tr_b16 v[68:69], v35 offset:0
v_mfma_f32_16x16x32_bf16 a[68:71], v[92:95], v[120:123], a[68:71]
ds_read_b64_tr_b16 v[70:71], v35 offset:1536
ds_read_b64_tr_b16 v[72:73], v36 offset:0
v_mfma_f32_16x16x32_bf16 a[92:95], v[96:99], v[120:123], a[92:95]
ds_read_b64_tr_b16 v[74:75], v36 offset:1536
ds_read_b64_tr_b16 v[76:77], v37 offset:0
ds_read_b64_tr_b16 v[78:79], v37 offset:1536
s_waitcnt lgkmcnt(0)
v_mfma_f32_16x16x32_bf16 a[0:3], v[56:59], v[40:43], a[0:3]
v_mfma_f32_16x16x32_bf16 a[24:27], v[56:59], v[44:47], a[24:27]
v_add_u32 v23, 0, v22
v_mfma_f32_16x16x32_bf16 a[48:51], v[56:59], v[48:51], a[48:51]
v_add_u32 v32, 0, v25
v_mfma_f32_16x16x32_bf16 a[72:75], v[56:59], v[52:55], a[72:75]
v_add_u32 v33, 0, v26
v_mfma_f32_16x16x32_bf16 a[4:7], v[60:63], v[40:43], a[4:7]
v_add_u32 v34, 0, v27
v_mfma_f32_16x16x32_bf16 a[28:31], v[60:63], v[44:47], a[28:31]
v_add_u32 v35, 0, v28
v_mfma_f32_16x16x32_bf16 a[52:55], v[60:63], v[48:51], a[52:55]
v_add_u32 v36, 0, v29
v_mfma_f32_16x16x32_bf16 a[76:79], v[60:63], v[52:55], a[76:79]
v_add_u32 v37, 0, v30
v_mfma_f32_16x16x32_bf16 a[8:11], v[64:67], v[40:43], a[8:11]
ds_read_b128 v[84:87], v23 offset:0
v_mfma_f32_16x16x32_bf16 a[32:35], v[64:67], v[44:47], a[32:35]
ds_read_b128 v[88:91], v23 offset:2048
v_mfma_f32_16x16x32_bf16 a[56:59], v[64:67], v[48:51], a[56:59]
ds_read_b128 v[92:95], v23 offset:4096
v_mfma_f32_16x16x32_bf16 a[80:83], v[64:67], v[52:55], a[80:83]
ds_read_b128 v[96:99], v23 offset:6144
v_mfma_f32_16x16x32_bf16 a[12:15], v[68:71], v[40:43], a[12:15]
ds_read_b64_tr_b16 v[100:101], v32 offset:12288
v_mfma_f32_16x16x32_bf16 a[36:39], v[68:71], v[44:47], a[36:39]
ds_read_b64_tr_b16 v[102:103], v32 offset:13824
v_mfma_f32_16x16x32_bf16 a[60:63], v[68:71], v[48:51], a[60:63]
ds_read_b64_tr_b16 v[104:105], v33 offset:12288
v_mfma_f32_16x16x32_bf16 a[84:87], v[68:71], v[52:55], a[84:87]
ds_read_b64_tr_b16 v[106:107], v33 offset:13824
v_mfma_f32_16x16x32_bf16 a[16:19], v[40:43], v[72:75], a[16:19]
ds_read_b64_tr_b16 v[108:109], v34 offset:12288
v_mfma_f32_16x16x32_bf16 a[40:43], v[44:47], v[72:75], a[40:43]
ds_read_b64_tr_b16 v[110:111], v34 offset:13824
v_mfma_f32_16x16x32_bf16 a[64:67], v[48:51], v[72:75], a[64:67]
ds_read_b64_tr_b16 v[112:113], v35 offset:12288
v_mfma_f32_16x16x32_bf16 a[88:91], v[52:55], v[72:75], a[88:91]
ds_read_b64_tr_b16 v[114:115], v35 offset:13824
v_mfma_f32_16x16x32_bf16 a[20:23], v[40:43], v[76:79], a[20:23]
ds_read_b64_tr_b16 v[116:117], v36 offset:12288
v_mfma_f32_16x16x32_bf16 a[44:47], v[44:47], v[76:79], a[44:47]
ds_read_b64_tr_b16 v[118:119], v36 offset:13824
v_mfma_f32_16x16x32_bf16 a[68:71], v[48:51], v[76:79], a[68:71]
ds_read_b64_tr_b16 v[120:121], v37 offset:12288
v_mfma_f32_16x16x32_bf16 a[92:95], v[52:55], v[76:79], a[92:95]
ds_read_b64_tr_b16 v[122:123], v37 offset:13824
s_waitcnt vmcnt(0)
s_barrier
s_waitcnt lgkmcnt(0)
v_mfma_f32_16x16x32_bf16 a[0:3], v[100:103], v[84:87], a[0:3]
s_mov_b32 s16, 640
s_mov_b32 s17, 1966080
v_mfma_f32_16x16x32_bf16 a[24:27], v[100:103], v[88:91], a[24:27]
s_add_u32 m0, s27, 81920
s_nop 0
v_mfma_f32_16x16x32_bf16 a[48:51], v[100:103], v[92:95], a[48:51]
buffer_load_dwordx4 v10, s[4:7], s16 offen lds
s_add_u32 m0, s27, 82944
v_mfma_f32_16x16x32_bf16 a[72:75], v[100:103], v[96:99], a[72:75]
s_nop 0
buffer_load_dwordx4 v11, s[4:7], s16 offen lds
s_add_u32 m0, s27, 83968
v_mfma_f32_16x16x32_bf16 a[4:7], v[104:107], v[84:87], a[4:7]
s_nop 0
buffer_load_dwordx4 v12, s[4:7], s16 offen lds
v_mfma_f32_16x16x32_bf16 a[28:31], v[104:107], v[88:91], a[28:31]
s_add_u32 m0, s27, 84992
s_nop 0
v_mfma_f32_16x16x32_bf16 a[52:55], v[104:107], v[92:95], a[52:55]
buffer_load_dwordx4 v13, s[4:7], s16 offen lds
s_add_u32 m0, s28, 98304
s_nop 0
v_mfma_f32_16x16x32_bf16 a[76:79], v[104:107], v[96:99], a[76:79]
buffer_load_dwordx4 v14, s[8:11], s17 offen lds
s_add_u32 m0, s28, 99328
v_mfma_f32_16x16x32_bf16 a[8:11], v[108:111], v[84:87], a[8:11]
s_nop 0
buffer_load_dwordx4 v15, s[8:11], s17 offen lds
v_mfma_f32_16x16x32_bf16 a[32:35], v[108:111], v[88:91], a[32:35]
s_add_u32 m0, s28, 100352
s_nop 0
v_mfma_f32_16x16x32_bf16 a[56:59], v[108:111], v[92:95], a[56:59]
buffer_load_dwordx4 v16, s[8:11], s17 offen lds
s_add_u32 m0, s28, 101376
s_nop 0
v_mfma_f32_16x16x32_bf16 a[80:83], v[108:111], v[96:99], a[80:83]
buffer_load_dwordx4 v17, s[8:11], s17 offen lds
s_add_u32 m0, s28, 102400
v_mfma_f32_16x16x32_bf16 a[12:15], v[112:115], v[84:87], a[12:15]
s_nop 0
buffer_load_dwordx4 v18, s[8:11], s17 offen lds
v_mfma_f32_16x16x32_bf16 a[36:39], v[112:115], v[88:91], a[36:39]
s_add_u32 m0, s28, 103424
s_nop 0
buffer_load_dwordx4 v19, s[8:11], s17 offen lds
v_mfma_f32_16x16x32_bf16 a[60:63], v[112:115], v[92:95], a[60:63]
v_add_u32 v23, 40960, v21
v_add_u32 v32, 40960, v25
v_mfma_f32_16x16x32_bf16 a[84:87], v[112:115], v[96:99], a[84:87]
v_add_u32 v33, 40960, v26
v_add_u32 v34, 40960, v27
v_mfma_f32_16x16x32_bf16 a[16:19], v[84:87], v[116:119], a[16:19]
v_add_u32 v35, 40960, v28
v_add_u32 v36, 40960, v29
v_mfma_f32_16x16x32_bf16 a[40:43], v[88:91], v[116:119], a[40:43]
v_add_u32 v37, 40960, v30
ds_read_b128 v[40:43], v23 offset:0
ds_read_b128 v[44:47], v23 offset:2048
v_mfma_f32_16x16x32_bf16 a[64:67], v[92:95], v[116:119], a[64:67]
ds_read_b128 v[48:51], v23 offset:4096
ds_read_b128 v[52:55], v23 offset:6144
v_mfma_f32_16x16x32_bf16 a[88:91], v[96:99], v[116:119], a[88:91]
ds_read_b64_tr_b16 v[56:57], v32 offset:0
ds_read_b64_tr_b16 v[58:59], v32 offset:1536
v_mfma_f32_16x16x32_bf16 a[20:23], v[84:87], v[120:123], a[20:23]
ds_read_b64_tr_b16 v[60:61], v33 offset:0
ds_read_b64_tr_b16 v[62:63], v33 offset:1536
ds_read_b64_tr_b16 v[64:65], v34 offset:0
v_mfma_f32_16x16x32_bf16 a[44:47], v[88:91], v[120:123], a[44:47]
ds_read_b64_tr_b16 v[66:67], v34 offset:1536
ds_read_b64_tr_b16 v[68:69], v35 offset:0
v_mfma_f32_16x16x32_bf16 a[68:71], v[92:95], v[120:123], a[68:71]
ds_read_b64_tr_b16 v[70:71], v35 offset:1536
ds_read_b64_tr_b16 v[72:73], v36 offset:0
v_mfma_f32_16x16x32_bf16 a[92:95], v[96:99], v[120:123], a[92:95]
ds_read_b64_tr_b16 v[74:75], v36 offset:1536
ds_read_b64_tr_b16 v[76:77], v37 offset:0
ds_read_b64_tr_b16 v[78:79], v37 offset:1536
s_waitcnt lgkmcnt(0)
v_mfma_f32_16x16x32_bf16 a[0:3], v[56:59], v[40:43], a[0:3]
v_mfma_f32_16x16x32_bf16 a[24:27], v[56:59], v[44:47], a[24:27]
v_add_u32 v23, 40960, v22
v_mfma_f32_16x16x32_bf16 a[48:51], v[56:59], v[48:51], a[48:51]
v_add_u32 v32, 40960, v25
v_mfma_f32_16x16x32_bf16 a[72:75], v[56:59], v[52:55], a[72:75]
v_add_u32 v33, 40960, v26
v_mfma_f32_16x16x32_bf16 a[4:7], v[60:63], v[40:43], a[4:7]
v_add_u32 v34, 40960, v27
v_mfma_f32_16x16x32_bf16 a[28:31], v[60:63], v[44:47], a[28:31]
v_add_u32 v35, 40960, v28
v_mfma_f32_16x16x32_bf16 a[52:55], v[60:63], v[48:51], a[52:55]
v_add_u32 v36, 40960, v29
v_mfma_f32_16x16x32_bf16 a[76:79], v[60:63], v[52:55], a[76:79]
v_add_u32 v37, 40960, v30
v_mfma_f32_16x16x32_bf16 a[8:11], v[64:67], v[40:43], a[8:11]
ds_read_b128 v[84:87], v23 offset:0
v_mfma_f32_16x16x32_bf16 a[32:35], v[64:67], v[44:47], a[32:35]
ds_read_b128 v[88:91], v23 offset:2048
v_mfma_f32_16x16x32_bf16 a[56:59], v[64:67], v[48:51], a[56:59]
ds_read_b128 v[92:95], v23 offset:4096
v_mfma_f32_16x16x32_bf16 a[80:83], v[64:67], v[52:55], a[80:83]
ds_read_b128 v[96:99], v23 offset:6144
v_mfma_f32_16x16x32_bf16 a[12:15], v[68:71], v[40:43], a[12:15]
ds_read_b64_tr_b16 v[100:101], v32 offset:12288
v_mfma_f32_16x16x32_bf16 a[36:39], v[68:71], v[44:47], a[36:39]
ds_read_b64_tr_b16 v[102:103], v32 offset:13824
v_mfma_f32_16x16x32_bf16 a[60:63], v[68:71], v[48:51], a[60:63]
ds_read_b64_tr_b16 v[104:105], v33 offset:12288
v_mfma_f32_16x16x32_bf16 a[84:87], v[68:71], v[52:55], a[84:87]
ds_read_b64_tr_b16 v[106:107], v33 offset:13824
v_mfma_f32_16x16x32_bf16 a[16:19], v[40:43], v[72:75], a[16:19]
ds_read_b64_tr_b16 v[108:109], v34 offset:12288
v_mfma_f32_16x16x32_bf16 a[40:43], v[44:47], v[72:75], a[40:43]
ds_read_b64_tr_b16 v[110:111], v34 offset:13824
v_mfma_f32_16x16x32_bf16 a[64:67], v[48:51], v[72:75], a[64:67]
ds_read_b64_tr_b16 v[112:113], v35 offset:12288
v_mfma_f32_16x16x32_bf16 a[88:91], v[52:55], v[72:75], a[88:91]
ds_read_b64_tr_b16 v[114:115], v35 offset:13824
v_mfma_f32_16x16x32_bf16 a[20:23], v[40:43], v[76:79], a[20:23]
ds_read_b64_tr_b16 v[116:117], v36 offset:12288
v_mfma_f32_16x16x32_bf16 a[44:47], v[44:47], v[76:79], a[44:47]
ds_read_b64_tr_b16 v[118:119], v36 offset:13824
v_mfma_f32_16x16x32_bf16 a[68:71], v[48:51], v[76:79], a[68:71]
ds_read_b64_tr_b16 v[120:121], v37 offset:12288
v_mfma_f32_16x16x32_bf16 a[92:95], v[52:55], v[76:79], a[92:95]
ds_read_b64_tr_b16 v[122:123], v37 offset:13824
s_waitcnt vmcnt(0)
s_barrier
s_waitcnt lgkmcnt(0)
v_mfma_f32_16x16x32_bf16 a[0:3], v[100:103], v[84:87], a[0:3]
s_mov_b32 s16, 768
s_mov_b32 s17, 2359296
v_mfma_f32_16x16x32_bf16 a[24:27], v[100:103], v[88:91], a[24:27]
s_add_u32 m0, s27, 0
s_nop 0
v_mfma_f32_16x16x32_bf16 a[48:51], v[100:103], v[92:95], a[48:51]
buffer_load_dwordx4 v10, s[4:7], s16 offen lds
s_add_u32 m0, s27, 1024
v_mfma_f32_16x16x32_bf16 a[72:75], v[100:103], v[96:99], a[72:75]
s_nop 0
buffer_load_dwordx4 v11, s[4:7], s16 offen lds
s_add_u32 m0, s27, 2048
v_mfma_f32_16x16x32_bf16 a[4:7], v[104:107], v[84:87], a[4:7]
s_nop 0
buffer_load_dwordx4 v12, s[4:7], s16 offen lds
v_mfma_f32_16x16x32_bf16 a[28:31], v[104:107], v[88:91], a[28:31]
s_add_u32 m0, s27, 3072
s_nop 0
v_mfma_f32_16x16x32_bf16 a[52:55], v[104:107], v[92:95], a[52:55]
buffer_load_dwordx4 v13, s[4:7], s16 offen lds
s_add_u32 m0, s28, 16384
s_nop 0
v_mfma_f32_16x16x32_bf16 a[76:79], v[104:107], v[96:99], a[76:79]
buffer_load_dwordx4 v14, s[8:11], s17 offen lds
s_add_u32 m0, s28, 17408
v_mfma_f32_16x16x32_bf16 a[8:11], v[108:111], v[84:87], a[8:11]
s_nop 0
buffer_load_dwordx4 v15, s[8:11], s17 offen lds
v_mfma_f32_16x16x32_bf16 a[32:35], v[108:111], v[88:91], a[32:35]
s_add_u32 m0, s28, 18432
s_nop 0
v_mfma_f32_16x16x32_bf16 a[56:59], v[108:111], v[92:95], a[56:59]
buffer_load_dwordx4 v16, s[8:11], s17 offen lds
s_add_u32 m0, s28, 19456
s_nop 0
v_mfma_f32_16x16x32_bf16 a[80:83], v[108:111], v[96:99], a[80:83]
buffer_load_dwordx4 v17, s[8:11], s17 offen lds
s_add_u32 m0, s28, 20480
v_mfma_f32_16x16x32_bf16 a[12:15], v[112:115], v[84:87], a[12:15]
s_nop 0
buffer_load_dwordx4 v18, s[8:11], s17 offen lds
v_mfma_f32_16x16x32_bf16 a[36:39], v[112:115], v[88:91], a[36:39]
s_add_u32 m0, s28, 21504
s_nop 0
buffer_load_dwordx4 v19, s[8:11], s17 offen lds
v_mfma_f32_16x16x32_bf16 a[60:63], v[112:115], v[92:95], a[60:63]
v_add_u32 v23, 81920, v21
v_add_u32 v32, 81920, v25
v_mfma_f32_16x16x32_bf16 a[84:87], v[112:115], v[96:99], a[84:87]
v_add_u32 v33, 81920, v26
v_add_u32 v34, 81920, v27
v_mfma_f32_16x16x32_bf16 a[16:19], v[84:87], v[116:119], a[16:19]
v_add_u32 v35, 81920, v28
v_add_u32 v36, 81920, v29
v_mfma_f32_16x16x32_bf16 a[40:43], v[88:91], v[116:119], a[40:43]
v_add_u32 v37, 81920, v30
ds_read_b128 v[40:43], v23 offset:0
ds_read_b128 v[44:47], v23 offset:2048
v_mfma_f32_16x16x32_bf16 a[64:67], v[92:95], v[116:119], a[64:67]
ds_read_b128 v[48:51], v23 offset:4096
ds_read_b128 v[52:55], v23 offset:6144
v_mfma_f32_16x16x32_bf16 a[88:91], v[96:99], v[116:119], a[88:91]
ds_read_b64_tr_b16 v[56:57], v32 offset:0
ds_read_b64_tr_b16 v[58:59], v32 offset:1536
v_mfma_f32_16x16x32_bf16 a[20:23], v[84:87], v[120:123], a[20:23]
ds_read_b64_tr_b16 v[60:61], v33 offset:0
ds_read_b64_tr_b16 v[62:63], v33 offset:1536
ds_read_b64_tr_b16 v[64:65], v34 offset:0
v_mfma_f32_16x16x32_bf16 a[44:47], v[88:91], v[120:123], a[44:47]
ds_read_b64_tr_b16 v[66:67], v34 offset:1536
ds_read_b64_tr_b16 v[68:69], v35 offset:0
v_mfma_f32_16x16x32_bf16 a[68:71], v[92:95], v[120:123], a[68:71]
ds_read_b64_tr_b16 v[70:71], v35 offset:1536
ds_read_b64_tr_b16 v[72:73], v36 offset:0
v_mfma_f32_16x16x32_bf16 a[92:95], v[96:99], v[120:123], a[92:95]
ds_read_b64_tr_b16 v[74:75], v36 offset:1536
ds_read_b64_tr_b16 v[76:77], v37 offset:0
ds_read_b64_tr_b16 v[78:79], v37 offset:1536
s_waitcnt lgkmcnt(0)
v_mfma_f32_16x16x32_bf16 a[0:3], v[56:59], v[40:43], a[0:3]
v_mfma_f32_16x16x32_bf16 a[24:27], v[56:59], v[44:47], a[24:27]
v_add_u32 v23, 81920, v22
v_mfma_f32_16x16x32_bf16 a[48:51], v[56:59], v[48:51], a[48:51]
v_add_u32 v32, 81920, v25
v_mfma_f32_16x16x32_bf16 a[72:75], v[56:59], v[52:55], a[72:75]
v_add_u32 v33, 81920, v26
v_mfma_f32_16x16x32_bf16 a[4:7], v[60:63], v[40:43], a[4:7]
v_add_u32 v34, 81920, v27
v_mfma_f32_16x16x32_bf16 a[28:31], v[60:63], v[44:47], a[28:31]
v_add_u32 v35, 81920, v28
v_mfma_f32_16x16x32_bf16 a[52:55], v[60:63], v[48:51], a[52:55]
v_add_u32 v36, 81920, v29
v_mfma_f32_16x16x32_bf16 a[76:79], v[60:63], v[52:55], a[76:79]
v_add_u32 v37, 81920, v30
v_mfma_f32_16x16x32_bf16 a[8:11], v[64:67], v[40:43], a[8:11]
ds_read_b128 v[84:87], v23 offset:0
v_mfma_f32_16x16x32_bf16 a[32:35], v[64:67], v[44:47], a[32:35]
ds_read_b128 v[88:91], v23 offset:2048
v_mfma_f32_16x16x32_bf16 a[56:59], v[64:67], v[48:51], a[56:59]
ds_read_b128 v[92:95], v23 offset:4096
v_mfma_f32_16x16x32_bf16 a[80:83], v[64:67], v[52:55], a[80:83]
ds_read_b128 v[96:99], v23 offset:6144
v_mfma_f32_16x16x32_bf16 a[12:15], v[68:71], v[40:43], a[12:15]
ds_read_b64_tr_b16 v[100:101], v32 offset:12288
v_mfma_f32_16x16x32_bf16 a[36:39], v[68:71], v[44:47], a[36:39]
ds_read_b64_tr_b16 v[102:103], v32 offset:13824
v_mfma_f32_16x16x32_bf16 a[60:63], v[68:71], v[48:51], a[60:63]
ds_read_b64_tr_b16 v[104:105], v33 offset:12288
v_mfma_f32_16x16x32_bf16 a[84:87], v[68:71], v[52:55], a[84:87]
ds_read_b64_tr_b16 v[106:107], v33 offset:13824
v_mfma_f32_16x16x32_bf16 a[16:19], v[40:43], v[72:75], a[16:19]
ds_read_b64_tr_b16 v[108:109], v34 offset:12288
v_mfma_f32_16x16x32_bf16 a[40:43], v[44:47], v[72:75], a[40:43]
ds_read_b64_tr_b16 v[110:111], v34 offset:13824
v_mfma_f32_16x16x32_bf16 a[64:67], v[48:51], v[72:75], a[64:67]
ds_read_b64_tr_b16 v[112:113], v35 offset:12288
v_mfma_f32_16x16x32_bf16 a[88:91], v[52:55], v[72:75], a[88:91]
ds_read_b64_tr_b16 v[114:115], v35 offset:13824
v_mfma_f32_16x16x32_bf16 a[20:23], v[40:43], v[76:79], a[20:23]
ds_read_b64_tr_b16 v[116:117], v36 offset:12288
v_mfma_f32_16x16x32_bf16 a[44:47], v[44:47], v[76:79], a[44:47]
ds_read_b64_tr_b16 v[118:119], v36 offset:13824
v_mfma_f32_16x16x32_bf16 a[68:71], v[48:51], v[76:79], a[68:71]
ds_read_b64_tr_b16 v[120:121], v37 offset:12288
v_mfma_f32_16x16x32_bf16 a[92:95], v[52:55], v[76:79], a[92:95]
ds_read_b64_tr_b16 v[122:123], v37 offset:13824
s_waitcnt vmcnt(0)
s_barrier
s_waitcnt lgkmcnt(0)
v_mfma_f32_16x16x32_bf16 a[0:3], v[100:103], v[84:87], a[0:3]
s_mov_b32 s16, 896
s_mov_b32 s17, 2752512
v_mfma_f32_16x16x32_bf16 a[24:27], v[100:103], v[88:91], a[24:27]
s_add_u32 m0, s27, 40960
s_nop 0
v_mfma_f32_16x16x32_bf16 a[48:51], v[100:103], v[92:95], a[48:51]
buffer_load_dwordx4 v10, s[4:7], s16 offen lds
s_add_u32 m0, s27, 41984
v_mfma_f32_16x16x32_bf16 a[72:75], v[100:103], v[96:99], a[72:75]
s_nop 0
buffer_load_dwordx4 v11, s[4:7], s16 offen lds
s_add_u32 m0, s27, 43008
v_mfma_f32_16x16x32_bf16 a[4:7], v[104:107], v[84:87], a[4:7]
s_nop 0
buffer_load_dwordx4 v12, s[4:7], s16 offen lds
v_mfma_f32_16x16x32_bf16 a[28:31], v[104:107], v[88:91], a[28:31]
s_add_u32 m0, s27, 44032
s_nop 0
v_mfma_f32_16x16x32_bf16 a[52:55], v[104:107], v[92:95], a[52:55]
buffer_load_dwordx4 v13, s[4:7], s16 offen lds
s_add_u32 m0, s28, 57344
s_nop 0
v_mfma_f32_16x16x32_bf16 a[76:79], v[104:107], v[96:99], a[76:79]
buffer_load_dwordx4 v14, s[8:11], s17 offen lds
s_add_u32 m0, s28, 58368
v_mfma_f32_16x16x32_bf16 a[8:11], v[108:111], v[84:87], a[8:11]
s_nop 0
buffer_load_dwordx4 v15, s[8:11], s17 offen lds
v_mfma_f32_16x16x32_bf16 a[32:35], v[108:111], v[88:91], a[32:35]
s_add_u32 m0, s28, 59392
s_nop 0
v_mfma_f32_16x16x32_bf16 a[56:59], v[108:111], v[92:95], a[56:59]
buffer_load_dwordx4 v16, s[8:11], s17 offen lds
s_add_u32 m0, s28, 60416
s_nop 0
v_mfma_f32_16x16x32_bf16 a[80:83], v[108:111], v[96:99], a[80:83]
buffer_load_dwordx4 v17, s[8:11], s17 offen lds
s_add_u32 m0, s28, 61440
v_mfma_f32_16x16x32_bf16 a[12:15], v[112:115], v[84:87], a[12:15]
s_nop 0
buffer_load_dwordx4 v18, s[8:11], s17 offen lds
v_mfma_f32_16x16x32_bf16 a[36:39], v[112:115], v[88:91], a[36:39]
s_add_u32 m0, s28, 62464
s_nop 0
buffer_load_dwordx4 v19, s[8:11], s17 offen lds
v_mfma_f32_16x16x32_bf16 a[60:63], v[112:115], v[92:95], a[60:63]
v_add_u32 v23, 0, v21
v_add_u32 v32, 0, v25
v_mfma_f32_16x16x32_bf16 a[84:87], v[112:115], v[96:99], a[84:87]
v_add_u32 v33, 0, v26
v_add_u32 v34, 0, v27
v_mfma_f32_16x16x32_bf16 a[16:19], v[84:87], v[116:119], a[16:19]
v_add_u32 v35, 0, v28
v_add_u32 v36, 0, v29
v_mfma_f32_16x16x32_bf16 a[40:43], v[88:91], v[116:119], a[40:43]
v_add_u32 v37, 0, v30
ds_read_b128 v[40:43], v23 offset:0
ds_read_b128 v[44:47], v23 offset:2048
v_mfma_f32_16x16x32_bf16 a[64:67], v[92:95], v[116:119], a[64:67]
ds_read_b128 v[48:51], v23 offset:4096
ds_read_b128 v[52:55], v23 offset:6144
v_mfma_f32_16x16x32_bf16 a[88:91], v[96:99], v[116:119], a[88:91]
ds_read_b64_tr_b16 v[56:57], v32 offset:0
ds_read_b64_tr_b16 v[58:59], v32 offset:1536
v_mfma_f32_16x16x32_bf16 a[20:23], v[84:87], v[120:123], a[20:23]
ds_read_b64_tr_b16 v[60:61], v33 offset:0
ds_read_b64_tr_b16 v[62:63], v33 offset:1536
ds_read_b64_tr_b16 v[64:65], v34 offset:0
v_mfma_f32_16x16x32_bf16 a[44:47], v[88:91], v[120:123], a[44:47]
ds_read_b64_tr_b16 v[66:67], v34 offset:1536
ds_read_b64_tr_b16 v[68:69], v35 offset:0
v_mfma_f32_16x16x32_bf16 a[68:71], v[92:95], v[120:123], a[68:71]
ds_read_b64_tr_b16 v[70:71], v35 offset:1536
ds_read_b64_tr_b16 v[72:73], v36 offset:0
v_mfma_f32_16x16x32_bf16 a[92:95], v[96:99], v[120:123], a[92:95]
ds_read_b64_tr_b16 v[74:75], v36 offset:1536
ds_read_b64_tr_b16 v[76:77], v37 offset:0
ds_read_b64_tr_b16 v[78:79], v37 offset:1536
s_waitcnt lgkmcnt(0)
v_mfma_f32_16x16x32_bf16 a[0:3], v[56:59], v[40:43], a[0:3]
v_mfma_f32_16x16x32_bf16 a[24:27], v[56:59], v[44:47], a[24:27]
v_add_u32 v23, 0, v22
v_mfma_f32_16x16x32_bf16 a[48:51], v[56:59], v[48:51], a[48:51]
v_add_u32 v32, 0, v25
v_mfma_f32_16x16x32_bf16 a[72:75], v[56:59], v[52:55], a[72:75]
v_add_u32 v33, 0, v26
v_mfma_f32_16x16x32_bf16 a[4:7], v[60:63], v[40:43], a[4:7]
v_add_u32 v34, 0, v27
v_mfma_f32_16x16x32_bf16 a[28:31], v[60:63], v[44:47], a[28:31]
v_add_u32 v35, 0, v28
v_mfma_f32_16x16x32_bf16 a[52:55], v[60:63], v[48:51], a[52:55]
v_add_u32 v36, 0, v29
v_mfma_f32_16x16x32_bf16 a[76:79], v[60:63], v[52:55], a[76:79]
v_add_u32 v37, 0, v30
v_mfma_f32_16x16x32_bf16 a[8:11], v[64:67], v[40:43], a[8:11]
ds_read_b128 v[84:87], v23 offset:0
v_mfma_f32_16x16x32_bf16 a[32:35], v[64:67], v[44:47], a[32:35]
ds_read_b128 v[88:91], v23 offset:2048
v_mfma_f32_16x16x32_bf16 a[56:59], v[64:67], v[48:51], a[56:59]
ds_read_b128 v[92:95], v23 offset:4096
v_mfma_f32_16x16x32_bf16 a[80:83], v[64:67], v[52:55], a[80:83]
ds_read_b128 v[96:99], v23 offset:6144
v_mfma_f32_16x16x32_bf16 a[12:15], v[68:71], v[40:43], a[12:15]
ds_read_b64_tr_b16 v[100:101], v32 offset:12288
v_mfma_f32_16x16x32_bf16 a[36:39], v[68:71], v[44:47], a[36:39]
ds_read_b64_tr_b16 v[102:103], v32 offset:13824
v_mfma_f32_16x16x32_bf16 a[60:63], v[68:71], v[48:51], a[60:63]
ds_read_b64_tr_b16 v[104:105], v33 offset:12288
v_mfma_f32_16x16x32_bf16 a[84:87], v[68:71], v[52:55], a[84:87]
ds_read_b64_tr_b16 v[106:107], v33 offset:13824
v_mfma_f32_16x16x32_bf16 a[16:19], v[40:43], v[72:75], a[16:19]
ds_read_b64_tr_b16 v[108:109], v34 offset:12288
v_mfma_f32_16x16x32_bf16 a[40:43], v[44:47], v[72:75], a[40:43]
ds_read_b64_tr_b16 v[110:111], v34 offset:13824
v_mfma_f32_16x16x32_bf16 a[64:67], v[48:51], v[72:75], a[64:67]
ds_read_b64_tr_b16 v[112:113], v35 offset:12288
v_mfma_f32_16x16x32_bf16 a[88:91], v[52:55], v[72:75], a[88:91]
ds_read_b64_tr_b16 v[114:115], v35 offset:13824
v_mfma_f32_16x16x32_bf16 a[20:23], v[40:43], v[76:79], a[20:23]
ds_read_b64_tr_b16 v[116:117], v36 offset:12288
v_mfma_f32_16x16x32_bf16 a[44:47], v[44:47], v[76:79], a[44:47]
ds_read_b64_tr_b16 v[118:119], v36 offset:13824
v_mfma_f32_16x16x32_bf16 a[68:71], v[48:51], v[76:79], a[68:71]
ds_read_b64_tr_b16 v[120:121], v37 offset:12288
v_mfma_f32_16x16x32_bf16 a[92:95], v[52:55], v[76:79], a[92:95]
ds_read_b64_tr_b16 v[122:123], v37 offset:13824
s_waitcnt vmcnt(0)
s_barrier
s_waitcnt lgkmcnt(0)
v_mfma_f32_16x16x32_bf16 a[0:3], v[100:103], v[84:87], a[0:3]
s_mov_b32 s16, 1024
s_mov_b32 s17, 3145728
v_mfma_f32_16x16x32_bf16 a[24:27], v[100:103], v[88:91], a[24:27]
s_add_u32 m0, s27, 81920
s_nop 0
v_mfma_f32_16x16x32_bf16 a[48:51], v[100:103], v[92:95], a[48:51]
buffer_load_dwordx4 v10, s[4:7], s16 offen lds
s_add_u32 m0, s27, 82944
v_mfma_f32_16x16x32_bf16 a[72:75], v[100:103], v[96:99], a[72:75]
s_nop 0
buffer_load_dwordx4 v11, s[4:7], s16 offen lds
s_add_u32 m0, s27, 83968
v_mfma_f32_16x16x32_bf16 a[4:7], v[104:107], v[84:87], a[4:7]
s_nop 0
buffer_load_dwordx4 v12, s[4:7], s16 offen lds
v_mfma_f32_16x16x32_bf16 a[28:31], v[104:107], v[88:91], a[28:31]
s_add_u32 m0, s27, 84992
s_nop 0
v_mfma_f32_16x16x32_bf16 a[52:55], v[104:107], v[92:95], a[52:55]
buffer_load_dwordx4 v13, s[4:7], s16 offen lds
s_add_u32 m0, s28, 98304
s_nop 0
v_mfma_f32_16x16x32_bf16 a[76:79], v[104:107], v[96:99], a[76:79]
buffer_load_dwordx4 v14, s[8:11], s17 offen lds
s_add_u32 m0, s28, 99328
v_mfma_f32_16x16x32_bf16 a[8:11], v[108:111], v[84:87], a[8:11]
s_nop 0
buffer_load_dwordx4 v15, s[8:11], s17 offen lds
v_mfma_f32_16x16x32_bf16 a[32:35], v[108:111], v[88:91], a[32:35]
s_add_u32 m0, s28, 100352
s_nop 0
v_mfma_f32_16x16x32_bf16 a[56:59], v[108:111], v[92:95], a[56:59]
buffer_load_dwordx4 v16, s[8:11], s17 offen lds
s_add_u32 m0, s28, 101376
s_nop 0
v_mfma_f32_16x16x32_bf16 a[80:83], v[108:111], v[96:99], a[80:83]
buffer_load_dwordx4 v17, s[8:11], s17 offen lds
s_add_u32 m0, s28, 102400
v_mfma_f32_16x16x32_bf16 a[12:15], v[112:115], v[84:87], a[12:15]
s_nop 0
buffer_load_dwordx4 v18, s[8:11], s17 offen lds
v_mfma_f32_16x16x32_bf16 a[36:39], v[112:115], v[88:91], a[36:39]
s_add_u32 m0, s28, 103424
s_nop 0
buffer_load_dwordx4 v19, s[8:11], s17 offen lds
v_mfma_f32_16x16x32_bf16 a[60:63], v[112:115], v[92:95], a[60:63]
v_add_u32 v23, 40960, v21
v_add_u32 v32, 40960, v25
v_mfma_f32_16x16x32_bf16 a[84:87], v[112:115], v[96:99], a[84:87]
v_add_u32 v33, 40960, v26
v_add_u32 v34, 40960, v27
v_mfma_f32_16x16x32_bf16 a[16:19], v[84:87], v[116:119], a[16:19]
v_add_u32 v35, 40960, v28
v_add_u32 v36, 40960, v29
v_mfma_f32_16x16x32_bf16 a[40:43], v[88:91], v[116:119], a[40:43]
v_add_u32 v37, 40960, v30
ds_read_b128 v[40:43], v23 offset:0
ds_read_b128 v[44:47], v23 offset:2048
v_mfma_f32_16x16x32_bf16 a[64:67], v[92:95], v[116:119], a[64:67]
ds_read_b128 v[48:51], v23 offset:4096
ds_read_b128 v[52:55], v23 offset:6144
v_mfma_f32_16x16x32_bf16 a[88:91], v[96:99], v[116:119], a[88:91]
ds_read_b64_tr_b16 v[56:57], v32 offset:0
ds_read_b64_tr_b16 v[58:59], v32 offset:1536
v_mfma_f32_16x16x32_bf16 a[20:23], v[84:87], v[120:123], a[20:23]
ds_read_b64_tr_b16 v[60:61], v33 offset:0
ds_read_b64_tr_b16 v[62:63], v33 offset:1536
ds_read_b64_tr_b16 v[64:65], v34 offset:0
v_mfma_f32_16x16x32_bf16 a[44:47], v[88:91], v[120:123], a[44:47]
ds_read_b64_tr_b16 v[66:67], v34 offset:1536
ds_read_b64_tr_b16 v[68:69], v35 offset:0
v_mfma_f32_16x16x32_bf16 a[68:71], v[92:95], v[120:123], a[68:71]
ds_read_b64_tr_b16 v[70:71], v35 offset:1536
ds_read_b64_tr_b16 v[72:73], v36 offset:0
v_mfma_f32_16x16x32_bf16 a[92:95], v[96:99], v[120:123], a[92:95]
ds_read_b64_tr_b16 v[74:75], v36 offset:1536
ds_read_b64_tr_b16 v[76:77], v37 offset:0
ds_read_b64_tr_b16 v[78:79], v37 offset:1536
s_waitcnt lgkmcnt(0)
v_mfma_f32_16x16x32_bf16 a[0:3], v[56:59], v[40:43], a[0:3]
v_mfma_f32_16x16x32_bf16 a[24:27], v[56:59], v[44:47], a[24:27]
v_add_u32 v23, 40960, v22
v_mfma_f32_16x16x32_bf16 a[48:51], v[56:59], v[48:51], a[48:51]
v_add_u32 v32, 40960, v25
v_mfma_f32_16x16x32_bf16 a[72:75], v[56:59], v[52:55], a[72:75]
v_add_u32 v33, 40960, v26
v_mfma_f32_16x16x32_bf16 a[4:7], v[60:63], v[40:43], a[4:7]
v_add_u32 v34, 40960, v27
v_mfma_f32_16x16x32_bf16 a[28:31], v[60:63], v[44:47], a[28:31]
v_add_u32 v35, 40960, v28
v_mfma_f32_16x16x32_bf16 a[52:55], v[60:63], v[48:51], a[52:55]
v_add_u32 v36, 40960, v29
v_mfma_f32_16x16x32_bf16 a[76:79], v[60:63], v[52:55], a[76:79]
v_add_u32 v37, 40960, v30
v_mfma_f32_16x16x32_bf16 a[8:11], v[64:67], v[40:43], a[8:11]
ds_read_b128 v[84:87], v23 offset:0
v_mfma_f32_16x16x32_bf16 a[32:35], v[64:67], v[44:47], a[32:35]
ds_read_b128 v[88:91], v23 offset:2048
v_mfma_f32_16x16x32_bf16 a[56:59], v[64:67], v[48:51], a[56:59]
ds_read_b128 v[92:95], v23 offset:4096
v_mfma_f32_16x16x32_bf16 a[80:83], v[64:67], v[52:55], a[80:83]
ds_read_b128 v[96:99], v23 offset:6144
v_mfma_f32_16x16x32_bf16 a[12:15], v[68:71], v[40:43], a[12:15]
ds_read_b64_tr_b16 v[100:101], v32 offset:12288
v_mfma_f32_16x16x32_bf16 a[36:39], v[68:71], v[44:47], a[36:39]
ds_read_b64_tr_b16 v[102:103], v32 offset:13824
v_mfma_f32_16x16x32_bf16 a[60:63], v[68:71], v[48:51], a[60:63]
ds_read_b64_tr_b16 v[104:105], v33 offset:12288
v_mfma_f32_16x16x32_bf16 a[84:87], v[68:71], v[52:55], a[84:87]
ds_read_b64_tr_b16 v[106:107], v33 offset:13824
v_mfma_f32_16x16x32_bf16 a[16:19], v[40:43], v[72:75], a[16:19]
ds_read_b64_tr_b16 v[108:109], v34 offset:12288
v_mfma_f32_16x16x32_bf16 a[40:43], v[44:47], v[72:75], a[40:43]
ds_read_b64_tr_b16 v[110:111], v34 offset:13824
v_mfma_f32_16x16x32_bf16 a[64:67], v[48:51], v[72:75], a[64:67]
ds_read_b64_tr_b16 v[112:113], v35 offset:12288
v_mfma_f32_16x16x32_bf16 a[88:91], v[52:55], v[72:75], a[88:91]
ds_read_b64_tr_b16 v[114:115], v35 offset:13824
v_mfma_f32_16x16x32_bf16 a[20:23], v[40:43], v[76:79], a[20:23]
ds_read_b64_tr_b16 v[116:117], v36 offset:12288
v_mfma_f32_16x16x32_bf16 a[44:47], v[44:47], v[76:79], a[44:47]
ds_read_b64_tr_b16 v[118:119], v36 offset:13824
v_mfma_f32_16x16x32_bf16 a[68:71], v[48:51], v[76:79], a[68:71]
ds_read_b64_tr_b16 v[120:121], v37 offset:12288
v_mfma_f32_16x16x32_bf16 a[92:95], v[52:55], v[76:79], a[92:95]
ds_read_b64_tr_b16 v[122:123], v37 offset:13824
s_waitcnt vmcnt(0)
s_barrier
s_waitcnt lgkmcnt(0)
v_mfma_f32_16x16x32_bf16 a[0:3], v[100:103], v[84:87], a[0:3]
s_mov_b32 s16, 1152
s_mov_b32 s17, 3538944
v_mfma_f32_16x16x32_bf16 a[24:27], v[100:103], v[88:91], a[24:27]
s_add_u32 m0, s27, 0
s_nop 0
v_mfma_f32_16x16x32_bf16 a[48:51], v[100:103], v[92:95], a[48:51]
buffer_load_dwordx4 v10, s[4:7], s16 offen lds
s_add_u32 m0, s27, 1024
v_mfma_f32_16x16x32_bf16 a[72:75], v[100:103], v[96:99], a[72:75]
s_nop 0
buffer_load_dwordx4 v11, s[4:7], s16 offen lds
s_add_u32 m0, s27, 2048
v_mfma_f32_16x16x32_bf16 a[4:7], v[104:107], v[84:87], a[4:7]
s_nop 0
buffer_load_dwordx4 v12, s[4:7], s16 offen lds
v_mfma_f32_16x16x32_bf16 a[28:31], v[104:107], v[88:91], a[28:31]
s_add_u32 m0, s27, 3072
s_nop 0
v_mfma_f32_16x16x32_bf16 a[52:55], v[104:107], v[92:95], a[52:55]
buffer_load_dwordx4 v13, s[4:7], s16 offen lds
s_add_u32 m0, s28, 16384
s_nop 0
v_mfma_f32_16x16x32_bf16 a[76:79], v[104:107], v[96:99], a[76:79]
buffer_load_dwordx4 v14, s[8:11], s17 offen lds
s_add_u32 m0, s28, 17408
v_mfma_f32_16x16x32_bf16 a[8:11], v[108:111], v[84:87], a[8:11]
s_nop 0
buffer_load_dwordx4 v15, s[8:11], s17 offen lds
v_mfma_f32_16x16x32_bf16 a[32:35], v[108:111], v[88:91], a[32:35]
s_add_u32 m0, s28, 18432
s_nop 0
v_mfma_f32_16x16x32_bf16 a[56:59], v[108:111], v[92:95], a[56:59]
buffer_load_dwordx4 v16, s[8:11], s17 offen lds
s_add_u32 m0, s28, 19456
s_nop 0
v_mfma_f32_16x16x32_bf16 a[80:83], v[108:111], v[96:99], a[80:83]
buffer_load_dwordx4 v17, s[8:11], s17 offen lds
s_add_u32 m0, s28, 20480
v_mfma_f32_16x16x32_bf16 a[12:15], v[112:115], v[84:87], a[12:15]
s_nop 0
buffer_load_dwordx4 v18, s[8:11], s17 offen lds
v_mfma_f32_16x16x32_bf16 a[36:39], v[112:115], v[88:91], a[36:39]
s_add_u32 m0, s28, 21504
s_nop 0
buffer_load_dwordx4 v19, s[8:11], s17 offen lds
v_mfma_f32_16x16x32_bf16 a[60:63], v[112:115], v[92:95], a[60:63]
v_add_u32 v23, 81920, v21
v_add_u32 v32, 81920, v25
v_mfma_f32_16x16x32_bf16 a[84:87], v[112:115], v[96:99], a[84:87]
v_add_u32 v33, 81920, v26
v_add_u32 v34, 81920, v27
v_mfma_f32_16x16x32_bf16 a[16:19], v[84:87], v[116:119], a[16:19]
v_add_u32 v35, 81920, v28
v_add_u32 v36, 81920, v29
v_mfma_f32_16x16x32_bf16 a[40:43], v[88:91], v[116:119], a[40:43]
v_add_u32 v37, 81920, v30
ds_read_b128 v[40:43], v23 offset:0
ds_read_b128 v[44:47], v23 offset:2048
v_mfma_f32_16x16x32_bf16 a[64:67], v[92:95], v[116:119], a[64:67]
ds_read_b128 v[48:51], v23 offset:4096
ds_read_b128 v[52:55], v23 offset:6144
v_mfma_f32_16x16x32_bf16 a[88:91], v[96:99], v[116:119], a[88:91]
ds_read_b64_tr_b16 v[56:57], v32 offset:0
ds_read_b64_tr_b16 v[58:59], v32 offset:1536
v_mfma_f32_16x16x32_bf16 a[20:23], v[84:87], v[120:123], a[20:23]
ds_read_b64_tr_b16 v[60:61], v33 offset:0
ds_read_b64_tr_b16 v[62:63], v33 offset:1536
ds_read_b64_tr_b16 v[64:65], v34 offset:0
v_mfma_f32_16x16x32_bf16 a[44:47], v[88:91], v[120:123], a[44:47]
ds_read_b64_tr_b16 v[66:67], v34 offset:1536
ds_read_b64_tr_b16 v[68:69], v35 offset:0
v_mfma_f32_16x16x32_bf16 a[68:71], v[92:95], v[120:123], a[68:71]
ds_read_b64_tr_b16 v[70:71], v35 offset:1536
ds_read_b64_tr_b16 v[72:73], v36 offset:0
v_mfma_f32_16x16x32_bf16 a[92:95], v[96:99], v[120:123], a[92:95]
ds_read_b64_tr_b16 v[74:75], v36 offset:1536
ds_read_b64_tr_b16 v[76:77], v37 offset:0
ds_read_b64_tr_b16 v[78:79], v37 offset:1536
s_waitcnt lgkmcnt(0)
v_mfma_f32_16x16x32_bf16 a[0:3], v[56:59], v[40:43], a[0:3]
v_mfma_f32_16x16x32_bf16 a[24:27], v[56:59], v[44:47], a[24:27]
v_add_u32 v23, 81920, v22
v_mfma_f32_16x16x32_bf16 a[48:51], v[56:59], v[48:51], a[48:51]
v_add_u32 v32, 81920, v25
v_mfma_f32_16x16x32_bf16 a[72:75], v[56:59], v[52:55], a[72:75]
v_add_u32 v33, 81920, v26
v_mfma_f32_16x16x32_bf16 a[4:7], v[60:63], v[40:43], a[4:7]
v_add_u32 v34, 81920, v27
v_mfma_f32_16x16x32_bf16 a[28:31], v[60:63], v[44:47], a[28:31]
v_add_u32 v35, 81920, v28
v_mfma_f32_16x16x32_bf16 a[52:55], v[60:63], v[48:51], a[52:55]
v_add_u32 v36, 81920, v29
v_mfma_f32_16x16x32_bf16 a[76:79], v[60:63], v[52:55], a[76:79]
v_add_u32 v37, 81920, v30
v_mfma_f32_16x16x32_bf16 a[8:11], v[64:67], v[40:43], a[8:11]
ds_read_b128 v[84:87], v23 offset:0
v_mfma_f32_16x16x32_bf16 a[32:35], v[64:67], v[44:47], a[32:35]
ds_read_b128 v[88:91], v23 offset:2048
v_mfma_f32_16x16x32_bf16 a[56:59], v[64:67], v[48:51], a[56:59]
ds_read_b128 v[92:95], v23 offset:4096
v_mfma_f32_16x16x32_bf16 a[80:83], v[64:67], v[52:55], a[80:83]
ds_read_b128 v[96:99], v23 offset:6144
v_mfma_f32_16x16x32_bf16 a[12:15], v[68:71], v[40:43], a[12:15]
ds_read_b64_tr_b16 v[100:101], v32 offset:12288
v_mfma_f32_16x16x32_bf16 a[36:39], v[68:71], v[44:47], a[36:39]
ds_read_b64_tr_b16 v[102:103], v32 offset:13824
v_mfma_f32_16x16x32_bf16 a[60:63], v[68:71], v[48:51], a[60:63]
ds_read_b64_tr_b16 v[104:105], v33 offset:12288
v_mfma_f32_16x16x32_bf16 a[84:87], v[68:71], v[52:55], a[84:87]
ds_read_b64_tr_b16 v[106:107], v33 offset:13824
v_mfma_f32_16x16x32_bf16 a[16:19], v[40:43], v[72:75], a[16:19]
ds_read_b64_tr_b16 v[108:109], v34 offset:12288
v_mfma_f32_16x16x32_bf16 a[40:43], v[44:47], v[72:75], a[40:43]
ds_read_b64_tr_b16 v[110:111], v34 offset:13824
v_mfma_f32_16x16x32_bf16 a[64:67], v[48:51], v[72:75], a[64:67]
ds_read_b64_tr_b16 v[112:113], v35 offset:12288
v_mfma_f32_16x16x32_bf16 a[88:91], v[52:55], v[72:75], a[88:91]
ds_read_b64_tr_b16 v[114:115], v35 offset:13824
v_mfma_f32_16x16x32_bf16 a[20:23], v[40:43], v[76:79], a[20:23]
ds_read_b64_tr_b16 v[116:117], v36 offset:12288
v_mfma_f32_16x16x32_bf16 a[44:47], v[44:47], v[76:79], a[44:47]
ds_read_b64_tr_b16 v[118:119], v36 offset:13824
v_mfma_f32_16x16x32_bf16 a[68:71], v[48:51], v[76:79], a[68:71]
ds_read_b64_tr_b16 v[120:121], v37 offset:12288
v_mfma_f32_16x16x32_bf16 a[92:95], v[52:55], v[76:79], a[92:95]
ds_read_b64_tr_b16 v[122:123], v37 offset:13824
s_waitcnt vmcnt(0)
s_barrier
s_waitcnt lgkmcnt(0)
v_mfma_f32_16x16x32_bf16 a[0:3], v[100:103], v[84:87], a[0:3]
s_mov_b32 s16, 1280
s_mov_b32 s17, 3932160
v_mfma_f32_16x16x32_bf16 a[24:27], v[100:103], v[88:91], a[24:27]
s_add_u32 m0, s27, 40960
s_nop 0
v_mfma_f32_16x16x32_bf16 a[48:51], v[100:103], v[92:95], a[48:51]
buffer_load_dwordx4 v10, s[4:7], s16 offen lds
s_add_u32 m0, s27, 41984
v_mfma_f32_16x16x32_bf16 a[72:75], v[100:103], v[96:99], a[72:75]
s_nop 0
buffer_load_dwordx4 v11, s[4:7], s16 offen lds
s_add_u32 m0, s27, 43008
v_mfma_f32_16x16x32_bf16 a[4:7], v[104:107], v[84:87], a[4:7]
s_nop 0
buffer_load_dwordx4 v12, s[4:7], s16 offen lds
v_mfma_f32_16x16x32_bf16 a[28:31], v[104:107], v[88:91], a[28:31]
s_add_u32 m0, s27, 44032
s_nop 0
v_mfma_f32_16x16x32_bf16 a[52:55], v[104:107], v[92:95], a[52:55]
buffer_load_dwordx4 v13, s[4:7], s16 offen lds
s_add_u32 m0, s28, 57344
s_nop 0
v_mfma_f32_16x16x32_bf16 a[76:79], v[104:107], v[96:99], a[76:79]
buffer_load_dwordx4 v14, s[8:11], s17 offen lds
s_add_u32 m0, s28, 58368
v_mfma_f32_16x16x32_bf16 a[8:11], v[108:111], v[84:87], a[8:11]
s_nop 0
buffer_load_dwordx4 v15, s[8:11], s17 offen lds
v_mfma_f32_16x16x32_bf16 a[32:35], v[108:111], v[88:91], a[32:35]
s_add_u32 m0, s28, 59392
s_nop 0
v_mfma_f32_16x16x32_bf16 a[56:59], v[108:111], v[92:95], a[56:59]
buffer_load_dwordx4 v16, s[8:11], s17 offen lds
s_add_u32 m0, s28, 60416
s_nop 0
v_mfma_f32_16x16x32_bf16 a[80:83], v[108:111], v[96:99], a[80:83]
buffer_load_dwordx4 v17, s[8:11], s17 offen lds
s_add_u32 m0, s28, 61440
v_mfma_f32_16x16x32_bf16 a[12:15], v[112:115], v[84:87], a[12:15]
s_nop 0
buffer_load_dwordx4 v18, s[8:11], s17 offen lds
v_mfma_f32_16x16x32_bf16 a[36:39], v[112:115], v[88:91], a[36:39]
s_add_u32 m0, s28, 62464
s_nop 0
buffer_load_dwordx4 v19, s[8:11], s17 offen lds
v_mfma_f32_16x16x32_bf16 a[60:63], v[112:115], v[92:95], a[60:63]
v_add_u32 v23, 0, v21
v_add_u32 v32, 0, v25
v_mfma_f32_16x16x32_bf16 a[84:87], v[112:115], v[96:99], a[84:87]
v_add_u32 v33, 0, v26
v_add_u32 v34, 0, v27
v_mfma_f32_16x16x32_bf16 a[16:19], v[84:87], v[116:119], a[16:19]
v_add_u32 v35, 0, v28
v_add_u32 v36, 0, v29
v_mfma_f32_16x16x32_bf16 a[40:43], v[88:91], v[116:119], a[40:43]
v_add_u32 v37, 0, v30
ds_read_b128 v[40:43], v23 offset:0
ds_read_b128 v[44:47], v23 offset:2048
v_mfma_f32_16x16x32_bf16 a[64:67], v[92:95], v[116:119], a[64:67]
ds_read_b128 v[48:51], v23 offset:4096
ds_read_b128 v[52:55], v23 offset:6144
v_mfma_f32_16x16x32_bf16 a[88:91], v[96:99], v[116:119], a[88:91]
ds_read_b64_tr_b16 v[56:57], v32 offset:0
ds_read_b64_tr_b16 v[58:59], v32 offset:1536
v_mfma_f32_16x16x32_bf16 a[20:23], v[84:87], v[120:123], a[20:23]
ds_read_b64_tr_b16 v[60:61], v33 offset:0
ds_read_b64_tr_b16 v[62:63], v33 offset:1536
ds_read_b64_tr_b16 v[64:65], v34 offset:0
v_mfma_f32_16x16x32_bf16 a[44:47], v[88:91], v[120:123], a[44:47]
ds_read_b64_tr_b16 v[66:67], v34 offset:1536
ds_read_b64_tr_b16 v[68:69], v35 offset:0
v_mfma_f32_16x16x32_bf16 a[68:71], v[92:95], v[120:123], a[68:71]
ds_read_b64_tr_b16 v[70:71], v35 offset:1536
ds_read_b64_tr_b16 v[72:73], v36 offset:0
v_mfma_f32_16x16x32_bf16 a[92:95], v[96:99], v[120:123], a[92:95]
ds_read_b64_tr_b16 v[74:75], v36 offset:1536
ds_read_b64_tr_b16 v[76:77], v37 offset:0
ds_read_b64_tr_b16 v[78:79], v37 offset:1536
s_waitcnt lgkmcnt(0)
v_mfma_f32_16x16x32_bf16 a[0:3], v[56:59], v[40:43], a[0:3]
v_mfma_f32_16x16x32_bf16 a[24:27], v[56:59], v[44:47], a[24:27]
v_add_u32 v23, 0, v22
v_mfma_f32_16x16x32_bf16 a[48:51], v[56:59], v[48:51], a[48:51]
v_add_u32 v32, 0, v25
v_mfma_f32_16x16x32_bf16 a[72:75], v[56:59], v[52:55], a[72:75]
v_add_u32 v33, 0, v26
v_mfma_f32_16x16x32_bf16 a[4:7], v[60:63], v[40:43], a[4:7]
v_add_u32 v34, 0, v27
v_mfma_f32_16x16x32_bf16 a[28:31], v[60:63], v[44:47], a[28:31]
v_add_u32 v35, 0, v28
v_mfma_f32_16x16x32_bf16 a[52:55], v[60:63], v[48:51], a[52:55]
v_add_u32 v36, 0, v29
v_mfma_f32_16x16x32_bf16 a[76:79], v[60:63], v[52:55], a[76:79]
v_add_u32 v37, 0, v30
v_mfma_f32_16x16x32_bf16 a[8:11], v[64:67], v[40:43], a[8:11]
ds_read_b128 v[84:87], v23 offset:0
v_mfma_f32_16x16x32_bf16 a[32:35], v[64:67], v[44:47], a[32:35]
ds_read_b128 v[88:91], v23 offset:2048
v_mfma_f32_16x16x32_bf16 a[56:59], v[64:67], v[48:51], a[56:59]
ds_read_b128 v[92:95], v23 offset:4096
v_mfma_f32_16x16x32_bf16 a[80:83], v[64:67], v[52:55], a[80:83]
ds_read_b128 v[96:99], v23 offset:6144
v_mfma_f32_16x16x32_bf16 a[12:15], v[68:71], v[40:43], a[12:15]
ds_read_b64_tr_b16 v[100:101], v32 offset:12288
v_mfma_f32_16x16x32_bf16 a[36:39], v[68:71], v[44:47], a[36:39]
ds_read_b64_tr_b16 v[102:103], v32 offset:13824
v_mfma_f32_16x16x32_bf16 a[60:63], v[68:71], v[48:51], a[60:63]
ds_read_b64_tr_b16 v[104:105], v33 offset:12288
v_mfma_f32_16x16x32_bf16 a[84:87], v[68:71], v[52:55], a[84:87]
ds_read_b64_tr_b16 v[106:107], v33 offset:13824
v_mfma_f32_16x16x32_bf16 a[16:19], v[40:43], v[72:75], a[16:19]
ds_read_b64_tr_b16 v[108:109], v34 offset:12288
v_mfma_f32_16x16x32_bf16 a[40:43], v[44:47], v[72:75], a[40:43]
ds_read_b64_tr_b16 v[110:111], v34 offset:13824
v_mfma_f32_16x16x32_bf16 a[64:67], v[48:51], v[72:75], a[64:67]
ds_read_b64_tr_b16 v[112:113], v35 offset:12288
v_mfma_f32_16x16x32_bf16 a[88:91], v[52:55], v[72:75], a[88:91]
ds_read_b64_tr_b16 v[114:115], v35 offset:13824
v_mfma_f32_16x16x32_bf16 a[20:23], v[40:43], v[76:79], a[20:23]
ds_read_b64_tr_b16 v[116:117], v36 offset:12288
v_mfma_f32_16x16x32_bf16 a[44:47], v[44:47], v[76:79], a[44:47]
ds_read_b64_tr_b16 v[118:119], v36 offset:13824
v_mfma_f32_16x16x32_bf16 a[68:71], v[48:51], v[76:79], a[68:71]
ds_read_b64_tr_b16 v[120:121], v37 offset:12288
v_mfma_f32_16x16x32_bf16 a[92:95], v[52:55], v[76:79], a[92:95]
ds_read_b64_tr_b16 v[122:123], v37 offset:13824
s_waitcnt vmcnt(0)
s_barrier
s_waitcnt lgkmcnt(0)
v_mfma_f32_16x16x32_bf16 a[0:3], v[100:103], v[84:87], a[0:3]
s_mov_b32 s16, 1408
s_mov_b32 s17, 4325376
v_mfma_f32_16x16x32_bf16 a[24:27], v[100:103], v[88:91], a[24:27]
s_add_u32 m0, s27, 81920
s_nop 0
v_mfma_f32_16x16x32_bf16 a[48:51], v[100:103], v[92:95], a[48:51]
buffer_load_dwordx4 v10, s[4:7], s16 offen lds
s_add_u32 m0, s27, 82944
v_mfma_f32_16x16x32_bf16 a[72:75], v[100:103], v[96:99], a[72:75]
s_nop 0
buffer_load_dwordx4 v11, s[4:7], s16 offen lds
s_add_u32 m0, s27, 83968
v_mfma_f32_16x16x32_bf16 a[4:7], v[104:107], v[84:87], a[4:7]
s_nop 0
buffer_load_dwordx4 v12, s[4:7], s16 offen lds
v_mfma_f32_16x16x32_bf16 a[28:31], v[104:107], v[88:91], a[28:31]
s_add_u32 m0, s27, 84992
s_nop 0
v_mfma_f32_16x16x32_bf16 a[52:55], v[104:107], v[92:95], a[52:55]
buffer_load_dwordx4 v13, s[4:7], s16 offen lds
s_add_u32 m0, s28, 98304
s_nop 0
v_mfma_f32_16x16x32_bf16 a[76:79], v[104:107], v[96:99], a[76:79]
buffer_load_dwordx4 v14, s[8:11], s17 offen lds
s_add_u32 m0, s28, 99328
v_mfma_f32_16x16x32_bf16 a[8:11], v[108:111], v[84:87], a[8:11]
s_nop 0
buffer_load_dwordx4 v15, s[8:11], s17 offen lds
v_mfma_f32_16x16x32_bf16 a[32:35], v[108:111], v[88:91], a[32:35]
s_add_u32 m0, s28, 100352
s_nop 0
v_mfma_f32_16x16x32_bf16 a[56:59], v[108:111], v[92:95], a[56:59]
buffer_load_dwordx4 v16, s[8:11], s17 offen lds
s_add_u32 m0, s28, 101376
s_nop 0
v_mfma_f32_16x16x32_bf16 a[80:83], v[108:111], v[96:99], a[80:83]
buffer_load_dwordx4 v17, s[8:11], s17 offen lds
s_add_u32 m0, s28, 102400
v_mfma_f32_16x16x32_bf16 a[12:15], v[112:115], v[84:87], a[12:15]
s_nop 0
buffer_load_dwordx4 v18, s[8:11], s17 offen lds
v_mfma_f32_16x16x32_bf16 a[36:39], v[112:115], v[88:91], a[36:39]
s_add_u32 m0, s28, 103424
s_nop 0
buffer_load_dwordx4 v19, s[8:11], s17 offen lds
v_mfma_f32_16x16x32_bf16 a[60:63], v[112:115], v[92:95], a[60:63]
v_add_u32 v23, 40960, v21
v_add_u32 v32, 40960, v25
v_mfma_f32_16x16x32_bf16 a[84:87], v[112:115], v[96:99], a[84:87]
v_add_u32 v33, 40960, v26
v_add_u32 v34, 40960, v27
v_mfma_f32_16x16x32_bf16 a[16:19], v[84:87], v[116:119], a[16:19]
v_add_u32 v35, 40960, v28
v_add_u32 v36, 40960, v29
v_mfma_f32_16x16x32_bf16 a[40:43], v[88:91], v[116:119], a[40:43]
v_add_u32 v37, 40960, v30
ds_read_b128 v[40:43], v23 offset:0
ds_read_b128 v[44:47], v23 offset:2048
v_mfma_f32_16x16x32_bf16 a[64:67], v[92:95], v[116:119], a[64:67]
ds_read_b128 v[48:51], v23 offset:4096
ds_read_b128 v[52:55], v23 offset:6144
v_mfma_f32_16x16x32_bf16 a[88:91], v[96:99], v[116:119], a[88:91]
ds_read_b64_tr_b16 v[56:57], v32 offset:0
ds_read_b64_tr_b16 v[58:59], v32 offset:1536
v_mfma_f32_16x16x32_bf16 a[20:23], v[84:87], v[120:123], a[20:23]
ds_read_b64_tr_b16 v[60:61], v33 offset:0
ds_read_b64_tr_b16 v[62:63], v33 offset:1536
ds_read_b64_tr_b16 v[64:65], v34 offset:0
v_mfma_f32_16x16x32_bf16 a[44:47], v[88:91], v[120:123], a[44:47]
ds_read_b64_tr_b16 v[66:67], v34 offset:1536
ds_read_b64_tr_b16 v[68:69], v35 offset:0
v_mfma_f32_16x16x32_bf16 a[68:71], v[92:95], v[120:123], a[68:71]
ds_read_b64_tr_b16 v[70:71], v35 offset:1536
ds_read_b64_tr_b16 v[72:73], v36 offset:0
v_mfma_f32_16x16x32_bf16 a[92:95], v[96:99], v[120:123], a[92:95]
ds_read_b64_tr_b16 v[74:75], v36 offset:1536
ds_read_b64_tr_b16 v[76:77], v37 offset:0
ds_read_b64_tr_b16 v[78:79], v37 offset:1536
s_waitcnt lgkmcnt(0)
v_mfma_f32_16x16x32_bf16 a[0:3], v[56:59], v[40:43], a[0:3]
v_mfma_f32_16x16x32_bf16 a[24:27], v[56:59], v[44:47], a[24:27]
v_add_u32 v23, 40960, v22
v_mfma_f32_16x16x32_bf16 a[48:51], v[56:59], v[48:51], a[48:51]
v_add_u32 v32, 40960, v25
v_mfma_f32_16x16x32_bf16 a[72:75], v[56:59], v[52:55], a[72:75]
v_add_u32 v33, 40960, v26
v_mfma_f32_16x16x32_bf16 a[4:7], v[60:63], v[40:43], a[4:7]
v_add_u32 v34, 40960, v27
v_mfma_f32_16x16x32_bf16 a[28:31], v[60:63], v[44:47], a[28:31]
v_add_u32 v35, 40960, v28
v_mfma_f32_16x16x32_bf16 a[52:55], v[60:63], v[48:51], a[52:55]
v_add_u32 v36, 40960, v29
v_mfma_f32_16x16x32_bf16 a[76:79], v[60:63], v[52:55], a[76:79]
v_add_u32 v37, 40960, v30
v_mfma_f32_16x16x32_bf16 a[8:11], v[64:67], v[40:43], a[8:11]
ds_read_b128 v[84:87], v23 offset:0
v_mfma_f32_16x16x32_bf16 a[32:35], v[64:67], v[44:47], a[32:35]
ds_read_b128 v[88:91], v23 offset:2048
v_mfma_f32_16x16x32_bf16 a[56:59], v[64:67], v[48:51], a[56:59]
ds_read_b128 v[92:95], v23 offset:4096
v_mfma_f32_16x16x32_bf16 a[80:83], v[64:67], v[52:55], a[80:83]
ds_read_b128 v[96:99], v23 offset:6144
v_mfma_f32_16x16x32_bf16 a[12:15], v[68:71], v[40:43], a[12:15]
ds_read_b64_tr_b16 v[100:101], v32 offset:12288
v_mfma_f32_16x16x32_bf16 a[36:39], v[68:71], v[44:47], a[36:39]
ds_read_b64_tr_b16 v[102:103], v32 offset:13824
v_mfma_f32_16x16x32_bf16 a[60:63], v[68:71], v[48:51], a[60:63]
ds_read_b64_tr_b16 v[104:105], v33 offset:12288
v_mfma_f32_16x16x32_bf16 a[84:87], v[68:71], v[52:55], a[84:87]
ds_read_b64_tr_b16 v[106:107], v33 offset:13824
v_mfma_f32_16x16x32_bf16 a[16:19], v[40:43], v[72:75], a[16:19]
ds_read_b64_tr_b16 v[108:109], v34 offset:12288
v_mfma_f32_16x16x32_bf16 a[40:43], v[44:47], v[72:75], a[40:43]
ds_read_b64_tr_b16 v[110:111], v34 offset:13824
v_mfma_f32_16x16x32_bf16 a[64:67], v[48:51], v[72:75], a[64:67]
ds_read_b64_tr_b16 v[112:113], v35 offset:12288
v_mfma_f32_16x16x32_bf16 a[88:91], v[52:55], v[72:75], a[88:91]
ds_read_b64_tr_b16 v[114:115], v35 offset:13824
v_mfma_f32_16x16x32_bf16 a[20:23], v[40:43], v[76:79], a[20:23]
ds_read_b64_tr_b16 v[116:117], v36 offset:12288
v_mfma_f32_16x16x32_bf16 a[44:47], v[44:47], v[76:79], a[44:47]
ds_read_b64_tr_b16 v[118:119], v36 offset:13824
v_mfma_f32_16x16x32_bf16 a[68:71], v[48:51], v[76:79], a[68:71]
ds_read_b64_tr_b16 v[120:121], v37 offset:12288
v_mfma_f32_16x16x32_bf16 a[92:95], v[52:55], v[76:79], a[92:95]
ds_read_b64_tr_b16 v[122:123], v37 offset:13824
s_waitcnt vmcnt(0)
s_barrier
s_waitcnt lgkmcnt(0)
v_mfma_f32_16x16x32_bf16 a[0:3], v[100:103], v[84:87], a[0:3]
s_mov_b32 s16, 1536
s_mov_b32 s17, 4718592
v_mfma_f32_16x16x32_bf16 a[24:27], v[100:103], v[88:91], a[24:27]
s_add_u32 m0, s27, 0
s_nop 0
v_mfma_f32_16x16x32_bf16 a[48:51], v[100:103], v[92:95], a[48:51]
buffer_load_dwordx4 v10, s[4:7], s16 offen lds
s_add_u32 m0, s27, 1024
v_mfma_f32_16x16x32_bf16 a[72:75], v[100:103], v[96:99], a[72:75]
s_nop 0
buffer_load_dwordx4 v11, s[4:7], s16 offen lds
s_add_u32 m0, s27, 2048
v_mfma_f32_16x16x32_bf16 a[4:7], v[104:107], v[84:87], a[4:7]
s_nop 0
buffer_load_dwordx4 v12, s[4:7], s16 offen lds
v_mfma_f32_16x16x32_bf16 a[28:31], v[104:107], v[88:91], a[28:31]
s_add_u32 m0, s27, 3072
s_nop 0
v_mfma_f32_16x16x32_bf16 a[52:55], v[104:107], v[92:95], a[52:55]
buffer_load_dwordx4 v13, s[4:7], s16 offen lds
s_add_u32 m0, s28, 16384
s_nop 0
v_mfma_f32_16x16x32_bf16 a[76:79], v[104:107], v[96:99], a[76:79]
buffer_load_dwordx4 v14, s[8:11], s17 offen lds
s_add_u32 m0, s28, 17408
v_mfma_f32_16x16x32_bf16 a[8:11], v[108:111], v[84:87], a[8:11]
s_nop 0
buffer_load_dwordx4 v15, s[8:11], s17 offen lds
v_mfma_f32_16x16x32_bf16 a[32:35], v[108:111], v[88:91], a[32:35]
s_add_u32 m0, s28, 18432
s_nop 0
v_mfma_f32_16x16x32_bf16 a[56:59], v[108:111], v[92:95], a[56:59]
buffer_load_dwordx4 v16, s[8:11], s17 offen lds
s_add_u32 m0, s28, 19456
s_nop 0
v_mfma_f32_16x16x32_bf16 a[80:83], v[108:111], v[96:99], a[80:83]
buffer_load_dwordx4 v17, s[8:11], s17 offen lds
s_add_u32 m0, s28, 20480
v_mfma_f32_16x16x32_bf16 a[12:15], v[112:115], v[84:87], a[12:15]
s_nop 0
buffer_load_dwordx4 v18, s[8:11], s17 offen lds
v_mfma_f32_16x16x32_bf16 a[36:39], v[112:115], v[88:91], a[36:39]
s_add_u32 m0, s28, 21504
s_nop 0
buffer_load_dwordx4 v19, s[8:11], s17 offen lds
v_mfma_f32_16x16x32_bf16 a[60:63], v[112:115], v[92:95], a[60:63]
v_add_u32 v23, 81920, v21
v_add_u32 v32, 81920, v25
v_mfma_f32_16x16x32_bf16 a[84:87], v[112:115], v[96:99], a[84:87]
v_add_u32 v33, 81920, v26
v_add_u32 v34, 81920, v27
v_mfma_f32_16x16x32_bf16 a[16:19], v[84:87], v[116:119], a[16:19]
v_add_u32 v35, 81920, v28
v_add_u32 v36, 81920, v29
v_mfma_f32_16x16x32_bf16 a[40:43], v[88:91], v[116:119], a[40:43]
v_add_u32 v37, 81920, v30
ds_read_b128 v[40:43], v23 offset:0
ds_read_b128 v[44:47], v23 offset:2048
v_mfma_f32_16x16x32_bf16 a[64:67], v[92:95], v[116:119], a[64:67]
ds_read_b128 v[48:51], v23 offset:4096
ds_read_b128 v[52:55], v23 offset:6144
v_mfma_f32_16x16x32_bf16 a[88:91], v[96:99], v[116:119], a[88:91]
ds_read_b64_tr_b16 v[56:57], v32 offset:0
ds_read_b64_tr_b16 v[58:59], v32 offset:1536
v_mfma_f32_16x16x32_bf16 a[20:23], v[84:87], v[120:123], a[20:23]
ds_read_b64_tr_b16 v[60:61], v33 offset:0
ds_read_b64_tr_b16 v[62:63], v33 offset:1536
ds_read_b64_tr_b16 v[64:65], v34 offset:0
v_mfma_f32_16x16x32_bf16 a[44:47], v[88:91], v[120:123], a[44:47]
ds_read_b64_tr_b16 v[66:67], v34 offset:1536
ds_read_b64_tr_b16 v[68:69], v35 offset:0
v_mfma_f32_16x16x32_bf16 a[68:71], v[92:95], v[120:123], a[68:71]
ds_read_b64_tr_b16 v[70:71], v35 offset:1536
ds_read_b64_tr_b16 v[72:73], v36 offset:0
v_mfma_f32_16x16x32_bf16 a[92:95], v[96:99], v[120:123], a[92:95]
ds_read_b64_tr_b16 v[74:75], v36 offset:1536
ds_read_b64_tr_b16 v[76:77], v37 offset:0
ds_read_b64_tr_b16 v[78:79], v37 offset:1536
s_waitcnt lgkmcnt(0)
v_mfma_f32_16x16x32_bf16 a[0:3], v[56:59], v[40:43], a[0:3]
v_mfma_f32_16x16x32_bf16 a[24:27], v[56:59], v[44:47], a[24:27]
v_add_u32 v23, 81920, v22
v_mfma_f32_16x16x32_bf16 a[48:51], v[56:59], v[48:51], a[48:51]
v_add_u32 v32, 81920, v25
v_mfma_f32_16x16x32_bf16 a[72:75], v[56:59], v[52:55], a[72:75]
v_add_u32 v33, 81920, v26
v_mfma_f32_16x16x32_bf16 a[4:7], v[60:63], v[40:43], a[4:7]
v_add_u32 v34, 81920, v27
v_mfma_f32_16x16x32_bf16 a[28:31], v[60:63], v[44:47], a[28:31]
v_add_u32 v35, 81920, v28
v_mfma_f32_16x16x32_bf16 a[52:55], v[60:63], v[48:51], a[52:55]
v_add_u32 v36, 81920, v29
v_mfma_f32_16x16x32_bf16 a[76:79], v[60:63], v[52:55], a[76:79]
v_add_u32 v37, 81920, v30
v_mfma_f32_16x16x32_bf16 a[8:11], v[64:67], v[40:43], a[8:11]
ds_read_b128 v[84:87], v23 offset:0
v_mfma_f32_16x16x32_bf16 a[32:35], v[64:67], v[44:47], a[32:35]
ds_read_b128 v[88:91], v23 offset:2048
v_mfma_f32_16x16x32_bf16 a[56:59], v[64:67], v[48:51], a[56:59]
ds_read_b128 v[92:95], v23 offset:4096
v_mfma_f32_16x16x32_bf16 a[80:83], v[64:67], v[52:55], a[80:83]
ds_read_b128 v[96:99], v23 offset:6144
v_mfma_f32_16x16x32_bf16 a[12:15], v[68:71], v[40:43], a[12:15]
ds_read_b64_tr_b16 v[100:101], v32 offset:12288
v_mfma_f32_16x16x32_bf16 a[36:39], v[68:71], v[44:47], a[36:39]
ds_read_b64_tr_b16 v[102:103], v32 offset:13824
v_mfma_f32_16x16x32_bf16 a[60:63], v[68:71], v[48:51], a[60:63]
ds_read_b64_tr_b16 v[104:105], v33 offset:12288
v_mfma_f32_16x16x32_bf16 a[84:87], v[68:71], v[52:55], a[84:87]
ds_read_b64_tr_b16 v[106:107], v33 offset:13824
v_mfma_f32_16x16x32_bf16 a[16:19], v[40:43], v[72:75], a[16:19]
ds_read_b64_tr_b16 v[108:109], v34 offset:12288
v_mfma_f32_16x16x32_bf16 a[40:43], v[44:47], v[72:75], a[40:43]
ds_read_b64_tr_b16 v[110:111], v34 offset:13824
v_mfma_f32_16x16x32_bf16 a[64:67], v[48:51], v[72:75], a[64:67]
ds_read_b64_tr_b16 v[112:113], v35 offset:12288
v_mfma_f32_16x16x32_bf16 a[88:91], v[52:55], v[72:75], a[88:91]
ds_read_b64_tr_b16 v[114:115], v35 offset:13824
v_mfma_f32_16x16x32_bf16 a[20:23], v[40:43], v[76:79], a[20:23]
ds_read_b64_tr_b16 v[116:117], v36 offset:12288
v_mfma_f32_16x16x32_bf16 a[44:47], v[44:47], v[76:79], a[44:47]
ds_read_b64_tr_b16 v[118:119], v36 offset:13824
v_mfma_f32_16x16x32_bf16 a[68:71], v[48:51], v[76:79], a[68:71]
ds_read_b64_tr_b16 v[120:121], v37 offset:12288
v_mfma_f32_16x16x32_bf16 a[92:95], v[52:55], v[76:79], a[92:95]
ds_read_b64_tr_b16 v[122:123], v37 offset:13824
s_waitcnt vmcnt(0)
s_barrier
s_waitcnt lgkmcnt(0)
v_mfma_f32_16x16x32_bf16 a[0:3], v[100:103], v[84:87], a[0:3]
s_mov_b32 s16, 1664
s_mov_b32 s17, 5111808
v_mfma_f32_16x16x32_bf16 a[24:27], v[100:103], v[88:91], a[24:27]
s_add_u32 m0, s27, 40960
s_nop 0
v_mfma_f32_16x16x32_bf16 a[48:51], v[100:103], v[92:95], a[48:51]
buffer_load_dwordx4 v10, s[4:7], s16 offen lds
s_add_u32 m0, s27, 41984
v_mfma_f32_16x16x32_bf16 a[72:75], v[100:103], v[96:99], a[72:75]
s_nop 0
buffer_load_dwordx4 v11, s[4:7], s16 offen lds
s_add_u32 m0, s27, 43008
v_mfma_f32_16x16x32_bf16 a[4:7], v[104:107], v[84:87], a[4:7]
s_nop 0
buffer_load_dwordx4 v12, s[4:7], s16 offen lds
v_mfma_f32_16x16x32_bf16 a[28:31], v[104:107], v[88:91], a[28:31]
s_add_u32 m0, s27, 44032
s_nop 0
v_mfma_f32_16x16x32_bf16 a[52:55], v[104:107], v[92:95], a[52:55]
buffer_load_dwordx4 v13, s[4:7], s16 offen lds
s_add_u32 m0, s28, 57344
s_nop 0
v_mfma_f32_16x16x32_bf16 a[76:79], v[104:107], v[96:99], a[76:79]
buffer_load_dwordx4 v14, s[8:11], s17 offen lds
s_add_u32 m0, s28, 58368
v_mfma_f32_16x16x32_bf16 a[8:11], v[108:111], v[84:87], a[8:11]
s_nop 0
buffer_load_dwordx4 v15, s[8:11], s17 offen lds
v_mfma_f32_16x16x32_bf16 a[32:35], v[108:111], v[88:91], a[32:35]
s_add_u32 m0, s28, 59392
s_nop 0
v_mfma_f32_16x16x32_bf16 a[56:59], v[108:111], v[92:95], a[56:59]
buffer_load_dwordx4 v16, s[8:11], s17 offen lds
s_add_u32 m0, s28, 60416
s_nop 0
v_mfma_f32_16x16x32_bf16 a[80:83], v[108:111], v[96:99], a[80:83]
buffer_load_dwordx4 v17, s[8:11], s17 offen lds
s_add_u32 m0, s28, 61440
v_mfma_f32_16x16x32_bf16 a[12:15], v[112:115], v[84:87], a[12:15]
s_nop 0
buffer_load_dwordx4 v18, s[8:11], s17 offen lds
v_mfma_f32_16x16x32_bf16 a[36:39], v[112:115], v[88:91], a[36:39]
s_add_u32 m0, s28, 62464
s_nop 0
buffer_load_dwordx4 v19, s[8:11], s17 offen lds
v_mfma_f32_16x16x32_bf16 a[60:63], v[112:115], v[92:95], a[60:63]
v_add_u32 v23, 0, v21
v_add_u32 v32, 0, v25
v_mfma_f32_16x16x32_bf16 a[84:87], v[112:115], v[96:99], a[84:87]
v_add_u32 v33, 0, v26
v_add_u32 v34, 0, v27
v_mfma_f32_16x16x32_bf16 a[16:19], v[84:87], v[116:119], a[16:19]
v_add_u32 v35, 0, v28
v_add_u32 v36, 0, v29
v_mfma_f32_16x16x32_bf16 a[40:43], v[88:91], v[116:119], a[40:43]
v_add_u32 v37, 0, v30
ds_read_b128 v[40:43], v23 offset:0
ds_read_b128 v[44:47], v23 offset:2048
v_mfma_f32_16x16x32_bf16 a[64:67], v[92:95], v[116:119], a[64:67]
ds_read_b128 v[48:51], v23 offset:4096
ds_read_b128 v[52:55], v23 offset:6144
v_mfma_f32_16x16x32_bf16 a[88:91], v[96:99], v[116:119], a[88:91]
ds_read_b64_tr_b16 v[56:57], v32 offset:0
ds_read_b64_tr_b16 v[58:59], v32 offset:1536
v_mfma_f32_16x16x32_bf16 a[20:23], v[84:87], v[120:123], a[20:23]
ds_read_b64_tr_b16 v[60:61], v33 offset:0
ds_read_b64_tr_b16 v[62:63], v33 offset:1536
ds_read_b64_tr_b16 v[64:65], v34 offset:0
v_mfma_f32_16x16x32_bf16 a[44:47], v[88:91], v[120:123], a[44:47]
ds_read_b64_tr_b16 v[66:67], v34 offset:1536
ds_read_b64_tr_b16 v[68:69], v35 offset:0
v_mfma_f32_16x16x32_bf16 a[68:71], v[92:95], v[120:123], a[68:71]
ds_read_b64_tr_b16 v[70:71], v35 offset:1536
ds_read_b64_tr_b16 v[72:73], v36 offset:0
v_mfma_f32_16x16x32_bf16 a[92:95], v[96:99], v[120:123], a[92:95]
ds_read_b64_tr_b16 v[74:75], v36 offset:1536
ds_read_b64_tr_b16 v[76:77], v37 offset:0
ds_read_b64_tr_b16 v[78:79], v37 offset:1536
s_waitcnt lgkmcnt(0)
v_mfma_f32_16x16x32_bf16 a[0:3], v[56:59], v[40:43], a[0:3]
v_mfma_f32_16x16x32_bf16 a[24:27], v[56:59], v[44:47], a[24:27]
v_add_u32 v23, 0, v22
v_mfma_f32_16x16x32_bf16 a[48:51], v[56:59], v[48:51], a[48:51]
v_add_u32 v32, 0, v25
v_mfma_f32_16x16x32_bf16 a[72:75], v[56:59], v[52:55], a[72:75]
v_add_u32 v33, 0, v26
v_mfma_f32_16x16x32_bf16 a[4:7], v[60:63], v[40:43], a[4:7]
v_add_u32 v34, 0, v27
v_mfma_f32_16x16x32_bf16 a[28:31], v[60:63], v[44:47], a[28:31]
v_add_u32 v35, 0, v28
v_mfma_f32_16x16x32_bf16 a[52:55], v[60:63], v[48:51], a[52:55]
v_add_u32 v36, 0, v29
v_mfma_f32_16x16x32_bf16 a[76:79], v[60:63], v[52:55], a[76:79]
v_add_u32 v37, 0, v30
v_mfma_f32_16x16x32_bf16 a[8:11], v[64:67], v[40:43], a[8:11]
ds_read_b128 v[84:87], v23 offset:0
v_mfma_f32_16x16x32_bf16 a[32:35], v[64:67], v[44:47], a[32:35]
ds_read_b128 v[88:91], v23 offset:2048
v_mfma_f32_16x16x32_bf16 a[56:59], v[64:67], v[48:51], a[56:59]
ds_read_b128 v[92:95], v23 offset:4096
v_mfma_f32_16x16x32_bf16 a[80:83], v[64:67], v[52:55], a[80:83]
ds_read_b128 v[96:99], v23 offset:6144
v_mfma_f32_16x16x32_bf16 a[12:15], v[68:71], v[40:43], a[12:15]
ds_read_b64_tr_b16 v[100:101], v32 offset:12288
v_mfma_f32_16x16x32_bf16 a[36:39], v[68:71], v[44:47], a[36:39]
ds_read_b64_tr_b16 v[102:103], v32 offset:13824
v_mfma_f32_16x16x32_bf16 a[60:63], v[68:71], v[48:51], a[60:63]
ds_read_b64_tr_b16 v[104:105], v33 offset:12288
v_mfma_f32_16x16x32_bf16 a[84:87], v[68:71], v[52:55], a[84:87]
ds_read_b64_tr_b16 v[106:107], v33 offset:13824
v_mfma_f32_16x16x32_bf16 a[16:19], v[40:43], v[72:75], a[16:19]
ds_read_b64_tr_b16 v[108:109], v34 offset:12288
v_mfma_f32_16x16x32_bf16 a[40:43], v[44:47], v[72:75], a[40:43]
ds_read_b64_tr_b16 v[110:111], v34 offset:13824
v_mfma_f32_16x16x32_bf16 a[64:67], v[48:51], v[72:75], a[64:67]
ds_read_b64_tr_b16 v[112:113], v35 offset:12288
v_mfma_f32_16x16x32_bf16 a[88:91], v[52:55], v[72:75], a[88:91]
ds_read_b64_tr_b16 v[114:115], v35 offset:13824
v_mfma_f32_16x16x32_bf16 a[20:23], v[40:43], v[76:79], a[20:23]
ds_read_b64_tr_b16 v[116:117], v36 offset:12288
v_mfma_f32_16x16x32_bf16 a[44:47], v[44:47], v[76:79], a[44:47]
ds_read_b64_tr_b16 v[118:119], v36 offset:13824
v_mfma_f32_16x16x32_bf16 a[68:71], v[48:51], v[76:79], a[68:71]
ds_read_b64_tr_b16 v[120:121], v37 offset:12288
v_mfma_f32_16x16x32_bf16 a[92:95], v[52:55], v[76:79], a[92:95]
ds_read_b64_tr_b16 v[122:123], v37 offset:13824
s_waitcnt vmcnt(0)
s_barrier
s_waitcnt lgkmcnt(0)
v_mfma_f32_16x16x32_bf16 a[0:3], v[100:103], v[84:87], a[0:3]
s_mov_b32 s16, 1792
s_mov_b32 s17, 5505024
v_mfma_f32_16x16x32_bf16 a[24:27], v[100:103], v[88:91], a[24:27]
s_add_u32 m0, s27, 81920
s_nop 0
v_mfma_f32_16x16x32_bf16 a[48:51], v[100:103], v[92:95], a[48:51]
buffer_load_dwordx4 v10, s[4:7], s16 offen lds
s_add_u32 m0, s27, 82944
v_mfma_f32_16x16x32_bf16 a[72:75], v[100:103], v[96:99], a[72:75]
s_nop 0
buffer_load_dwordx4 v11, s[4:7], s16 offen lds
s_add_u32 m0, s27, 83968
v_mfma_f32_16x16x32_bf16 a[4:7], v[104:107], v[84:87], a[4:7]
s_nop 0
buffer_load_dwordx4 v12, s[4:7], s16 offen lds
v_mfma_f32_16x16x32_bf16 a[28:31], v[104:107], v[88:91], a[28:31]
s_add_u32 m0, s27, 84992
s_nop 0
v_mfma_f32_16x16x32_bf16 a[52:55], v[104:107], v[92:95], a[52:55]
buffer_load_dwordx4 v13, s[4:7], s16 offen lds
s_add_u32 m0, s28, 98304
s_nop 0
v_mfma_f32_16x16x32_bf16 a[76:79], v[104:107], v[96:99], a[76:79]
buffer_load_dwordx4 v14, s[8:11], s17 offen lds
s_add_u32 m0, s28, 99328
v_mfma_f32_16x16x32_bf16 a[8:11], v[108:111], v[84:87], a[8:11]
s_nop 0
buffer_load_dwordx4 v15, s[8:11], s17 offen lds
v_mfma_f32_16x16x32_bf16 a[32:35], v[108:111], v[88:91], a[32:35]
s_add_u32 m0, s28, 100352
s_nop 0
v_mfma_f32_16x16x32_bf16 a[56:59], v[108:111], v[92:95], a[56:59]
buffer_load_dwordx4 v16, s[8:11], s17 offen lds
s_add_u32 m0, s28, 101376
s_nop 0
v_mfma_f32_16x16x32_bf16 a[80:83], v[108:111], v[96:99], a[80:83]
buffer_load_dwordx4 v17, s[8:11], s17 offen lds
s_add_u32 m0, s28, 102400
v_mfma_f32_16x16x32_bf16 a[12:15], v[112:115], v[84:87], a[12:15]
s_nop 0
buffer_load_dwordx4 v18, s[8:11], s17 offen lds
v_mfma_f32_16x16x32_bf16 a[36:39], v[112:115], v[88:91], a[36:39]
s_add_u32 m0, s28, 103424
s_nop 0
buffer_load_dwordx4 v19, s[8:11], s17 offen lds
v_mfma_f32_16x16x32_bf16 a[60:63], v[112:115], v[92:95], a[60:63]
v_add_u32 v23, 40960, v21
v_add_u32 v32, 40960, v25
v_mfma_f32_16x16x32_bf16 a[84:87], v[112:115], v[96:99], a[84:87]
v_add_u32 v33, 40960, v26
v_add_u32 v34, 40960, v27
v_mfma_f32_16x16x32_bf16 a[16:19], v[84:87], v[116:119], a[16:19]
v_add_u32 v35, 40960, v28
v_add_u32 v36, 40960, v29
v_mfma_f32_16x16x32_bf16 a[40:43], v[88:91], v[116:119], a[40:43]
v_add_u32 v37, 40960, v30
ds_read_b128 v[40:43], v23 offset:0
ds_read_b128 v[44:47], v23 offset:2048
v_mfma_f32_16x16x32_bf16 a[64:67], v[92:95], v[116:119], a[64:67]
ds_read_b128 v[48:51], v23 offset:4096
ds_read_b128 v[52:55], v23 offset:6144
v_mfma_f32_16x16x32_bf16 a[88:91], v[96:99], v[116:119], a[88:91]
ds_read_b64_tr_b16 v[56:57], v32 offset:0
ds_read_b64_tr_b16 v[58:59], v32 offset:1536
v_mfma_f32_16x16x32_bf16 a[20:23], v[84:87], v[120:123], a[20:23]
ds_read_b64_tr_b16 v[60:61], v33 offset:0
ds_read_b64_tr_b16 v[62:63], v33 offset:1536
ds_read_b64_tr_b16 v[64:65], v34 offset:0
v_mfma_f32_16x16x32_bf16 a[44:47], v[88:91], v[120:123], a[44:47]
ds_read_b64_tr_b16 v[66:67], v34 offset:1536
ds_read_b64_tr_b16 v[68:69], v35 offset:0
v_mfma_f32_16x16x32_bf16 a[68:71], v[92:95], v[120:123], a[68:71]
ds_read_b64_tr_b16 v[70:71], v35 offset:1536
ds_read_b64_tr_b16 v[72:73], v36 offset:0
v_mfma_f32_16x16x32_bf16 a[92:95], v[96:99], v[120:123], a[92:95]
ds_read_b64_tr_b16 v[74:75], v36 offset:1536
ds_read_b64_tr_b16 v[76:77], v37 offset:0
ds_read_b64_tr_b16 v[78:79], v37 offset:1536
s_waitcnt lgkmcnt(0)
v_mfma_f32_16x16x32_bf16 a[0:3], v[56:59], v[40:43], a[0:3]
v_mfma_f32_16x16x32_bf16 a[24:27], v[56:59], v[44:47], a[24:27]
v_add_u32 v23, 40960, v22
v_mfma_f32_16x16x32_bf16 a[48:51], v[56:59], v[48:51], a[48:51]
v_add_u32 v32, 40960, v25
v_mfma_f32_16x16x32_bf16 a[72:75], v[56:59], v[52:55], a[72:75]
v_add_u32 v33, 40960, v26
v_mfma_f32_16x16x32_bf16 a[4:7], v[60:63], v[40:43], a[4:7]
v_add_u32 v34, 40960, v27
v_mfma_f32_16x16x32_bf16 a[28:31], v[60:63], v[44:47], a[28:31]
v_add_u32 v35, 40960, v28
v_mfma_f32_16x16x32_bf16 a[52:55], v[60:63], v[48:51], a[52:55]
v_add_u32 v36, 40960, v29
v_mfma_f32_16x16x32_bf16 a[76:79], v[60:63], v[52:55], a[76:79]
v_add_u32 v37, 40960, v30
v_mfma_f32_16x16x32_bf16 a[8:11], v[64:67], v[40:43], a[8:11]
ds_read_b128 v[84:87], v23 offset:0
v_mfma_f32_16x16x32_bf16 a[32:35], v[64:67], v[44:47], a[32:35]
ds_read_b128 v[88:91], v23 offset:2048
v_mfma_f32_16x16x32_bf16 a[56:59], v[64:67], v[48:51], a[56:59]
ds_read_b128 v[92:95], v23 offset:4096
v_mfma_f32_16x16x32_bf16 a[80:83], v[64:67], v[52:55], a[80:83]
ds_read_b128 v[96:99], v23 offset:6144
v_mfma_f32_16x16x32_bf16 a[12:15], v[68:71], v[40:43], a[12:15]
ds_read_b64_tr_b16 v[100:101], v32 offset:12288
v_mfma_f32_16x16x32_bf16 a[36:39], v[68:71], v[44:47], a[36:39]
ds_read_b64_tr_b16 v[102:103], v32 offset:13824
v_mfma_f32_16x16x32_bf16 a[60:63], v[68:71], v[48:51], a[60:63]
ds_read_b64_tr_b16 v[104:105], v33 offset:12288
v_mfma_f32_16x16x32_bf16 a[84:87], v[68:71], v[52:55], a[84:87]
ds_read_b64_tr_b16 v[106:107], v33 offset:13824
v_mfma_f32_16x16x32_bf16 a[16:19], v[40:43], v[72:75], a[16:19]
ds_read_b64_tr_b16 v[108:109], v34 offset:12288
v_mfma_f32_16x16x32_bf16 a[40:43], v[44:47], v[72:75], a[40:43]
ds_read_b64_tr_b16 v[110:111], v34 offset:13824
v_mfma_f32_16x16x32_bf16 a[64:67], v[48:51], v[72:75], a[64:67]
ds_read_b64_tr_b16 v[112:113], v35 offset:12288
v_mfma_f32_16x16x32_bf16 a[88:91], v[52:55], v[72:75], a[88:91]
ds_read_b64_tr_b16 v[114:115], v35 offset:13824
v_mfma_f32_16x16x32_bf16 a[20:23], v[40:43], v[76:79], a[20:23]
ds_read_b64_tr_b16 v[116:117], v36 offset:12288
v_mfma_f32_16x16x32_bf16 a[44:47], v[44:47], v[76:79], a[44:47]
ds_read_b64_tr_b16 v[118:119], v36 offset:13824
v_mfma_f32_16x16x32_bf16 a[68:71], v[48:51], v[76:79], a[68:71]
ds_read_b64_tr_b16 v[120:121], v37 offset:12288
v_mfma_f32_16x16x32_bf16 a[92:95], v[52:55], v[76:79], a[92:95]
ds_read_b64_tr_b16 v[122:123], v37 offset:13824
s_waitcnt vmcnt(0)
s_barrier
s_waitcnt lgkmcnt(0)
v_mfma_f32_16x16x32_bf16 a[0:3], v[100:103], v[84:87], a[0:3]
s_mov_b32 s16, 1920
s_mov_b32 s17, 5898240
v_mfma_f32_16x16x32_bf16 a[24:27], v[100:103], v[88:91], a[24:27]
s_add_u32 m0, s27, 0
s_nop 0
v_mfma_f32_16x16x32_bf16 a[48:51], v[100:103], v[92:95], a[48:51]
buffer_load_dwordx4 v10, s[4:7], s16 offen lds
s_add_u32 m0, s27, 1024
v_mfma_f32_16x16x32_bf16 a[72:75], v[100:103], v[96:99], a[72:75]
s_nop 0
buffer_load_dwordx4 v11, s[4:7], s16 offen lds
s_add_u32 m0, s27, 2048
v_mfma_f32_16x16x32_bf16 a[4:7], v[104:107], v[84:87], a[4:7]
s_nop 0
buffer_load_dwordx4 v12, s[4:7], s16 offen lds
v_mfma_f32_16x16x32_bf16 a[28:31], v[104:107], v[88:91], a[28:31]
s_add_u32 m0, s27, 3072
s_nop 0
v_mfma_f32_16x16x32_bf16 a[52:55], v[104:107], v[92:95], a[52:55]
buffer_load_dwordx4 v13, s[4:7], s16 offen lds
s_add_u32 m0, s28, 16384
s_nop 0
v_mfma_f32_16x16x32_bf16 a[76:79], v[104:107], v[96:99], a[76:79]
buffer_load_dwordx4 v14, s[8:11], s17 offen lds
s_add_u32 m0, s28, 17408
v_mfma_f32_16x16x32_bf16 a[8:11], v[108:111], v[84:87], a[8:11]
s_nop 0
buffer_load_dwordx4 v15, s[8:11], s17 offen lds
v_mfma_f32_16x16x32_bf16 a[32:35], v[108:111], v[88:91], a[32:35]
s_add_u32 m0, s28, 18432
s_nop 0
v_mfma_f32_16x16x32_bf16 a[56:59], v[108:111], v[92:95], a[56:59]
buffer_load_dwordx4 v16, s[8:11], s17 offen lds
s_add_u32 m0, s28, 19456
s_nop 0
v_mfma_f32_16x16x32_bf16 a[80:83], v[108:111], v[96:99], a[80:83]
buffer_load_dwordx4 v17, s[8:11], s17 offen lds
s_add_u32 m0, s28, 20480
v_mfma_f32_16x16x32_bf16 a[12:15], v[112:115], v[84:87], a[12:15]
s_nop 0
buffer_load_dwordx4 v18, s[8:11], s17 offen lds
v_mfma_f32_16x16x32_bf16 a[36:39], v[112:115], v[88:91], a[36:39]
s_add_u32 m0, s28, 21504
s_nop 0
buffer_load_dwordx4 v19, s[8:11], s17 offen lds
v_mfma_f32_16x16x32_bf16 a[60:63], v[112:115], v[92:95], a[60:63]
v_add_u32 v23, 81920, v21
v_add_u32 v32, 81920, v25
v_mfma_f32_16x16x32_bf16 a[84:87], v[112:115], v[96:99], a[84:87]
v_add_u32 v33, 81920, v26
v_add_u32 v34, 81920, v27
v_mfma_f32_16x16x32_bf16 a[16:19], v[84:87], v[116:119], a[16:19]
v_add_u32 v35, 81920, v28
v_add_u32 v36, 81920, v29
v_mfma_f32_16x16x32_bf16 a[40:43], v[88:91], v[116:119], a[40:43]
v_add_u32 v37, 81920, v30
ds_read_b128 v[40:43], v23 offset:0
ds_read_b128 v[44:47], v23 offset:2048
v_mfma_f32_16x16x32_bf16 a[64:67], v[92:95], v[116:119], a[64:67]
ds_read_b128 v[48:51], v23 offset:4096
ds_read_b128 v[52:55], v23 offset:6144
v_mfma_f32_16x16x32_bf16 a[88:91], v[96:99], v[116:119], a[88:91]
ds_read_b64_tr_b16 v[56:57], v32 offset:0
ds_read_b64_tr_b16 v[58:59], v32 offset:1536
v_mfma_f32_16x16x32_bf16 a[20:23], v[84:87], v[120:123], a[20:23]
ds_read_b64_tr_b16 v[60:61], v33 offset:0
ds_read_b64_tr_b16 v[62:63], v33 offset:1536
ds_read_b64_tr_b16 v[64:65], v34 offset:0
v_mfma_f32_16x16x32_bf16 a[44:47], v[88:91], v[120:123], a[44:47]
ds_read_b64_tr_b16 v[66:67], v34 offset:1536
ds_read_b64_tr_b16 v[68:69], v35 offset:0
v_mfma_f32_16x16x32_bf16 a[68:71], v[92:95], v[120:123], a[68:71]
ds_read_b64_tr_b16 v[70:71], v35 offset:1536
ds_read_b64_tr_b16 v[72:73], v36 offset:0
v_mfma_f32_16x16x32_bf16 a[92:95], v[96:99], v[120:123], a[92:95]
ds_read_b64_tr_b16 v[74:75], v36 offset:1536
ds_read_b64_tr_b16 v[76:77], v37 offset:0
ds_read_b64_tr_b16 v[78:79], v37 offset:1536
s_waitcnt lgkmcnt(0)
v_mfma_f32_16x16x32_bf16 a[0:3], v[56:59], v[40:43], a[0:3]
v_mfma_f32_16x16x32_bf16 a[24:27], v[56:59], v[44:47], a[24:27]
v_add_u32 v23, 81920, v22
v_mfma_f32_16x16x32_bf16 a[48:51], v[56:59], v[48:51], a[48:51]
v_add_u32 v32, 81920, v25
v_mfma_f32_16x16x32_bf16 a[72:75], v[56:59], v[52:55], a[72:75]
v_add_u32 v33, 81920, v26
v_mfma_f32_16x16x32_bf16 a[4:7], v[60:63], v[40:43], a[4:7]
v_add_u32 v34, 81920, v27
v_mfma_f32_16x16x32_bf16 a[28:31], v[60:63], v[44:47], a[28:31]
v_add_u32 v35, 81920, v28
v_mfma_f32_16x16x32_bf16 a[52:55], v[60:63], v[48:51], a[52:55]
v_add_u32 v36, 81920, v29
v_mfma_f32_16x16x32_bf16 a[76:79], v[60:63], v[52:55], a[76:79]
v_add_u32 v37, 81920, v30
v_mfma_f32_16x16x32_bf16 a[8:11], v[64:67], v[40:43], a[8:11]
ds_read_b128 v[84:87], v23 offset:0
v_mfma_f32_16x16x32_bf16 a[32:35], v[64:67], v[44:47], a[32:35]
ds_read_b128 v[88:91], v23 offset:2048
v_mfma_f32_16x16x32_bf16 a[56:59], v[64:67], v[48:51], a[56:59]
ds_read_b128 v[92:95], v23 offset:4096
v_mfma_f32_16x16x32_bf16 a[80:83], v[64:67], v[52:55], a[80:83]
ds_read_b128 v[96:99], v23 offset:6144
v_mfma_f32_16x16x32_bf16 a[12:15], v[68:71], v[40:43], a[12:15]
ds_read_b64_tr_b16 v[100:101], v32 offset:12288
v_mfma_f32_16x16x32_bf16 a[36:39], v[68:71], v[44:47], a[36:39]
ds_read_b64_tr_b16 v[102:103], v32 offset:13824
v_mfma_f32_16x16x32_bf16 a[60:63], v[68:71], v[48:51], a[60:63]
ds_read_b64_tr_b16 v[104:105], v33 offset:12288
v_mfma_f32_16x16x32_bf16 a[84:87], v[68:71], v[52:55], a[84:87]
ds_read_b64_tr_b16 v[106:107], v33 offset:13824
v_mfma_f32_16x16x32_bf16 a[16:19], v[40:43], v[72:75], a[16:19]
ds_read_b64_tr_b16 v[108:109], v34 offset:12288
v_mfma_f32_16x16x32_bf16 a[40:43], v[44:47], v[72:75], a[40:43]
ds_read_b64_tr_b16 v[110:111], v34 offset:13824
v_mfma_f32_16x16x32_bf16 a[64:67], v[48:51], v[72:75], a[64:67]
ds_read_b64_tr_b16 v[112:113], v35 offset:12288
v_mfma_f32_16x16x32_bf16 a[88:91], v[52:55], v[72:75], a[88:91]
ds_read_b64_tr_b16 v[114:115], v35 offset:13824
v_mfma_f32_16x16x32_bf16 a[20:23], v[40:43], v[76:79], a[20:23]
ds_read_b64_tr_b16 v[116:117], v36 offset:12288
v_mfma_f32_16x16x32_bf16 a[44:47], v[44:47], v[76:79], a[44:47]
ds_read_b64_tr_b16 v[118:119], v36 offset:13824
v_mfma_f32_16x16x32_bf16 a[68:71], v[48:51], v[76:79], a[68:71]
ds_read_b64_tr_b16 v[120:121], v37 offset:12288
v_mfma_f32_16x16x32_bf16 a[92:95], v[52:55], v[76:79], a[92:95]
ds_read_b64_tr_b16 v[122:123], v37 offset:13824
s_waitcnt vmcnt(0)
s_barrier
s_waitcnt lgkmcnt(0)
v_mfma_f32_16x16x32_bf16 a[0:3], v[100:103], v[84:87], a[0:3]
v_mfma_f32_16x16x32_bf16 a[24:27], v[100:103], v[88:91], a[24:27]
v_add_u32 v23, 0, v21
v_mfma_f32_16x16x32_bf16 a[48:51], v[100:103], v[92:95], a[48:51]
v_add_u32 v32, 0, v25
v_mfma_f32_16x16x32_bf16 a[72:75], v[100:103], v[96:99], a[72:75]
v_add_u32 v33, 0, v26
v_mfma_f32_16x16x32_bf16 a[4:7], v[104:107], v[84:87], a[4:7]
v_add_u32 v34, 0, v27
v_mfma_f32_16x16x32_bf16 a[28:31], v[104:107], v[88:91], a[28:31]
v_add_u32 v35, 0, v28
v_mfma_f32_16x16x32_bf16 a[52:55], v[104:107], v[92:95], a[52:55]
v_add_u32 v36, 0, v29
v_mfma_f32_16x16x32_bf16 a[76:79], v[104:107], v[96:99], a[76:79]
v_add_u32 v37, 0, v30
v_mfma_f32_16x16x32_bf16 a[8:11], v[108:111], v[84:87], a[8:11]
ds_read_b128 v[40:43], v23 offset:0
v_mfma_f32_16x16x32_bf16 a[32:35], v[108:111], v[88:91], a[32:35]
ds_read_b128 v[44:47], v23 offset:2048
v_mfma_f32_16x16x32_bf16 a[56:59], v[108:111], v[92:95], a[56:59]
ds_read_b128 v[48:51], v23 offset:4096
v_mfma_f32_16x16x32_bf16 a[80:83], v[108:111], v[96:99], a[80:83]
ds_read_b128 v[52:55], v23 offset:6144
v_mfma_f32_16x16x32_bf16 a[12:15], v[112:115], v[84:87], a[12:15]
ds_read_b64_tr_b16 v[56:57], v32 offset:0
v_mfma_f32_16x16x32_bf16 a[36:39], v[112:115], v[88:91], a[36:39]
ds_read_b64_tr_b16 v[58:59], v32 offset:1536
v_mfma_f32_16x16x32_bf16 a[60:63], v[112:115], v[92:95], a[60:63]
ds_read_b64_tr_b16 v[60:61], v33 offset:0
v_mfma_f32_16x16x32_bf16 a[84:87], v[112:115], v[96:99], a[84:87]
ds_read_b64_tr_b16 v[62:63], v33 offset:1536
v_mfma_f32_16x16x32_bf16 a[16:19], v[84:87], v[116:119], a[16:19]
ds_read_b64_tr_b16 v[64:65], v34 offset:0
v_mfma_f32_16x16x32_bf16 a[40:43], v[88:91], v[116:119], a[40:43]
ds_read_b64_tr_b16 v[66:67], v34 offset:1536
v_mfma_f32_16x16x32_bf16 a[64:67], v[92:95], v[116:119], a[64:67]
ds_read_b64_tr_b16 v[68:69], v35 offset:0
v_mfma_f32_16x16x32_bf16 a[88:91], v[96:99], v[116:119], a[88:91]
ds_read_b64_tr_b16 v[70:71], v35 offset:1536
v_mfma_f32_16x16x32_bf16 a[20:23], v[84:87], v[120:123], a[20:23]
ds_read_b64_tr_b16 v[72:73], v36 offset:0
v_mfma_f32_16x16x32_bf16 a[44:47], v[88:91], v[120:123], a[44:47]
ds_read_b64_tr_b16 v[74:75], v36 offset:1536
v_mfma_f32_16x16x32_bf16 a[68:71], v[92:95], v[120:123], a[68:71]
ds_read_b64_tr_b16 v[76:77], v37 offset:0
v_mfma_f32_16x16x32_bf16 a[92:95], v[96:99], v[120:123], a[92:95]
ds_read_b64_tr_b16 v[78:79], v37 offset:1536
s_waitcnt lgkmcnt(0)
v_mfma_f32_16x16x32_bf16 a[0:3], v[56:59], v[40:43], a[0:3]
v_mfma_f32_16x16x32_bf16 a[24:27], v[56:59], v[44:47], a[24:27]
v_add_u32 v23, 0, v22
v_mfma_f32_16x16x32_bf16 a[48:51], v[56:59], v[48:51], a[48:51]
v_add_u32 v32, 0, v25
v_mfma_f32_16x16x32_bf16 a[72:75], v[56:59], v[52:55], a[72:75]
v_add_u32 v33, 0, v26
v_mfma_f32_16x16x32_bf16 a[4:7], v[60:63], v[40:43], a[4:7]
v_add_u32 v34, 0, v27
v_mfma_f32_16x16x32_bf16 a[28:31], v[60:63], v[44:47], a[28:31]
v_add_u32 v35, 0, v28
v_mfma_f32_16x16x32_bf16 a[52:55], v[60:63], v[48:51], a[52:55]
v_add_u32 v36, 0, v29
v_mfma_f32_16x16x32_bf16 a[76:79], v[60:63], v[52:55], a[76:79]
v_add_u32 v37, 0, v30
v_mfma_f32_16x16x32_bf16 a[8:11], v[64:67], v[40:43], a[8:11]
ds_read_b128 v[84:87], v23 offset:0
v_mfma_f32_16x16x32_bf16 a[32:35], v[64:67], v[44:47], a[32:35]
ds_read_b128 v[88:91], v23 offset:2048
v_mfma_f32_16x16x32_bf16 a[56:59], v[64:67], v[48:51], a[56:59]
ds_read_b128 v[92:95], v23 offset:4096
v_mfma_f32_16x16x32_bf16 a[80:83], v[64:67], v[52:55], a[80:83]
ds_read_b128 v[96:99], v23 offset:6144
v_mfma_f32_16x16x32_bf16 a[12:15], v[68:71], v[40:43], a[12:15]
ds_read_b64_tr_b16 v[100:101], v32 offset:12288
v_mfma_f32_16x16x32_bf16 a[36:39], v[68:71], v[44:47], a[36:39]
ds_read_b64_tr_b16 v[102:103], v32 offset:13824
v_mfma_f32_16x16x32_bf16 a[60:63], v[68:71], v[48:51], a[60:63]
ds_read_b64_tr_b16 v[104:105], v33 offset:12288
v_mfma_f32_16x16x32_bf16 a[84:87], v[68:71], v[52:55], a[84:87]
ds_read_b64_tr_b16 v[106:107], v33 offset:13824
v_mfma_f32_16x16x32_bf16 a[16:19], v[40:43], v[72:75], a[16:19]
ds_read_b64_tr_b16 v[108:109], v34 offset:12288
v_mfma_f32_16x16x32_bf16 a[40:43], v[44:47], v[72:75], a[40:43]
ds_read_b64_tr_b16 v[110:111], v34 offset:13824
v_mfma_f32_16x16x32_bf16 a[64:67], v[48:51], v[72:75], a[64:67]
ds_read_b64_tr_b16 v[112:113], v35 offset:12288
v_mfma_f32_16x16x32_bf16 a[88:91], v[52:55], v[72:75], a[88:91]
ds_read_b64_tr_b16 v[114:115], v35 offset:13824
v_mfma_f32_16x16x32_bf16 a[20:23], v[40:43], v[76:79], a[20:23]
ds_read_b64_tr_b16 v[116:117], v36 offset:12288
v_mfma_f32_16x16x32_bf16 a[44:47], v[44:47], v[76:79], a[44:47]
ds_read_b64_tr_b16 v[118:119], v36 offset:13824
v_mfma_f32_16x16x32_bf16 a[68:71], v[48:51], v[76:79], a[68:71]
ds_read_b64_tr_b16 v[120:121], v37 offset:12288
v_mfma_f32_16x16x32_bf16 a[92:95], v[52:55], v[76:79], a[92:95]
ds_read_b64_tr_b16 v[122:123], v37 offset:13824
s_waitcnt vmcnt(0)
s_barrier
s_waitcnt lgkmcnt(0)
v_mfma_f32_16x16x32_bf16 a[0:3], v[100:103], v[84:87], a[0:3]
v_mfma_f32_16x16x32_bf16 a[24:27], v[100:103], v[88:91], a[24:27]
v_add_u32 v23, 40960, v21
v_mfma_f32_16x16x32_bf16 a[48:51], v[100:103], v[92:95], a[48:51]
v_add_u32 v32, 40960, v25
v_mfma_f32_16x16x32_bf16 a[72:75], v[100:103], v[96:99], a[72:75]
v_add_u32 v33, 40960, v26
v_mfma_f32_16x16x32_bf16 a[4:7], v[104:107], v[84:87], a[4:7]
v_add_u32 v34, 40960, v27
v_mfma_f32_16x16x32_bf16 a[28:31], v[104:107], v[88:91], a[28:31]
v_add_u32 v35, 40960, v28
v_mfma_f32_16x16x32_bf16 a[52:55], v[104:107], v[92:95], a[52:55]
v_add_u32 v36, 40960, v29
v_mfma_f32_16x16x32_bf16 a[76:79], v[104:107], v[96:99], a[76:79]
v_add_u32 v37, 40960, v30
v_mfma_f32_16x16x32_bf16 a[8:11], v[108:111], v[84:87], a[8:11]
ds_read_b128 v[40:43], v23 offset:0
v_mfma_f32_16x16x32_bf16 a[32:35], v[108:111], v[88:91], a[32:35]
ds_read_b128 v[44:47], v23 offset:2048
v_mfma_f32_16x16x32_bf16 a[56:59], v[108:111], v[92:95], a[56:59]
ds_read_b128 v[48:51], v23 offset:4096
v_mfma_f32_16x16x32_bf16 a[80:83], v[108:111], v[96:99], a[80:83]
ds_read_b128 v[52:55], v23 offset:6144
v_mfma_f32_16x16x32_bf16 a[12:15], v[112:115], v[84:87], a[12:15]
ds_read_b64_tr_b16 v[56:57], v32 offset:0
v_mfma_f32_16x16x32_bf16 a[36:39], v[112:115], v[88:91], a[36:39]
ds_read_b64_tr_b16 v[58:59], v32 offset:1536
v_mfma_f32_16x16x32_bf16 a[60:63], v[112:115], v[92:95], a[60:63]
ds_read_b64_tr_b16 v[60:61], v33 offset:0
v_mfma_f32_16x16x32_bf16 a[84:87], v[112:115], v[96:99], a[84:87]
ds_read_b64_tr_b16 v[62:63], v33 offset:1536
v_mfma_f32_16x16x32_bf16 a[16:19], v[84:87], v[116:119], a[16:19]
ds_read_b64_tr_b16 v[64:65], v34 offset:0
v_mfma_f32_16x16x32_bf16 a[40:43], v[88:91], v[116:119], a[40:43]
ds_read_b64_tr_b16 v[66:67], v34 offset:1536
v_mfma_f32_16x16x32_bf16 a[64:67], v[92:95], v[116:119], a[64:67]
ds_read_b64_tr_b16 v[68:69], v35 offset:0
v_mfma_f32_16x16x32_bf16 a[88:91], v[96:99], v[116:119], a[88:91]
ds_read_b64_tr_b16 v[70:71], v35 offset:1536
v_mfma_f32_16x16x32_bf16 a[20:23], v[84:87], v[120:123], a[20:23]
ds_read_b64_tr_b16 v[72:73], v36 offset:0
v_mfma_f32_16x16x32_bf16 a[44:47], v[88:91], v[120:123], a[44:47]
ds_read_b64_tr_b16 v[74:75], v36 offset:1536
v_mfma_f32_16x16x32_bf16 a[68:71], v[92:95], v[120:123], a[68:71]
ds_read_b64_tr_b16 v[76:77], v37 offset:0
v_mfma_f32_16x16x32_bf16 a[92:95], v[96:99], v[120:123], a[92:95]
ds_read_b64_tr_b16 v[78:79], v37 offset:1536
s_waitcnt vmcnt(0) lgkmcnt(0)
s_nop 15
s_nop 7
v_and_b32 v4, 15, v1
v_lshrrev_b32 v5, 4, v1
v_lshrrev_b32 v6, 1, v2
v_and_b32 v7, 1, v2
v_lshl_add_u32 v8, v6, 6, v4
s_lshl_b32 s25, s22, 7
v_add_u32 v9, s25, v8
v_xor_b32 v60, 16, v1
v_lshlrev_b32 v60, 2, v60
v_xor_b32 v61, 32, v1
v_lshlrev_b32 v61, 2, v61
v_lshlrev_b32 v3, 3, v8
v_add_u32 v3, 122880, v3
ds_read_b64 v[64:65], v3 offset:0
ds_read_b64 v[66:67], v3 offset:128
ds_read_b64 v[68:69], v3 offset:256
ds_read_b64 v[70:71], v3 offset:384
s_load_dwordx2 s[4:5], s[0:1], 88
s_load_dwordx2 s[8:9], s[0:1], 16
s_load_dwordx2 s[12:13], s[0:1], 88
s_load_dwordx2 s[16:17], s[0:1], 88
s_waitcnt lgkmcnt(0)
s_add_u32 s4, s4, 54525952
s_addc_u32 s5, s5, 0
s_mov_b32 s6, 122880
s_mov_b32 s7, 0x00020000
s_mov_b32 s10, 65536
s_mov_b32 s11, 0x00020000
s_add_u32 s12, s12, 4194304
s_addc_u32 s13, s13, 0
s_mov_b32 s14, 8388608
s_mov_b32 s15, 0x00020000
s_add_u32 s16, s16, 41943040
s_addc_u32 s17, s17, 0
s_mov_b32 s18, 8650752
s_mov_b32 s19, 0x00020000
s_lshl_b32 s25, s23, 1
v_add_u32 v10, s25, v7
v_lshlrev_b32 v11, 5, v10
v_lshl_add_u32 v12, v5, 2, v11
v_lshlrev_b32 v12, 2, v12
buffer_load_dwordx4 v[72:75], v12, s[4:7], 0 offen offset:0
buffer_load_dwordx4 v[76:79], v12, s[4:7], 0 offen offset:64
v_add_u32 v13, 4096, v12
buffer_load_dwordx4 v[80:83], v13, s[4:7], 0 offen offset:0
buffer_load_dwordx4 v[84:87], v13, s[4:7], 0 offen offset:64
v_add_u32 v14, v11, v4
v_lshlrev_b32 v14, 2, v14
v_add_u32 v14, 8192, v14
buffer_load_dword v88, v14, s[4:7], 0 offen
buffer_load_dword v89, v14, s[4:7], 0 offen offset:64
v_add_u32 v17, 30720, v12
v_add_u32 v18, 30720, v13
v_add_u32 v19, 30720, v14
buffer_load_dwordx4 v[200:203], v17, s[4:7], 0 offen offset:0
buffer_load_dwordx4 v[204:207], v17, s[4:7], 0 offen offset:64
buffer_load_dwordx4 v[208:211], v18, s[4:7], 0 offen offset:0
buffer_load_dwordx4 v[212:215], v18, s[4:7], 0 offen offset:64
buffer_load_dword v216, v19, s[4:7], 0 offen
buffer_load_dword v217, v19, s[4:7], 0 offen offset:64
v_add_u32 v17, 61440, v12
v_add_u32 v18, 61440, v13
v_add_u32 v19, 61440, v14
buffer_load_dwordx4 v[218:221], v17, s[4:7], 0 offen offset:0
buffer_load_dwordx4 v[222:225], v17, s[4:7], 0 offen offset:64
buffer_load_dwordx4 v[226:229], v18, s[4:7], 0 offen offset:0
buffer_load_dwordx4 v[230:233], v18, s[4:7], 0 offen offset:64
buffer_load_dword v234, v19, s[4:7], 0 offen
buffer_load_dword v235, v19, s[4:7], 0 offen offset:64
v_add_u32 v17, 92160, v12
v_add_u32 v18, 92160, v13
v_add_u32 v19, 92160, v14
buffer_load_dwordx4 v[236:239], v17, s[4:7], 0 offen offset:0
buffer_load_dwordx4 v[240:243], v17, s[4:7], 0 offen offset:64
buffer_load_dwordx4 v[244:247], v18, s[4:7], 0 offen offset:0
buffer_load_dwordx4 v[248:251], v18, s[4:7], 0 offen offset:64
buffer_load_dword v252, v19, s[4:7], 0 offen
buffer_load_dword v253, v19, s[4:7], 0 offen offset:64
s_waitcnt vmcnt(0)
v_add_f32 v72, v72, v200
v_add_f32 v73, v73, v201
v_add_f32 v74, v74, v202
v_add_f32 v75, v75, v203
v_add_f32 v76, v76, v204
v_add_f32 v77, v77, v205
v_add_f32 v78, v78, v206
v_add_f32 v79, v79, v207
v_add_f32 v80, v80, v208
v_add_f32 v81, v81, v209
v_add_f32 v82, v82, v210
v_add_f32 v83, v83, v211
v_add_f32 v84, v84, v212
v_add_f32 v85, v85, v213
v_add_f32 v86, v86, v214
v_add_f32 v87, v87, v215
v_add_f32 v88, v88, v216
v_add_f32 v89, v89, v217
v_add_f32 v72, v72, v218
v_add_f32 v73, v73, v219
v_add_f32 v74, v74, v220
v_add_f32 v75, v75, v221
v_add_f32 v76, v76, v222
v_add_f32 v77, v77, v223
v_add_f32 v78, v78, v224
v_add_f32 v79, v79, v225
v_add_f32 v80, v80, v226
v_add_f32 v81, v81, v227
v_add_f32 v82, v82, v228
v_add_f32 v83, v83, v229
v_add_f32 v84, v84, v230
v_add_f32 v85, v85, v231
v_add_f32 v86, v86, v232
v_add_f32 v87, v87, v233
v_add_f32 v88, v88, v234
v_add_f32 v89, v89, v235
v_add_f32 v72, v72, v236
v_add_f32 v73, v73, v237
v_add_f32 v74, v74, v238
v_add_f32 v75, v75, v239
v_add_f32 v76, v76, v240
v_add_f32 v77, v77, v241
v_add_f32 v78, v78, v242
v_add_f32 v79, v79, v243
v_add_f32 v80, v80, v244
v_add_f32 v81, v81, v245
v_add_f32 v82, v82, v246
v_add_f32 v83, v83, v247
v_add_f32 v84, v84, v248
v_add_f32 v85, v85, v249
v_add_f32 v86, v86, v250
v_add_f32 v87, v87, v251
v_add_f32 v88, v88, v252
v_add_f32 v89, v89, v253
v_lshl_add_u32 v15, v6, 6, 0
v_lshl_add_u32 v15, v5, 2, v15
v_lshlrev_b32 v15, 3, v15
v_add_u32 v15, 122880, v15
v_lshlrev_b32 v16, 11, v10
v_lshl_add_u32 v16, v5, 8, v16
v_lshl_add_u32 v16, v4, 1, v16
buffer_load_ushort v128, v16, s[8:11], 0 offen offset:0
buffer_load_ushort v129, v16, s[8:11], 0 offen offset:64
buffer_load_ushort v130, v16, s[8:11], 0 offen offset:128
buffer_load_ushort v131, v16, s[8:11], 0 offen offset:192
buffer_load_ushort v132, v16, s[8:11], 0 offen offset:1024
buffer_load_ushort v133, v16, s[8:11], 0 offen offset:1088
buffer_load_ushort v134, v16, s[8:11], 0 offen offset:1152
buffer_load_ushort v135, v16, s[8:11], 0 offen offset:1216
buffer_load_ushort v136, v16, s[8:11], 0 offen offset:32
buffer_load_ushort v137, v16, s[8:11], 0 offen offset:96
buffer_load_ushort v138, v16, s[8:11], 0 offen offset:160
buffer_load_ushort v139, v16, s[8:11], 0 offen offset:224
buffer_load_ushort v140, v16, s[8:11], 0 offen offset:1056
buffer_load_ushort v141, v16, s[8:11], 0 offen offset:1120
buffer_load_ushort v142, v16, s[8:11], 0 offen offset:1184
buffer_load_ushort v143, v16, s[8:11], 0 offen offset:1248
s_waitcnt vmcnt(0)
v_lshl_or_b32 v90, v129, 16, v128
v_lshl_or_b32 v91, v131, 16, v130
v_lshl_or_b32 v92, v133, 16, v132
v_lshl_or_b32 v93, v135, 16, v134
v_lshl_or_b32 v94, v137, 16, v136
v_lshl_or_b32 v95, v139, 16, v138
v_lshl_or_b32 v96, v141, 16, v140
v_lshl_or_b32 v97, v143, 16, v142
v_mov_b32 v98, 0x3f803f80
v_mov_b32 v99, 0x3f803f80
v_accvgpr_write_b32 a112, 0
v_accvgpr_write_b32 a113, 0
v_accvgpr_write_b32 a114, 0
v_accvgpr_write_b32 a115, 0
v_accvgpr_write_b32 a116, 0
v_accvgpr_write_b32 a117, 0
v_accvgpr_write_b32 a118, 0
v_accvgpr_write_b32 a119, 0
v_accvgpr_write_b32 a120, 0
v_accvgpr_write_b32 a121, 0
v_accvgpr_write_b32 a122, 0
v_accvgpr_write_b32 a123, 0
v_accvgpr_write_b32 a124, 0
v_accvgpr_write_b32 a125, 0
v_accvgpr_write_b32 a126, 0
v_accvgpr_write_b32 a127, 0
v_accvgpr_write_b32 a128, 0
v_accvgpr_write_b32 a129, 0
v_accvgpr_write_b32 a130, 0
v_accvgpr_write_b32 a131, 0
v_accvgpr_write_b32 a132, 0
v_accvgpr_write_b32 a133, 0
v_accvgpr_write_b32 a134, 0
v_accvgpr_write_b32 a135, 0
v_accvgpr_write_b32 a136, 0
v_accvgpr_write_b32 a137, 0
v_accvgpr_write_b32 a138, 0
v_accvgpr_write_b32 a139, 0
v_accvgpr_write_b32 a140, 0
v_accvgpr_write_b32 a141, 0
v_accvgpr_write_b32 a142, 0
v_accvgpr_write_b32 a143, 0
v_accvgpr_write_b32 a144, 0
v_accvgpr_write_b32 a145, 0
v_accvgpr_write_b32 a146, 0
v_accvgpr_write_b32 a147, 0
v_accvgpr_write_b32 a148, 0
v_accvgpr_write_b32 a149, 0
v_accvgpr_write_b32 a150, 0
v_accvgpr_write_b32 a151, 0
v_accvgpr_write_b32 a152, 0
v_accvgpr_write_b32 a153, 0
v_accvgpr_write_b32 a154, 0
v_accvgpr_write_b32 a155, 0
v_accvgpr_write_b32 a156, 0
v_accvgpr_write_b32 a157, 0
v_accvgpr_write_b32 a158, 0
v_accvgpr_write_b32 a159, 0
s_waitcnt lgkmcnt(0)
ds_read_b128 v[160:163], v15 offset:0
ds_read_b128 v[164:167], v15 offset:16
v_accvgpr_read_b32 v104, a0
v_fma_f32 v104, -v64, v72, v104
v_mul_f32 v104, v104, v65
v_accvgpr_read_b32 v105, a1
v_fma_f32 v105, -v64, v73, v105
v_mul_f32 v105, v105, v65
v_accvgpr_read_b32 v106, a2
v_fma_f32 v106, -v64, v74, v106
v_mul_f32 v106, v106, v65
v_accvgpr_read_b32 v107, a3
v_fma_f32 v107, -v64, v75, v107
v_mul_f32 v107, v107, v65
v_cvt_pk_bf16_f32 v168, v104, v105
v_cvt_pk_bf16_f32 v169, v106, v107
v_accvgpr_read_b32 v104, a4
v_fma_f32 v104, -v64, v76, v104
v_mul_f32 v104, v104, v65
v_accvgpr_read_b32 v105, a5
v_fma_f32 v105, -v64, v77, v105
v_mul_f32 v105, v105, v65
v_accvgpr_read_b32 v106, a6
v_fma_f32 v106, -v64, v78, v106
v_mul_f32 v106, v106, v65
v_accvgpr_read_b32 v107, a7
v_fma_f32 v107, -v64, v79, v107
v_mul_f32 v107, v107, v65
v_cvt_pk_bf16_f32 v170, v104, v105
v_cvt_pk_bf16_f32 v171, v106, v107
v_accvgpr_read_b32 v104, a8
v_fma_f32 v104, -v64, v80, v104
v_mul_f32 v104, v104, v65
v_accvgpr_read_b32 v105, a9
v_fma_f32 v105, -v64, v81, v105
v_mul_f32 v105, v105, v65
v_accvgpr_read_b32 v106, a10
v_fma_f32 v106, -v64, v82, v106
v_mul_f32 v106, v106, v65
v_accvgpr_read_b32 v107, a11
v_fma_f32 v107, -v64, v83, v107
v_mul_f32 v107, v107, v65
v_cvt_pk_bf16_f32 v172, v104, v105
v_cvt_pk_bf16_f32 v173, v106, v107
v_accvgpr_read_b32 v104, a12
v_fma_f32 v104, -v64, v84, v104
v_mul_f32 v104, v104, v65
v_accvgpr_read_b32 v105, a13
v_fma_f32 v105, -v64, v85, v105
v_mul_f32 v105, v105, v65
v_accvgpr_read_b32 v106, a14
v_fma_f32 v106, -v64, v86, v106
v_mul_f32 v106, v106, v65
v_accvgpr_read_b32 v107, a15
v_fma_f32 v107, -v64, v87, v107
v_mul_f32 v107, v107, v65
v_cvt_pk_bf16_f32 v174, v104, v105
v_cvt_pk_bf16_f32 v175, v106, v107
s_waitcnt lgkmcnt(0)
v_accvgpr_read_b32 v104, a16
v_fma_f32 v104, -v160, v88, v104
v_mul_f32 v104, v104, v161
v_accvgpr_read_b32 v105, a17
v_fma_f32 v105, -v162, v88, v105
v_mul_f32 v105, v105, v163
v_accvgpr_read_b32 v106, a18
v_fma_f32 v106, -v164, v88, v106
v_mul_f32 v106, v106, v165
v_accvgpr_read_b32 v107, a19
v_fma_f32 v107, -v166, v88, v107
v_mul_f32 v107, v107, v167
v_cvt_pk_bf16_f32 v176, v104, v105
v_cvt_pk_bf16_f32 v177, v106, v107
v_accvgpr_read_b32 v104, a20
v_fma_f32 v104, -v160, v89, v104
v_mul_f32 v104, v104, v161
v_accvgpr_read_b32 v105, a21
v_fma_f32 v105, -v162, v89, v105
v_mul_f32 v105, v105, v163
v_accvgpr_read_b32 v106, a22
v_fma_f32 v106, -v164, v89, v106
v_mul_f32 v106, v106, v165
v_accvgpr_read_b32 v107, a23
v_fma_f32 v107, -v166, v89, v107
v_mul_f32 v107, v107, v167
v_cvt_pk_bf16_f32 v178, v104, v105
v_cvt_pk_bf16_f32 v179, v106, v107
s_nop 1
v_mfma_f32_16x16x16_bf16 v[180:183], v[90:91], v[168:169], 0
v_mfma_f32_16x16x16_bf16 v[188:191], v[172:173], v[90:91], 0
v_mfma_f32_16x16x16_bf16 v[180:183], v[92:93], v[170:171], v[180:183]
v_mfma_f32_16x16x16_bf16 v[188:191], v[174:175], v[92:93], v[188:191]
v_mfma_f32_16x16x16_bf16 v[184:187], v[94:95], v[168:169], 0
v_mfma_f32_16x16x16_bf16 v[192:195], v[172:173], v[94:95], 0
v_mfma_f32_16x16x16_bf16 v[184:187], v[96:97], v[170:171], v[184:187]
v_mfma_f32_16x16x16_bf16 v[192:195], v[174:175], v[96:97], v[192:195]
s_nop 15
v_cvt_pk_bf16_f32 v110, v180, v181
v_lshlrev_b32 v180, 16, v110
v_and_b32 v181, 0xffff0000, v110
v_cvt_pk_bf16_f32 v110, v182, v183
v_lshlrev_b32 v182, 16, v110
v_and_b32 v183, 0xffff0000, v110
v_cvt_pk_bf16_f32 v110, v184, v185
v_lshlrev_b32 v184, 16, v110
v_and_b32 v185, 0xffff0000, v110
v_cvt_pk_bf16_f32 v110, v186, v187
v_lshlrev_b32 v186, 16, v110
v_and_b32 v187, 0xffff0000, v110
v_cvt_pk_bf16_f32 v110, v188, v189
v_lshlrev_b32 v188, 16, v110
v_and_b32 v189, 0xffff0000, v110
v_cvt_pk_bf16_f32 v110, v190, v191
v_lshlrev_b32 v190, 16, v110
v_and_b32 v191, 0xffff0000, v110
v_cvt_pk_bf16_f32 v110, v192, v193
v_lshlrev_b32 v192, 16, v110
v_and_b32 v193, 0xffff0000, v110
v_cvt_pk_bf16_f32 v110, v194, v195
v_lshlrev_b32 v194, 16, v110
v_and_b32 v195, 0xffff0000, v110
v_max3_f32 v104, v180, v181, v182
v_max3_f32 v104, v104, v183, v184
v_max3_f32 v104, v104, v185, v186
v_max_f32 v104, v104, v187
v_min3_f32 v105, v180, v181, v182
v_min3_f32 v105, v105, v183, v184
v_min3_f32 v105, v105, v185, v186
v_min_f32 v105, v105, v187
ds_bpermute_b32 v106, v60, v104
ds_bpermute_b32 v107, v60, v105
s_waitcnt lgkmcnt(0)
v_max_f32 v104, v104, v106
v_min_f32 v105, v105, v107
ds_bpermute_b32 v106, v61, v104
ds_bpermute_b32 v107, v61, v105
s_waitcnt lgkmcnt(0)
v_max_f32 v104, v104, v106
v_min_f32 v105, v105, v107
v_mov_b32 v106, 0
v_mov_b32 v107, 0
v_sub_f32 v128, v180, v104
v_sub_f32 v136, v105, v180
v_mul_f32 v128, 1069066811, v128
v_mul_f32 v136, 1069066811, v136
v_exp_f32 v128, v128
v_exp_f32 v136, v136
s_nop 0
v_add_f32 v106, v106, v128
v_add_f32 v107, v107, v136
v_sub_f32 v129, v181, v104
v_sub_f32 v137, v105, v181
v_mul_f32 v129, 1069066811, v129
v_mul_f32 v137, 1069066811, v137
v_exp_f32 v129, v129
v_exp_f32 v137, v137
s_nop 0
v_add_f32 v106, v106, v129
v_add_f32 v107, v107, v137
v_sub_f32 v130, v182, v104
v_sub_f32 v138, v105, v182
v_mul_f32 v130, 1069066811, v130
v_mul_f32 v138, 1069066811, v138
v_exp_f32 v130, v130
v_exp_f32 v138, v138
s_nop 0
v_add_f32 v106, v106, v130
v_add_f32 v107, v107, v138
v_sub_f32 v131, v183, v104
v_sub_f32 v139, v105, v183
v_mul_f32 v131, 1069066811, v131
v_mul_f32 v139, 1069066811, v139
v_exp_f32 v131, v131
v_exp_f32 v139, v139
s_nop 0
v_add_f32 v106, v106, v131
v_add_f32 v107, v107, v139
v_sub_f32 v132, v184, v104
v_sub_f32 v140, v105, v184
v_mul_f32 v132, 1069066811, v132
v_mul_f32 v140, 1069066811, v140
v_exp_f32 v132, v132
v_exp_f32 v140, v140
s_nop 0
v_add_f32 v106, v106, v132
v_add_f32 v107, v107, v140
v_sub_f32 v133, v185, v104
v_sub_f32 v141, v105, v185
v_mul_f32 v133, 1069066811, v133
v_mul_f32 v141, 1069066811, v141
v_exp_f32 v133, v133
v_exp_f32 v141, v141
s_nop 0
v_add_f32 v106, v106, v133
v_add_f32 v107, v107, v141
v_sub_f32 v134, v186, v104
v_sub_f32 v142, v105, v186
v_mul_f32 v134, 1069066811, v134
v_mul_f32 v142, 1069066811, v142
v_exp_f32 v134, v134
v_exp_f32 v142, v142
s_nop 0
v_add_f32 v106, v106, v134
v_add_f32 v107, v107, v142
v_sub_f32 v135, v187, v104
v_sub_f32 v143, v105, v187
v_mul_f32 v135, 1069066811, v135
v_mul_f32 v143, 1069066811, v143
v_exp_f32 v135, v135
v_exp_f32 v143, v143
s_nop 0
v_add_f32 v106, v106, v135
v_add_f32 v107, v107, v143
ds_bpermute_b32 v108, v60, v106
ds_bpermute_b32 v109, v60, v107
s_waitcnt lgkmcnt(0)
v_add_f32 v106, v106, v108
v_add_f32 v107, v107, v109
ds_bpermute_b32 v108, v61, v106
ds_bpermute_b32 v109, v61, v107
s_waitcnt lgkmcnt(0)
v_add_f32 v106, v106, v108
v_add_f32 v107, v107, v109
v_rcp_f32 v106, v106
v_rcp_f32 v107, v107
s_nop 0
v_mul_f32 v128, v128, v106
v_mul_f32 v136, v136, v107
v_mul_f32 v129, v129, v106
v_mul_f32 v137, v137, v107
v_mul_f32 v130, v130, v106
v_mul_f32 v138, v138, v107
v_mul_f32 v131, v131, v106
v_mul_f32 v139, v139, v107
v_mul_f32 v132, v132, v106
v_mul_f32 v140, v140, v107
v_mul_f32 v133, v133, v106
v_mul_f32 v141, v141, v107
v_mul_f32 v134, v134, v106
v_mul_f32 v142, v142, v107
v_mul_f32 v135, v135, v106
v_mul_f32 v143, v143, v107
v_add_u32 v108, 0, v9
v_lshl_add_u32 v108, v108, 5, v10
v_lshlrev_b32 v108, 7, v108
v_lshl_add_u32 v108, v5, 3, v108
v_cvt_pk_bf16_f32 v110, v128, v129
v_cvt_pk_bf16_f32 v111, v130, v131
buffer_store_dwordx2 v[110:111], v108, s[12:15], 0 offen offset:0
s_nop 1
v_cvt_pk_bf16_f32 v110, v132, v133
v_cvt_pk_bf16_f32 v111, v134, v135
buffer_store_dwordx2 v[110:111], v108, s[12:15], 0 offen offset:32
s_nop 1
v_cvt_pk_bf16_f32 v110, v136, v137
v_cvt_pk_bf16_f32 v111, v138, v139
buffer_store_dwordx2 v[110:111], v108, s[12:15], 0 offen offset:64
s_nop 1
v_cvt_pk_bf16_f32 v110, v140, v141
v_cvt_pk_bf16_f32 v111, v142, v143
buffer_store_dwordx2 v[110:111], v108, s[12:15], 0 offen offset:96
s_nop 1
v_max_f32 v104, v188, v192
v_min_f32 v105, v188, v192
s_nop 1
v_max_f32_dpp v104, v104, v104 row_ror:8 row_mask:0xf bank_mask:0xf
v_min_f32_dpp v105, v105, v105 row_ror:8 row_mask:0xf bank_mask:0xf
s_nop 1
v_max_f32_dpp v104, v104, v104 row_ror:4 row_mask:0xf bank_mask:0xf
v_min_f32_dpp v105, v105, v105 row_ror:4 row_mask:0xf bank_mask:0xf
s_nop 1
v_max_f32_dpp v104, v104, v104 row_ror:2 row_mask:0xf bank_mask:0xf
v_min_f32_dpp v105, v105, v105 row_ror:2 row_mask:0xf bank_mask:0xf
s_nop 1
v_max_f32_dpp v104, v104, v104 row_ror:1 row_mask:0xf bank_mask:0xf
v_min_f32_dpp v105, v105, v105 row_ror:1 row_mask:0xf bank_mask:0xf
v_sub_f32 v128, v188, v104
v_sub_f32 v136, v105, v188
v_mul_f32 v128, 1069066811, v128
v_mul_f32 v136, 1069066811, v136
v_exp_f32 v128, v128
v_exp_f32 v136, v136
v_sub_f32 v132, v192, v104
v_sub_f32 v140, v105, v192
v_mul_f32 v132, 1069066811, v132
v_mul_f32 v140, 1069066811, v140
v_exp_f32 v132, v132
v_exp_f32 v140, v140
s_nop 0
v_add_f32 v104, v128, v132
v_add_f32 v105, v136, v140
s_nop 1
v_add_f32_dpp v104, v104, v104 row_ror:8 row_mask:0xf bank_mask:0xf
v_add_f32_dpp v105, v105, v105 row_ror:8 row_mask:0xf bank_mask:0xf
s_nop 1
v_add_f32_dpp v104, v104, v104 row_ror:4 row_mask:0xf bank_mask:0xf
v_add_f32_dpp v105, v105, v105 row_ror:4 row_mask:0xf bank_mask:0xf
s_nop 1
v_add_f32_dpp v104, v104, v104 row_ror:2 row_mask:0xf bank_mask:0xf
v_add_f32_dpp v105, v105, v105 row_ror:2 row_mask:0xf bank_mask:0xf
s_nop 1
v_add_f32_dpp v104, v104, v104 row_ror:1 row_mask:0xf bank_mask:0xf
v_add_f32_dpp v105, v105, v105 row_ror:1 row_mask:0xf bank_mask:0xf
v_rcp_f32 v104, v104
v_rcp_f32 v105, v105
s_nop 0
v_mul_f32 v128, v128, v104
v_mul_f32 v136, v136, v105
v_mul_f32 v132, v132, v104
v_mul_f32 v140, v140, v105
v_max_f32 v104, v189, v193
v_min_f32 v105, v189, v193
s_nop 1
v_max_f32_dpp v104, v104, v104 row_ror:8 row_mask:0xf bank_mask:0xf
v_min_f32_dpp v105, v105, v105 row_ror:8 row_mask:0xf bank_mask:0xf
s_nop 1
v_max_f32_dpp v104, v104, v104 row_ror:4 row_mask:0xf bank_mask:0xf
v_min_f32_dpp v105, v105, v105 row_ror:4 row_mask:0xf bank_mask:0xf
s_nop 1
v_max_f32_dpp v104, v104, v104 row_ror:2 row_mask:0xf bank_mask:0xf
v_min_f32_dpp v105, v105, v105 row_ror:2 row_mask:0xf bank_mask:0xf
s_nop 1
v_max_f32_dpp v104, v104, v104 row_ror:1 row_mask:0xf bank_mask:0xf
v_min_f32_dpp v105, v105, v105 row_ror:1 row_mask:0xf bank_mask:0xf
v_sub_f32 v129, v189, v104
v_sub_f32 v137, v105, v189
v_mul_f32 v129, 1069066811, v129
v_mul_f32 v137, 1069066811, v137
v_exp_f32 v129, v129
v_exp_f32 v137, v137
v_sub_f32 v133, v193, v104
v_sub_f32 v141, v105, v193
v_mul_f32 v133, 1069066811, v133
v_mul_f32 v141, 1069066811, v141
v_exp_f32 v133, v133
v_exp_f32 v141, v141
s_nop 0
v_add_f32 v104, v129, v133
v_add_f32 v105, v137, v141
s_nop 1
v_add_f32_dpp v104, v104, v104 row_ror:8 row_mask:0xf bank_mask:0xf
v_add_f32_dpp v105, v105, v105 row_ror:8 row_mask:0xf bank_mask:0xf
s_nop 1
v_add_f32_dpp v104, v104, v104 row_ror:4 row_mask:0xf bank_mask:0xf
v_add_f32_dpp v105, v105, v105 row_ror:4 row_mask:0xf bank_mask:0xf
s_nop 1
v_add_f32_dpp v104, v104, v104 row_ror:2 row_mask:0xf bank_mask:0xf
v_add_f32_dpp v105, v105, v105 row_ror:2 row_mask:0xf bank_mask:0xf
s_nop 1
v_add_f32_dpp v104, v104, v104 row_ror:1 row_mask:0xf bank_mask:0xf
v_add_f32_dpp v105, v105, v105 row_ror:1 row_mask:0xf bank_mask:0xf
v_rcp_f32 v104, v104
v_rcp_f32 v105, v105
s_nop 0
v_mul_f32 v129, v129, v104
v_mul_f32 v137, v137, v105
v_mul_f32 v133, v133, v104
v_mul_f32 v141, v141, v105
v_max_f32 v104, v190, v194
v_min_f32 v105, v190, v194
s_nop 1
v_max_f32_dpp v104, v104, v104 row_ror:8 row_mask:0xf bank_mask:0xf
v_min_f32_dpp v105, v105, v105 row_ror:8 row_mask:0xf bank_mask:0xf
s_nop 1
v_max_f32_dpp v104, v104, v104 row_ror:4 row_mask:0xf bank_mask:0xf
v_min_f32_dpp v105, v105, v105 row_ror:4 row_mask:0xf bank_mask:0xf
s_nop 1
v_max_f32_dpp v104, v104, v104 row_ror:2 row_mask:0xf bank_mask:0xf
v_min_f32_dpp v105, v105, v105 row_ror:2 row_mask:0xf bank_mask:0xf
s_nop 1
v_max_f32_dpp v104, v104, v104 row_ror:1 row_mask:0xf bank_mask:0xf
v_min_f32_dpp v105, v105, v105 row_ror:1 row_mask:0xf bank_mask:0xf
v_sub_f32 v130, v190, v104
v_sub_f32 v138, v105, v190
v_mul_f32 v130, 1069066811, v130
v_mul_f32 v138, 1069066811, v138
v_exp_f32 v130, v130
v_exp_f32 v138, v138
v_sub_f32 v134, v194, v104
v_sub_f32 v142, v105, v194
v_mul_f32 v134, 1069066811, v134
v_mul_f32 v142, 1069066811, v142
v_exp_f32 v134, v134
v_exp_f32 v142, v142
s_nop 0
v_add_f32 v104, v130, v134
v_add_f32 v105, v138, v142
s_nop 1
v_add_f32_dpp v104, v104, v104 row_ror:8 row_mask:0xf bank_mask:0xf
v_add_f32_dpp v105, v105, v105 row_ror:8 row_mask:0xf bank_mask:0xf
s_nop 1
v_add_f32_dpp v104, v104, v104 row_ror:4 row_mask:0xf bank_mask:0xf
v_add_f32_dpp v105, v105, v105 row_ror:4 row_mask:0xf bank_mask:0xf
s_nop 1
v_add_f32_dpp v104, v104, v104 row_ror:2 row_mask:0xf bank_mask:0xf
v_add_f32_dpp v105, v105, v105 row_ror:2 row_mask:0xf bank_mask:0xf
s_nop 1
v_add_f32_dpp v104, v104, v104 row_ror:1 row_mask:0xf bank_mask:0xf
v_add_f32_dpp v105, v105, v105 row_ror:1 row_mask:0xf bank_mask:0xf
v_rcp_f32 v104, v104
v_rcp_f32 v105, v105
s_nop 0
v_mul_f32 v130, v130, v104
v_mul_f32 v138, v138, v105
v_mul_f32 v134, v134, v104
v_mul_f32 v142, v142, v105
v_max_f32 v104, v191, v195
v_min_f32 v105, v191, v195
s_nop 1
v_max_f32_dpp v104, v104, v104 row_ror:8 row_mask:0xf bank_mask:0xf
v_min_f32_dpp v105, v105, v105 row_ror:8 row_mask:0xf bank_mask:0xf
s_nop 1
v_max_f32_dpp v104, v104, v104 row_ror:4 row_mask:0xf bank_mask:0xf
v_min_f32_dpp v105, v105, v105 row_ror:4 row_mask:0xf bank_mask:0xf
s_nop 1
v_max_f32_dpp v104, v104, v104 row_ror:2 row_mask:0xf bank_mask:0xf
v_min_f32_dpp v105, v105, v105 row_ror:2 row_mask:0xf bank_mask:0xf
s_nop 1
v_max_f32_dpp v104, v104, v104 row_ror:1 row_mask:0xf bank_mask:0xf
v_min_f32_dpp v105, v105, v105 row_ror:1 row_mask:0xf bank_mask:0xf
v_sub_f32 v131, v191, v104
v_sub_f32 v139, v105, v191
v_mul_f32 v131, 1069066811, v131
v_mul_f32 v139, 1069066811, v139
v_exp_f32 v131, v131
v_exp_f32 v139, v139
v_sub_f32 v135, v195, v104
v_sub_f32 v143, v105, v195
v_mul_f32 v135, 1069066811, v135
v_mul_f32 v143, 1069066811, v143
v_exp_f32 v135, v135
v_exp_f32 v143, v143
s_nop 0
v_add_f32 v104, v131, v135
v_add_f32 v105, v139, v143
s_nop 1
v_add_f32_dpp v104, v104, v104 row_ror:8 row_mask:0xf bank_mask:0xf
v_add_f32_dpp v105, v105, v105 row_ror:8 row_mask:0xf bank_mask:0xf
s_nop 1
v_add_f32_dpp v104, v104, v104 row_ror:4 row_mask:0xf bank_mask:0xf
v_add_f32_dpp v105, v105, v105 row_ror:4 row_mask:0xf bank_mask:0xf
s_nop 1
v_add_f32_dpp v104, v104, v104 row_ror:2 row_mask:0xf bank_mask:0xf
v_add_f32_dpp v105, v105, v105 row_ror:2 row_mask:0xf bank_mask:0xf
s_nop 1
v_add_f32_dpp v104, v104, v104 row_ror:1 row_mask:0xf bank_mask:0xf
v_add_f32_dpp v105, v105, v105 row_ror:1 row_mask:0xf bank_mask:0xf
v_rcp_f32 v104, v104
v_rcp_f32 v105, v105
s_nop 0
v_mul_f32 v131, v131, v104
v_mul_f32 v139, v139, v105
v_mul_f32 v135, v135, v104
v_mul_f32 v143, v143, v105
v_cvt_pk_bf16_f32 v144, v128, v129
v_cvt_pk_bf16_f32 v145, v130, v131
v_cvt_pk_bf16_f32 v146, v132, v133
v_cvt_pk_bf16_f32 v147, v134, v135
v_cvt_pk_bf16_f32 v148, v136, v137
v_cvt_pk_bf16_f32 v149, v138, v139
v_cvt_pk_bf16_f32 v150, v140, v141
v_cvt_pk_bf16_f32 v151, v142, v143
s_nop 1
v_mfma_f32_16x16x16_bf16 a[112:115], v[144:145], v[176:177], a[112:115]
v_mfma_f32_16x16x16_bf16 a[116:119], v[144:145], v[178:179], a[116:119]
v_mfma_f32_16x16x16_bf16 a[120:123], v[144:145], v[98:99], a[120:123]
v_mfma_f32_16x16x16_bf16 a[124:127], v[146:147], v[176:177], a[124:127]
v_mfma_f32_16x16x16_bf16 a[128:131], v[146:147], v[178:179], a[128:131]
v_mfma_f32_16x16x16_bf16 a[132:135], v[146:147], v[98:99], a[132:135]
v_mfma_f32_16x16x16_bf16 a[136:139], v[148:149], v[176:177], a[136:139]
v_mfma_f32_16x16x16_bf16 a[140:143], v[148:149], v[178:179], a[140:143]
v_mfma_f32_16x16x16_bf16 a[144:147], v[148:149], v[98:99], a[144:147]
v_mfma_f32_16x16x16_bf16 a[148:151], v[150:151], v[176:177], a[148:151]
v_mfma_f32_16x16x16_bf16 a[152:155], v[150:151], v[178:179], a[152:155]
v_mfma_f32_16x16x16_bf16 a[156:159], v[150:151], v[98:99], a[156:159]
s_waitcnt lgkmcnt(0)
ds_read_b128 v[160:163], v15 offset:128
ds_read_b128 v[164:167], v15 offset:144
v_accvgpr_read_b32 v104, a24
v_fma_f32 v104, -v66, v72, v104
v_mul_f32 v104, v104, v67
v_accvgpr_read_b32 v105, a25
v_fma_f32 v105, -v66, v73, v105
v_mul_f32 v105, v105, v67
v_accvgpr_read_b32 v106, a26
v_fma_f32 v106, -v66, v74, v106
v_mul_f32 v106, v106, v67
v_accvgpr_read_b32 v107, a27
v_fma_f32 v107, -v66, v75, v107
v_mul_f32 v107, v107, v67
v_cvt_pk_bf16_f32 v168, v104, v105
v_cvt_pk_bf16_f32 v169, v106, v107
v_accvgpr_read_b32 v104, a28
v_fma_f32 v104, -v66, v76, v104
v_mul_f32 v104, v104, v67
v_accvgpr_read_b32 v105, a29
v_fma_f32 v105, -v66, v77, v105
v_mul_f32 v105, v105, v67
v_accvgpr_read_b32 v106, a30
v_fma_f32 v106, -v66, v78, v106
v_mul_f32 v106, v106, v67
v_accvgpr_read_b32 v107, a31
v_fma_f32 v107, -v66, v79, v107
v_mul_f32 v107, v107, v67
v_cvt_pk_bf16_f32 v170, v104, v105
v_cvt_pk_bf16_f32 v171, v106, v107
v_accvgpr_read_b32 v104, a32
v_fma_f32 v104, -v66, v80, v104
v_mul_f32 v104, v104, v67
v_accvgpr_read_b32 v105, a33
v_fma_f32 v105, -v66, v81, v105
v_mul_f32 v105, v105, v67
v_accvgpr_read_b32 v106, a34
v_fma_f32 v106, -v66, v82, v106
v_mul_f32 v106, v106, v67
v_accvgpr_read_b32 v107, a35
v_fma_f32 v107, -v66, v83, v107
v_mul_f32 v107, v107, v67
v_cvt_pk_bf16_f32 v172, v104, v105
v_cvt_pk_bf16_f32 v173, v106, v107
v_accvgpr_read_b32 v104, a36
v_fma_f32 v104, -v66, v84, v104
v_mul_f32 v104, v104, v67
v_accvgpr_read_b32 v105, a37
v_fma_f32 v105, -v66, v85, v105
v_mul_f32 v105, v105, v67
v_accvgpr_read_b32 v106, a38
v_fma_f32 v106, -v66, v86, v106
v_mul_f32 v106, v106, v67
v_accvgpr_read_b32 v107, a39
v_fma_f32 v107, -v66, v87, v107
v_mul_f32 v107, v107, v67
v_cvt_pk_bf16_f32 v174, v104, v105
v_cvt_pk_bf16_f32 v175, v106, v107
s_waitcnt lgkmcnt(0)
v_accvgpr_read_b32 v104, a40
v_fma_f32 v104, -v160, v88, v104
v_mul_f32 v104, v104, v161
v_accvgpr_read_b32 v105, a41
v_fma_f32 v105, -v162, v88, v105
v_mul_f32 v105, v105, v163
v_accvgpr_read_b32 v106, a42
v_fma_f32 v106, -v164, v88, v106
v_mul_f32 v106, v106, v165
v_accvgpr_read_b32 v107, a43
v_fma_f32 v107, -v166, v88, v107
v_mul_f32 v107, v107, v167
v_cvt_pk_bf16_f32 v176, v104, v105
v_cvt_pk_bf16_f32 v177, v106, v107
v_accvgpr_read_b32 v104, a44
v_fma_f32 v104, -v160, v89, v104
v_mul_f32 v104, v104, v161
v_accvgpr_read_b32 v105, a45
v_fma_f32 v105, -v162, v89, v105
v_mul_f32 v105, v105, v163
v_accvgpr_read_b32 v106, a46
v_fma_f32 v106, -v164, v89, v106
v_mul_f32 v106, v106, v165
v_accvgpr_read_b32 v107, a47
v_fma_f32 v107, -v166, v89, v107
v_mul_f32 v107, v107, v167
v_cvt_pk_bf16_f32 v178, v104, v105
v_cvt_pk_bf16_f32 v179, v106, v107
s_nop 1
v_mfma_f32_16x16x16_bf16 v[180:183], v[90:91], v[168:169], 0
v_mfma_f32_16x16x16_bf16 v[188:191], v[172:173], v[90:91], 0
v_mfma_f32_16x16x16_bf16 v[180:183], v[92:93], v[170:171], v[180:183]
v_mfma_f32_16x16x16_bf16 v[188:191], v[174:175], v[92:93], v[188:191]
v_mfma_f32_16x16x16_bf16 v[184:187], v[94:95], v[168:169], 0
v_mfma_f32_16x16x16_bf16 v[192:195], v[172:173], v[94:95], 0
v_mfma_f32_16x16x16_bf16 v[184:187], v[96:97], v[170:171], v[184:187]
v_mfma_f32_16x16x16_bf16 v[192:195], v[174:175], v[96:97], v[192:195]
s_nop 15
v_cvt_pk_bf16_f32 v110, v180, v181
v_lshlrev_b32 v180, 16, v110
v_and_b32 v181, 0xffff0000, v110
v_cvt_pk_bf16_f32 v110, v182, v183
v_lshlrev_b32 v182, 16, v110
v_and_b32 v183, 0xffff0000, v110
v_cvt_pk_bf16_f32 v110, v184, v185
v_lshlrev_b32 v184, 16, v110
v_and_b32 v185, 0xffff0000, v110
v_cvt_pk_bf16_f32 v110, v186, v187
v_lshlrev_b32 v186, 16, v110
v_and_b32 v187, 0xffff0000, v110
v_cvt_pk_bf16_f32 v110, v188, v189
v_lshlrev_b32 v188, 16, v110
v_and_b32 v189, 0xffff0000, v110
v_cvt_pk_bf16_f32 v110, v190, v191
v_lshlrev_b32 v190, 16, v110
v_and_b32 v191, 0xffff0000, v110
v_cvt_pk_bf16_f32 v110, v192, v193
v_lshlrev_b32 v192, 16, v110
v_and_b32 v193, 0xffff0000, v110
v_cvt_pk_bf16_f32 v110, v194, v195
v_lshlrev_b32 v194, 16, v110
v_and_b32 v195, 0xffff0000, v110
v_max3_f32 v104, v180, v181, v182
v_max3_f32 v104, v104, v183, v184
v_max3_f32 v104, v104, v185, v186
v_max_f32 v104, v104, v187
v_min3_f32 v105, v180, v181, v182
v_min3_f32 v105, v105, v183, v184
v_min3_f32 v105, v105, v185, v186
v_min_f32 v105, v105, v187
ds_bpermute_b32 v106, v60, v104
ds_bpermute_b32 v107, v60, v105
s_waitcnt lgkmcnt(0)
v_max_f32 v104, v104, v106
v_min_f32 v105, v105, v107
ds_bpermute_b32 v106, v61, v104
ds_bpermute_b32 v107, v61, v105
s_waitcnt lgkmcnt(0)
v_max_f32 v104, v104, v106
v_min_f32 v105, v105, v107
v_mov_b32 v106, 0
v_mov_b32 v107, 0
v_sub_f32 v128, v180, v104
v_sub_f32 v136, v105, v180
v_mul_f32 v128, 1069066811, v128
v_mul_f32 v136, 1069066811, v136
v_exp_f32 v128, v128
v_exp_f32 v136, v136
s_nop 0
v_add_f32 v106, v106, v128
v_add_f32 v107, v107, v136
v_sub_f32 v129, v181, v104
v_sub_f32 v137, v105, v181
v_mul_f32 v129, 1069066811, v129
v_mul_f32 v137, 1069066811, v137
v_exp_f32 v129, v129
v_exp_f32 v137, v137
s_nop 0
v_add_f32 v106, v106, v129
v_add_f32 v107, v107, v137
v_sub_f32 v130, v182, v104
v_sub_f32 v138, v105, v182
v_mul_f32 v130, 1069066811, v130
v_mul_f32 v138, 1069066811, v138
v_exp_f32 v130, v130
v_exp_f32 v138, v138
s_nop 0
v_add_f32 v106, v106, v130
v_add_f32 v107, v107, v138
v_sub_f32 v131, v183, v104
v_sub_f32 v139, v105, v183
v_mul_f32 v131, 1069066811, v131
v_mul_f32 v139, 1069066811, v139
v_exp_f32 v131, v131
v_exp_f32 v139, v139
s_nop 0
v_add_f32 v106, v106, v131
v_add_f32 v107, v107, v139
v_sub_f32 v132, v184, v104
v_sub_f32 v140, v105, v184
v_mul_f32 v132, 1069066811, v132
v_mul_f32 v140, 1069066811, v140
v_exp_f32 v132, v132
v_exp_f32 v140, v140
s_nop 0
v_add_f32 v106, v106, v132
v_add_f32 v107, v107, v140
v_sub_f32 v133, v185, v104
v_sub_f32 v141, v105, v185
v_mul_f32 v133, 1069066811, v133
v_mul_f32 v141, 1069066811, v141
v_exp_f32 v133, v133
v_exp_f32 v141, v141
s_nop 0
v_add_f32 v106, v106, v133
v_add_f32 v107, v107, v141
v_sub_f32 v134, v186, v104
v_sub_f32 v142, v105, v186
v_mul_f32 v134, 1069066811, v134
v_mul_f32 v142, 1069066811, v142
v_exp_f32 v134, v134
v_exp_f32 v142, v142
s_nop 0
v_add_f32 v106, v106, v134
v_add_f32 v107, v107, v142
v_sub_f32 v135, v187, v104
v_sub_f32 v143, v105, v187
v_mul_f32 v135, 1069066811, v135
v_mul_f32 v143, 1069066811, v143
v_exp_f32 v135, v135
v_exp_f32 v143, v143
s_nop 0
v_add_f32 v106, v106, v135
v_add_f32 v107, v107, v143
ds_bpermute_b32 v108, v60, v106
ds_bpermute_b32 v109, v60, v107
s_waitcnt lgkmcnt(0)
v_add_f32 v106, v106, v108
v_add_f32 v107, v107, v109
ds_bpermute_b32 v108, v61, v106
ds_bpermute_b32 v109, v61, v107
s_waitcnt lgkmcnt(0)
v_add_f32 v106, v106, v108
v_add_f32 v107, v107, v109
v_rcp_f32 v106, v106
v_rcp_f32 v107, v107
s_nop 0
v_mul_f32 v128, v128, v106
v_mul_f32 v136, v136, v107
v_mul_f32 v129, v129, v106
v_mul_f32 v137, v137, v107
v_mul_f32 v130, v130, v106
v_mul_f32 v138, v138, v107
v_mul_f32 v131, v131, v106
v_mul_f32 v139, v139, v107
v_mul_f32 v132, v132, v106
v_mul_f32 v140, v140, v107
v_mul_f32 v133, v133, v106
v_mul_f32 v141, v141, v107
v_mul_f32 v134, v134, v106
v_mul_f32 v142, v142, v107
v_mul_f32 v135, v135, v106
v_mul_f32 v143, v143, v107
v_add_u32 v108, 16, v9
v_lshl_add_u32 v108, v108, 5, v10
v_lshlrev_b32 v108, 7, v108
v_lshl_add_u32 v108, v5, 3, v108
v_cvt_pk_bf16_f32 v110, v128, v129
v_cvt_pk_bf16_f32 v111, v130, v131
buffer_store_dwordx2 v[110:111], v108, s[12:15], 0 offen offset:0
s_nop 1
v_cvt_pk_bf16_f32 v110, v132, v133
v_cvt_pk_bf16_f32 v111, v134, v135
buffer_store_dwordx2 v[110:111], v108, s[12:15], 0 offen offset:32
s_nop 1
v_cvt_pk_bf16_f32 v110, v136, v137
v_cvt_pk_bf16_f32 v111, v138, v139
buffer_store_dwordx2 v[110:111], v108, s[12:15], 0 offen offset:64
s_nop 1
v_cvt_pk_bf16_f32 v110, v140, v141
v_cvt_pk_bf16_f32 v111, v142, v143
buffer_store_dwordx2 v[110:111], v108, s[12:15], 0 offen offset:96
s_nop 1
v_max_f32 v104, v188, v192
v_min_f32 v105, v188, v192
s_nop 1
v_max_f32_dpp v104, v104, v104 row_ror:8 row_mask:0xf bank_mask:0xf
v_min_f32_dpp v105, v105, v105 row_ror:8 row_mask:0xf bank_mask:0xf
s_nop 1
v_max_f32_dpp v104, v104, v104 row_ror:4 row_mask:0xf bank_mask:0xf
v_min_f32_dpp v105, v105, v105 row_ror:4 row_mask:0xf bank_mask:0xf
s_nop 1
v_max_f32_dpp v104, v104, v104 row_ror:2 row_mask:0xf bank_mask:0xf
v_min_f32_dpp v105, v105, v105 row_ror:2 row_mask:0xf bank_mask:0xf
s_nop 1
v_max_f32_dpp v104, v104, v104 row_ror:1 row_mask:0xf bank_mask:0xf
v_min_f32_dpp v105, v105, v105 row_ror:1 row_mask:0xf bank_mask:0xf
v_sub_f32 v128, v188, v104
v_sub_f32 v136, v105, v188
v_mul_f32 v128, 1069066811, v128
v_mul_f32 v136, 1069066811, v136
v_exp_f32 v128, v128
v_exp_f32 v136, v136
v_sub_f32 v132, v192, v104
v_sub_f32 v140, v105, v192
v_mul_f32 v132, 1069066811, v132
v_mul_f32 v140, 1069066811, v140
v_exp_f32 v132, v132
v_exp_f32 v140, v140
s_nop 0
v_add_f32 v104, v128, v132
v_add_f32 v105, v136, v140
s_nop 1
v_add_f32_dpp v104, v104, v104 row_ror:8 row_mask:0xf bank_mask:0xf
v_add_f32_dpp v105, v105, v105 row_ror:8 row_mask:0xf bank_mask:0xf
s_nop 1
v_add_f32_dpp v104, v104, v104 row_ror:4 row_mask:0xf bank_mask:0xf
v_add_f32_dpp v105, v105, v105 row_ror:4 row_mask:0xf bank_mask:0xf
s_nop 1
v_add_f32_dpp v104, v104, v104 row_ror:2 row_mask:0xf bank_mask:0xf
v_add_f32_dpp v105, v105, v105 row_ror:2 row_mask:0xf bank_mask:0xf
s_nop 1
v_add_f32_dpp v104, v104, v104 row_ror:1 row_mask:0xf bank_mask:0xf
v_add_f32_dpp v105, v105, v105 row_ror:1 row_mask:0xf bank_mask:0xf
v_rcp_f32 v104, v104
v_rcp_f32 v105, v105
s_nop 0
v_mul_f32 v128, v128, v104
v_mul_f32 v136, v136, v105
v_mul_f32 v132, v132, v104
v_mul_f32 v140, v140, v105
v_max_f32 v104, v189, v193
v_min_f32 v105, v189, v193
s_nop 1
v_max_f32_dpp v104, v104, v104 row_ror:8 row_mask:0xf bank_mask:0xf
v_min_f32_dpp v105, v105, v105 row_ror:8 row_mask:0xf bank_mask:0xf
s_nop 1
v_max_f32_dpp v104, v104, v104 row_ror:4 row_mask:0xf bank_mask:0xf
v_min_f32_dpp v105, v105, v105 row_ror:4 row_mask:0xf bank_mask:0xf
s_nop 1
v_max_f32_dpp v104, v104, v104 row_ror:2 row_mask:0xf bank_mask:0xf
v_min_f32_dpp v105, v105, v105 row_ror:2 row_mask:0xf bank_mask:0xf
s_nop 1
v_max_f32_dpp v104, v104, v104 row_ror:1 row_mask:0xf bank_mask:0xf
v_min_f32_dpp v105, v105, v105 row_ror:1 row_mask:0xf bank_mask:0xf
v_sub_f32 v129, v189, v104
v_sub_f32 v137, v105, v189
v_mul_f32 v129, 1069066811, v129
v_mul_f32 v137, 1069066811, v137
v_exp_f32 v129, v129
v_exp_f32 v137, v137
v_sub_f32 v133, v193, v104
v_sub_f32 v141, v105, v193
v_mul_f32 v133, 1069066811, v133
v_mul_f32 v141, 1069066811, v141
v_exp_f32 v133, v133
v_exp_f32 v141, v141
s_nop 0
v_add_f32 v104, v129, v133
v_add_f32 v105, v137, v141
s_nop 1
v_add_f32_dpp v104, v104, v104 row_ror:8 row_mask:0xf bank_mask:0xf
v_add_f32_dpp v105, v105, v105 row_ror:8 row_mask:0xf bank_mask:0xf
s_nop 1
v_add_f32_dpp v104, v104, v104 row_ror:4 row_mask:0xf bank_mask:0xf
v_add_f32_dpp v105, v105, v105 row_ror:4 row_mask:0xf bank_mask:0xf
s_nop 1
v_add_f32_dpp v104, v104, v104 row_ror:2 row_mask:0xf bank_mask:0xf
v_add_f32_dpp v105, v105, v105 row_ror:2 row_mask:0xf bank_mask:0xf
s_nop 1
v_add_f32_dpp v104, v104, v104 row_ror:1 row_mask:0xf bank_mask:0xf
v_add_f32_dpp v105, v105, v105 row_ror:1 row_mask:0xf bank_mask:0xf
v_rcp_f32 v104, v104
v_rcp_f32 v105, v105
s_nop 0
v_mul_f32 v129, v129, v104
v_mul_f32 v137, v137, v105
v_mul_f32 v133, v133, v104
v_mul_f32 v141, v141, v105
v_max_f32 v104, v190, v194
v_min_f32 v105, v190, v194
s_nop 1
v_max_f32_dpp v104, v104, v104 row_ror:8 row_mask:0xf bank_mask:0xf
v_min_f32_dpp v105, v105, v105 row_ror:8 row_mask:0xf bank_mask:0xf
s_nop 1
v_max_f32_dpp v104, v104, v104 row_ror:4 row_mask:0xf bank_mask:0xf
v_min_f32_dpp v105, v105, v105 row_ror:4 row_mask:0xf bank_mask:0xf
s_nop 1
v_max_f32_dpp v104, v104, v104 row_ror:2 row_mask:0xf bank_mask:0xf
v_min_f32_dpp v105, v105, v105 row_ror:2 row_mask:0xf bank_mask:0xf
s_nop 1
v_max_f32_dpp v104, v104, v104 row_ror:1 row_mask:0xf bank_mask:0xf
v_min_f32_dpp v105, v105, v105 row_ror:1 row_mask:0xf bank_mask:0xf
v_sub_f32 v130, v190, v104
v_sub_f32 v138, v105, v190
v_mul_f32 v130, 1069066811, v130
v_mul_f32 v138, 1069066811, v138
v_exp_f32 v130, v130
v_exp_f32 v138, v138
v_sub_f32 v134, v194, v104
v_sub_f32 v142, v105, v194
v_mul_f32 v134, 1069066811, v134
v_mul_f32 v142, 1069066811, v142
v_exp_f32 v134, v134
v_exp_f32 v142, v142
s_nop 0
v_add_f32 v104, v130, v134
v_add_f32 v105, v138, v142
s_nop 1
v_add_f32_dpp v104, v104, v104 row_ror:8 row_mask:0xf bank_mask:0xf
v_add_f32_dpp v105, v105, v105 row_ror:8 row_mask:0xf bank_mask:0xf
s_nop 1
v_add_f32_dpp v104, v104, v104 row_ror:4 row_mask:0xf bank_mask:0xf
v_add_f32_dpp v105, v105, v105 row_ror:4 row_mask:0xf bank_mask:0xf
s_nop 1
v_add_f32_dpp v104, v104, v104 row_ror:2 row_mask:0xf bank_mask:0xf
v_add_f32_dpp v105, v105, v105 row_ror:2 row_mask:0xf bank_mask:0xf
s_nop 1
v_add_f32_dpp v104, v104, v104 row_ror:1 row_mask:0xf bank_mask:0xf
v_add_f32_dpp v105, v105, v105 row_ror:1 row_mask:0xf bank_mask:0xf
v_rcp_f32 v104, v104
v_rcp_f32 v105, v105
s_nop 0
v_mul_f32 v130, v130, v104
v_mul_f32 v138, v138, v105
v_mul_f32 v134, v134, v104
v_mul_f32 v142, v142, v105
v_max_f32 v104, v191, v195
v_min_f32 v105, v191, v195
s_nop 1
v_max_f32_dpp v104, v104, v104 row_ror:8 row_mask:0xf bank_mask:0xf
v_min_f32_dpp v105, v105, v105 row_ror:8 row_mask:0xf bank_mask:0xf
s_nop 1
v_max_f32_dpp v104, v104, v104 row_ror:4 row_mask:0xf bank_mask:0xf
v_min_f32_dpp v105, v105, v105 row_ror:4 row_mask:0xf bank_mask:0xf
s_nop 1
v_max_f32_dpp v104, v104, v104 row_ror:2 row_mask:0xf bank_mask:0xf
v_min_f32_dpp v105, v105, v105 row_ror:2 row_mask:0xf bank_mask:0xf
s_nop 1
v_max_f32_dpp v104, v104, v104 row_ror:1 row_mask:0xf bank_mask:0xf
v_min_f32_dpp v105, v105, v105 row_ror:1 row_mask:0xf bank_mask:0xf
v_sub_f32 v131, v191, v104
v_sub_f32 v139, v105, v191
v_mul_f32 v131, 1069066811, v131
v_mul_f32 v139, 1069066811, v139
v_exp_f32 v131, v131
v_exp_f32 v139, v139
v_sub_f32 v135, v195, v104
v_sub_f32 v143, v105, v195
v_mul_f32 v135, 1069066811, v135
v_mul_f32 v143, 1069066811, v143
v_exp_f32 v135, v135
v_exp_f32 v143, v143
s_nop 0
v_add_f32 v104, v131, v135
v_add_f32 v105, v139, v143
s_nop 1
v_add_f32_dpp v104, v104, v104 row_ror:8 row_mask:0xf bank_mask:0xf
v_add_f32_dpp v105, v105, v105 row_ror:8 row_mask:0xf bank_mask:0xf
s_nop 1
v_add_f32_dpp v104, v104, v104 row_ror:4 row_mask:0xf bank_mask:0xf
v_add_f32_dpp v105, v105, v105 row_ror:4 row_mask:0xf bank_mask:0xf
s_nop 1
v_add_f32_dpp v104, v104, v104 row_ror:2 row_mask:0xf bank_mask:0xf
v_add_f32_dpp v105, v105, v105 row_ror:2 row_mask:0xf bank_mask:0xf
s_nop 1
v_add_f32_dpp v104, v104, v104 row_ror:1 row_mask:0xf bank_mask:0xf
v_add_f32_dpp v105, v105, v105 row_ror:1 row_mask:0xf bank_mask:0xf
v_rcp_f32 v104, v104
v_rcp_f32 v105, v105
s_nop 0
v_mul_f32 v131, v131, v104
v_mul_f32 v139, v139, v105
v_mul_f32 v135, v135, v104
v_mul_f32 v143, v143, v105
v_cvt_pk_bf16_f32 v144, v128, v129
v_cvt_pk_bf16_f32 v145, v130, v131
v_cvt_pk_bf16_f32 v146, v132, v133
v_cvt_pk_bf16_f32 v147, v134, v135
v_cvt_pk_bf16_f32 v148, v136, v137
v_cvt_pk_bf16_f32 v149, v138, v139
v_cvt_pk_bf16_f32 v150, v140, v141
v_cvt_pk_bf16_f32 v151, v142, v143
s_nop 1
v_mfma_f32_16x16x16_bf16 a[112:115], v[144:145], v[176:177], a[112:115]
v_mfma_f32_16x16x16_bf16 a[116:119], v[144:145], v[178:179], a[116:119]
v_mfma_f32_16x16x16_bf16 a[120:123], v[144:145], v[98:99], a[120:123]
v_mfma_f32_16x16x16_bf16 a[124:127], v[146:147], v[176:177], a[124:127]
v_mfma_f32_16x16x16_bf16 a[128:131], v[146:147], v[178:179], a[128:131]
v_mfma_f32_16x16x16_bf16 a[132:135], v[146:147], v[98:99], a[132:135]
v_mfma_f32_16x16x16_bf16 a[136:139], v[148:149], v[176:177], a[136:139]
v_mfma_f32_16x16x16_bf16 a[140:143], v[148:149], v[178:179], a[140:143]
v_mfma_f32_16x16x16_bf16 a[144:147], v[148:149], v[98:99], a[144:147]
v_mfma_f32_16x16x16_bf16 a[148:151], v[150:151], v[176:177], a[148:151]
v_mfma_f32_16x16x16_bf16 a[152:155], v[150:151], v[178:179], a[152:155]
v_mfma_f32_16x16x16_bf16 a[156:159], v[150:151], v[98:99], a[156:159]
s_waitcnt lgkmcnt(0)
ds_read_b128 v[160:163], v15 offset:256
ds_read_b128 v[164:167], v15 offset:272
v_accvgpr_read_b32 v104, a48
v_fma_f32 v104, -v68, v72, v104
v_mul_f32 v104, v104, v69
v_accvgpr_read_b32 v105, a49
v_fma_f32 v105, -v68, v73, v105
v_mul_f32 v105, v105, v69
v_accvgpr_read_b32 v106, a50
v_fma_f32 v106, -v68, v74, v106
v_mul_f32 v106, v106, v69
v_accvgpr_read_b32 v107, a51
v_fma_f32 v107, -v68, v75, v107
v_mul_f32 v107, v107, v69
v_cvt_pk_bf16_f32 v168, v104, v105
v_cvt_pk_bf16_f32 v169, v106, v107
v_accvgpr_read_b32 v104, a52
v_fma_f32 v104, -v68, v76, v104
v_mul_f32 v104, v104, v69
v_accvgpr_read_b32 v105, a53
v_fma_f32 v105, -v68, v77, v105
v_mul_f32 v105, v105, v69
v_accvgpr_read_b32 v106, a54
v_fma_f32 v106, -v68, v78, v106
v_mul_f32 v106, v106, v69
v_accvgpr_read_b32 v107, a55
v_fma_f32 v107, -v68, v79, v107
v_mul_f32 v107, v107, v69
v_cvt_pk_bf16_f32 v170, v104, v105
v_cvt_pk_bf16_f32 v171, v106, v107
v_accvgpr_read_b32 v104, a56
v_fma_f32 v104, -v68, v80, v104
v_mul_f32 v104, v104, v69
v_accvgpr_read_b32 v105, a57
v_fma_f32 v105, -v68, v81, v105
v_mul_f32 v105, v105, v69
v_accvgpr_read_b32 v106, a58
v_fma_f32 v106, -v68, v82, v106
v_mul_f32 v106, v106, v69
v_accvgpr_read_b32 v107, a59
v_fma_f32 v107, -v68, v83, v107
v_mul_f32 v107, v107, v69
v_cvt_pk_bf16_f32 v172, v104, v105
v_cvt_pk_bf16_f32 v173, v106, v107
v_accvgpr_read_b32 v104, a60
v_fma_f32 v104, -v68, v84, v104
v_mul_f32 v104, v104, v69
v_accvgpr_read_b32 v105, a61
v_fma_f32 v105, -v68, v85, v105
v_mul_f32 v105, v105, v69
v_accvgpr_read_b32 v106, a62
v_fma_f32 v106, -v68, v86, v106
v_mul_f32 v106, v106, v69
v_accvgpr_read_b32 v107, a63
v_fma_f32 v107, -v68, v87, v107
v_mul_f32 v107, v107, v69
v_cvt_pk_bf16_f32 v174, v104, v105
v_cvt_pk_bf16_f32 v175, v106, v107
s_waitcnt lgkmcnt(0)
v_accvgpr_read_b32 v104, a64
v_fma_f32 v104, -v160, v88, v104
v_mul_f32 v104, v104, v161
v_accvgpr_read_b32 v105, a65
v_fma_f32 v105, -v162, v88, v105
v_mul_f32 v105, v105, v163
v_accvgpr_read_b32 v106, a66
v_fma_f32 v106, -v164, v88, v106
v_mul_f32 v106, v106, v165
v_accvgpr_read_b32 v107, a67
v_fma_f32 v107, -v166, v88, v107
v_mul_f32 v107, v107, v167
v_cvt_pk_bf16_f32 v176, v104, v105
v_cvt_pk_bf16_f32 v177, v106, v107
v_accvgpr_read_b32 v104, a68
v_fma_f32 v104, -v160, v89, v104
v_mul_f32 v104, v104, v161
v_accvgpr_read_b32 v105, a69
v_fma_f32 v105, -v162, v89, v105
v_mul_f32 v105, v105, v163
v_accvgpr_read_b32 v106, a70
v_fma_f32 v106, -v164, v89, v106
v_mul_f32 v106, v106, v165
v_accvgpr_read_b32 v107, a71
v_fma_f32 v107, -v166, v89, v107
v_mul_f32 v107, v107, v167
v_cvt_pk_bf16_f32 v178, v104, v105
v_cvt_pk_bf16_f32 v179, v106, v107
s_nop 1
v_mfma_f32_16x16x16_bf16 v[180:183], v[90:91], v[168:169], 0
v_mfma_f32_16x16x16_bf16 v[188:191], v[172:173], v[90:91], 0
v_mfma_f32_16x16x16_bf16 v[180:183], v[92:93], v[170:171], v[180:183]
v_mfma_f32_16x16x16_bf16 v[188:191], v[174:175], v[92:93], v[188:191]
v_mfma_f32_16x16x16_bf16 v[184:187], v[94:95], v[168:169], 0
v_mfma_f32_16x16x16_bf16 v[192:195], v[172:173], v[94:95], 0
v_mfma_f32_16x16x16_bf16 v[184:187], v[96:97], v[170:171], v[184:187]
v_mfma_f32_16x16x16_bf16 v[192:195], v[174:175], v[96:97], v[192:195]
s_nop 15
v_cvt_pk_bf16_f32 v110, v180, v181
v_lshlrev_b32 v180, 16, v110
v_and_b32 v181, 0xffff0000, v110
v_cvt_pk_bf16_f32 v110, v182, v183
v_lshlrev_b32 v182, 16, v110
v_and_b32 v183, 0xffff0000, v110
v_cvt_pk_bf16_f32 v110, v184, v185
v_lshlrev_b32 v184, 16, v110
v_and_b32 v185, 0xffff0000, v110
v_cvt_pk_bf16_f32 v110, v186, v187
v_lshlrev_b32 v186, 16, v110
v_and_b32 v187, 0xffff0000, v110
v_cvt_pk_bf16_f32 v110, v188, v189
v_lshlrev_b32 v188, 16, v110
v_and_b32 v189, 0xffff0000, v110
v_cvt_pk_bf16_f32 v110, v190, v191
v_lshlrev_b32 v190, 16, v110
v_and_b32 v191, 0xffff0000, v110
v_cvt_pk_bf16_f32 v110, v192, v193
v_lshlrev_b32 v192, 16, v110
v_and_b32 v193, 0xffff0000, v110
v_cvt_pk_bf16_f32 v110, v194, v195
v_lshlrev_b32 v194, 16, v110
v_and_b32 v195, 0xffff0000, v110
v_max3_f32 v104, v180, v181, v182
v_max3_f32 v104, v104, v183, v184
v_max3_f32 v104, v104, v185, v186
v_max_f32 v104, v104, v187
v_min3_f32 v105, v180, v181, v182
v_min3_f32 v105, v105, v183, v184
v_min3_f32 v105, v105, v185, v186
v_min_f32 v105, v105, v187
ds_bpermute_b32 v106, v60, v104
ds_bpermute_b32 v107, v60, v105
s_waitcnt lgkmcnt(0)
v_max_f32 v104, v104, v106
v_min_f32 v105, v105, v107
ds_bpermute_b32 v106, v61, v104
ds_bpermute_b32 v107, v61, v105
s_waitcnt lgkmcnt(0)
v_max_f32 v104, v104, v106
v_min_f32 v105, v105, v107
v_mov_b32 v106, 0
v_mov_b32 v107, 0
v_sub_f32 v128, v180, v104
v_sub_f32 v136, v105, v180
v_mul_f32 v128, 1069066811, v128
v_mul_f32 v136, 1069066811, v136
v_exp_f32 v128, v128
v_exp_f32 v136, v136
s_nop 0
v_add_f32 v106, v106, v128
v_add_f32 v107, v107, v136
v_sub_f32 v129, v181, v104
v_sub_f32 v137, v105, v181
v_mul_f32 v129, 1069066811, v129
v_mul_f32 v137, 1069066811, v137
v_exp_f32 v129, v129
v_exp_f32 v137, v137
s_nop 0
v_add_f32 v106, v106, v129
v_add_f32 v107, v107, v137
v_sub_f32 v130, v182, v104
v_sub_f32 v138, v105, v182
v_mul_f32 v130, 1069066811, v130
v_mul_f32 v138, 1069066811, v138
v_exp_f32 v130, v130
v_exp_f32 v138, v138
s_nop 0
v_add_f32 v106, v106, v130
v_add_f32 v107, v107, v138
v_sub_f32 v131, v183, v104
v_sub_f32 v139, v105, v183
v_mul_f32 v131, 1069066811, v131
v_mul_f32 v139, 1069066811, v139
v_exp_f32 v131, v131
v_exp_f32 v139, v139
s_nop 0
v_add_f32 v106, v106, v131
v_add_f32 v107, v107, v139
v_sub_f32 v132, v184, v104
v_sub_f32 v140, v105, v184
v_mul_f32 v132, 1069066811, v132
v_mul_f32 v140, 1069066811, v140
v_exp_f32 v132, v132
v_exp_f32 v140, v140
s_nop 0
v_add_f32 v106, v106, v132
v_add_f32 v107, v107, v140
v_sub_f32 v133, v185, v104
v_sub_f32 v141, v105, v185
v_mul_f32 v133, 1069066811, v133
v_mul_f32 v141, 1069066811, v141
v_exp_f32 v133, v133
v_exp_f32 v141, v141
s_nop 0
v_add_f32 v106, v106, v133
v_add_f32 v107, v107, v141
v_sub_f32 v134, v186, v104
v_sub_f32 v142, v105, v186
v_mul_f32 v134, 1069066811, v134
v_mul_f32 v142, 1069066811, v142
v_exp_f32 v134, v134
v_exp_f32 v142, v142
s_nop 0
v_add_f32 v106, v106, v134
v_add_f32 v107, v107, v142
v_sub_f32 v135, v187, v104
v_sub_f32 v143, v105, v187
v_mul_f32 v135, 1069066811, v135
v_mul_f32 v143, 1069066811, v143
v_exp_f32 v135, v135
v_exp_f32 v143, v143
s_nop 0
v_add_f32 v106, v106, v135
v_add_f32 v107, v107, v143
ds_bpermute_b32 v108, v60, v106
ds_bpermute_b32 v109, v60, v107
s_waitcnt lgkmcnt(0)
v_add_f32 v106, v106, v108
v_add_f32 v107, v107, v109
ds_bpermute_b32 v108, v61, v106
ds_bpermute_b32 v109, v61, v107
s_waitcnt lgkmcnt(0)
v_add_f32 v106, v106, v108
v_add_f32 v107, v107, v109
v_rcp_f32 v106, v106
v_rcp_f32 v107, v107
s_nop 0
v_mul_f32 v128, v128, v106
v_mul_f32 v136, v136, v107
v_mul_f32 v129, v129, v106
v_mul_f32 v137, v137, v107
v_mul_f32 v130, v130, v106
v_mul_f32 v138, v138, v107
v_mul_f32 v131, v131, v106
v_mul_f32 v139, v139, v107
v_mul_f32 v132, v132, v106
v_mul_f32 v140, v140, v107
v_mul_f32 v133, v133, v106
v_mul_f32 v141, v141, v107
v_mul_f32 v134, v134, v106
v_mul_f32 v142, v142, v107
v_mul_f32 v135, v135, v106
v_mul_f32 v143, v143, v107
v_add_u32 v108, 32, v9
v_lshl_add_u32 v108, v108, 5, v10
v_lshlrev_b32 v108, 7, v108
v_lshl_add_u32 v108, v5, 3, v108
v_cvt_pk_bf16_f32 v110, v128, v129
v_cvt_pk_bf16_f32 v111, v130, v131
buffer_store_dwordx2 v[110:111], v108, s[12:15], 0 offen offset:0
s_nop 1
v_cvt_pk_bf16_f32 v110, v132, v133
v_cvt_pk_bf16_f32 v111, v134, v135
buffer_store_dwordx2 v[110:111], v108, s[12:15], 0 offen offset:32
s_nop 1
v_cvt_pk_bf16_f32 v110, v136, v137
v_cvt_pk_bf16_f32 v111, v138, v139
buffer_store_dwordx2 v[110:111], v108, s[12:15], 0 offen offset:64
s_nop 1
v_cvt_pk_bf16_f32 v110, v140, v141
v_cvt_pk_bf16_f32 v111, v142, v143
buffer_store_dwordx2 v[110:111], v108, s[12:15], 0 offen offset:96
s_nop 1
v_max_f32 v104, v188, v192
v_min_f32 v105, v188, v192
s_nop 1
v_max_f32_dpp v104, v104, v104 row_ror:8 row_mask:0xf bank_mask:0xf
v_min_f32_dpp v105, v105, v105 row_ror:8 row_mask:0xf bank_mask:0xf
s_nop 1
v_max_f32_dpp v104, v104, v104 row_ror:4 row_mask:0xf bank_mask:0xf
v_min_f32_dpp v105, v105, v105 row_ror:4 row_mask:0xf bank_mask:0xf
s_nop 1
v_max_f32_dpp v104, v104, v104 row_ror:2 row_mask:0xf bank_mask:0xf
v_min_f32_dpp v105, v105, v105 row_ror:2 row_mask:0xf bank_mask:0xf
s_nop 1
v_max_f32_dpp v104, v104, v104 row_ror:1 row_mask:0xf bank_mask:0xf
v_min_f32_dpp v105, v105, v105 row_ror:1 row_mask:0xf bank_mask:0xf
v_sub_f32 v128, v188, v104
v_sub_f32 v136, v105, v188
v_mul_f32 v128, 1069066811, v128
v_mul_f32 v136, 1069066811, v136
v_exp_f32 v128, v128
v_exp_f32 v136, v136
v_sub_f32 v132, v192, v104
v_sub_f32 v140, v105, v192
v_mul_f32 v132, 1069066811, v132
v_mul_f32 v140, 1069066811, v140
v_exp_f32 v132, v132
v_exp_f32 v140, v140
s_nop 0
v_add_f32 v104, v128, v132
v_add_f32 v105, v136, v140
s_nop 1
v_add_f32_dpp v104, v104, v104 row_ror:8 row_mask:0xf bank_mask:0xf
v_add_f32_dpp v105, v105, v105 row_ror:8 row_mask:0xf bank_mask:0xf
s_nop 1
v_add_f32_dpp v104, v104, v104 row_ror:4 row_mask:0xf bank_mask:0xf
v_add_f32_dpp v105, v105, v105 row_ror:4 row_mask:0xf bank_mask:0xf
s_nop 1
v_add_f32_dpp v104, v104, v104 row_ror:2 row_mask:0xf bank_mask:0xf
v_add_f32_dpp v105, v105, v105 row_ror:2 row_mask:0xf bank_mask:0xf
s_nop 1
v_add_f32_dpp v104, v104, v104 row_ror:1 row_mask:0xf bank_mask:0xf
v_add_f32_dpp v105, v105, v105 row_ror:1 row_mask:0xf bank_mask:0xf
v_rcp_f32 v104, v104
v_rcp_f32 v105, v105
s_nop 0
v_mul_f32 v128, v128, v104
v_mul_f32 v136, v136, v105
v_mul_f32 v132, v132, v104
v_mul_f32 v140, v140, v105
v_max_f32 v104, v189, v193
v_min_f32 v105, v189, v193
s_nop 1
v_max_f32_dpp v104, v104, v104 row_ror:8 row_mask:0xf bank_mask:0xf
v_min_f32_dpp v105, v105, v105 row_ror:8 row_mask:0xf bank_mask:0xf
s_nop 1
v_max_f32_dpp v104, v104, v104 row_ror:4 row_mask:0xf bank_mask:0xf
v_min_f32_dpp v105, v105, v105 row_ror:4 row_mask:0xf bank_mask:0xf
s_nop 1
v_max_f32_dpp v104, v104, v104 row_ror:2 row_mask:0xf bank_mask:0xf
v_min_f32_dpp v105, v105, v105 row_ror:2 row_mask:0xf bank_mask:0xf
s_nop 1
v_max_f32_dpp v104, v104, v104 row_ror:1 row_mask:0xf bank_mask:0xf
v_min_f32_dpp v105, v105, v105 row_ror:1 row_mask:0xf bank_mask:0xf
v_sub_f32 v129, v189, v104
v_sub_f32 v137, v105, v189
v_mul_f32 v129, 1069066811, v129
v_mul_f32 v137, 1069066811, v137
v_exp_f32 v129, v129
v_exp_f32 v137, v137
v_sub_f32 v133, v193, v104
v_sub_f32 v141, v105, v193
v_mul_f32 v133, 1069066811, v133
v_mul_f32 v141, 1069066811, v141
v_exp_f32 v133, v133
v_exp_f32 v141, v141
s_nop 0
v_add_f32 v104, v129, v133
v_add_f32 v105, v137, v141
s_nop 1
v_add_f32_dpp v104, v104, v104 row_ror:8 row_mask:0xf bank_mask:0xf
v_add_f32_dpp v105, v105, v105 row_ror:8 row_mask:0xf bank_mask:0xf
s_nop 1
v_add_f32_dpp v104, v104, v104 row_ror:4 row_mask:0xf bank_mask:0xf
v_add_f32_dpp v105, v105, v105 row_ror:4 row_mask:0xf bank_mask:0xf
s_nop 1
v_add_f32_dpp v104, v104, v104 row_ror:2 row_mask:0xf bank_mask:0xf
v_add_f32_dpp v105, v105, v105 row_ror:2 row_mask:0xf bank_mask:0xf
s_nop 1
v_add_f32_dpp v104, v104, v104 row_ror:1 row_mask:0xf bank_mask:0xf
v_add_f32_dpp v105, v105, v105 row_ror:1 row_mask:0xf bank_mask:0xf
v_rcp_f32 v104, v104
v_rcp_f32 v105, v105
s_nop 0
v_mul_f32 v129, v129, v104
v_mul_f32 v137, v137, v105
v_mul_f32 v133, v133, v104
v_mul_f32 v141, v141, v105
v_max_f32 v104, v190, v194
v_min_f32 v105, v190, v194
s_nop 1
v_max_f32_dpp v104, v104, v104 row_ror:8 row_mask:0xf bank_mask:0xf
v_min_f32_dpp v105, v105, v105 row_ror:8 row_mask:0xf bank_mask:0xf
s_nop 1
v_max_f32_dpp v104, v104, v104 row_ror:4 row_mask:0xf bank_mask:0xf
v_min_f32_dpp v105, v105, v105 row_ror:4 row_mask:0xf bank_mask:0xf
s_nop 1
v_max_f32_dpp v104, v104, v104 row_ror:2 row_mask:0xf bank_mask:0xf
v_min_f32_dpp v105, v105, v105 row_ror:2 row_mask:0xf bank_mask:0xf
s_nop 1
v_max_f32_dpp v104, v104, v104 row_ror:1 row_mask:0xf bank_mask:0xf
v_min_f32_dpp v105, v105, v105 row_ror:1 row_mask:0xf bank_mask:0xf
v_sub_f32 v130, v190, v104
v_sub_f32 v138, v105, v190
v_mul_f32 v130, 1069066811, v130
v_mul_f32 v138, 1069066811, v138
v_exp_f32 v130, v130
v_exp_f32 v138, v138
v_sub_f32 v134, v194, v104
v_sub_f32 v142, v105, v194
v_mul_f32 v134, 1069066811, v134
v_mul_f32 v142, 1069066811, v142
v_exp_f32 v134, v134
v_exp_f32 v142, v142
s_nop 0
v_add_f32 v104, v130, v134
v_add_f32 v105, v138, v142
s_nop 1
v_add_f32_dpp v104, v104, v104 row_ror:8 row_mask:0xf bank_mask:0xf
v_add_f32_dpp v105, v105, v105 row_ror:8 row_mask:0xf bank_mask:0xf
s_nop 1
v_add_f32_dpp v104, v104, v104 row_ror:4 row_mask:0xf bank_mask:0xf
v_add_f32_dpp v105, v105, v105 row_ror:4 row_mask:0xf bank_mask:0xf
s_nop 1
v_add_f32_dpp v104, v104, v104 row_ror:2 row_mask:0xf bank_mask:0xf
v_add_f32_dpp v105, v105, v105 row_ror:2 row_mask:0xf bank_mask:0xf
s_nop 1
v_add_f32_dpp v104, v104, v104 row_ror:1 row_mask:0xf bank_mask:0xf
v_add_f32_dpp v105, v105, v105 row_ror:1 row_mask:0xf bank_mask:0xf
v_rcp_f32 v104, v104
v_rcp_f32 v105, v105
s_nop 0
v_mul_f32 v130, v130, v104
v_mul_f32 v138, v138, v105
v_mul_f32 v134, v134, v104
v_mul_f32 v142, v142, v105
v_max_f32 v104, v191, v195
v_min_f32 v105, v191, v195
s_nop 1
v_max_f32_dpp v104, v104, v104 row_ror:8 row_mask:0xf bank_mask:0xf
v_min_f32_dpp v105, v105, v105 row_ror:8 row_mask:0xf bank_mask:0xf
s_nop 1
v_max_f32_dpp v104, v104, v104 row_ror:4 row_mask:0xf bank_mask:0xf
v_min_f32_dpp v105, v105, v105 row_ror:4 row_mask:0xf bank_mask:0xf
s_nop 1
v_max_f32_dpp v104, v104, v104 row_ror:2 row_mask:0xf bank_mask:0xf
v_min_f32_dpp v105, v105, v105 row_ror:2 row_mask:0xf bank_mask:0xf
s_nop 1
v_max_f32_dpp v104, v104, v104 row_ror:1 row_mask:0xf bank_mask:0xf
v_min_f32_dpp v105, v105, v105 row_ror:1 row_mask:0xf bank_mask:0xf
v_sub_f32 v131, v191, v104
v_sub_f32 v139, v105, v191
v_mul_f32 v131, 1069066811, v131
v_mul_f32 v139, 1069066811, v139
v_exp_f32 v131, v131
v_exp_f32 v139, v139
v_sub_f32 v135, v195, v104
v_sub_f32 v143, v105, v195
v_mul_f32 v135, 1069066811, v135
v_mul_f32 v143, 1069066811, v143
v_exp_f32 v135, v135
v_exp_f32 v143, v143
s_nop 0
v_add_f32 v104, v131, v135
v_add_f32 v105, v139, v143
s_nop 1
v_add_f32_dpp v104, v104, v104 row_ror:8 row_mask:0xf bank_mask:0xf
v_add_f32_dpp v105, v105, v105 row_ror:8 row_mask:0xf bank_mask:0xf
s_nop 1
v_add_f32_dpp v104, v104, v104 row_ror:4 row_mask:0xf bank_mask:0xf
v_add_f32_dpp v105, v105, v105 row_ror:4 row_mask:0xf bank_mask:0xf
s_nop 1
v_add_f32_dpp v104, v104, v104 row_ror:2 row_mask:0xf bank_mask:0xf
v_add_f32_dpp v105, v105, v105 row_ror:2 row_mask:0xf bank_mask:0xf
s_nop 1
v_add_f32_dpp v104, v104, v104 row_ror:1 row_mask:0xf bank_mask:0xf
v_add_f32_dpp v105, v105, v105 row_ror:1 row_mask:0xf bank_mask:0xf
v_rcp_f32 v104, v104
v_rcp_f32 v105, v105
s_nop 0
v_mul_f32 v131, v131, v104
v_mul_f32 v139, v139, v105
v_mul_f32 v135, v135, v104
v_mul_f32 v143, v143, v105
v_cvt_pk_bf16_f32 v144, v128, v129
v_cvt_pk_bf16_f32 v145, v130, v131
v_cvt_pk_bf16_f32 v146, v132, v133
v_cvt_pk_bf16_f32 v147, v134, v135
v_cvt_pk_bf16_f32 v148, v136, v137
v_cvt_pk_bf16_f32 v149, v138, v139
v_cvt_pk_bf16_f32 v150, v140, v141
v_cvt_pk_bf16_f32 v151, v142, v143
s_nop 1
v_mfma_f32_16x16x16_bf16 a[112:115], v[144:145], v[176:177], a[112:115]
v_mfma_f32_16x16x16_bf16 a[116:119], v[144:145], v[178:179], a[116:119]
v_mfma_f32_16x16x16_bf16 a[120:123], v[144:145], v[98:99], a[120:123]
v_mfma_f32_16x16x16_bf16 a[124:127], v[146:147], v[176:177], a[124:127]
v_mfma_f32_16x16x16_bf16 a[128:131], v[146:147], v[178:179], a[128:131]
v_mfma_f32_16x16x16_bf16 a[132:135], v[146:147], v[98:99], a[132:135]
v_mfma_f32_16x16x16_bf16 a[136:139], v[148:149], v[176:177], a[136:139]
v_mfma_f32_16x16x16_bf16 a[140:143], v[148:149], v[178:179], a[140:143]
v_mfma_f32_16x16x16_bf16 a[144:147], v[148:149], v[98:99], a[144:147]
v_mfma_f32_16x16x16_bf16 a[148:151], v[150:151], v[176:177], a[148:151]
v_mfma_f32_16x16x16_bf16 a[152:155], v[150:151], v[178:179], a[152:155]
v_mfma_f32_16x16x16_bf16 a[156:159], v[150:151], v[98:99], a[156:159]
s_waitcnt lgkmcnt(0)
ds_read_b128 v[160:163], v15 offset:384
ds_read_b128 v[164:167], v15 offset:400
v_accvgpr_read_b32 v104, a72
v_fma_f32 v104, -v70, v72, v104
v_mul_f32 v104, v104, v71
v_accvgpr_read_b32 v105, a73
v_fma_f32 v105, -v70, v73, v105
v_mul_f32 v105, v105, v71
v_accvgpr_read_b32 v106, a74
v_fma_f32 v106, -v70, v74, v106
v_mul_f32 v106, v106, v71
v_accvgpr_read_b32 v107, a75
v_fma_f32 v107, -v70, v75, v107
v_mul_f32 v107, v107, v71
v_cvt_pk_bf16_f32 v168, v104, v105
v_cvt_pk_bf16_f32 v169, v106, v107
v_accvgpr_read_b32 v104, a76
v_fma_f32 v104, -v70, v76, v104
v_mul_f32 v104, v104, v71
v_accvgpr_read_b32 v105, a77
v_fma_f32 v105, -v70, v77, v105
v_mul_f32 v105, v105, v71
v_accvgpr_read_b32 v106, a78
v_fma_f32 v106, -v70, v78, v106
v_mul_f32 v106, v106, v71
v_accvgpr_read_b32 v107, a79
v_fma_f32 v107, -v70, v79, v107
v_mul_f32 v107, v107, v71
v_cvt_pk_bf16_f32 v170, v104, v105
v_cvt_pk_bf16_f32 v171, v106, v107
v_accvgpr_read_b32 v104, a80
v_fma_f32 v104, -v70, v80, v104
v_mul_f32 v104, v104, v71
v_accvgpr_read_b32 v105, a81
v_fma_f32 v105, -v70, v81, v105
v_mul_f32 v105, v105, v71
v_accvgpr_read_b32 v106, a82
v_fma_f32 v106, -v70, v82, v106
v_mul_f32 v106, v106, v71
v_accvgpr_read_b32 v107, a83
v_fma_f32 v107, -v70, v83, v107
v_mul_f32 v107, v107, v71
v_cvt_pk_bf16_f32 v172, v104, v105
v_cvt_pk_bf16_f32 v173, v106, v107
v_accvgpr_read_b32 v104, a84
v_fma_f32 v104, -v70, v84, v104
v_mul_f32 v104, v104, v71
v_accvgpr_read_b32 v105, a85
v_fma_f32 v105, -v70, v85, v105
v_mul_f32 v105, v105, v71
v_accvgpr_read_b32 v106, a86
v_fma_f32 v106, -v70, v86, v106
v_mul_f32 v106, v106, v71
v_accvgpr_read_b32 v107, a87
v_fma_f32 v107, -v70, v87, v107
v_mul_f32 v107, v107, v71
v_cvt_pk_bf16_f32 v174, v104, v105
v_cvt_pk_bf16_f32 v175, v106, v107
s_waitcnt lgkmcnt(0)
v_accvgpr_read_b32 v104, a88
v_fma_f32 v104, -v160, v88, v104
v_mul_f32 v104, v104, v161
v_accvgpr_read_b32 v105, a89
v_fma_f32 v105, -v162, v88, v105
v_mul_f32 v105, v105, v163
v_accvgpr_read_b32 v106, a90
v_fma_f32 v106, -v164, v88, v106
v_mul_f32 v106, v106, v165
v_accvgpr_read_b32 v107, a91
v_fma_f32 v107, -v166, v88, v107
v_mul_f32 v107, v107, v167
v_cvt_pk_bf16_f32 v176, v104, v105
v_cvt_pk_bf16_f32 v177, v106, v107
v_accvgpr_read_b32 v104, a92
v_fma_f32 v104, -v160, v89, v104
v_mul_f32 v104, v104, v161
v_accvgpr_read_b32 v105, a93
v_fma_f32 v105, -v162, v89, v105
v_mul_f32 v105, v105, v163
v_accvgpr_read_b32 v106, a94
v_fma_f32 v106, -v164, v89, v106
v_mul_f32 v106, v106, v165
v_accvgpr_read_b32 v107, a95
v_fma_f32 v107, -v166, v89, v107
v_mul_f32 v107, v107, v167
v_cvt_pk_bf16_f32 v178, v104, v105
v_cvt_pk_bf16_f32 v179, v106, v107
s_nop 1
v_mfma_f32_16x16x16_bf16 v[180:183], v[90:91], v[168:169], 0
v_mfma_f32_16x16x16_bf16 v[188:191], v[172:173], v[90:91], 0
v_mfma_f32_16x16x16_bf16 v[180:183], v[92:93], v[170:171], v[180:183]
v_mfma_f32_16x16x16_bf16 v[188:191], v[174:175], v[92:93], v[188:191]
v_mfma_f32_16x16x16_bf16 v[184:187], v[94:95], v[168:169], 0
v_mfma_f32_16x16x16_bf16 v[192:195], v[172:173], v[94:95], 0
v_mfma_f32_16x16x16_bf16 v[184:187], v[96:97], v[170:171], v[184:187]
v_mfma_f32_16x16x16_bf16 v[192:195], v[174:175], v[96:97], v[192:195]
s_nop 15
v_cvt_pk_bf16_f32 v110, v180, v181
v_lshlrev_b32 v180, 16, v110
v_and_b32 v181, 0xffff0000, v110
v_cvt_pk_bf16_f32 v110, v182, v183
v_lshlrev_b32 v182, 16, v110
v_and_b32 v183, 0xffff0000, v110
v_cvt_pk_bf16_f32 v110, v184, v185
v_lshlrev_b32 v184, 16, v110
v_and_b32 v185, 0xffff0000, v110
v_cvt_pk_bf16_f32 v110, v186, v187
v_lshlrev_b32 v186, 16, v110
v_and_b32 v187, 0xffff0000, v110
v_cvt_pk_bf16_f32 v110, v188, v189
v_lshlrev_b32 v188, 16, v110
v_and_b32 v189, 0xffff0000, v110
v_cvt_pk_bf16_f32 v110, v190, v191
v_lshlrev_b32 v190, 16, v110
v_and_b32 v191, 0xffff0000, v110
v_cvt_pk_bf16_f32 v110, v192, v193
v_lshlrev_b32 v192, 16, v110
v_and_b32 v193, 0xffff0000, v110
v_cvt_pk_bf16_f32 v110, v194, v195
v_lshlrev_b32 v194, 16, v110
v_and_b32 v195, 0xffff0000, v110
v_max3_f32 v104, v180, v181, v182
v_max3_f32 v104, v104, v183, v184
v_max3_f32 v104, v104, v185, v186
v_max_f32 v104, v104, v187
v_min3_f32 v105, v180, v181, v182
v_min3_f32 v105, v105, v183, v184
v_min3_f32 v105, v105, v185, v186
v_min_f32 v105, v105, v187
ds_bpermute_b32 v106, v60, v104
ds_bpermute_b32 v107, v60, v105
s_waitcnt lgkmcnt(0)
v_max_f32 v104, v104, v106
v_min_f32 v105, v105, v107
ds_bpermute_b32 v106, v61, v104
ds_bpermute_b32 v107, v61, v105
s_waitcnt lgkmcnt(0)
v_max_f32 v104, v104, v106
v_min_f32 v105, v105, v107
v_mov_b32 v106, 0
v_mov_b32 v107, 0
v_sub_f32 v128, v180, v104
v_sub_f32 v136, v105, v180
v_mul_f32 v128, 1069066811, v128
v_mul_f32 v136, 1069066811, v136
v_exp_f32 v128, v128
v_exp_f32 v136, v136
s_nop 0
v_add_f32 v106, v106, v128
v_add_f32 v107, v107, v136
v_sub_f32 v129, v181, v104
v_sub_f32 v137, v105, v181
v_mul_f32 v129, 1069066811, v129
v_mul_f32 v137, 1069066811, v137
v_exp_f32 v129, v129
v_exp_f32 v137, v137
s_nop 0
v_add_f32 v106, v106, v129
v_add_f32 v107, v107, v137
v_sub_f32 v130, v182, v104
v_sub_f32 v138, v105, v182
v_mul_f32 v130, 1069066811, v130
v_mul_f32 v138, 1069066811, v138
v_exp_f32 v130, v130
v_exp_f32 v138, v138
s_nop 0
v_add_f32 v106, v106, v130
v_add_f32 v107, v107, v138
v_sub_f32 v131, v183, v104
v_sub_f32 v139, v105, v183
v_mul_f32 v131, 1069066811, v131
v_mul_f32 v139, 1069066811, v139
v_exp_f32 v131, v131
v_exp_f32 v139, v139
s_nop 0
v_add_f32 v106, v106, v131
v_add_f32 v107, v107, v139
v_sub_f32 v132, v184, v104
v_sub_f32 v140, v105, v184
v_mul_f32 v132, 1069066811, v132
v_mul_f32 v140, 1069066811, v140
v_exp_f32 v132, v132
v_exp_f32 v140, v140
s_nop 0
v_add_f32 v106, v106, v132
v_add_f32 v107, v107, v140
v_sub_f32 v133, v185, v104
v_sub_f32 v141, v105, v185
v_mul_f32 v133, 1069066811, v133
v_mul_f32 v141, 1069066811, v141
v_exp_f32 v133, v133
v_exp_f32 v141, v141
s_nop 0
v_add_f32 v106, v106, v133
v_add_f32 v107, v107, v141
v_sub_f32 v134, v186, v104
v_sub_f32 v142, v105, v186
v_mul_f32 v134, 1069066811, v134
v_mul_f32 v142, 1069066811, v142
v_exp_f32 v134, v134
v_exp_f32 v142, v142
s_nop 0
v_add_f32 v106, v106, v134
v_add_f32 v107, v107, v142
v_sub_f32 v135, v187, v104
v_sub_f32 v143, v105, v187
v_mul_f32 v135, 1069066811, v135
v_mul_f32 v143, 1069066811, v143
v_exp_f32 v135, v135
v_exp_f32 v143, v143
s_nop 0
v_add_f32 v106, v106, v135
v_add_f32 v107, v107, v143
ds_bpermute_b32 v108, v60, v106
ds_bpermute_b32 v109, v60, v107
s_waitcnt lgkmcnt(0)
v_add_f32 v106, v106, v108
v_add_f32 v107, v107, v109
ds_bpermute_b32 v108, v61, v106
ds_bpermute_b32 v109, v61, v107
s_waitcnt lgkmcnt(0)
v_add_f32 v106, v106, v108
v_add_f32 v107, v107, v109
v_rcp_f32 v106, v106
v_rcp_f32 v107, v107
s_nop 0
v_mul_f32 v128, v128, v106
v_mul_f32 v136, v136, v107
v_mul_f32 v129, v129, v106
v_mul_f32 v137, v137, v107
v_mul_f32 v130, v130, v106
v_mul_f32 v138, v138, v107
v_mul_f32 v131, v131, v106
v_mul_f32 v139, v139, v107
v_mul_f32 v132, v132, v106
v_mul_f32 v140, v140, v107
v_mul_f32 v133, v133, v106
v_mul_f32 v141, v141, v107
v_mul_f32 v134, v134, v106
v_mul_f32 v142, v142, v107
v_mul_f32 v135, v135, v106
v_mul_f32 v143, v143, v107
v_add_u32 v108, 48, v9
v_lshl_add_u32 v108, v108, 5, v10
v_lshlrev_b32 v108, 7, v108
v_lshl_add_u32 v108, v5, 3, v108
v_cvt_pk_bf16_f32 v110, v128, v129
v_cvt_pk_bf16_f32 v111, v130, v131
buffer_store_dwordx2 v[110:111], v108, s[12:15], 0 offen offset:0
s_nop 1
v_cvt_pk_bf16_f32 v110, v132, v133
v_cvt_pk_bf16_f32 v111, v134, v135
buffer_store_dwordx2 v[110:111], v108, s[12:15], 0 offen offset:32
s_nop 1
v_cvt_pk_bf16_f32 v110, v136, v137
v_cvt_pk_bf16_f32 v111, v138, v139
buffer_store_dwordx2 v[110:111], v108, s[12:15], 0 offen offset:64
s_nop 1
v_cvt_pk_bf16_f32 v110, v140, v141
v_cvt_pk_bf16_f32 v111, v142, v143
buffer_store_dwordx2 v[110:111], v108, s[12:15], 0 offen offset:96
s_nop 1
v_max_f32 v104, v188, v192
v_min_f32 v105, v188, v192
s_nop 1
v_max_f32_dpp v104, v104, v104 row_ror:8 row_mask:0xf bank_mask:0xf
v_min_f32_dpp v105, v105, v105 row_ror:8 row_mask:0xf bank_mask:0xf
s_nop 1
v_max_f32_dpp v104, v104, v104 row_ror:4 row_mask:0xf bank_mask:0xf
v_min_f32_dpp v105, v105, v105 row_ror:4 row_mask:0xf bank_mask:0xf
s_nop 1
v_max_f32_dpp v104, v104, v104 row_ror:2 row_mask:0xf bank_mask:0xf
v_min_f32_dpp v105, v105, v105 row_ror:2 row_mask:0xf bank_mask:0xf
s_nop 1
v_max_f32_dpp v104, v104, v104 row_ror:1 row_mask:0xf bank_mask:0xf
v_min_f32_dpp v105, v105, v105 row_ror:1 row_mask:0xf bank_mask:0xf
v_sub_f32 v128, v188, v104
v_sub_f32 v136, v105, v188
v_mul_f32 v128, 1069066811, v128
v_mul_f32 v136, 1069066811, v136
v_exp_f32 v128, v128
v_exp_f32 v136, v136
v_sub_f32 v132, v192, v104
v_sub_f32 v140, v105, v192
v_mul_f32 v132, 1069066811, v132
v_mul_f32 v140, 1069066811, v140
v_exp_f32 v132, v132
v_exp_f32 v140, v140
s_nop 0
v_add_f32 v104, v128, v132
v_add_f32 v105, v136, v140
s_nop 1
v_add_f32_dpp v104, v104, v104 row_ror:8 row_mask:0xf bank_mask:0xf
v_add_f32_dpp v105, v105, v105 row_ror:8 row_mask:0xf bank_mask:0xf
s_nop 1
v_add_f32_dpp v104, v104, v104 row_ror:4 row_mask:0xf bank_mask:0xf
v_add_f32_dpp v105, v105, v105 row_ror:4 row_mask:0xf bank_mask:0xf
s_nop 1
v_add_f32_dpp v104, v104, v104 row_ror:2 row_mask:0xf bank_mask:0xf
v_add_f32_dpp v105, v105, v105 row_ror:2 row_mask:0xf bank_mask:0xf
s_nop 1
v_add_f32_dpp v104, v104, v104 row_ror:1 row_mask:0xf bank_mask:0xf
v_add_f32_dpp v105, v105, v105 row_ror:1 row_mask:0xf bank_mask:0xf
v_rcp_f32 v104, v104
v_rcp_f32 v105, v105
s_nop 0
v_mul_f32 v128, v128, v104
v_mul_f32 v136, v136, v105
v_mul_f32 v132, v132, v104
v_mul_f32 v140, v140, v105
v_max_f32 v104, v189, v193
v_min_f32 v105, v189, v193
s_nop 1
v_max_f32_dpp v104, v104, v104 row_ror:8 row_mask:0xf bank_mask:0xf
v_min_f32_dpp v105, v105, v105 row_ror:8 row_mask:0xf bank_mask:0xf
s_nop 1
v_max_f32_dpp v104, v104, v104 row_ror:4 row_mask:0xf bank_mask:0xf
v_min_f32_dpp v105, v105, v105 row_ror:4 row_mask:0xf bank_mask:0xf
s_nop 1
v_max_f32_dpp v104, v104, v104 row_ror:2 row_mask:0xf bank_mask:0xf
v_min_f32_dpp v105, v105, v105 row_ror:2 row_mask:0xf bank_mask:0xf
s_nop 1
v_max_f32_dpp v104, v104, v104 row_ror:1 row_mask:0xf bank_mask:0xf
v_min_f32_dpp v105, v105, v105 row_ror:1 row_mask:0xf bank_mask:0xf
v_sub_f32 v129, v189, v104
v_sub_f32 v137, v105, v189
v_mul_f32 v129, 1069066811, v129
v_mul_f32 v137, 1069066811, v137
v_exp_f32 v129, v129
v_exp_f32 v137, v137
v_sub_f32 v133, v193, v104
v_sub_f32 v141, v105, v193
v_mul_f32 v133, 1069066811, v133
v_mul_f32 v141, 1069066811, v141
v_exp_f32 v133, v133
v_exp_f32 v141, v141
s_nop 0
v_add_f32 v104, v129, v133
v_add_f32 v105, v137, v141
s_nop 1
v_add_f32_dpp v104, v104, v104 row_ror:8 row_mask:0xf bank_mask:0xf
v_add_f32_dpp v105, v105, v105 row_ror:8 row_mask:0xf bank_mask:0xf
s_nop 1
v_add_f32_dpp v104, v104, v104 row_ror:4 row_mask:0xf bank_mask:0xf
v_add_f32_dpp v105, v105, v105 row_ror:4 row_mask:0xf bank_mask:0xf
s_nop 1
v_add_f32_dpp v104, v104, v104 row_ror:2 row_mask:0xf bank_mask:0xf
v_add_f32_dpp v105, v105, v105 row_ror:2 row_mask:0xf bank_mask:0xf
s_nop 1
v_add_f32_dpp v104, v104, v104 row_ror:1 row_mask:0xf bank_mask:0xf
v_add_f32_dpp v105, v105, v105 row_ror:1 row_mask:0xf bank_mask:0xf
v_rcp_f32 v104, v104
v_rcp_f32 v105, v105
s_nop 0
v_mul_f32 v129, v129, v104
v_mul_f32 v137, v137, v105
v_mul_f32 v133, v133, v104
v_mul_f32 v141, v141, v105
v_max_f32 v104, v190, v194
v_min_f32 v105, v190, v194
s_nop 1
v_max_f32_dpp v104, v104, v104 row_ror:8 row_mask:0xf bank_mask:0xf
v_min_f32_dpp v105, v105, v105 row_ror:8 row_mask:0xf bank_mask:0xf
s_nop 1
v_max_f32_dpp v104, v104, v104 row_ror:4 row_mask:0xf bank_mask:0xf
v_min_f32_dpp v105, v105, v105 row_ror:4 row_mask:0xf bank_mask:0xf
s_nop 1
v_max_f32_dpp v104, v104, v104 row_ror:2 row_mask:0xf bank_mask:0xf
v_min_f32_dpp v105, v105, v105 row_ror:2 row_mask:0xf bank_mask:0xf
s_nop 1
v_max_f32_dpp v104, v104, v104 row_ror:1 row_mask:0xf bank_mask:0xf
v_min_f32_dpp v105, v105, v105 row_ror:1 row_mask:0xf bank_mask:0xf
v_sub_f32 v130, v190, v104
v_sub_f32 v138, v105, v190
v_mul_f32 v130, 1069066811, v130
v_mul_f32 v138, 1069066811, v138
v_exp_f32 v130, v130
v_exp_f32 v138, v138
v_sub_f32 v134, v194, v104
v_sub_f32 v142, v105, v194
v_mul_f32 v134, 1069066811, v134
v_mul_f32 v142, 1069066811, v142
v_exp_f32 v134, v134
v_exp_f32 v142, v142
s_nop 0
v_add_f32 v104, v130, v134
v_add_f32 v105, v138, v142
s_nop 1
v_add_f32_dpp v104, v104, v104 row_ror:8 row_mask:0xf bank_mask:0xf
v_add_f32_dpp v105, v105, v105 row_ror:8 row_mask:0xf bank_mask:0xf
s_nop 1
v_add_f32_dpp v104, v104, v104 row_ror:4 row_mask:0xf bank_mask:0xf
v_add_f32_dpp v105, v105, v105 row_ror:4 row_mask:0xf bank_mask:0xf
s_nop 1
v_add_f32_dpp v104, v104, v104 row_ror:2 row_mask:0xf bank_mask:0xf
v_add_f32_dpp v105, v105, v105 row_ror:2 row_mask:0xf bank_mask:0xf
s_nop 1
v_add_f32_dpp v104, v104, v104 row_ror:1 row_mask:0xf bank_mask:0xf
v_add_f32_dpp v105, v105, v105 row_ror:1 row_mask:0xf bank_mask:0xf
v_rcp_f32 v104, v104
v_rcp_f32 v105, v105
s_nop 0
v_mul_f32 v130, v130, v104
v_mul_f32 v138, v138, v105
v_mul_f32 v134, v134, v104
v_mul_f32 v142, v142, v105
v_max_f32 v104, v191, v195
v_min_f32 v105, v191, v195
s_nop 1
v_max_f32_dpp v104, v104, v104 row_ror:8 row_mask:0xf bank_mask:0xf
v_min_f32_dpp v105, v105, v105 row_ror:8 row_mask:0xf bank_mask:0xf
s_nop 1
v_max_f32_dpp v104, v104, v104 row_ror:4 row_mask:0xf bank_mask:0xf
v_min_f32_dpp v105, v105, v105 row_ror:4 row_mask:0xf bank_mask:0xf
s_nop 1
v_max_f32_dpp v104, v104, v104 row_ror:2 row_mask:0xf bank_mask:0xf
v_min_f32_dpp v105, v105, v105 row_ror:2 row_mask:0xf bank_mask:0xf
s_nop 1
v_max_f32_dpp v104, v104, v104 row_ror:1 row_mask:0xf bank_mask:0xf
v_min_f32_dpp v105, v105, v105 row_ror:1 row_mask:0xf bank_mask:0xf
v_sub_f32 v131, v191, v104
v_sub_f32 v139, v105, v191
v_mul_f32 v131, 1069066811, v131
v_mul_f32 v139, 1069066811, v139
v_exp_f32 v131, v131
v_exp_f32 v139, v139
v_sub_f32 v135, v195, v104
v_sub_f32 v143, v105, v195
v_mul_f32 v135, 1069066811, v135
v_mul_f32 v143, 1069066811, v143
v_exp_f32 v135, v135
v_exp_f32 v143, v143
s_nop 0
v_add_f32 v104, v131, v135
v_add_f32 v105, v139, v143
s_nop 1
v_add_f32_dpp v104, v104, v104 row_ror:8 row_mask:0xf bank_mask:0xf
v_add_f32_dpp v105, v105, v105 row_ror:8 row_mask:0xf bank_mask:0xf
s_nop 1
v_add_f32_dpp v104, v104, v104 row_ror:4 row_mask:0xf bank_mask:0xf
v_add_f32_dpp v105, v105, v105 row_ror:4 row_mask:0xf bank_mask:0xf
s_nop 1
v_add_f32_dpp v104, v104, v104 row_ror:2 row_mask:0xf bank_mask:0xf
v_add_f32_dpp v105, v105, v105 row_ror:2 row_mask:0xf bank_mask:0xf
s_nop 1
v_add_f32_dpp v104, v104, v104 row_ror:1 row_mask:0xf bank_mask:0xf
v_add_f32_dpp v105, v105, v105 row_ror:1 row_mask:0xf bank_mask:0xf
v_rcp_f32 v104, v104
v_rcp_f32 v105, v105
s_nop 0
v_mul_f32 v131, v131, v104
v_mul_f32 v139, v139, v105
v_mul_f32 v135, v135, v104
v_mul_f32 v143, v143, v105
v_cvt_pk_bf16_f32 v144, v128, v129
v_cvt_pk_bf16_f32 v145, v130, v131
v_cvt_pk_bf16_f32 v146, v132, v133
v_cvt_pk_bf16_f32 v147, v134, v135
v_cvt_pk_bf16_f32 v148, v136, v137
v_cvt_pk_bf16_f32 v149, v138, v139
v_cvt_pk_bf16_f32 v150, v140, v141
v_cvt_pk_bf16_f32 v151, v142, v143
s_nop 1
v_mfma_f32_16x16x16_bf16 a[112:115], v[144:145], v[176:177], a[112:115]
v_mfma_f32_16x16x16_bf16 a[116:119], v[144:145], v[178:179], a[116:119]
v_mfma_f32_16x16x16_bf16 a[120:123], v[144:145], v[98:99], a[120:123]
v_mfma_f32_16x16x16_bf16 a[124:127], v[146:147], v[176:177], a[124:127]
v_mfma_f32_16x16x16_bf16 a[128:131], v[146:147], v[178:179], a[128:131]
v_mfma_f32_16x16x16_bf16 a[132:135], v[146:147], v[98:99], a[132:135]
v_mfma_f32_16x16x16_bf16 a[136:139], v[148:149], v[176:177], a[136:139]
v_mfma_f32_16x16x16_bf16 a[140:143], v[148:149], v[178:179], a[140:143]
v_mfma_f32_16x16x16_bf16 a[144:147], v[148:149], v[98:99], a[144:147]
v_mfma_f32_16x16x16_bf16 a[148:151], v[150:151], v[176:177], a[148:151]
v_mfma_f32_16x16x16_bf16 a[152:155], v[150:151], v[178:179], a[152:155]
v_mfma_f32_16x16x16_bf16 a[156:159], v[150:151], v[98:99], a[156:159]
s_nop 15
s_lshl_b32 s25, s22, 1
v_add_u32 v104, s25, v6
v_lshl_add_u32 v104, v10, 5, v104
s_movk_i32 s26, 2112
v_mul_lo_u32 v104, v104, s26
v_lshl_add_u32 v105, v5, 7, v104
v_add_u32 v105, v105, v4
v_lshlrev_b32 v105, 2, v105
v_accvgpr_read_b32 v106, a112
v_add_u32 v107, 0, v105
buffer_store_dword v106, v107, s[16:19], 0 offen offset:0
v_accvgpr_read_b32 v106, a113
v_add_u32 v107, 0, v105
buffer_store_dword v106, v107, s[16:19], 0 offen offset:128
v_accvgpr_read_b32 v106, a114
v_add_u32 v107, 0, v105
buffer_store_dword v106, v107, s[16:19], 0 offen offset:256
v_accvgpr_read_b32 v106, a115
v_add_u32 v107, 0, v105
buffer_store_dword v106, v107, s[16:19], 0 offen offset:384
v_accvgpr_read_b32 v106, a116
v_add_u32 v107, 0, v105
buffer_store_dword v106, v107, s[16:19], 0 offen offset:64
v_accvgpr_read_b32 v106, a117
v_add_u32 v107, 0, v105
buffer_store_dword v106, v107, s[16:19], 0 offen offset:192
v_accvgpr_read_b32 v106, a118
v_add_u32 v107, 0, v105
buffer_store_dword v106, v107, s[16:19], 0 offen offset:320
v_accvgpr_read_b32 v106, a119
v_add_u32 v107, 0, v105
buffer_store_dword v106, v107, s[16:19], 0 offen offset:448
v_accvgpr_read_b32 v106, a124
v_add_u32 v107, 2048, v105
buffer_store_dword v106, v107, s[16:19], 0 offen offset:0
v_accvgpr_read_b32 v106, a125
v_add_u32 v107, 2048, v105
buffer_store_dword v106, v107, s[16:19], 0 offen offset:128
v_accvgpr_read_b32 v106, a126
v_add_u32 v107, 2048, v105
buffer_store_dword v106, v107, s[16:19], 0 offen offset:256
v_accvgpr_read_b32 v106, a127
v_add_u32 v107, 2048, v105
buffer_store_dword v106, v107, s[16:19], 0 offen offset:384
v_accvgpr_read_b32 v106, a128
v_add_u32 v107, 2048, v105
buffer_store_dword v106, v107, s[16:19], 0 offen offset:64
v_accvgpr_read_b32 v106, a129
v_add_u32 v107, 2048, v105
buffer_store_dword v106, v107, s[16:19], 0 offen offset:192
v_accvgpr_read_b32 v106, a130
v_add_u32 v107, 2048, v105
buffer_store_dword v106, v107, s[16:19], 0 offen offset:320
v_accvgpr_read_b32 v106, a131
v_add_u32 v107, 2048, v105
buffer_store_dword v106, v107, s[16:19], 0 offen offset:448
v_accvgpr_read_b32 v106, a136
v_add_u32 v107, 4096, v105
buffer_store_dword v106, v107, s[16:19], 0 offen offset:0
v_accvgpr_read_b32 v106, a137
v_add_u32 v107, 4096, v105
buffer_store_dword v106, v107, s[16:19], 0 offen offset:128
v_accvgpr_read_b32 v106, a138
v_add_u32 v107, 4096, v105
buffer_store_dword v106, v107, s[16:19], 0 offen offset:256
v_accvgpr_read_b32 v106, a139
v_add_u32 v107, 4096, v105
buffer_store_dword v106, v107, s[16:19], 0 offen offset:384
v_accvgpr_read_b32 v106, a140
v_add_u32 v107, 4096, v105
buffer_store_dword v106, v107, s[16:19], 0 offen offset:64
v_accvgpr_read_b32 v106, a141
v_add_u32 v107, 4096, v105
buffer_store_dword v106, v107, s[16:19], 0 offen offset:192
v_accvgpr_read_b32 v106, a142
v_add_u32 v107, 4096, v105
buffer_store_dword v106, v107, s[16:19], 0 offen offset:320
v_accvgpr_read_b32 v106, a143
v_add_u32 v107, 4096, v105
buffer_store_dword v106, v107, s[16:19], 0 offen offset:448
v_accvgpr_read_b32 v106, a148
v_add_u32 v107, 6144, v105
buffer_store_dword v106, v107, s[16:19], 0 offen offset:0
v_accvgpr_read_b32 v106, a149
v_add_u32 v107, 6144, v105
buffer_store_dword v106, v107, s[16:19], 0 offen offset:128
v_accvgpr_read_b32 v106, a150
v_add_u32 v107, 6144, v105
buffer_store_dword v106, v107, s[16:19], 0 offen offset:256
v_accvgpr_read_b32 v106, a151
v_add_u32 v107, 6144, v105
buffer_store_dword v106, v107, s[16:19], 0 offen offset:384
v_accvgpr_read_b32 v106, a152
v_add_u32 v107, 6144, v105
buffer_store_dword v106, v107, s[16:19], 0 offen offset:64
v_accvgpr_read_b32 v106, a153
v_add_u32 v107, 6144, v105
buffer_store_dword v106, v107, s[16:19], 0 offen offset:192
v_accvgpr_read_b32 v106, a154
v_add_u32 v107, 6144, v105
buffer_store_dword v106, v107, s[16:19], 0 offen offset:320
v_accvgpr_read_b32 v106, a155
v_add_u32 v107, 6144, v105
buffer_store_dword v106, v107, s[16:19], 0 offen offset:448
v_lshl_add_u32 v105, v5, 2, v104
v_lshlrev_b32 v105, 2, v105
v_add_u32 v105, 8192, v105
v_cmp_eq_u32 vcc, 0, v4
s_and_saveexec_b64 s[30:31], vcc
v_accvgpr_read_b32 v106, a120
buffer_store_dword v106, v105, s[16:19], 0 offen offset:0
v_accvgpr_read_b32 v106, a121
buffer_store_dword v106, v105, s[16:19], 0 offen offset:4
v_accvgpr_read_b32 v106, a122
buffer_store_dword v106, v105, s[16:19], 0 offen offset:8
v_accvgpr_read_b32 v106, a123
buffer_store_dword v106, v105, s[16:19], 0 offen offset:12
v_accvgpr_read_b32 v106, a132
buffer_store_dword v106, v105, s[16:19], 0 offen offset:64
v_accvgpr_read_b32 v106, a133
buffer_store_dword v106, v105, s[16:19], 0 offen offset:68
v_accvgpr_read_b32 v106, a134
buffer_store_dword v106, v105, s[16:19], 0 offen offset:72
v_accvgpr_read_b32 v106, a135
buffer_store_dword v106, v105, s[16:19], 0 offen offset:76
v_accvgpr_read_b32 v106, a144
buffer_store_dword v106, v105, s[16:19], 0 offen offset:128
v_accvgpr_read_b32 v106, a145
buffer_store_dword v106, v105, s[16:19], 0 offen offset:132
v_accvgpr_read_b32 v106, a146
buffer_store_dword v106, v105, s[16:19], 0 offen offset:136
v_accvgpr_read_b32 v106, a147
buffer_store_dword v106, v105, s[16:19], 0 offen offset:140
v_accvgpr_read_b32 v106, a156
buffer_store_dword v106, v105, s[16:19], 0 offen offset:192
v_accvgpr_read_b32 v106, a157
buffer_store_dword v106, v105, s[16:19], 0 offen offset:196
v_accvgpr_read_b32 v106, a158
buffer_store_dword v106, v105, s[16:19], 0 offen offset:200
v_accvgpr_read_b32 v106, a159
buffer_store_dword v106, v105, s[16:19], 0 offen offset:204
s_mov_b64 exec, s[30:31]
qkv_kernel_end:
s_endpgm
.globl a3_kernel
.p2align 8
.type a3_kernel,@function
a3_kernel:
s_cmp_ge_u32 s2, 128
s_cbranch_scc1 a3_kernel_end
s_load_dwordx2 s[4:5], s[0:1], 88
s_load_dwordx2 s[8:9], s[0:1], 88
s_load_dwordx2 s[12:13], s[0:1], 88
s_lshr_b32 s20, s2, 2
s_and_b32 s21, s2, 3
v_and_b32 v1, 63, v0
v_lshrrev_b32 v2, 6, v0
v_and_b32 v4, 15, v1
v_lshrrev_b32 v5, 4, v1
s_waitcnt lgkmcnt(0)
s_add_u32 s4, s4, 41943040
s_addc_u32 s5, s5, 0
s_mov_b32 s6, 8650752
s_mov_b32 s7, 0x00020000
s_add_u32 s8, s8, 4194304
s_addc_u32 s9, s9, 0
s_mov_b32 s10, 8388608
s_mov_b32 s11, 0x00020000
s_add_u32 s12, s12, 12582912
s_addc_u32 s13, s13, 0
s_mov_b32 s14, 4194304
s_mov_b32 s15, 0x00020000
v_lshlrev_b32 v6, 2, v0
v_mov_b32 v7, 0
ds_write_b32 v6, v7 offset:0
ds_write_b32 v6, v7 offset:1024
ds_write_b32 v6, v7 offset:2048
ds_write_b32 v6, v7 offset:3072
ds_write_b32 v6, v7 offset:4096
ds_write_b32 v6, v7 offset:5120
ds_write_b32 v6, v7 offset:6144
s_waitcnt lgkmcnt(0)
s_barrier
s_mul_i32 s22, s20, 270336
v_lshlrev_b32 v8, 2, v0
v_add_u32 v8, 0, v8
v_lshlrev_b32 v9, 2, v8
v_add_u32 v9, s22, v9
v_add_u32 v11, 0, v9
buffer_load_dwordx4 v[20:23], v11, s[4:7], 0 offen
v_add_u32 v11, 8448, v9
buffer_load_dwordx4 v[24:27], v11, s[4:7], 0 offen
v_add_u32 v11, 16896, v9
buffer_load_dwordx4 v[28:31], v11, s[4:7], 0 offen
v_add_u32 v11, 25344, v9
buffer_load_dwordx4 v[32:35], v11, s[4:7], 0 offen
v_add_u32 v11, 33792, v9
buffer_load_dwordx4 v[36:39], v11, s[4:7], 0 offen
v_add_u32 v11, 42240, v9
buffer_load_dwordx4 v[40:43], v11, s[4:7], 0 offen
v_add_u32 v11, 50688, v9
buffer_load_dwordx4 v[44:47], v11, s[4:7], 0 offen
v_add_u32 v11, 59136, v9
buffer_load_dwordx4 v[48:51], v11, s[4:7], 0 offen
v_add_u32 v11, 67584, v9
buffer_load_dwordx4 v[52:55], v11, s[4:7], 0 offen
v_add_u32 v11, 76032, v9
buffer_load_dwordx4 v[56:59], v11, s[4:7], 0 offen
v_add_u32 v11, 84480, v9
buffer_load_dwordx4 v[60:63], v11, s[4:7], 0 offen
v_add_u32 v11, 92928, v9
buffer_load_dwordx4 v[64:67], v11, s[4:7], 0 offen
v_add_u32 v11, 101376, v9
buffer_load_dwordx4 v[68:71], v11, s[4:7], 0 offen
v_add_u32 v11, 109824, v9
buffer_load_dwordx4 v[72:75], v11, s[4:7], 0 offen
v_add_u32 v11, 118272, v9
buffer_load_dwordx4 v[76:79], v11, s[4:7], 0 offen
v_add_u32 v11, 126720, v9
buffer_load_dwordx4 v[80:83], v11, s[4:7], 0 offen
v_add_u32 v11, 135168, v9
buffer_load_dwordx4 v[84:87], v11, s[4:7], 0 offen
v_add_u32 v11, 143616, v9
buffer_load_dwordx4 v[88:91], v11, s[4:7], 0 offen
v_add_u32 v11, 152064, v9
buffer_load_dwordx4 v[92:95], v11, s[4:7], 0 offen
v_add_u32 v11, 160512, v9
buffer_load_dwordx4 v[96:99], v11, s[4:7], 0 offen
v_add_u32 v11, 168960, v9
buffer_load_dwordx4 v[100:103], v11, s[4:7], 0 offen
v_add_u32 v11, 177408, v9
buffer_load_dwordx4 v[104:107], v11, s[4:7], 0 offen
v_add_u32 v11, 185856, v9
buffer_load_dwordx4 v[108:111], v11, s[4:7], 0 offen
v_add_u32 v11, 194304, v9
buffer_load_dwordx4 v[112:115], v11, s[4:7], 0 offen
v_add_u32 v11, 202752, v9
buffer_load_dwordx4 v[116:119], v11, s[4:7], 0 offen
v_add_u32 v11, 211200, v9
buffer_load_dwordx4 v[120:123], v11, s[4:7], 0 offen
v_add_u32 v11, 219648, v9
buffer_load_dwordx4 v[124:127], v11, s[4:7], 0 offen
v_add_u32 v11, 228096, v9
buffer_load_dwordx4 v[128:131], v11, s[4:7], 0 offen
v_add_u32 v11, 236544, v9
buffer_load_dwordx4 v[132:135], v11, s[4:7], 0 offen
v_add_u32 v11, 244992, v9
buffer_load_dwordx4 v[136:139], v11, s[4:7], 0 offen
v_add_u32 v11, 253440, v9
buffer_load_dwordx4 v[140:143], v11, s[4:7], 0 offen
v_add_u32 v11, 261888, v9
buffer_load_dwordx4 v[144:147], v11, s[4:7], 0 offen
s_waitcnt vmcnt(0)
v_add_f32 v20, v20, v24
v_add_f32 v21, v21, v25
v_add_f32 v22, v22, v26
v_add_f32 v23, v23, v27
v_add_f32 v20, v20, v28
v_add_f32 v21, v21, v29
v_add_f32 v22, v22, v30
v_add_f32 v23, v23, v31
v_add_f32 v20, v20, v32
v_add_f32 v21, v21, v33
v_add_f32 v22, v22, v34
v_add_f32 v23, v23, v35
v_add_f32 v20, v20, v36
v_add_f32 v21, v21, v37
v_add_f32 v22, v22, v38
v_add_f32 v23, v23, v39
v_add_f32 v20, v20, v40
v_add_f32 v21, v21, v41
v_add_f32 v22, v22, v42
v_add_f32 v23, v23, v43
v_add_f32 v20, v20, v44
v_add_f32 v21, v21, v45
v_add_f32 v22, v22, v46
v_add_f32 v23, v23, v47
v_add_f32 v20, v20, v48
v_add_f32 v21, v21, v49
v_add_f32 v22, v22, v50
v_add_f32 v23, v23, v51
v_add_f32 v20, v20, v52
v_add_f32 v21, v21, v53
v_add_f32 v22, v22, v54
v_add_f32 v23, v23, v55
v_add_f32 v20, v20, v56
v_add_f32 v21, v21, v57
v_add_f32 v22, v22, v58
v_add_f32 v23, v23, v59
v_add_f32 v20, v20, v60
v_add_f32 v21, v21, v61
v_add_f32 v22, v22, v62
v_add_f32 v23, v23, v63
v_add_f32 v20, v20, v64
v_add_f32 v21, v21, v65
v_add_f32 v22, v22, v66
v_add_f32 v23, v23, v67
v_add_f32 v20, v20, v68
v_add_f32 v21, v21, v69
v_add_f32 v22, v22, v70
v_add_f32 v23, v23, v71
v_add_f32 v20, v20, v72
v_add_f32 v21, v21, v73
v_add_f32 v22, v22, v74
v_add_f32 v23, v23, v75
v_add_f32 v20, v20, v76
v_add_f32 v21, v21, v77
v_add_f32 v22, v22, v78
v_add_f32 v23, v23, v79
v_add_f32 v20, v20, v80
v_add_f32 v21, v21, v81
v_add_f32 v22, v22, v82
v_add_f32 v23, v23, v83
v_add_f32 v20, v20, v84
v_add_f32 v21, v21, v85
v_add_f32 v22, v22, v86
v_add_f32 v23, v23, v87
v_add_f32 v20, v20, v88
v_add_f32 v21, v21, v89
v_add_f32 v22, v22, v90
v_add_f32 v23, v23, v91
v_add_f32 v20, v20, v92
v_add_f32 v21, v21, v93
v_add_f32 v22, v22, v94
v_add_f32 v23, v23, v95
v_add_f32 v20, v20, v96
v_add_f32 v21, v21, v97
v_add_f32 v22, v22, v98
v_add_f32 v23, v23, v99
v_add_f32 v20, v20, v100
v_add_f32 v21, v21, v101
v_add_f32 v22, v22, v102
v_add_f32 v23, v23, v103
v_add_f32 v20, v20, v104
v_add_f32 v21, v21, v105
v_add_f32 v22, v22, v106
v_add_f32 v23, v23, v107
v_add_f32 v20, v20, v108
v_add_f32 v21, v21, v109
v_add_f32 v22, v22, v110
v_add_f32 v23, v23, v111
v_add_f32 v20, v20, v112
v_add_f32 v21, v21, v113
v_add_f32 v22, v22, v114
v_add_f32 v23, v23, v115
v_add_f32 v20, v20, v116
v_add_f32 v21, v21, v117
v_add_f32 v22, v22, v118
v_add_f32 v23, v23, v119
v_add_f32 v20, v20, v120
v_add_f32 v21, v21, v121
v_add_f32 v22, v22, v122
v_add_f32 v23, v23, v123
v_add_f32 v20, v20, v124
v_add_f32 v21, v21, v125
v_add_f32 v22, v22, v126
v_add_f32 v23, v23, v127
v_add_f32 v20, v20, v128
v_add_f32 v21, v21, v129
v_add_f32 v22, v22, v130
v_add_f32 v23, v23, v131
v_add_f32 v20, v20, v132
v_add_f32 v21, v21, v133
v_add_f32 v22, v22, v134
v_add_f32 v23, v23, v135
v_add_f32 v20, v20, v136
v_add_f32 v21, v21, v137
v_add_f32 v22, v22, v138
v_add_f32 v23, v23, v139
v_add_f32 v20, v20, v140
v_add_f32 v21, v21, v141
v_add_f32 v22, v22, v142
v_add_f32 v23, v23, v143
v_add_f32 v20, v20, v144
v_add_f32 v21, v21, v145
v_add_f32 v22, v22, v146
v_add_f32 v23, v23, v147
v_lshrrev_b32 v12, 5, v8
v_and_b32 v13, 31, v8
v_mul_u32_u24 v13, 144, v13
v_lshl_add_u32 v13, v12, 1, v13
v_cvt_pk_bf16_f32 v10, v20, v20
ds_write_b16 v13, v10 offset:0
v_cvt_pk_bf16_f32 v10, v21, v21
ds_write_b16 v13, v10 offset:144
v_cvt_pk_bf16_f32 v10, v22, v22
ds_write_b16 v13, v10 offset:288
v_cvt_pk_bf16_f32 v10, v23, v23
ds_write_b16 v13, v10 offset:432
v_lshlrev_b32 v8, 2, v0
v_add_u32 v8, 1024, v8
v_lshlrev_b32 v9, 2, v8
v_add_u32 v9, s22, v9
v_add_u32 v11, 0, v9
buffer_load_dwordx4 v[20:23], v11, s[4:7], 0 offen
v_add_u32 v11, 8448, v9
buffer_load_dwordx4 v[24:27], v11, s[4:7], 0 offen
v_add_u32 v11, 16896, v9
buffer_load_dwordx4 v[28:31], v11, s[4:7], 0 offen
v_add_u32 v11, 25344, v9
buffer_load_dwordx4 v[32:35], v11, s[4:7], 0 offen
v_add_u32 v11, 33792, v9
buffer_load_dwordx4 v[36:39], v11, s[4:7], 0 offen
v_add_u32 v11, 42240, v9
buffer_load_dwordx4 v[40:43], v11, s[4:7], 0 offen
v_add_u32 v11, 50688, v9
buffer_load_dwordx4 v[44:47], v11, s[4:7], 0 offen
v_add_u32 v11, 59136, v9
buffer_load_dwordx4 v[48:51], v11, s[4:7], 0 offen
v_add_u32 v11, 67584, v9
buffer_load_dwordx4 v[52:55], v11, s[4:7], 0 offen
v_add_u32 v11, 76032, v9
buffer_load_dwordx4 v[56:59], v11, s[4:7], 0 offen
v_add_u32 v11, 84480, v9
buffer_load_dwordx4 v[60:63], v11, s[4:7], 0 offen
v_add_u32 v11, 92928, v9
buffer_load_dwordx4 v[64:67], v11, s[4:7], 0 offen
v_add_u32 v11, 101376, v9
buffer_load_dwordx4 v[68:71], v11, s[4:7], 0 offen
v_add_u32 v11, 109824, v9
buffer_load_dwordx4 v[72:75], v11, s[4:7], 0 offen
v_add_u32 v11, 118272, v9
buffer_load_dwordx4 v[76:79], v11, s[4:7], 0 offen
v_add_u32 v11, 126720, v9
buffer_load_dwordx4 v[80:83], v11, s[4:7], 0 offen
v_add_u32 v11, 135168, v9
buffer_load_dwordx4 v[84:87], v11, s[4:7], 0 offen
v_add_u32 v11, 143616, v9
buffer_load_dwordx4 v[88:91], v11, s[4:7], 0 offen
v_add_u32 v11, 152064, v9
buffer_load_dwordx4 v[92:95], v11, s[4:7], 0 offen
v_add_u32 v11, 160512, v9
buffer_load_dwordx4 v[96:99], v11, s[4:7], 0 offen
v_add_u32 v11, 168960, v9
buffer_load_dwordx4 v[100:103], v11, s[4:7], 0 offen
v_add_u32 v11, 177408, v9
buffer_load_dwordx4 v[104:107], v11, s[4:7], 0 offen
v_add_u32 v11, 185856, v9
buffer_load_dwordx4 v[108:111], v11, s[4:7], 0 offen
v_add_u32 v11, 194304, v9
buffer_load_dwordx4 v[112:115], v11, s[4:7], 0 offen
v_add_u32 v11, 202752, v9
buffer_load_dwordx4 v[116:119], v11, s[4:7], 0 offen
v_add_u32 v11, 211200, v9
buffer_load_dwordx4 v[120:123], v11, s[4:7], 0 offen
v_add_u32 v11, 219648, v9
buffer_load_dwordx4 v[124:127], v11, s[4:7], 0 offen
v_add_u32 v11, 228096, v9
buffer_load_dwordx4 v[128:131], v11, s[4:7], 0 offen
v_add_u32 v11, 236544, v9
buffer_load_dwordx4 v[132:135], v11, s[4:7], 0 offen
v_add_u32 v11, 244992, v9
buffer_load_dwordx4 v[136:139], v11, s[4:7], 0 offen
v_add_u32 v11, 253440, v9
buffer_load_dwordx4 v[140:143], v11, s[4:7], 0 offen
v_add_u32 v11, 261888, v9
buffer_load_dwordx4 v[144:147], v11, s[4:7], 0 offen
s_waitcnt vmcnt(0)
v_add_f32 v20, v20, v24
v_add_f32 v21, v21, v25
v_add_f32 v22, v22, v26
v_add_f32 v23, v23, v27
v_add_f32 v20, v20, v28
v_add_f32 v21, v21, v29
v_add_f32 v22, v22, v30
v_add_f32 v23, v23, v31
v_add_f32 v20, v20, v32
v_add_f32 v21, v21, v33
v_add_f32 v22, v22, v34
v_add_f32 v23, v23, v35
v_add_f32 v20, v20, v36
v_add_f32 v21, v21, v37
v_add_f32 v22, v22, v38
v_add_f32 v23, v23, v39
v_add_f32 v20, v20, v40
v_add_f32 v21, v21, v41
v_add_f32 v22, v22, v42
v_add_f32 v23, v23, v43
v_add_f32 v20, v20, v44
v_add_f32 v21, v21, v45
v_add_f32 v22, v22, v46
v_add_f32 v23, v23, v47
v_add_f32 v20, v20, v48
v_add_f32 v21, v21, v49
v_add_f32 v22, v22, v50
v_add_f32 v23, v23, v51
v_add_f32 v20, v20, v52
v_add_f32 v21, v21, v53
v_add_f32 v22, v22, v54
v_add_f32 v23, v23, v55
v_add_f32 v20, v20, v56
v_add_f32 v21, v21, v57
v_add_f32 v22, v22, v58
v_add_f32 v23, v23, v59
v_add_f32 v20, v20, v60
v_add_f32 v21, v21, v61
v_add_f32 v22, v22, v62
v_add_f32 v23, v23, v63
v_add_f32 v20, v20, v64
v_add_f32 v21, v21, v65
v_add_f32 v22, v22, v66
v_add_f32 v23, v23, v67
v_add_f32 v20, v20, v68
v_add_f32 v21, v21, v69
v_add_f32 v22, v22, v70
v_add_f32 v23, v23, v71
v_add_f32 v20, v20, v72
v_add_f32 v21, v21, v73
v_add_f32 v22, v22, v74
v_add_f32 v23, v23, v75
v_add_f32 v20, v20, v76
v_add_f32 v21, v21, v77
v_add_f32 v22, v22, v78
v_add_f32 v23, v23, v79
v_add_f32 v20, v20, v80
v_add_f32 v21, v21, v81
v_add_f32 v22, v22, v82
v_add_f32 v23, v23, v83
v_add_f32 v20, v20, v84
v_add_f32 v21, v21, v85
v_add_f32 v22, v22, v86
v_add_f32 v23, v23, v87
v_add_f32 v20, v20, v88
v_add_f32 v21, v21, v89
v_add_f32 v22, v22, v90
v_add_f32 v23, v23, v91
v_add_f32 v20, v20, v92
v_add_f32 v21, v21, v93
v_add_f32 v22, v22, v94
v_add_f32 v23, v23, v95
v_add_f32 v20, v20, v96
v_add_f32 v21, v21, v97
v_add_f32 v22, v22, v98
v_add_f32 v23, v23, v99
v_add_f32 v20, v20, v100
v_add_f32 v21, v21, v101
v_add_f32 v22, v22, v102
v_add_f32 v23, v23, v103
v_add_f32 v20, v20, v104
v_add_f32 v21, v21, v105
v_add_f32 v22, v22, v106
v_add_f32 v23, v23, v107
v_add_f32 v20, v20, v108
v_add_f32 v21, v21, v109
v_add_f32 v22, v22, v110
v_add_f32 v23, v23, v111
v_add_f32 v20, v20, v112
v_add_f32 v21, v21, v113
v_add_f32 v22, v22, v114
v_add_f32 v23, v23, v115
v_add_f32 v20, v20, v116
v_add_f32 v21, v21, v117
v_add_f32 v22, v22, v118
v_add_f32 v23, v23, v119
v_add_f32 v20, v20, v120
v_add_f32 v21, v21, v121
v_add_f32 v22, v22, v122
v_add_f32 v23, v23, v123
v_add_f32 v20, v20, v124
v_add_f32 v21, v21, v125
v_add_f32 v22, v22, v126
v_add_f32 v23, v23, v127
v_add_f32 v20, v20, v128
v_add_f32 v21, v21, v129
v_add_f32 v22, v22, v130
v_add_f32 v23, v23, v131
v_add_f32 v20, v20, v132
v_add_f32 v21, v21, v133
v_add_f32 v22, v22, v134
v_add_f32 v23, v23, v135
v_add_f32 v20, v20, v136
v_add_f32 v21, v21, v137
v_add_f32 v22, v22, v138
v_add_f32 v23, v23, v139
v_add_f32 v20, v20, v140
v_add_f32 v21, v21, v141
v_add_f32 v22, v22, v142
v_add_f32 v23, v23, v143
v_add_f32 v20, v20, v144
v_add_f32 v21, v21, v145
v_add_f32 v22, v22, v146
v_add_f32 v23, v23, v147
v_lshrrev_b32 v12, 5, v8
v_and_b32 v13, 31, v8
v_mul_u32_u24 v13, 144, v13
v_lshl_add_u32 v13, v12, 1, v13
v_cvt_pk_bf16_f32 v10, v20, v20
ds_write_b16 v13, v10 offset:0
v_cvt_pk_bf16_f32 v10, v21, v21
ds_write_b16 v13, v10 offset:144
v_cvt_pk_bf16_f32 v10, v22, v22
ds_write_b16 v13, v10 offset:288
v_cvt_pk_bf16_f32 v10, v23, v23
ds_write_b16 v13, v10 offset:432
v_lshlrev_b32 v8, 2, v0
v_add_u32 v8, 2048, v8
v_lshlrev_b32 v9, 2, v8
v_add_u32 v9, s22, v9
v_cmp_gt_u32 vcc, 16, v0
s_and_saveexec_b64 s[30:31], vcc
v_add_u32 v11, 0, v9
buffer_load_dwordx4 v[20:23], v11, s[4:7], 0 offen
v_add_u32 v11, 8448, v9
buffer_load_dwordx4 v[24:27], v11, s[4:7], 0 offen
v_add_u32 v11, 16896, v9
buffer_load_dwordx4 v[28:31], v11, s[4:7], 0 offen
v_add_u32 v11, 25344, v9
buffer_load_dwordx4 v[32:35], v11, s[4:7], 0 offen
v_add_u32 v11, 33792, v9
buffer_load_dwordx4 v[36:39], v11, s[4:7], 0 offen
v_add_u32 v11, 42240, v9
buffer_load_dwordx4 v[40:43], v11, s[4:7], 0 offen
v_add_u32 v11, 50688, v9
buffer_load_dwordx4 v[44:47], v11, s[4:7], 0 offen
v_add_u32 v11, 59136, v9
buffer_load_dwordx4 v[48:51], v11, s[4:7], 0 offen
v_add_u32 v11, 67584, v9
buffer_load_dwordx4 v[52:55], v11, s[4:7], 0 offen
v_add_u32 v11, 76032, v9
buffer_load_dwordx4 v[56:59], v11, s[4:7], 0 offen
v_add_u32 v11, 84480, v9
buffer_load_dwordx4 v[60:63], v11, s[4:7], 0 offen
v_add_u32 v11, 92928, v9
buffer_load_dwordx4 v[64:67], v11, s[4:7], 0 offen
v_add_u32 v11, 101376, v9
buffer_load_dwordx4 v[68:71], v11, s[4:7], 0 offen
v_add_u32 v11, 109824, v9
buffer_load_dwordx4 v[72:75], v11, s[4:7], 0 offen
v_add_u32 v11, 118272, v9
buffer_load_dwordx4 v[76:79], v11, s[4:7], 0 offen
v_add_u32 v11, 126720, v9
buffer_load_dwordx4 v[80:83], v11, s[4:7], 0 offen
v_add_u32 v11, 135168, v9
buffer_load_dwordx4 v[84:87], v11, s[4:7], 0 offen
v_add_u32 v11, 143616, v9
buffer_load_dwordx4 v[88:91], v11, s[4:7], 0 offen
v_add_u32 v11, 152064, v9
buffer_load_dwordx4 v[92:95], v11, s[4:7], 0 offen
v_add_u32 v11, 160512, v9
buffer_load_dwordx4 v[96:99], v11, s[4:7], 0 offen
v_add_u32 v11, 168960, v9
buffer_load_dwordx4 v[100:103], v11, s[4:7], 0 offen
v_add_u32 v11, 177408, v9
buffer_load_dwordx4 v[104:107], v11, s[4:7], 0 offen
v_add_u32 v11, 185856, v9
buffer_load_dwordx4 v[108:111], v11, s[4:7], 0 offen
v_add_u32 v11, 194304, v9
buffer_load_dwordx4 v[112:115], v11, s[4:7], 0 offen
v_add_u32 v11, 202752, v9
buffer_load_dwordx4 v[116:119], v11, s[4:7], 0 offen
v_add_u32 v11, 211200, v9
buffer_load_dwordx4 v[120:123], v11, s[4:7], 0 offen
v_add_u32 v11, 219648, v9
buffer_load_dwordx4 v[124:127], v11, s[4:7], 0 offen
v_add_u32 v11, 228096, v9
buffer_load_dwordx4 v[128:131], v11, s[4:7], 0 offen
v_add_u32 v11, 236544, v9
buffer_load_dwordx4 v[132:135], v11, s[4:7], 0 offen
v_add_u32 v11, 244992, v9
buffer_load_dwordx4 v[136:139], v11, s[4:7], 0 offen
v_add_u32 v11, 253440, v9
buffer_load_dwordx4 v[140:143], v11, s[4:7], 0 offen
v_add_u32 v11, 261888, v9
buffer_load_dwordx4 v[144:147], v11, s[4:7], 0 offen
s_waitcnt vmcnt(0)
v_add_f32 v20, v20, v24
v_add_f32 v21, v21, v25
v_add_f32 v22, v22, v26
v_add_f32 v23, v23, v27
v_add_f32 v20, v20, v28
v_add_f32 v21, v21, v29
v_add_f32 v22, v22, v30
v_add_f32 v23, v23, v31
v_add_f32 v20, v20, v32
v_add_f32 v21, v21, v33
v_add_f32 v22, v22, v34
v_add_f32 v23, v23, v35
v_add_f32 v20, v20, v36
v_add_f32 v21, v21, v37
v_add_f32 v22, v22, v38
v_add_f32 v23, v23, v39
v_add_f32 v20, v20, v40
v_add_f32 v21, v21, v41
v_add_f32 v22, v22, v42
v_add_f32 v23, v23, v43
v_add_f32 v20, v20, v44
v_add_f32 v21, v21, v45
v_add_f32 v22, v22, v46
v_add_f32 v23, v23, v47
v_add_f32 v20, v20, v48
v_add_f32 v21, v21, v49
v_add_f32 v22, v22, v50
v_add_f32 v23, v23, v51
v_add_f32 v20, v20, v52
v_add_f32 v21, v21, v53
v_add_f32 v22, v22, v54
v_add_f32 v23, v23, v55
v_add_f32 v20, v20, v56
v_add_f32 v21, v21, v57
v_add_f32 v22, v22, v58
v_add_f32 v23, v23, v59
v_add_f32 v20, v20, v60
v_add_f32 v21, v21, v61
v_add_f32 v22, v22, v62
v_add_f32 v23, v23, v63
v_add_f32 v20, v20, v64
v_add_f32 v21, v21, v65
v_add_f32 v22, v22, v66
v_add_f32 v23, v23, v67
v_add_f32 v20, v20, v68
v_add_f32 v21, v21, v69
v_add_f32 v22, v22, v70
v_add_f32 v23, v23, v71
v_add_f32 v20, v20, v72
v_add_f32 v21, v21, v73
v_add_f32 v22, v22, v74
v_add_f32 v23, v23, v75
v_add_f32 v20, v20, v76
v_add_f32 v21, v21, v77
v_add_f32 v22, v22, v78
v_add_f32 v23, v23, v79
v_add_f32 v20, v20, v80
v_add_f32 v21, v21, v81
v_add_f32 v22, v22, v82
v_add_f32 v23, v23, v83
v_add_f32 v20, v20, v84
v_add_f32 v21, v21, v85
v_add_f32 v22, v22, v86
v_add_f32 v23, v23, v87
v_add_f32 v20, v20, v88
v_add_f32 v21, v21, v89
v_add_f32 v22, v22, v90
v_add_f32 v23, v23, v91
v_add_f32 v20, v20, v92
v_add_f32 v21, v21, v93
v_add_f32 v22, v22, v94
v_add_f32 v23, v23, v95
v_add_f32 v20, v20, v96
v_add_f32 v21, v21, v97
v_add_f32 v22, v22, v98
v_add_f32 v23, v23, v99
v_add_f32 v20, v20, v100
v_add_f32 v21, v21, v101
v_add_f32 v22, v22, v102
v_add_f32 v23, v23, v103
v_add_f32 v20, v20, v104
v_add_f32 v21, v21, v105
v_add_f32 v22, v22, v106
v_add_f32 v23, v23, v107
v_add_f32 v20, v20, v108
v_add_f32 v21, v21, v109
v_add_f32 v22, v22, v110
v_add_f32 v23, v23, v111
v_add_f32 v20, v20, v112
v_add_f32 v21, v21, v113
v_add_f32 v22, v22, v114
v_add_f32 v23, v23, v115
v_add_f32 v20, v20, v116
v_add_f32 v21, v21, v117
v_add_f32 v22, v22, v118
v_add_f32 v23, v23, v119
v_add_f32 v20, v20, v120
v_add_f32 v21, v21, v121
v_add_f32 v22, v22, v122
v_add_f32 v23, v23, v123
v_add_f32 v20, v20, v124
v_add_f32 v21, v21, v125
v_add_f32 v22, v22, v126
v_add_f32 v23, v23, v127
v_add_f32 v20, v20, v128
v_add_f32 v21, v21, v129
v_add_f32 v22, v22, v130
v_add_f32 v23, v23, v131
v_add_f32 v20, v20, v132
v_add_f32 v21, v21, v133
v_add_f32 v22, v22, v134
v_add_f32 v23, v23, v135
v_add_f32 v20, v20, v136
v_add_f32 v21, v21, v137
v_add_f32 v22, v22, v138
v_add_f32 v23, v23, v139
v_add_f32 v20, v20, v140
v_add_f32 v21, v21, v141
v_add_f32 v22, v22, v142
v_add_f32 v23, v23, v143
v_add_f32 v20, v20, v144
v_add_f32 v21, v21, v145
v_add_f32 v22, v22, v146
v_add_f32 v23, v23, v147
v_lshrrev_b32 v12, 5, v8
v_and_b32 v13, 31, v8
v_subrev_u32 v12, 2048, v8
v_mov_b32 v13, 32
v_mul_u32_u24 v13, 144, v13
v_lshl_add_u32 v13, v12, 1, v13
v_cvt_pk_bf16_f32 v10, v20, v20
ds_write_b16 v13, v10 offset:0
v_cvt_pk_bf16_f32 v10, v21, v21
ds_write_b16 v13, v10 offset:2
v_cvt_pk_bf16_f32 v10, v22, v22
ds_write_b16 v13, v10 offset:4
v_cvt_pk_bf16_f32 v10, v23, v23
ds_write_b16 v13, v10 offset:6
s_mov_b64 exec, s[30:31]
s_waitcnt lgkmcnt(0)
s_barrier
v_mul_u32_u24 v8, 144, v4
v_lshl_add_u32 v8, v5, 4, v8
ds_read_b128 v[60:63], v8 offset:0
ds_read_b128 v[64:67], v8 offset:64
ds_read_b128 v[68:71], v8 offset:2304
ds_read_b128 v[72:75], v8 offset:2368
ds_read_b128 v[76:79], v8 offset:4608
ds_read_b128 v[80:83], v8 offset:4672
s_lshl_b32 s23, s21, 9
v_lshl_add_u32 v9, v2, 7, v4
v_add_u32 v9, s23, v9
v_lshl_add_u32 v10, v9, 5, s20
v_lshlrev_b32 v10, 7, v10
v_lshl_add_u32 v10, v5, 4, v10
v_add_u32 v11, 0, v10
buffer_load_dwordx4 v[100:103], v11, s[8:11], 0 offen
v_add_u32 v11, 64, v10
buffer_load_dwordx4 v[104:107], v11, s[8:11], 0 offen
v_add_u32 v11, 65536, v10
buffer_load_dwordx4 v[108:111], v11, s[8:11], 0 offen
v_add_u32 v11, 65600, v10
buffer_load_dwordx4 v[112:115], v11, s[8:11], 0 offen
v_add_u32 v11, 131072, v10
buffer_load_dwordx4 v[116:119], v11, s[8:11], 0 offen
v_add_u32 v11, 131136, v10
buffer_load_dwordx4 v[120:123], v11, s[8:11], 0 offen
v_add_u32 v11, 196608, v10
buffer_load_dwordx4 v[124:127], v11, s[8:11], 0 offen
v_add_u32 v11, 196672, v10
buffer_load_dwordx4 v[128:131], v11, s[8:11], 0 offen
v_add_u32 v11, 262144, v10
buffer_load_dwordx4 v[132:135], v11, s[8:11], 0 offen
v_add_u32 v11, 262208, v10
buffer_load_dwordx4 v[136:139], v11, s[8:11], 0 offen
v_add_u32 v11, 327680, v10
buffer_load_dwordx4 v[140:143], v11, s[8:11], 0 offen
v_add_u32 v11, 327744, v10
buffer_load_dwordx4 v[144:147], v11, s[8:11], 0 offen
v_add_u32 v11, 393216, v10
buffer_load_dwordx4 v[148:151], v11, s[8:11], 0 offen
v_add_u32 v11, 393280, v10
buffer_load_dwordx4 v[152:155], v11, s[8:11], 0 offen
v_add_u32 v11, 458752, v10
buffer_load_dwordx4 v[156:159], v11, s[8:11], 0 offen
v_add_u32 v11, 458816, v10
buffer_load_dwordx4 v[160:163], v11, s[8:11], 0 offen
v_lshlrev_b32 v12, 2, v4
v_lshlrev_b32 v13, 11, v9
s_lshl_b32 s24, s20, 6
v_add_u32 v13, s24, v13
v_lshl_add_u32 v13, v5, 3, v13
s_waitcnt vmcnt(0) lgkmcnt(0)
v_mfma_f32_16x16x32_bf16 v[180:183], v[60:63], v[100:103], 0
v_mfma_f32_16x16x32_bf16 v[180:183], v[64:67], v[104:107], v[180:183]
v_mfma_f32_16x16x32_bf16 v[184:187], v[68:71], v[100:103], 0
v_mfma_f32_16x16x32_bf16 v[184:187], v[72:75], v[104:107], v[184:187]
v_mfma_f32_16x16x32_bf16 v[188:191], v[76:79], v[100:103], 0
v_mfma_f32_16x16x32_bf16 v[188:191], v[80:83], v[104:107], v[188:191]
s_nop 15
ds_bpermute_b32 v192, v12, v188
s_waitcnt lgkmcnt(0)
v_cvt_pk_bf16_f32 v192, v192, v192
v_lshlrev_b32 v192, 16, v192
v_add_f32 v192, 0x358637bd, v192
v_cvt_pk_bf16_f32 v192, v192, v192
v_lshlrev_b32 v192, 16, v192
v_rcp_f32 v192, v192
v_cvt_pk_bf16_f32 v193, v180, v181
v_lshlrev_b32 v180, 16, v193
v_and_b32 v181, 0xffff0000, v193
v_cvt_pk_bf16_f32 v193, v182, v183
v_lshlrev_b32 v182, 16, v193
v_and_b32 v183, 0xffff0000, v193
v_cvt_pk_bf16_f32 v193, v184, v185
v_lshlrev_b32 v184, 16, v193
v_and_b32 v185, 0xffff0000, v193
v_cvt_pk_bf16_f32 v193, v186, v187
v_lshlrev_b32 v186, 16, v193
v_and_b32 v187, 0xffff0000, v193
v_mul_f32 v180, v180, v192
v_mul_f32 v181, v181, v192
v_mul_f32 v182, v182, v192
v_mul_f32 v183, v183, v192
v_mul_f32 v184, v184, v192
v_mul_f32 v185, v185, v192
v_mul_f32 v186, v186, v192
v_mul_f32 v187, v187, v192
v_add_u32 v14, 0, v13
v_cvt_pk_bf16_f32 v194, v180, v181
v_cvt_pk_bf16_f32 v195, v182, v183
buffer_store_dwordx2 v[194:195], v14, s[12:15], 0 offen offset:0
s_nop 1
v_cvt_pk_bf16_f32 v194, v184, v185
v_cvt_pk_bf16_f32 v195, v186, v187
buffer_store_dwordx2 v[194:195], v14, s[12:15], 0 offen offset:32
s_nop 1
v_mfma_f32_16x16x32_bf16 v[180:183], v[60:63], v[108:111], 0
v_mfma_f32_16x16x32_bf16 v[180:183], v[64:67], v[112:115], v[180:183]
v_mfma_f32_16x16x32_bf16 v[184:187], v[68:71], v[108:111], 0
v_mfma_f32_16x16x32_bf16 v[184:187], v[72:75], v[112:115], v[184:187]
v_mfma_f32_16x16x32_bf16 v[188:191], v[76:79], v[108:111], 0
v_mfma_f32_16x16x32_bf16 v[188:191], v[80:83], v[112:115], v[188:191]
s_nop 15
ds_bpermute_b32 v192, v12, v188
s_waitcnt lgkmcnt(0)
v_cvt_pk_bf16_f32 v192, v192, v192
v_lshlrev_b32 v192, 16, v192
v_add_f32 v192, 0x358637bd, v192
v_cvt_pk_bf16_f32 v192, v192, v192
v_lshlrev_b32 v192, 16, v192
v_rcp_f32 v192, v192
v_cvt_pk_bf16_f32 v193, v180, v181
v_lshlrev_b32 v180, 16, v193
v_and_b32 v181, 0xffff0000, v193
v_cvt_pk_bf16_f32 v193, v182, v183
v_lshlrev_b32 v182, 16, v193
v_and_b32 v183, 0xffff0000, v193
v_cvt_pk_bf16_f32 v193, v184, v185
v_lshlrev_b32 v184, 16, v193
v_and_b32 v185, 0xffff0000, v193
v_cvt_pk_bf16_f32 v193, v186, v187
v_lshlrev_b32 v186, 16, v193
v_and_b32 v187, 0xffff0000, v193
v_mul_f32 v180, v180, v192
v_mul_f32 v181, v181, v192
v_mul_f32 v182, v182, v192
v_mul_f32 v183, v183, v192
v_mul_f32 v184, v184, v192
v_mul_f32 v185, v185, v192
v_mul_f32 v186, v186, v192
v_mul_f32 v187, v187, v192
v_add_u32 v14, 32768, v13
v_cvt_pk_bf16_f32 v194, v180, v181
v_cvt_pk_bf16_f32 v195, v182, v183
buffer_store_dwordx2 v[194:195], v14, s[12:15], 0 offen offset:0
s_nop 1
v_cvt_pk_bf16_f32 v194, v184, v185
v_cvt_pk_bf16_f32 v195, v186, v187
buffer_store_dwordx2 v[194:195], v14, s[12:15], 0 offen offset:32
s_nop 1
v_mfma_f32_16x16x32_bf16 v[180:183], v[60:63], v[116:119], 0
v_mfma_f32_16x16x32_bf16 v[180:183], v[64:67], v[120:123], v[180:183]
v_mfma_f32_16x16x32_bf16 v[184:187], v[68:71], v[116:119], 0
v_mfma_f32_16x16x32_bf16 v[184:187], v[72:75], v[120:123], v[184:187]
v_mfma_f32_16x16x32_bf16 v[188:191], v[76:79], v[116:119], 0
v_mfma_f32_16x16x32_bf16 v[188:191], v[80:83], v[120:123], v[188:191]
s_nop 15
ds_bpermute_b32 v192, v12, v188
s_waitcnt lgkmcnt(0)
v_cvt_pk_bf16_f32 v192, v192, v192
v_lshlrev_b32 v192, 16, v192
v_add_f32 v192, 0x358637bd, v192
v_cvt_pk_bf16_f32 v192, v192, v192
v_lshlrev_b32 v192, 16, v192
v_rcp_f32 v192, v192
v_cvt_pk_bf16_f32 v193, v180, v181
v_lshlrev_b32 v180, 16, v193
v_and_b32 v181, 0xffff0000, v193
v_cvt_pk_bf16_f32 v193, v182, v183
v_lshlrev_b32 v182, 16, v193
v_and_b32 v183, 0xffff0000, v193
v_cvt_pk_bf16_f32 v193, v184, v185
v_lshlrev_b32 v184, 16, v193
v_and_b32 v185, 0xffff0000, v193
v_cvt_pk_bf16_f32 v193, v186, v187
v_lshlrev_b32 v186, 16, v193
v_and_b32 v187, 0xffff0000, v193
v_mul_f32 v180, v180, v192
v_mul_f32 v181, v181, v192
v_mul_f32 v182, v182, v192
v_mul_f32 v183, v183, v192
v_mul_f32 v184, v184, v192
v_mul_f32 v185, v185, v192
v_mul_f32 v186, v186, v192
v_mul_f32 v187, v187, v192
v_add_u32 v14, 65536, v13
v_cvt_pk_bf16_f32 v194, v180, v181
v_cvt_pk_bf16_f32 v195, v182, v183
buffer_store_dwordx2 v[194:195], v14, s[12:15], 0 offen offset:0
s_nop 1
v_cvt_pk_bf16_f32 v194, v184, v185
v_cvt_pk_bf16_f32 v195, v186, v187
buffer_store_dwordx2 v[194:195], v14, s[12:15], 0 offen offset:32
s_nop 1
v_mfma_f32_16x16x32_bf16 v[180:183], v[60:63], v[124:127], 0
v_mfma_f32_16x16x32_bf16 v[180:183], v[64:67], v[128:131], v[180:183]
v_mfma_f32_16x16x32_bf16 v[184:187], v[68:71], v[124:127], 0
v_mfma_f32_16x16x32_bf16 v[184:187], v[72:75], v[128:131], v[184:187]
v_mfma_f32_16x16x32_bf16 v[188:191], v[76:79], v[124:127], 0
v_mfma_f32_16x16x32_bf16 v[188:191], v[80:83], v[128:131], v[188:191]
s_nop 15
ds_bpermute_b32 v192, v12, v188
s_waitcnt lgkmcnt(0)
v_cvt_pk_bf16_f32 v192, v192, v192
v_lshlrev_b32 v192, 16, v192
v_add_f32 v192, 0x358637bd, v192
v_cvt_pk_bf16_f32 v192, v192, v192
v_lshlrev_b32 v192, 16, v192
v_rcp_f32 v192, v192
v_cvt_pk_bf16_f32 v193, v180, v181
v_lshlrev_b32 v180, 16, v193
v_and_b32 v181, 0xffff0000, v193
v_cvt_pk_bf16_f32 v193, v182, v183
v_lshlrev_b32 v182, 16, v193
v_and_b32 v183, 0xffff0000, v193
v_cvt_pk_bf16_f32 v193, v184, v185
v_lshlrev_b32 v184, 16, v193
v_and_b32 v185, 0xffff0000, v193
v_cvt_pk_bf16_f32 v193, v186, v187
v_lshlrev_b32 v186, 16, v193
v_and_b32 v187, 0xffff0000, v193
v_mul_f32 v180, v180, v192
v_mul_f32 v181, v181, v192
v_mul_f32 v182, v182, v192
v_mul_f32 v183, v183, v192
v_mul_f32 v184, v184, v192
v_mul_f32 v185, v185, v192
v_mul_f32 v186, v186, v192
v_mul_f32 v187, v187, v192
v_add_u32 v14, 98304, v13
v_cvt_pk_bf16_f32 v194, v180, v181
v_cvt_pk_bf16_f32 v195, v182, v183
buffer_store_dwordx2 v[194:195], v14, s[12:15], 0 offen offset:0
s_nop 1
v_cvt_pk_bf16_f32 v194, v184, v185
v_cvt_pk_bf16_f32 v195, v186, v187
buffer_store_dwordx2 v[194:195], v14, s[12:15], 0 offen offset:32
s_nop 1
v_mfma_f32_16x16x32_bf16 v[180:183], v[60:63], v[132:135], 0
v_mfma_f32_16x16x32_bf16 v[180:183], v[64:67], v[136:139], v[180:183]
v_mfma_f32_16x16x32_bf16 v[184:187], v[68:71], v[132:135], 0
v_mfma_f32_16x16x32_bf16 v[184:187], v[72:75], v[136:139], v[184:187]
v_mfma_f32_16x16x32_bf16 v[188:191], v[76:79], v[132:135], 0
v_mfma_f32_16x16x32_bf16 v[188:191], v[80:83], v[136:139], v[188:191]
s_nop 15
ds_bpermute_b32 v192, v12, v188
s_waitcnt lgkmcnt(0)
v_cvt_pk_bf16_f32 v192, v192, v192
v_lshlrev_b32 v192, 16, v192
v_add_f32 v192, 0x358637bd, v192
v_cvt_pk_bf16_f32 v192, v192, v192
v_lshlrev_b32 v192, 16, v192
v_rcp_f32 v192, v192
v_cvt_pk_bf16_f32 v193, v180, v181
v_lshlrev_b32 v180, 16, v193
v_and_b32 v181, 0xffff0000, v193
v_cvt_pk_bf16_f32 v193, v182, v183
v_lshlrev_b32 v182, 16, v193
v_and_b32 v183, 0xffff0000, v193
v_cvt_pk_bf16_f32 v193, v184, v185
v_lshlrev_b32 v184, 16, v193
v_and_b32 v185, 0xffff0000, v193
v_cvt_pk_bf16_f32 v193, v186, v187
v_lshlrev_b32 v186, 16, v193
v_and_b32 v187, 0xffff0000, v193
v_mul_f32 v180, v180, v192
v_mul_f32 v181, v181, v192
v_mul_f32 v182, v182, v192
v_mul_f32 v183, v183, v192
v_mul_f32 v184, v184, v192
v_mul_f32 v185, v185, v192
v_mul_f32 v186, v186, v192
v_mul_f32 v187, v187, v192
v_add_u32 v14, 131072, v13
v_cvt_pk_bf16_f32 v194, v180, v181
v_cvt_pk_bf16_f32 v195, v182, v183
buffer_store_dwordx2 v[194:195], v14, s[12:15], 0 offen offset:0
s_nop 1
v_cvt_pk_bf16_f32 v194, v184, v185
v_cvt_pk_bf16_f32 v195, v186, v187
buffer_store_dwordx2 v[194:195], v14, s[12:15], 0 offen offset:32
s_nop 1
v_mfma_f32_16x16x32_bf16 v[180:183], v[60:63], v[140:143], 0
v_mfma_f32_16x16x32_bf16 v[180:183], v[64:67], v[144:147], v[180:183]
v_mfma_f32_16x16x32_bf16 v[184:187], v[68:71], v[140:143], 0
v_mfma_f32_16x16x32_bf16 v[184:187], v[72:75], v[144:147], v[184:187]
v_mfma_f32_16x16x32_bf16 v[188:191], v[76:79], v[140:143], 0
v_mfma_f32_16x16x32_bf16 v[188:191], v[80:83], v[144:147], v[188:191]
s_nop 15
ds_bpermute_b32 v192, v12, v188
s_waitcnt lgkmcnt(0)
v_cvt_pk_bf16_f32 v192, v192, v192
v_lshlrev_b32 v192, 16, v192
v_add_f32 v192, 0x358637bd, v192
v_cvt_pk_bf16_f32 v192, v192, v192
v_lshlrev_b32 v192, 16, v192
v_rcp_f32 v192, v192
v_cvt_pk_bf16_f32 v193, v180, v181
v_lshlrev_b32 v180, 16, v193
v_and_b32 v181, 0xffff0000, v193
v_cvt_pk_bf16_f32 v193, v182, v183
v_lshlrev_b32 v182, 16, v193
v_and_b32 v183, 0xffff0000, v193
v_cvt_pk_bf16_f32 v193, v184, v185
v_lshlrev_b32 v184, 16, v193
v_and_b32 v185, 0xffff0000, v193
v_cvt_pk_bf16_f32 v193, v186, v187
v_lshlrev_b32 v186, 16, v193
v_and_b32 v187, 0xffff0000, v193
v_mul_f32 v180, v180, v192
v_mul_f32 v181, v181, v192
v_mul_f32 v182, v182, v192
v_mul_f32 v183, v183, v192
v_mul_f32 v184, v184, v192
v_mul_f32 v185, v185, v192
v_mul_f32 v186, v186, v192
v_mul_f32 v187, v187, v192
v_add_u32 v14, 163840, v13
v_cvt_pk_bf16_f32 v194, v180, v181
v_cvt_pk_bf16_f32 v195, v182, v183
buffer_store_dwordx2 v[194:195], v14, s[12:15], 0 offen offset:0
s_nop 1
v_cvt_pk_bf16_f32 v194, v184, v185
v_cvt_pk_bf16_f32 v195, v186, v187
buffer_store_dwordx2 v[194:195], v14, s[12:15], 0 offen offset:32
s_nop 1
v_mfma_f32_16x16x32_bf16 v[180:183], v[60:63], v[148:151], 0
v_mfma_f32_16x16x32_bf16 v[180:183], v[64:67], v[152:155], v[180:183]
v_mfma_f32_16x16x32_bf16 v[184:187], v[68:71], v[148:151], 0
v_mfma_f32_16x16x32_bf16 v[184:187], v[72:75], v[152:155], v[184:187]
v_mfma_f32_16x16x32_bf16 v[188:191], v[76:79], v[148:151], 0
v_mfma_f32_16x16x32_bf16 v[188:191], v[80:83], v[152:155], v[188:191]
s_nop 15
ds_bpermute_b32 v192, v12, v188
s_waitcnt lgkmcnt(0)
v_cvt_pk_bf16_f32 v192, v192, v192
v_lshlrev_b32 v192, 16, v192
v_add_f32 v192, 0x358637bd, v192
v_cvt_pk_bf16_f32 v192, v192, v192
v_lshlrev_b32 v192, 16, v192
v_rcp_f32 v192, v192
v_cvt_pk_bf16_f32 v193, v180, v181
v_lshlrev_b32 v180, 16, v193
v_and_b32 v181, 0xffff0000, v193
v_cvt_pk_bf16_f32 v193, v182, v183
v_lshlrev_b32 v182, 16, v193
v_and_b32 v183, 0xffff0000, v193
v_cvt_pk_bf16_f32 v193, v184, v185
v_lshlrev_b32 v184, 16, v193
v_and_b32 v185, 0xffff0000, v193
v_cvt_pk_bf16_f32 v193, v186, v187
v_lshlrev_b32 v186, 16, v193
v_and_b32 v187, 0xffff0000, v193
v_mul_f32 v180, v180, v192
v_mul_f32 v181, v181, v192
v_mul_f32 v182, v182, v192
v_mul_f32 v183, v183, v192
v_mul_f32 v184, v184, v192
v_mul_f32 v185, v185, v192
v_mul_f32 v186, v186, v192
v_mul_f32 v187, v187, v192
v_add_u32 v14, 196608, v13
v_cvt_pk_bf16_f32 v194, v180, v181
v_cvt_pk_bf16_f32 v195, v182, v183
buffer_store_dwordx2 v[194:195], v14, s[12:15], 0 offen offset:0
s_nop 1
v_cvt_pk_bf16_f32 v194, v184, v185
v_cvt_pk_bf16_f32 v195, v186, v187
buffer_store_dwordx2 v[194:195], v14, s[12:15], 0 offen offset:32
s_nop 1
v_mfma_f32_16x16x32_bf16 v[180:183], v[60:63], v[156:159], 0
v_mfma_f32_16x16x32_bf16 v[180:183], v[64:67], v[160:163], v[180:183]
v_mfma_f32_16x16x32_bf16 v[184:187], v[68:71], v[156:159], 0
v_mfma_f32_16x16x32_bf16 v[184:187], v[72:75], v[160:163], v[184:187]
v_mfma_f32_16x16x32_bf16 v[188:191], v[76:79], v[156:159], 0
v_mfma_f32_16x16x32_bf16 v[188:191], v[80:83], v[160:163], v[188:191]
s_nop 15
ds_bpermute_b32 v192, v12, v188
s_waitcnt lgkmcnt(0)
v_cvt_pk_bf16_f32 v192, v192, v192
v_lshlrev_b32 v192, 16, v192
v_add_f32 v192, 0x358637bd, v192
v_cvt_pk_bf16_f32 v192, v192, v192
v_lshlrev_b32 v192, 16, v192
v_rcp_f32 v192, v192
v_cvt_pk_bf16_f32 v193, v180, v181
v_lshlrev_b32 v180, 16, v193
v_and_b32 v181, 0xffff0000, v193
v_cvt_pk_bf16_f32 v193, v182, v183
v_lshlrev_b32 v182, 16, v193
v_and_b32 v183, 0xffff0000, v193
v_cvt_pk_bf16_f32 v193, v184, v185
v_lshlrev_b32 v184, 16, v193
v_and_b32 v185, 0xffff0000, v193
v_cvt_pk_bf16_f32 v193, v186, v187
v_lshlrev_b32 v186, 16, v193
v_and_b32 v187, 0xffff0000, v193
v_mul_f32 v180, v180, v192
v_mul_f32 v181, v181, v192
v_mul_f32 v182, v182, v192
v_mul_f32 v183, v183, v192
v_mul_f32 v184, v184, v192
v_mul_f32 v185, v185, v192
v_mul_f32 v186, v186, v192
v_mul_f32 v187, v187, v192
v_add_u32 v14, 229376, v13
v_cvt_pk_bf16_f32 v194, v180, v181
v_cvt_pk_bf16_f32 v195, v182, v183
buffer_store_dwordx2 v[194:195], v14, s[12:15], 0 offen offset:0
s_nop 1
v_cvt_pk_bf16_f32 v194, v184, v185
v_cvt_pk_bf16_f32 v195, v186, v187
buffer_store_dwordx2 v[194:195], v14, s[12:15], 0 offen offset:32
s_nop 1
a3_kernel_end:
s_endpgm
.globl wo_kernel
.p2align 8
.type wo_kernel,@function
wo_kernel:
s_cmp_ge_u32 s2, 256
s_cbranch_scc1 wo_kernel_end
s_load_dwordx2 s[4:5], s[0:1], 88
s_load_dwordx2 s[8:9], s[0:1], 24
s_and_b32 s20, s2, 7
s_lshr_b32 s21, s2, 3
s_lshr_b32 s22, s20, 1
s_lshl_b32 s22, s22, 2
s_and_b32 s23, s21, 3
s_add_u32 s22, s22, s23
s_and_b32 s23, s20, 1
s_lshl_b32 s23, s23, 3
s_lshr_b32 s24, s21, 2
s_add_u32 s23, s23, s24
v_and_b32 v1, 63, v0
v_lshrrev_b32 v2, 6, v0
s_waitcnt lgkmcnt(0)
s_add_u32 s4, s4, 12582912
s_addc_u32 s5, s5, 0
s_mov_b32 s6, 4194304
s_mov_b32 s7, 0x00020000
s_mov_b32 s10, 2097152
s_mov_b32 s11, 0x00020000
v_lshrrev_b32 v3, 3, v1
v_and_b32 v4, 7, v1
v_xor_b32 v4, v4, v3
v_lshlrev_b32 v4, 4, v4
s_lshl_b32 s25, s22, 7
v_lshlrev_b32 v5, 5, v2
v_add_u32 v5, s25, v5
v_add_u32 v5, v5, v3
s_mov_b32 s26, 2048
v_mul_lo_u32 v5, v5, s26
v_add_u32 v10, v5, v4
v_add_u32 v11, 16384, v10
v_add_u32 v12, 32768, v10
v_add_u32 v13, 49152, v10
v_mul_u32_u24 v3, 128, v2
v_add_u32 v3, 0, v3
v_add_u32 v3, v3, v1
v_mul_u32_u24 v4, 8192, v3
v_lshrrev_b32 v4, 16, v4
v_mul_u32_u24 v5, 8, v4
v_sub_u32 v5, v3, v5
v_bfe_u32 v6, v4, 3, 1
v_bfe_u32 v7, v4, 1, 1
v_lshl_or_b32 v6, v7, 1, v6
v_lshlrev_b32 v6, 1, v6
v_xor_b32 v5, v5, v6
s_mul_i32 s25, s23, 128
v_lshlrev_b32 v9, 4, v5
v_add_u32 v9, s25, v9
v_mul_u32_u24 v4, 2048, v4
v_add_u32 v14, v4, v9
v_mul_u32_u24 v3, 128, v2
v_add_u32 v3, 64, v3
v_add_u32 v3, v3, v1
v_mul_u32_u24 v4, 8192, v3
v_lshrrev_b32 v4, 16, v4
v_mul_u32_u24 v5, 8, v4
v_sub_u32 v5, v3, v5
v_bfe_u32 v6, v4, 3, 1
v_bfe_u32 v7, v4, 1, 1
v_lshl_or_b32 v6, v7, 1, v6
v_lshlrev_b32 v6, 1, v6
v_xor_b32 v5, v5, v6
s_mul_i32 s25, s23, 128
v_lshlrev_b32 v9, 4, v5
v_add_u32 v9, s25, v9
v_mul_u32_u24 v4, 2048, v4
v_add_u32 v15, v4, v9
v_lshrrev_b32 v3, 1, v2
v_lshlrev_b32 v3, 6, v3
v_and_b32 v4, 15, v1
v_add_u32 v3, v3, v4
v_lshlrev_b32 v3, 7, v3
v_lshrrev_b32 v5, 4, v1
v_and_b32 v6, 7, v1
v_xor_b32 v5, v5, v6
v_lshlrev_b32 v5, 4, v5
v_add_u32 v21, v3, v5
v_xor_b32 v22, 64, v21
v_lshrrev_b32 v3, 4, v1
v_bfe_u32 v4, v1, 2, 2
v_lshl_add_u32 v5, v3, 3, v4
v_mul_u32_u24 v5, 128, v5
v_and_b32 v6, 3, v1
v_lshl_add_u32 v5, v6, 3, v5
v_add_u32 v5, 16384, v5
v_and_b32 v6, 1, v3
v_bfe_u32 v7, v1, 3, 1
v_lshl_or_b32 v6, v7, 1, v6
v_and_b32 v7, 1, v2
v_mul_u32_u24 v7, 2, v7
v_add_u32 v8, 0, v7
v_xor_b32 v8, v8, v6
v_lshl_add_u32 v25, v8, 5, v5
v_add_u32 v8, 1, v7
v_xor_b32 v8, v8, v6
v_lshl_add_u32 v26, v8, 5, v5
v_accvgpr_write_b32 a0, 0
v_accvgpr_write_b32 a1, 0
v_accvgpr_write_b32 a2, 0
v_accvgpr_write_b32 a3, 0
v_accvgpr_write_b32 a4, 0
v_accvgpr_write_b32 a5, 0
v_accvgpr_write_b32 a6, 0
v_accvgpr_write_b32 a7, 0
v_accvgpr_write_b32 a8, 0
v_accvgpr_write_b32 a9, 0
v_accvgpr_write_b32 a10, 0
v_accvgpr_write_b32 a11, 0
v_accvgpr_write_b32 a12, 0
v_accvgpr_write_b32 a13, 0
v_accvgpr_write_b32 a14, 0
v_accvgpr_write_b32 a15, 0
v_accvgpr_write_b32 a16, 0
v_accvgpr_write_b32 a17, 0
v_accvgpr_write_b32 a18, 0
v_accvgpr_write_b32 a19, 0
v_accvgpr_write_b32 a20, 0
v_accvgpr_write_b32 a21, 0
v_accvgpr_write_b32 a22, 0
v_accvgpr_write_b32 a23, 0
v_accvgpr_write_b32 a24, 0
v_accvgpr_write_b32 a25, 0
v_accvgpr_write_b32 a26, 0
v_accvgpr_write_b32 a27, 0
v_accvgpr_write_b32 a28, 0
v_accvgpr_write_b32 a29, 0
v_accvgpr_write_b32 a30, 0
v_accvgpr_write_b32 a31, 0
v_readfirstlane_b32 s27, v2
s_nop 3
s_mul_i32 s28, s27, 2048
s_lshl_b32 s27, s27, 12
s_mov_b32 s16, 0
s_mov_b32 s17, 0
s_add_u32 m0, s27, 0
s_nop 0
buffer_load_dwordx4 v10, s[4:7], s16 offen lds
s_add_u32 m0, s27, 1024
s_nop 0
buffer_load_dwordx4 v11, s[4:7], s16 offen lds
s_add_u32 m0, s27, 2048
s_nop 0
buffer_load_dwordx4 v12, s[4:7], s16 offen lds
s_add_u32 m0, s27, 3072
s_nop 0
buffer_load_dwordx4 v13, s[4:7], s16 offen lds
s_add_u32 m0, s28, 16384
s_nop 0
buffer_load_dwordx4 v14, s[8:11], s17 offen lds
s_add_u32 m0, s28, 17408
s_nop 0
buffer_load_dwordx4 v15, s[8:11], s17 offen lds
s_mov_b32 s16, 128
s_mov_b32 s17, 131072
s_add_u32 m0, s27, 24576
s_nop 0
buffer_load_dwordx4 v10, s[4:7], s16 offen lds
s_add_u32 m0, s27, 25600
s_nop 0
buffer_load_dwordx4 v11, s[4:7], s16 offen lds
s_add_u32 m0, s27, 26624
s_nop 0
buffer_load_dwordx4 v12, s[4:7], s16 offen lds
s_add_u32 m0, s27, 27648
s_nop 0
buffer_load_dwordx4 v13, s[4:7], s16 offen lds
s_add_u32 m0, s28, 40960
s_nop 0
buffer_load_dwordx4 v14, s[8:11], s17 offen lds
s_add_u32 m0, s28, 41984
s_nop 0
buffer_load_dwordx4 v15, s[8:11], s17 offen lds
s_mov_b32 s16, 256
s_mov_b32 s17, 262144
s_add_u32 m0, s27, 49152
s_nop 0
buffer_load_dwordx4 v10, s[4:7], s16 offen lds
s_add_u32 m0, s27, 50176
s_nop 0
buffer_load_dwordx4 v11, s[4:7], s16 offen lds
s_add_u32 m0, s27, 51200
s_nop 0
buffer_load_dwordx4 v12, s[4:7], s16 offen lds
s_add_u32 m0, s27, 52224
s_nop 0
buffer_load_dwordx4 v13, s[4:7], s16 offen lds
s_add_u32 m0, s28, 65536
s_nop 0
buffer_load_dwordx4 v14, s[8:11], s17 offen lds
s_add_u32 m0, s28, 66560
s_nop 0
buffer_load_dwordx4 v15, s[8:11], s17 offen lds
s_mov_b32 s16, 384
s_mov_b32 s17, 393216
s_add_u32 m0, s27, 73728
s_nop 0
buffer_load_dwordx4 v10, s[4:7], s16 offen lds
s_add_u32 m0, s27, 74752
s_nop 0
buffer_load_dwordx4 v11, s[4:7], s16 offen lds
s_add_u32 m0, s27, 75776
s_nop 0
buffer_load_dwordx4 v12, s[4:7], s16 offen lds
s_add_u32 m0, s27, 76800
s_nop 0
buffer_load_dwordx4 v13, s[4:7], s16 offen lds
s_add_u32 m0, s28, 90112
s_nop 0
buffer_load_dwordx4 v14, s[8:11], s17 offen lds
s_add_u32 m0, s28, 91136
s_nop 0
buffer_load_dwordx4 v15, s[8:11], s17 offen lds
s_waitcnt vmcnt(18) lgkmcnt(0)
s_barrier
v_add_u32 v23, 0, v21
v_add_u32 v32, 0, v25
v_add_u32 v33, 0, v26
ds_read_b128 v[40:43], v23 offset:0
ds_read_b128 v[44:47], v23 offset:2048
ds_read_b128 v[48:51], v23 offset:4096
ds_read_b128 v[52:55], v23 offset:6144
ds_read_b64_tr_b16 v[56:57], v32 offset:0
ds_read_b64_tr_b16 v[58:59], v32 offset:512
ds_read_b64_tr_b16 v[60:61], v33 offset:0
ds_read_b64_tr_b16 v[62:63], v33 offset:512
s_waitcnt lgkmcnt(0)
v_mfma_f32_16x16x32_bf16 a[0:3], v[56:59], v[40:43], a[0:3]
v_add_u32 v23, 0, v22
v_mfma_f32_16x16x32_bf16 a[8:11], v[56:59], v[44:47], a[8:11]
v_add_u32 v32, 0, v25
v_mfma_f32_16x16x32_bf16 a[16:19], v[56:59], v[48:51], a[16:19]
v_add_u32 v33, 0, v26
ds_read_b128 v[84:87], v23 offset:0
v_mfma_f32_16x16x32_bf16 a[24:27], v[56:59], v[52:55], a[24:27]
ds_read_b128 v[88:91], v23 offset:2048
v_mfma_f32_16x16x32_bf16 a[4:7], v[60:63], v[40:43], a[4:7]
ds_read_b128 v[92:95], v23 offset:4096
v_mfma_f32_16x16x32_bf16 a[12:15], v[60:63], v[44:47], a[12:15]
ds_read_b128 v[96:99], v23 offset:6144
ds_read_b64_tr_b16 v[100:101], v32 offset:4096
v_mfma_f32_16x16x32_bf16 a[20:23], v[60:63], v[48:51], a[20:23]
ds_read_b64_tr_b16 v[102:103], v32 offset:4608
v_mfma_f32_16x16x32_bf16 a[28:31], v[60:63], v[52:55], a[28:31]
ds_read_b64_tr_b16 v[104:105], v33 offset:4096
ds_read_b64_tr_b16 v[106:107], v33 offset:4608
s_waitcnt vmcnt(12)
s_barrier
s_waitcnt lgkmcnt(0)
v_mfma_f32_16x16x32_bf16 a[0:3], v[100:103], v[84:87], a[0:3]
s_mov_b32 s16, 512
s_mov_b32 s17, 524288
s_add_u32 m0, s27, 98304
v_mfma_f32_16x16x32_bf16 a[8:11], v[100:103], v[88:91], a[8:11]
s_nop 0
buffer_load_dwordx4 v10, s[4:7], s16 offen lds
s_add_u32 m0, s27, 99328
s_nop 0
v_mfma_f32_16x16x32_bf16 a[16:19], v[100:103], v[92:95], a[16:19]
buffer_load_dwordx4 v11, s[4:7], s16 offen lds
s_add_u32 m0, s27, 100352
s_nop 0
buffer_load_dwordx4 v12, s[4:7], s16 offen lds
v_mfma_f32_16x16x32_bf16 a[24:27], v[100:103], v[96:99], a[24:27]
s_add_u32 m0, s27, 101376
s_nop 0
buffer_load_dwordx4 v13, s[4:7], s16 offen lds
s_add_u32 m0, s28, 114688
v_mfma_f32_16x16x32_bf16 a[4:7], v[104:107], v[84:87], a[4:7]
s_nop 0
buffer_load_dwordx4 v14, s[8:11], s17 offen lds
s_add_u32 m0, s28, 115712
s_nop 0
v_mfma_f32_16x16x32_bf16 a[12:15], v[104:107], v[88:91], a[12:15]
buffer_load_dwordx4 v15, s[8:11], s17 offen lds
v_add_u32 v23, 24576, v21
v_add_u32 v32, 24576, v25
v_add_u32 v33, 24576, v26
v_mfma_f32_16x16x32_bf16 a[20:23], v[104:107], v[92:95], a[20:23]
ds_read_b128 v[40:43], v23 offset:0
ds_read_b128 v[44:47], v23 offset:2048
ds_read_b128 v[48:51], v23 offset:4096
ds_read_b128 v[52:55], v23 offset:6144
v_mfma_f32_16x16x32_bf16 a[28:31], v[104:107], v[96:99], a[28:31]
ds_read_b64_tr_b16 v[56:57], v32 offset:0
ds_read_b64_tr_b16 v[58:59], v32 offset:512
ds_read_b64_tr_b16 v[60:61], v33 offset:0
ds_read_b64_tr_b16 v[62:63], v33 offset:512
s_waitcnt lgkmcnt(0)
v_mfma_f32_16x16x32_bf16 a[0:3], v[56:59], v[40:43], a[0:3]
v_add_u32 v23, 24576, v22
v_mfma_f32_16x16x32_bf16 a[8:11], v[56:59], v[44:47], a[8:11]
v_add_u32 v32, 24576, v25
v_mfma_f32_16x16x32_bf16 a[16:19], v[56:59], v[48:51], a[16:19]
v_add_u32 v33, 24576, v26
ds_read_b128 v[84:87], v23 offset:0
v_mfma_f32_16x16x32_bf16 a[24:27], v[56:59], v[52:55], a[24:27]
ds_read_b128 v[88:91], v23 offset:2048
v_mfma_f32_16x16x32_bf16 a[4:7], v[60:63], v[40:43], a[4:7]
ds_read_b128 v[92:95], v23 offset:4096
v_mfma_f32_16x16x32_bf16 a[12:15], v[60:63], v[44:47], a[12:15]
ds_read_b128 v[96:99], v23 offset:6144
ds_read_b64_tr_b16 v[100:101], v32 offset:4096
v_mfma_f32_16x16x32_bf16 a[20:23], v[60:63], v[48:51], a[20:23]
ds_read_b64_tr_b16 v[102:103], v32 offset:4608
v_mfma_f32_16x16x32_bf16 a[28:31], v[60:63], v[52:55], a[28:31]
ds_read_b64_tr_b16 v[104:105], v33 offset:4096
ds_read_b64_tr_b16 v[106:107], v33 offset:4608
s_waitcnt vmcnt(12)
s_barrier
s_waitcnt lgkmcnt(0)
v_mfma_f32_16x16x32_bf16 a[0:3], v[100:103], v[84:87], a[0:3]
s_mov_b32 s16, 640
s_mov_b32 s17, 655360
s_add_u32 m0, s27, 0
v_mfma_f32_16x16x32_bf16 a[8:11], v[100:103], v[88:91], a[8:11]
s_nop 0
buffer_load_dwordx4 v10, s[4:7], s16 offen lds
s_add_u32 m0, s27, 1024
s_nop 0
v_mfma_f32_16x16x32_bf16 a[16:19], v[100:103], v[92:95], a[16:19]
buffer_load_dwordx4 v11, s[4:7], s16 offen lds
s_add_u32 m0, s27, 2048
s_nop 0
buffer_load_dwordx4 v12, s[4:7], s16 offen lds
v_mfma_f32_16x16x32_bf16 a[24:27], v[100:103], v[96:99], a[24:27]
s_add_u32 m0, s27, 3072
s_nop 0
buffer_load_dwordx4 v13, s[4:7], s16 offen lds
s_add_u32 m0, s28, 16384
v_mfma_f32_16x16x32_bf16 a[4:7], v[104:107], v[84:87], a[4:7]
s_nop 0
buffer_load_dwordx4 v14, s[8:11], s17 offen lds
s_add_u32 m0, s28, 17408
s_nop 0
v_mfma_f32_16x16x32_bf16 a[12:15], v[104:107], v[88:91], a[12:15]
buffer_load_dwordx4 v15, s[8:11], s17 offen lds
v_add_u32 v23, 49152, v21
v_add_u32 v32, 49152, v25
v_add_u32 v33, 49152, v26
v_mfma_f32_16x16x32_bf16 a[20:23], v[104:107], v[92:95], a[20:23]
ds_read_b128 v[40:43], v23 offset:0
ds_read_b128 v[44:47], v23 offset:2048
ds_read_b128 v[48:51], v23 offset:4096
ds_read_b128 v[52:55], v23 offset:6144
v_mfma_f32_16x16x32_bf16 a[28:31], v[104:107], v[96:99], a[28:31]
ds_read_b64_tr_b16 v[56:57], v32 offset:0
ds_read_b64_tr_b16 v[58:59], v32 offset:512
ds_read_b64_tr_b16 v[60:61], v33 offset:0
ds_read_b64_tr_b16 v[62:63], v33 offset:512
s_waitcnt lgkmcnt(0)
v_mfma_f32_16x16x32_bf16 a[0:3], v[56:59], v[40:43], a[0:3]
v_add_u32 v23, 49152, v22
v_mfma_f32_16x16x32_bf16 a[8:11], v[56:59], v[44:47], a[8:11]
v_add_u32 v32, 49152, v25
v_mfma_f32_16x16x32_bf16 a[16:19], v[56:59], v[48:51], a[16:19]
v_add_u32 v33, 49152, v26
ds_read_b128 v[84:87], v23 offset:0
v_mfma_f32_16x16x32_bf16 a[24:27], v[56:59], v[52:55], a[24:27]
ds_read_b128 v[88:91], v23 offset:2048
v_mfma_f32_16x16x32_bf16 a[4:7], v[60:63], v[40:43], a[4:7]
ds_read_b128 v[92:95], v23 offset:4096
v_mfma_f32_16x16x32_bf16 a[12:15], v[60:63], v[44:47], a[12:15]
ds_read_b128 v[96:99], v23 offset:6144
ds_read_b64_tr_b16 v[100:101], v32 offset:4096
v_mfma_f32_16x16x32_bf16 a[20:23], v[60:63], v[48:51], a[20:23]
ds_read_b64_tr_b16 v[102:103], v32 offset:4608
v_mfma_f32_16x16x32_bf16 a[28:31], v[60:63], v[52:55], a[28:31]
ds_read_b64_tr_b16 v[104:105], v33 offset:4096
ds_read_b64_tr_b16 v[106:107], v33 offset:4608
s_waitcnt vmcnt(12)
s_barrier
s_waitcnt lgkmcnt(0)
v_mfma_f32_16x16x32_bf16 a[0:3], v[100:103], v[84:87], a[0:3]
s_mov_b32 s16, 768
s_mov_b32 s17, 786432
s_add_u32 m0, s27, 24576
v_mfma_f32_16x16x32_bf16 a[8:11], v[100:103], v[88:91], a[8:11]
s_nop 0
buffer_load_dwordx4 v10, s[4:7], s16 offen lds
s_add_u32 m0, s27, 25600
s_nop 0
v_mfma_f32_16x16x32_bf16 a[16:19], v[100:103], v[92:95], a[16:19]
buffer_load_dwordx4 v11, s[4:7], s16 offen lds
s_add_u32 m0, s27, 26624
s_nop 0
buffer_load_dwordx4 v12, s[4:7], s16 offen lds
v_mfma_f32_16x16x32_bf16 a[24:27], v[100:103], v[96:99], a[24:27]
s_add_u32 m0, s27, 27648
s_nop 0
buffer_load_dwordx4 v13, s[4:7], s16 offen lds
s_add_u32 m0, s28, 40960
v_mfma_f32_16x16x32_bf16 a[4:7], v[104:107], v[84:87], a[4:7]
s_nop 0
buffer_load_dwordx4 v14, s[8:11], s17 offen lds
s_add_u32 m0, s28, 41984
s_nop 0
v_mfma_f32_16x16x32_bf16 a[12:15], v[104:107], v[88:91], a[12:15]
buffer_load_dwordx4 v15, s[8:11], s17 offen lds
v_add_u32 v23, 73728, v21
v_add_u32 v32, 73728, v25
v_add_u32 v33, 73728, v26
v_mfma_f32_16x16x32_bf16 a[20:23], v[104:107], v[92:95], a[20:23]
ds_read_b128 v[40:43], v23 offset:0
ds_read_b128 v[44:47], v23 offset:2048
ds_read_b128 v[48:51], v23 offset:4096
ds_read_b128 v[52:55], v23 offset:6144
v_mfma_f32_16x16x32_bf16 a[28:31], v[104:107], v[96:99], a[28:31]
ds_read_b64_tr_b16 v[56:57], v32 offset:0
ds_read_b64_tr_b16 v[58:59], v32 offset:512
ds_read_b64_tr_b16 v[60:61], v33 offset:0
ds_read_b64_tr_b16 v[62:63], v33 offset:512
s_waitcnt lgkmcnt(0)
v_mfma_f32_16x16x32_bf16 a[0:3], v[56:59], v[40:43], a[0:3]
v_add_u32 v23, 73728, v22
v_mfma_f32_16x16x32_bf16 a[8:11], v[56:59], v[44:47], a[8:11]
v_add_u32 v32, 73728, v25
v_mfma_f32_16x16x32_bf16 a[16:19], v[56:59], v[48:51], a[16:19]
v_add_u32 v33, 73728, v26
ds_read_b128 v[84:87], v23 offset:0
v_mfma_f32_16x16x32_bf16 a[24:27], v[56:59], v[52:55], a[24:27]
ds_read_b128 v[88:91], v23 offset:2048
v_mfma_f32_16x16x32_bf16 a[4:7], v[60:63], v[40:43], a[4:7]
ds_read_b128 v[92:95], v23 offset:4096
v_mfma_f32_16x16x32_bf16 a[12:15], v[60:63], v[44:47], a[12:15]
ds_read_b128 v[96:99], v23 offset:6144
ds_read_b64_tr_b16 v[100:101], v32 offset:4096
v_mfma_f32_16x16x32_bf16 a[20:23], v[60:63], v[48:51], a[20:23]
ds_read_b64_tr_b16 v[102:103], v32 offset:4608
v_mfma_f32_16x16x32_bf16 a[28:31], v[60:63], v[52:55], a[28:31]
ds_read_b64_tr_b16 v[104:105], v33 offset:4096
ds_read_b64_tr_b16 v[106:107], v33 offset:4608
s_waitcnt vmcnt(12)
s_barrier
s_waitcnt lgkmcnt(0)
v_mfma_f32_16x16x32_bf16 a[0:3], v[100:103], v[84:87], a[0:3]
s_mov_b32 s16, 896
s_mov_b32 s17, 917504
s_add_u32 m0, s27, 49152
v_mfma_f32_16x16x32_bf16 a[8:11], v[100:103], v[88:91], a[8:11]
s_nop 0
buffer_load_dwordx4 v10, s[4:7], s16 offen lds
s_add_u32 m0, s27, 50176
s_nop 0
v_mfma_f32_16x16x32_bf16 a[16:19], v[100:103], v[92:95], a[16:19]
buffer_load_dwordx4 v11, s[4:7], s16 offen lds
s_add_u32 m0, s27, 51200
s_nop 0
buffer_load_dwordx4 v12, s[4:7], s16 offen lds
v_mfma_f32_16x16x32_bf16 a[24:27], v[100:103], v[96:99], a[24:27]
s_add_u32 m0, s27, 52224
s_nop 0
buffer_load_dwordx4 v13, s[4:7], s16 offen lds
s_add_u32 m0, s28, 65536
v_mfma_f32_16x16x32_bf16 a[4:7], v[104:107], v[84:87], a[4:7]
s_nop 0
buffer_load_dwordx4 v14, s[8:11], s17 offen lds
s_add_u32 m0, s28, 66560
s_nop 0
v_mfma_f32_16x16x32_bf16 a[12:15], v[104:107], v[88:91], a[12:15]
buffer_load_dwordx4 v15, s[8:11], s17 offen lds
v_add_u32 v23, 98304, v21
v_add_u32 v32, 98304, v25
v_add_u32 v33, 98304, v26
v_mfma_f32_16x16x32_bf16 a[20:23], v[104:107], v[92:95], a[20:23]
ds_read_b128 v[40:43], v23 offset:0
ds_read_b128 v[44:47], v23 offset:2048
ds_read_b128 v[48:51], v23 offset:4096
ds_read_b128 v[52:55], v23 offset:6144
v_mfma_f32_16x16x32_bf16 a[28:31], v[104:107], v[96:99], a[28:31]
ds_read_b64_tr_b16 v[56:57], v32 offset:0
ds_read_b64_tr_b16 v[58:59], v32 offset:512
ds_read_b64_tr_b16 v[60:61], v33 offset:0
ds_read_b64_tr_b16 v[62:63], v33 offset:512
s_waitcnt lgkmcnt(0)
v_mfma_f32_16x16x32_bf16 a[0:3], v[56:59], v[40:43], a[0:3]
v_add_u32 v23, 98304, v22
v_mfma_f32_16x16x32_bf16 a[8:11], v[56:59], v[44:47], a[8:11]
v_add_u32 v32, 98304, v25
v_mfma_f32_16x16x32_bf16 a[16:19], v[56:59], v[48:51], a[16:19]
v_add_u32 v33, 98304, v26
ds_read_b128 v[84:87], v23 offset:0
v_mfma_f32_16x16x32_bf16 a[24:27], v[56:59], v[52:55], a[24:27]
ds_read_b128 v[88:91], v23 offset:2048
v_mfma_f32_16x16x32_bf16 a[4:7], v[60:63], v[40:43], a[4:7]
ds_read_b128 v[92:95], v23 offset:4096
v_mfma_f32_16x16x32_bf16 a[12:15], v[60:63], v[44:47], a[12:15]
ds_read_b128 v[96:99], v23 offset:6144
ds_read_b64_tr_b16 v[100:101], v32 offset:4096
v_mfma_f32_16x16x32_bf16 a[20:23], v[60:63], v[48:51], a[20:23]
ds_read_b64_tr_b16 v[102:103], v32 offset:4608
v_mfma_f32_16x16x32_bf16 a[28:31], v[60:63], v[52:55], a[28:31]
ds_read_b64_tr_b16 v[104:105], v33 offset:4096
ds_read_b64_tr_b16 v[106:107], v33 offset:4608
s_waitcnt vmcnt(12)
s_barrier
s_waitcnt lgkmcnt(0)
v_mfma_f32_16x16x32_bf16 a[0:3], v[100:103], v[84:87], a[0:3]
s_mov_b32 s16, 1024
s_mov_b32 s17, 1048576
s_add_u32 m0, s27, 73728
v_mfma_f32_16x16x32_bf16 a[8:11], v[100:103], v[88:91], a[8:11]
s_nop 0
buffer_load_dwordx4 v10, s[4:7], s16 offen lds
s_add_u32 m0, s27, 74752
s_nop 0
v_mfma_f32_16x16x32_bf16 a[16:19], v[100:103], v[92:95], a[16:19]
buffer_load_dwordx4 v11, s[4:7], s16 offen lds
s_add_u32 m0, s27, 75776
s_nop 0
buffer_load_dwordx4 v12, s[4:7], s16 offen lds
v_mfma_f32_16x16x32_bf16 a[24:27], v[100:103], v[96:99], a[24:27]
s_add_u32 m0, s27, 76800
s_nop 0
buffer_load_dwordx4 v13, s[4:7], s16 offen lds
s_add_u32 m0, s28, 90112
v_mfma_f32_16x16x32_bf16 a[4:7], v[104:107], v[84:87], a[4:7]
s_nop 0
buffer_load_dwordx4 v14, s[8:11], s17 offen lds
s_add_u32 m0, s28, 91136
s_nop 0
v_mfma_f32_16x16x32_bf16 a[12:15], v[104:107], v[88:91], a[12:15]
buffer_load_dwordx4 v15, s[8:11], s17 offen lds
v_add_u32 v23, 0, v21
v_add_u32 v32, 0, v25
v_add_u32 v33, 0, v26
v_mfma_f32_16x16x32_bf16 a[20:23], v[104:107], v[92:95], a[20:23]
ds_read_b128 v[40:43], v23 offset:0
ds_read_b128 v[44:47], v23 offset:2048
ds_read_b128 v[48:51], v23 offset:4096
ds_read_b128 v[52:55], v23 offset:6144
v_mfma_f32_16x16x32_bf16 a[28:31], v[104:107], v[96:99], a[28:31]
ds_read_b64_tr_b16 v[56:57], v32 offset:0
ds_read_b64_tr_b16 v[58:59], v32 offset:512
ds_read_b64_tr_b16 v[60:61], v33 offset:0
ds_read_b64_tr_b16 v[62:63], v33 offset:512
s_waitcnt lgkmcnt(0)
v_mfma_f32_16x16x32_bf16 a[0:3], v[56:59], v[40:43], a[0:3]
v_add_u32 v23, 0, v22
v_mfma_f32_16x16x32_bf16 a[8:11], v[56:59], v[44:47], a[8:11]
v_add_u32 v32, 0, v25
v_mfma_f32_16x16x32_bf16 a[16:19], v[56:59], v[48:51], a[16:19]
v_add_u32 v33, 0, v26
ds_read_b128 v[84:87], v23 offset:0
v_mfma_f32_16x16x32_bf16 a[24:27], v[56:59], v[52:55], a[24:27]
ds_read_b128 v[88:91], v23 offset:2048
v_mfma_f32_16x16x32_bf16 a[4:7], v[60:63], v[40:43], a[4:7]
ds_read_b128 v[92:95], v23 offset:4096
v_mfma_f32_16x16x32_bf16 a[12:15], v[60:63], v[44:47], a[12:15]
ds_read_b128 v[96:99], v23 offset:6144
ds_read_b64_tr_b16 v[100:101], v32 offset:4096
v_mfma_f32_16x16x32_bf16 a[20:23], v[60:63], v[48:51], a[20:23]
ds_read_b64_tr_b16 v[102:103], v32 offset:4608
v_mfma_f32_16x16x32_bf16 a[28:31], v[60:63], v[52:55], a[28:31]
ds_read_b64_tr_b16 v[104:105], v33 offset:4096
ds_read_b64_tr_b16 v[106:107], v33 offset:4608
s_waitcnt vmcnt(12)
s_barrier
s_waitcnt lgkmcnt(0)
v_mfma_f32_16x16x32_bf16 a[0:3], v[100:103], v[84:87], a[0:3]
s_mov_b32 s16, 1152
s_mov_b32 s17, 1179648
s_add_u32 m0, s27, 98304
v_mfma_f32_16x16x32_bf16 a[8:11], v[100:103], v[88:91], a[8:11]
s_nop 0
buffer_load_dwordx4 v10, s[4:7], s16 offen lds
s_add_u32 m0, s27, 99328
s_nop 0
v_mfma_f32_16x16x32_bf16 a[16:19], v[100:103], v[92:95], a[16:19]
buffer_load_dwordx4 v11, s[4:7], s16 offen lds
s_add_u32 m0, s27, 100352
s_nop 0
buffer_load_dwordx4 v12, s[4:7], s16 offen lds
v_mfma_f32_16x16x32_bf16 a[24:27], v[100:103], v[96:99], a[24:27]
s_add_u32 m0, s27, 101376
s_nop 0
buffer_load_dwordx4 v13, s[4:7], s16 offen lds
s_add_u32 m0, s28, 114688
v_mfma_f32_16x16x32_bf16 a[4:7], v[104:107], v[84:87], a[4:7]
s_nop 0
buffer_load_dwordx4 v14, s[8:11], s17 offen lds
s_add_u32 m0, s28, 115712
s_nop 0
v_mfma_f32_16x16x32_bf16 a[12:15], v[104:107], v[88:91], a[12:15]
buffer_load_dwordx4 v15, s[8:11], s17 offen lds
v_add_u32 v23, 24576, v21
v_add_u32 v32, 24576, v25
v_add_u32 v33, 24576, v26
v_mfma_f32_16x16x32_bf16 a[20:23], v[104:107], v[92:95], a[20:23]
ds_read_b128 v[40:43], v23 offset:0
ds_read_b128 v[44:47], v23 offset:2048
ds_read_b128 v[48:51], v23 offset:4096
ds_read_b128 v[52:55], v23 offset:6144
v_mfma_f32_16x16x32_bf16 a[28:31], v[104:107], v[96:99], a[28:31]
ds_read_b64_tr_b16 v[56:57], v32 offset:0
ds_read_b64_tr_b16 v[58:59], v32 offset:512
ds_read_b64_tr_b16 v[60:61], v33 offset:0
ds_read_b64_tr_b16 v[62:63], v33 offset:512
s_waitcnt lgkmcnt(0)
v_mfma_f32_16x16x32_bf16 a[0:3], v[56:59], v[40:43], a[0:3]
v_add_u32 v23, 24576, v22
v_mfma_f32_16x16x32_bf16 a[8:11], v[56:59], v[44:47], a[8:11]
v_add_u32 v32, 24576, v25
v_mfma_f32_16x16x32_bf16 a[16:19], v[56:59], v[48:51], a[16:19]
v_add_u32 v33, 24576, v26
ds_read_b128 v[84:87], v23 offset:0
v_mfma_f32_16x16x32_bf16 a[24:27], v[56:59], v[52:55], a[24:27]
ds_read_b128 v[88:91], v23 offset:2048
v_mfma_f32_16x16x32_bf16 a[4:7], v[60:63], v[40:43], a[4:7]
ds_read_b128 v[92:95], v23 offset:4096
v_mfma_f32_16x16x32_bf16 a[12:15], v[60:63], v[44:47], a[12:15]
ds_read_b128 v[96:99], v23 offset:6144
ds_read_b64_tr_b16 v[100:101], v32 offset:4096
v_mfma_f32_16x16x32_bf16 a[20:23], v[60:63], v[48:51], a[20:23]
ds_read_b64_tr_b16 v[102:103], v32 offset:4608
v_mfma_f32_16x16x32_bf16 a[28:31], v[60:63], v[52:55], a[28:31]
ds_read_b64_tr_b16 v[104:105], v33 offset:4096
ds_read_b64_tr_b16 v[106:107], v33 offset:4608
s_waitcnt vmcnt(12)
s_barrier
s_waitcnt lgkmcnt(0)
v_mfma_f32_16x16x32_bf16 a[0:3], v[100:103], v[84:87], a[0:3]
s_mov_b32 s16, 1280
s_mov_b32 s17, 1310720
s_add_u32 m0, s27, 0
v_mfma_f32_16x16x32_bf16 a[8:11], v[100:103], v[88:91], a[8:11]
s_nop 0
buffer_load_dwordx4 v10, s[4:7], s16 offen lds
s_add_u32 m0, s27, 1024
s_nop 0
v_mfma_f32_16x16x32_bf16 a[16:19], v[100:103], v[92:95], a[16:19]
buffer_load_dwordx4 v11, s[4:7], s16 offen lds
s_add_u32 m0, s27, 2048
s_nop 0
buffer_load_dwordx4 v12, s[4:7], s16 offen lds
v_mfma_f32_16x16x32_bf16 a[24:27], v[100:103], v[96:99], a[24:27]
s_add_u32 m0, s27, 3072
s_nop 0
buffer_load_dwordx4 v13, s[4:7], s16 offen lds
s_add_u32 m0, s28, 16384
v_mfma_f32_16x16x32_bf16 a[4:7], v[104:107], v[84:87], a[4:7]
s_nop 0
buffer_load_dwordx4 v14, s[8:11], s17 offen lds
s_add_u32 m0, s28, 17408
s_nop 0
v_mfma_f32_16x16x32_bf16 a[12:15], v[104:107], v[88:91], a[12:15]
buffer_load_dwordx4 v15, s[8:11], s17 offen lds
v_add_u32 v23, 49152, v21
v_add_u32 v32, 49152, v25
v_add_u32 v33, 49152, v26
v_mfma_f32_16x16x32_bf16 a[20:23], v[104:107], v[92:95], a[20:23]
ds_read_b128 v[40:43], v23 offset:0
ds_read_b128 v[44:47], v23 offset:2048
ds_read_b128 v[48:51], v23 offset:4096
ds_read_b128 v[52:55], v23 offset:6144
v_mfma_f32_16x16x32_bf16 a[28:31], v[104:107], v[96:99], a[28:31]
ds_read_b64_tr_b16 v[56:57], v32 offset:0
ds_read_b64_tr_b16 v[58:59], v32 offset:512
ds_read_b64_tr_b16 v[60:61], v33 offset:0
ds_read_b64_tr_b16 v[62:63], v33 offset:512
s_waitcnt lgkmcnt(0)
v_mfma_f32_16x16x32_bf16 a[0:3], v[56:59], v[40:43], a[0:3]
v_add_u32 v23, 49152, v22
v_mfma_f32_16x16x32_bf16 a[8:11], v[56:59], v[44:47], a[8:11]
v_add_u32 v32, 49152, v25
v_mfma_f32_16x16x32_bf16 a[16:19], v[56:59], v[48:51], a[16:19]
v_add_u32 v33, 49152, v26
ds_read_b128 v[84:87], v23 offset:0
v_mfma_f32_16x16x32_bf16 a[24:27], v[56:59], v[52:55], a[24:27]
ds_read_b128 v[88:91], v23 offset:2048
v_mfma_f32_16x16x32_bf16 a[4:7], v[60:63], v[40:43], a[4:7]
ds_read_b128 v[92:95], v23 offset:4096
v_mfma_f32_16x16x32_bf16 a[12:15], v[60:63], v[44:47], a[12:15]
ds_read_b128 v[96:99], v23 offset:6144
ds_read_b64_tr_b16 v[100:101], v32 offset:4096
v_mfma_f32_16x16x32_bf16 a[20:23], v[60:63], v[48:51], a[20:23]
ds_read_b64_tr_b16 v[102:103], v32 offset:4608
v_mfma_f32_16x16x32_bf16 a[28:31], v[60:63], v[52:55], a[28:31]
ds_read_b64_tr_b16 v[104:105], v33 offset:4096
ds_read_b64_tr_b16 v[106:107], v33 offset:4608
s_waitcnt vmcnt(12)
s_barrier
s_waitcnt lgkmcnt(0)
v_mfma_f32_16x16x32_bf16 a[0:3], v[100:103], v[84:87], a[0:3]
s_mov_b32 s16, 1408
s_mov_b32 s17, 1441792
s_add_u32 m0, s27, 24576
v_mfma_f32_16x16x32_bf16 a[8:11], v[100:103], v[88:91], a[8:11]
s_nop 0
buffer_load_dwordx4 v10, s[4:7], s16 offen lds
s_add_u32 m0, s27, 25600
s_nop 0
v_mfma_f32_16x16x32_bf16 a[16:19], v[100:103], v[92:95], a[16:19]
buffer_load_dwordx4 v11, s[4:7], s16 offen lds
s_add_u32 m0, s27, 26624
s_nop 0
buffer_load_dwordx4 v12, s[4:7], s16 offen lds
v_mfma_f32_16x16x32_bf16 a[24:27], v[100:103], v[96:99], a[24:27]
s_add_u32 m0, s27, 27648
s_nop 0
buffer_load_dwordx4 v13, s[4:7], s16 offen lds
s_add_u32 m0, s28, 40960
v_mfma_f32_16x16x32_bf16 a[4:7], v[104:107], v[84:87], a[4:7]
s_nop 0
buffer_load_dwordx4 v14, s[8:11], s17 offen lds
s_add_u32 m0, s28, 41984
s_nop 0
v_mfma_f32_16x16x32_bf16 a[12:15], v[104:107], v[88:91], a[12:15]
buffer_load_dwordx4 v15, s[8:11], s17 offen lds
v_add_u32 v23, 73728, v21
v_add_u32 v32, 73728, v25
v_add_u32 v33, 73728, v26
v_mfma_f32_16x16x32_bf16 a[20:23], v[104:107], v[92:95], a[20:23]
ds_read_b128 v[40:43], v23 offset:0
ds_read_b128 v[44:47], v23 offset:2048
ds_read_b128 v[48:51], v23 offset:4096
ds_read_b128 v[52:55], v23 offset:6144
v_mfma_f32_16x16x32_bf16 a[28:31], v[104:107], v[96:99], a[28:31]
ds_read_b64_tr_b16 v[56:57], v32 offset:0
ds_read_b64_tr_b16 v[58:59], v32 offset:512
ds_read_b64_tr_b16 v[60:61], v33 offset:0
ds_read_b64_tr_b16 v[62:63], v33 offset:512
s_waitcnt lgkmcnt(0)
v_mfma_f32_16x16x32_bf16 a[0:3], v[56:59], v[40:43], a[0:3]
v_add_u32 v23, 73728, v22
v_mfma_f32_16x16x32_bf16 a[8:11], v[56:59], v[44:47], a[8:11]
v_add_u32 v32, 73728, v25
v_mfma_f32_16x16x32_bf16 a[16:19], v[56:59], v[48:51], a[16:19]
v_add_u32 v33, 73728, v26
ds_read_b128 v[84:87], v23 offset:0
v_mfma_f32_16x16x32_bf16 a[24:27], v[56:59], v[52:55], a[24:27]
ds_read_b128 v[88:91], v23 offset:2048
v_mfma_f32_16x16x32_bf16 a[4:7], v[60:63], v[40:43], a[4:7]
ds_read_b128 v[92:95], v23 offset:4096
v_mfma_f32_16x16x32_bf16 a[12:15], v[60:63], v[44:47], a[12:15]
ds_read_b128 v[96:99], v23 offset:6144
ds_read_b64_tr_b16 v[100:101], v32 offset:4096
v_mfma_f32_16x16x32_bf16 a[20:23], v[60:63], v[48:51], a[20:23]
ds_read_b64_tr_b16 v[102:103], v32 offset:4608
v_mfma_f32_16x16x32_bf16 a[28:31], v[60:63], v[52:55], a[28:31]
ds_read_b64_tr_b16 v[104:105], v33 offset:4096
ds_read_b64_tr_b16 v[106:107], v33 offset:4608
s_waitcnt vmcnt(12)
s_barrier
s_waitcnt lgkmcnt(0)
v_mfma_f32_16x16x32_bf16 a[0:3], v[100:103], v[84:87], a[0:3]
s_mov_b32 s16, 1536
s_mov_b32 s17, 1572864
s_add_u32 m0, s27, 49152
v_mfma_f32_16x16x32_bf16 a[8:11], v[100:103], v[88:91], a[8:11]
s_nop 0
buffer_load_dwordx4 v10, s[4:7], s16 offen lds
s_add_u32 m0, s27, 50176
s_nop 0
v_mfma_f32_16x16x32_bf16 a[16:19], v[100:103], v[92:95], a[16:19]
buffer_load_dwordx4 v11, s[4:7], s16 offen lds
s_add_u32 m0, s27, 51200
s_nop 0
buffer_load_dwordx4 v12, s[4:7], s16 offen lds
v_mfma_f32_16x16x32_bf16 a[24:27], v[100:103], v[96:99], a[24:27]
s_add_u32 m0, s27, 52224
s_nop 0
buffer_load_dwordx4 v13, s[4:7], s16 offen lds
s_add_u32 m0, s28, 65536
v_mfma_f32_16x16x32_bf16 a[4:7], v[104:107], v[84:87], a[4:7]
s_nop 0
buffer_load_dwordx4 v14, s[8:11], s17 offen lds
s_add_u32 m0, s28, 66560
s_nop 0
v_mfma_f32_16x16x32_bf16 a[12:15], v[104:107], v[88:91], a[12:15]
buffer_load_dwordx4 v15, s[8:11], s17 offen lds
v_add_u32 v23, 98304, v21
v_add_u32 v32, 98304, v25
v_add_u32 v33, 98304, v26
v_mfma_f32_16x16x32_bf16 a[20:23], v[104:107], v[92:95], a[20:23]
ds_read_b128 v[40:43], v23 offset:0
ds_read_b128 v[44:47], v23 offset:2048
ds_read_b128 v[48:51], v23 offset:4096
ds_read_b128 v[52:55], v23 offset:6144
v_mfma_f32_16x16x32_bf16 a[28:31], v[104:107], v[96:99], a[28:31]
ds_read_b64_tr_b16 v[56:57], v32 offset:0
ds_read_b64_tr_b16 v[58:59], v32 offset:512
ds_read_b64_tr_b16 v[60:61], v33 offset:0
ds_read_b64_tr_b16 v[62:63], v33 offset:512
s_waitcnt lgkmcnt(0)
v_mfma_f32_16x16x32_bf16 a[0:3], v[56:59], v[40:43], a[0:3]
v_add_u32 v23, 98304, v22
v_mfma_f32_16x16x32_bf16 a[8:11], v[56:59], v[44:47], a[8:11]
v_add_u32 v32, 98304, v25
v_mfma_f32_16x16x32_bf16 a[16:19], v[56:59], v[48:51], a[16:19]
v_add_u32 v33, 98304, v26
ds_read_b128 v[84:87], v23 offset:0
v_mfma_f32_16x16x32_bf16 a[24:27], v[56:59], v[52:55], a[24:27]
ds_read_b128 v[88:91], v23 offset:2048
v_mfma_f32_16x16x32_bf16 a[4:7], v[60:63], v[40:43], a[4:7]
ds_read_b128 v[92:95], v23 offset:4096
v_mfma_f32_16x16x32_bf16 a[12:15], v[60:63], v[44:47], a[12:15]
ds_read_b128 v[96:99], v23 offset:6144
ds_read_b64_tr_b16 v[100:101], v32 offset:4096
v_mfma_f32_16x16x32_bf16 a[20:23], v[60:63], v[48:51], a[20:23]
ds_read_b64_tr_b16 v[102:103], v32 offset:4608
v_mfma_f32_16x16x32_bf16 a[28:31], v[60:63], v[52:55], a[28:31]
ds_read_b64_tr_b16 v[104:105], v33 offset:4096
ds_read_b64_tr_b16 v[106:107], v33 offset:4608
s_waitcnt vmcnt(12)
s_barrier
s_waitcnt lgkmcnt(0)
v_mfma_f32_16x16x32_bf16 a[0:3], v[100:103], v[84:87], a[0:3]
s_mov_b32 s16, 1664
s_mov_b32 s17, 1703936
s_add_u32 m0, s27, 73728
v_mfma_f32_16x16x32_bf16 a[8:11], v[100:103], v[88:91], a[8:11]
s_nop 0
buffer_load_dwordx4 v10, s[4:7], s16 offen lds
s_add_u32 m0, s27, 74752
s_nop 0
v_mfma_f32_16x16x32_bf16 a[16:19], v[100:103], v[92:95], a[16:19]
buffer_load_dwordx4 v11, s[4:7], s16 offen lds
s_add_u32 m0, s27, 75776
s_nop 0
buffer_load_dwordx4 v12, s[4:7], s16 offen lds
v_mfma_f32_16x16x32_bf16 a[24:27], v[100:103], v[96:99], a[24:27]
s_add_u32 m0, s27, 76800
s_nop 0
buffer_load_dwordx4 v13, s[4:7], s16 offen lds
s_add_u32 m0, s28, 90112
v_mfma_f32_16x16x32_bf16 a[4:7], v[104:107], v[84:87], a[4:7]
s_nop 0
buffer_load_dwordx4 v14, s[8:11], s17 offen lds
s_add_u32 m0, s28, 91136
s_nop 0
v_mfma_f32_16x16x32_bf16 a[12:15], v[104:107], v[88:91], a[12:15]
buffer_load_dwordx4 v15, s[8:11], s17 offen lds
v_add_u32 v23, 0, v21
v_add_u32 v32, 0, v25
v_add_u32 v33, 0, v26
v_mfma_f32_16x16x32_bf16 a[20:23], v[104:107], v[92:95], a[20:23]
ds_read_b128 v[40:43], v23 offset:0
ds_read_b128 v[44:47], v23 offset:2048
ds_read_b128 v[48:51], v23 offset:4096
ds_read_b128 v[52:55], v23 offset:6144
v_mfma_f32_16x16x32_bf16 a[28:31], v[104:107], v[96:99], a[28:31]
ds_read_b64_tr_b16 v[56:57], v32 offset:0
ds_read_b64_tr_b16 v[58:59], v32 offset:512
ds_read_b64_tr_b16 v[60:61], v33 offset:0
ds_read_b64_tr_b16 v[62:63], v33 offset:512
s_waitcnt lgkmcnt(0)
v_mfma_f32_16x16x32_bf16 a[0:3], v[56:59], v[40:43], a[0:3]
v_add_u32 v23, 0, v22
v_mfma_f32_16x16x32_bf16 a[8:11], v[56:59], v[44:47], a[8:11]
v_add_u32 v32, 0, v25
v_mfma_f32_16x16x32_bf16 a[16:19], v[56:59], v[48:51], a[16:19]
v_add_u32 v33, 0, v26
ds_read_b128 v[84:87], v23 offset:0
v_mfma_f32_16x16x32_bf16 a[24:27], v[56:59], v[52:55], a[24:27]
ds_read_b128 v[88:91], v23 offset:2048
v_mfma_f32_16x16x32_bf16 a[4:7], v[60:63], v[40:43], a[4:7]
ds_read_b128 v[92:95], v23 offset:4096
v_mfma_f32_16x16x32_bf16 a[12:15], v[60:63], v[44:47], a[12:15]
ds_read_b128 v[96:99], v23 offset:6144
ds_read_b64_tr_b16 v[100:101], v32 offset:4096
v_mfma_f32_16x16x32_bf16 a[20:23], v[60:63], v[48:51], a[20:23]
ds_read_b64_tr_b16 v[102:103], v32 offset:4608
v_mfma_f32_16x16x32_bf16 a[28:31], v[60:63], v[52:55], a[28:31]
ds_read_b64_tr_b16 v[104:105], v33 offset:4096
ds_read_b64_tr_b16 v[106:107], v33 offset:4608
s_waitcnt vmcnt(12)
s_barrier
s_waitcnt lgkmcnt(0)
v_mfma_f32_16x16x32_bf16 a[0:3], v[100:103], v[84:87], a[0:3]
s_mov_b32 s16, 1792
s_mov_b32 s17, 1835008
s_add_u32 m0, s27, 98304
v_mfma_f32_16x16x32_bf16 a[8:11], v[100:103], v[88:91], a[8:11]
s_nop 0
buffer_load_dwordx4 v10, s[4:7], s16 offen lds
s_add_u32 m0, s27, 99328
s_nop 0
v_mfma_f32_16x16x32_bf16 a[16:19], v[100:103], v[92:95], a[16:19]
buffer_load_dwordx4 v11, s[4:7], s16 offen lds
s_add_u32 m0, s27, 100352
s_nop 0
buffer_load_dwordx4 v12, s[4:7], s16 offen lds
v_mfma_f32_16x16x32_bf16 a[24:27], v[100:103], v[96:99], a[24:27]
s_add_u32 m0, s27, 101376
s_nop 0
buffer_load_dwordx4 v13, s[4:7], s16 offen lds
s_add_u32 m0, s28, 114688
v_mfma_f32_16x16x32_bf16 a[4:7], v[104:107], v[84:87], a[4:7]
s_nop 0
buffer_load_dwordx4 v14, s[8:11], s17 offen lds
s_add_u32 m0, s28, 115712
s_nop 0
v_mfma_f32_16x16x32_bf16 a[12:15], v[104:107], v[88:91], a[12:15]
buffer_load_dwordx4 v15, s[8:11], s17 offen lds
v_add_u32 v23, 24576, v21
v_add_u32 v32, 24576, v25
v_add_u32 v33, 24576, v26
v_mfma_f32_16x16x32_bf16 a[20:23], v[104:107], v[92:95], a[20:23]
ds_read_b128 v[40:43], v23 offset:0
ds_read_b128 v[44:47], v23 offset:2048
ds_read_b128 v[48:51], v23 offset:4096
ds_read_b128 v[52:55], v23 offset:6144
v_mfma_f32_16x16x32_bf16 a[28:31], v[104:107], v[96:99], a[28:31]
ds_read_b64_tr_b16 v[56:57], v32 offset:0
ds_read_b64_tr_b16 v[58:59], v32 offset:512
ds_read_b64_tr_b16 v[60:61], v33 offset:0
ds_read_b64_tr_b16 v[62:63], v33 offset:512
s_waitcnt lgkmcnt(0)
v_mfma_f32_16x16x32_bf16 a[0:3], v[56:59], v[40:43], a[0:3]
v_add_u32 v23, 24576, v22
v_mfma_f32_16x16x32_bf16 a[8:11], v[56:59], v[44:47], a[8:11]
v_add_u32 v32, 24576, v25
v_mfma_f32_16x16x32_bf16 a[16:19], v[56:59], v[48:51], a[16:19]
v_add_u32 v33, 24576, v26
ds_read_b128 v[84:87], v23 offset:0
v_mfma_f32_16x16x32_bf16 a[24:27], v[56:59], v[52:55], a[24:27]
ds_read_b128 v[88:91], v23 offset:2048
v_mfma_f32_16x16x32_bf16 a[4:7], v[60:63], v[40:43], a[4:7]
ds_read_b128 v[92:95], v23 offset:4096
v_mfma_f32_16x16x32_bf16 a[12:15], v[60:63], v[44:47], a[12:15]
ds_read_b128 v[96:99], v23 offset:6144
ds_read_b64_tr_b16 v[100:101], v32 offset:4096
v_mfma_f32_16x16x32_bf16 a[20:23], v[60:63], v[48:51], a[20:23]
ds_read_b64_tr_b16 v[102:103], v32 offset:4608
v_mfma_f32_16x16x32_bf16 a[28:31], v[60:63], v[52:55], a[28:31]
ds_read_b64_tr_b16 v[104:105], v33 offset:4096
ds_read_b64_tr_b16 v[106:107], v33 offset:4608
s_waitcnt vmcnt(12)
s_barrier
s_waitcnt lgkmcnt(0)
v_mfma_f32_16x16x32_bf16 a[0:3], v[100:103], v[84:87], a[0:3]
s_mov_b32 s16, 1920
s_mov_b32 s17, 1966080
s_add_u32 m0, s27, 0
v_mfma_f32_16x16x32_bf16 a[8:11], v[100:103], v[88:91], a[8:11]
s_nop 0
buffer_load_dwordx4 v10, s[4:7], s16 offen lds
s_add_u32 m0, s27, 1024
s_nop 0
v_mfma_f32_16x16x32_bf16 a[16:19], v[100:103], v[92:95], a[16:19]
buffer_load_dwordx4 v11, s[4:7], s16 offen lds
s_add_u32 m0, s27, 2048
s_nop 0
buffer_load_dwordx4 v12, s[4:7], s16 offen lds
v_mfma_f32_16x16x32_bf16 a[24:27], v[100:103], v[96:99], a[24:27]
s_add_u32 m0, s27, 3072
s_nop 0
buffer_load_dwordx4 v13, s[4:7], s16 offen lds
s_add_u32 m0, s28, 16384
v_mfma_f32_16x16x32_bf16 a[4:7], v[104:107], v[84:87], a[4:7]
s_nop 0
buffer_load_dwordx4 v14, s[8:11], s17 offen lds
s_add_u32 m0, s28, 17408
s_nop 0
v_mfma_f32_16x16x32_bf16 a[12:15], v[104:107], v[88:91], a[12:15]
buffer_load_dwordx4 v15, s[8:11], s17 offen lds
v_add_u32 v23, 49152, v21
v_add_u32 v32, 49152, v25
v_add_u32 v33, 49152, v26
v_mfma_f32_16x16x32_bf16 a[20:23], v[104:107], v[92:95], a[20:23]
ds_read_b128 v[40:43], v23 offset:0
ds_read_b128 v[44:47], v23 offset:2048
ds_read_b128 v[48:51], v23 offset:4096
ds_read_b128 v[52:55], v23 offset:6144
v_mfma_f32_16x16x32_bf16 a[28:31], v[104:107], v[96:99], a[28:31]
ds_read_b64_tr_b16 v[56:57], v32 offset:0
ds_read_b64_tr_b16 v[58:59], v32 offset:512
ds_read_b64_tr_b16 v[60:61], v33 offset:0
ds_read_b64_tr_b16 v[62:63], v33 offset:512
s_waitcnt lgkmcnt(0)
v_mfma_f32_16x16x32_bf16 a[0:3], v[56:59], v[40:43], a[0:3]
v_add_u32 v23, 49152, v22
v_mfma_f32_16x16x32_bf16 a[8:11], v[56:59], v[44:47], a[8:11]
v_add_u32 v32, 49152, v25
v_mfma_f32_16x16x32_bf16 a[16:19], v[56:59], v[48:51], a[16:19]
v_add_u32 v33, 49152, v26
ds_read_b128 v[84:87], v23 offset:0
v_mfma_f32_16x16x32_bf16 a[24:27], v[56:59], v[52:55], a[24:27]
ds_read_b128 v[88:91], v23 offset:2048
v_mfma_f32_16x16x32_bf16 a[4:7], v[60:63], v[40:43], a[4:7]
ds_read_b128 v[92:95], v23 offset:4096
v_mfma_f32_16x16x32_bf16 a[12:15], v[60:63], v[44:47], a[12:15]
ds_read_b128 v[96:99], v23 offset:6144
ds_read_b64_tr_b16 v[100:101], v32 offset:4096
v_mfma_f32_16x16x32_bf16 a[20:23], v[60:63], v[48:51], a[20:23]
ds_read_b64_tr_b16 v[102:103], v32 offset:4608
v_mfma_f32_16x16x32_bf16 a[28:31], v[60:63], v[52:55], a[28:31]
ds_read_b64_tr_b16 v[104:105], v33 offset:4096
ds_read_b64_tr_b16 v[106:107], v33 offset:4608
s_waitcnt vmcnt(12)
s_barrier
s_waitcnt lgkmcnt(0)
v_mfma_f32_16x16x32_bf16 a[0:3], v[100:103], v[84:87], a[0:3]
v_add_u32 v23, 73728, v21
v_mfma_f32_16x16x32_bf16 a[8:11], v[100:103], v[88:91], a[8:11]
v_add_u32 v32, 73728, v25
v_mfma_f32_16x16x32_bf16 a[16:19], v[100:103], v[92:95], a[16:19]
v_add_u32 v33, 73728, v26
ds_read_b128 v[40:43], v23 offset:0
v_mfma_f32_16x16x32_bf16 a[24:27], v[100:103], v[96:99], a[24:27]
ds_read_b128 v[44:47], v23 offset:2048
v_mfma_f32_16x16x32_bf16 a[4:7], v[104:107], v[84:87], a[4:7]
ds_read_b128 v[48:51], v23 offset:4096
v_mfma_f32_16x16x32_bf16 a[12:15], v[104:107], v[88:91], a[12:15]
ds_read_b128 v[52:55], v23 offset:6144
ds_read_b64_tr_b16 v[56:57], v32 offset:0
v_mfma_f32_16x16x32_bf16 a[20:23], v[104:107], v[92:95], a[20:23]
ds_read_b64_tr_b16 v[58:59], v32 offset:512
v_mfma_f32_16x16x32_bf16 a[28:31], v[104:107], v[96:99], a[28:31]
ds_read_b64_tr_b16 v[60:61], v33 offset:0
ds_read_b64_tr_b16 v[62:63], v33 offset:512
s_waitcnt lgkmcnt(0)
v_mfma_f32_16x16x32_bf16 a[0:3], v[56:59], v[40:43], a[0:3]
v_add_u32 v23, 73728, v22
v_mfma_f32_16x16x32_bf16 a[8:11], v[56:59], v[44:47], a[8:11]
v_add_u32 v32, 73728, v25
v_mfma_f32_16x16x32_bf16 a[16:19], v[56:59], v[48:51], a[16:19]
v_add_u32 v33, 73728, v26
ds_read_b128 v[84:87], v23 offset:0
v_mfma_f32_16x16x32_bf16 a[24:27], v[56:59], v[52:55], a[24:27]
ds_read_b128 v[88:91], v23 offset:2048
v_mfma_f32_16x16x32_bf16 a[4:7], v[60:63], v[40:43], a[4:7]
ds_read_b128 v[92:95], v23 offset:4096
v_mfma_f32_16x16x32_bf16 a[12:15], v[60:63], v[44:47], a[12:15]
ds_read_b128 v[96:99], v23 offset:6144
ds_read_b64_tr_b16 v[100:101], v32 offset:4096
v_mfma_f32_16x16x32_bf16 a[20:23], v[60:63], v[48:51], a[20:23]
ds_read_b64_tr_b16 v[102:103], v32 offset:4608
v_mfma_f32_16x16x32_bf16 a[28:31], v[60:63], v[52:55], a[28:31]
ds_read_b64_tr_b16 v[104:105], v33 offset:4096
ds_read_b64_tr_b16 v[106:107], v33 offset:4608
s_waitcnt vmcnt(6)
s_barrier
s_waitcnt lgkmcnt(0)
v_mfma_f32_16x16x32_bf16 a[0:3], v[100:103], v[84:87], a[0:3]
v_add_u32 v23, 98304, v21
v_mfma_f32_16x16x32_bf16 a[8:11], v[100:103], v[88:91], a[8:11]
v_add_u32 v32, 98304, v25
v_mfma_f32_16x16x32_bf16 a[16:19], v[100:103], v[92:95], a[16:19]
v_add_u32 v33, 98304, v26
ds_read_b128 v[40:43], v23 offset:0
v_mfma_f32_16x16x32_bf16 a[24:27], v[100:103], v[96:99], a[24:27]
ds_read_b128 v[44:47], v23 offset:2048
v_mfma_f32_16x16x32_bf16 a[4:7], v[104:107], v[84:87], a[4:7]
ds_read_b128 v[48:51], v23 offset:4096
v_mfma_f32_16x16x32_bf16 a[12:15], v[104:107], v[88:91], a[12:15]
ds_read_b128 v[52:55], v23 offset:6144
ds_read_b64_tr_b16 v[56:57], v32 offset:0
v_mfma_f32_16x16x32_bf16 a[20:23], v[104:107], v[92:95], a[20:23]
ds_read_b64_tr_b16 v[58:59], v32 offset:512
v_mfma_f32_16x16x32_bf16 a[28:31], v[104:107], v[96:99], a[28:31]
ds_read_b64_tr_b16 v[60:61], v33 offset:0
ds_read_b64_tr_b16 v[62:63], v33 offset:512
s_waitcnt lgkmcnt(0)
v_mfma_f32_16x16x32_bf16 a[0:3], v[56:59], v[40:43], a[0:3]
v_add_u32 v23, 98304, v22
v_mfma_f32_16x16x32_bf16 a[8:11], v[56:59], v[44:47], a[8:11]
v_add_u32 v32, 98304, v25
v_mfma_f32_16x16x32_bf16 a[16:19], v[56:59], v[48:51], a[16:19]
v_add_u32 v33, 98304, v26
ds_read_b128 v[84:87], v23 offset:0
v_mfma_f32_16x16x32_bf16 a[24:27], v[56:59], v[52:55], a[24:27]
ds_read_b128 v[88:91], v23 offset:2048
v_mfma_f32_16x16x32_bf16 a[4:7], v[60:63], v[40:43], a[4:7]
ds_read_b128 v[92:95], v23 offset:4096
v_mfma_f32_16x16x32_bf16 a[12:15], v[60:63], v[44:47], a[12:15]
ds_read_b128 v[96:99], v23 offset:6144
ds_read_b64_tr_b16 v[100:101], v32 offset:4096
v_mfma_f32_16x16x32_bf16 a[20:23], v[60:63], v[48:51], a[20:23]
ds_read_b64_tr_b16 v[102:103], v32 offset:4608
v_mfma_f32_16x16x32_bf16 a[28:31], v[60:63], v[52:55], a[28:31]
ds_read_b64_tr_b16 v[104:105], v33 offset:4096
ds_read_b64_tr_b16 v[106:107], v33 offset:4608
s_waitcnt vmcnt(0)
s_barrier
s_waitcnt lgkmcnt(0)
v_mfma_f32_16x16x32_bf16 a[0:3], v[100:103], v[84:87], a[0:3]
v_add_u32 v23, 0, v21
v_mfma_f32_16x16x32_bf16 a[8:11], v[100:103], v[88:91], a[8:11]
v_add_u32 v32, 0, v25
v_mfma_f32_16x16x32_bf16 a[16:19], v[100:103], v[92:95], a[16:19]
v_add_u32 v33, 0, v26
ds_read_b128 v[40:43], v23 offset:0
v_mfma_f32_16x16x32_bf16 a[24:27], v[100:103], v[96:99], a[24:27]
ds_read_b128 v[44:47], v23 offset:2048
v_mfma_f32_16x16x32_bf16 a[4:7], v[104:107], v[84:87], a[4:7]
ds_read_b128 v[48:51], v23 offset:4096
v_mfma_f32_16x16x32_bf16 a[12:15], v[104:107], v[88:91], a[12:15]
ds_read_b128 v[52:55], v23 offset:6144
ds_read_b64_tr_b16 v[56:57], v32 offset:0
v_mfma_f32_16x16x32_bf16 a[20:23], v[104:107], v[92:95], a[20:23]
ds_read_b64_tr_b16 v[58:59], v32 offset:512
v_mfma_f32_16x16x32_bf16 a[28:31], v[104:107], v[96:99], a[28:31]
ds_read_b64_tr_b16 v[60:61], v33 offset:0
ds_read_b64_tr_b16 v[62:63], v33 offset:512
s_waitcnt lgkmcnt(0)
v_mfma_f32_16x16x32_bf16 a[0:3], v[56:59], v[40:43], a[0:3]
v_add_u32 v23, 0, v22
v_mfma_f32_16x16x32_bf16 a[8:11], v[56:59], v[44:47], a[8:11]
v_add_u32 v32, 0, v25
v_mfma_f32_16x16x32_bf16 a[16:19], v[56:59], v[48:51], a[16:19]
v_add_u32 v33, 0, v26
ds_read_b128 v[84:87], v23 offset:0
v_mfma_f32_16x16x32_bf16 a[24:27], v[56:59], v[52:55], a[24:27]
ds_read_b128 v[88:91], v23 offset:2048
v_mfma_f32_16x16x32_bf16 a[4:7], v[60:63], v[40:43], a[4:7]
ds_read_b128 v[92:95], v23 offset:4096
v_mfma_f32_16x16x32_bf16 a[12:15], v[60:63], v[44:47], a[12:15]
ds_read_b128 v[96:99], v23 offset:6144
ds_read_b64_tr_b16 v[100:101], v32 offset:4096
v_mfma_f32_16x16x32_bf16 a[20:23], v[60:63], v[48:51], a[20:23]
ds_read_b64_tr_b16 v[102:103], v32 offset:4608
v_mfma_f32_16x16x32_bf16 a[28:31], v[60:63], v[52:55], a[28:31]
ds_read_b64_tr_b16 v[104:105], v33 offset:4096
ds_read_b64_tr_b16 v[106:107], v33 offset:4608
s_waitcnt vmcnt(0)
s_barrier
s_waitcnt lgkmcnt(0)
v_mfma_f32_16x16x32_bf16 a[0:3], v[100:103], v[84:87], a[0:3]
v_add_u32 v23, 24576, v21
v_mfma_f32_16x16x32_bf16 a[8:11], v[100:103], v[88:91], a[8:11]
v_add_u32 v32, 24576, v25
v_mfma_f32_16x16x32_bf16 a[16:19], v[100:103], v[92:95], a[16:19]
v_add_u32 v33, 24576, v26
ds_read_b128 v[40:43], v23 offset:0
v_mfma_f32_16x16x32_bf16 a[24:27], v[100:103], v[96:99], a[24:27]
ds_read_b128 v[44:47], v23 offset:2048
v_mfma_f32_16x16x32_bf16 a[4:7], v[104:107], v[84:87], a[4:7]
ds_read_b128 v[48:51], v23 offset:4096
v_mfma_f32_16x16x32_bf16 a[12:15], v[104:107], v[88:91], a[12:15]
ds_read_b128 v[52:55], v23 offset:6144
ds_read_b64_tr_b16 v[56:57], v32 offset:0
v_mfma_f32_16x16x32_bf16 a[20:23], v[104:107], v[92:95], a[20:23]
ds_read_b64_tr_b16 v[58:59], v32 offset:512
v_mfma_f32_16x16x32_bf16 a[28:31], v[104:107], v[96:99], a[28:31]
ds_read_b64_tr_b16 v[60:61], v33 offset:0
ds_read_b64_tr_b16 v[62:63], v33 offset:512
s_waitcnt vmcnt(0) lgkmcnt(0)
s_nop 15
s_nop 7
v_and_b32 v4, 15, v1
v_lshrrev_b32 v5, 4, v1
v_lshrrev_b32 v6, 1, v2
v_and_b32 v7, 1, v2
v_lshl_add_u32 v8, v6, 6, v4
s_lshl_b32 s25, s22, 7
v_add_u32 v9, s25, v8
v_xor_b32 v60, 16, v1
v_lshlrev_b32 v60, 2, v60
v_xor_b32 v61, 32, v1
v_lshlrev_b32 v61, 2, v61
s_mul_i32 s25, s23, 64
v_mul_u32_u24 v10, 32, v7
v_add_u32 v10, s25, v10
v_lshl_add_u32 v10, v5, 2, v10
s_mov_b32 s26, 1024
v_mul_lo_u32 v11, v9, s26
v_add_u32 v11, v11, v10
v_lshlrev_b32 v11, 1, v11
s_load_dwordx2 s[12:13], s[0:1], 88
s_load_dwordx2 s[4:5], s[0:1], 88
s_load_dwordx2 s[16:17], s[0:1], 88
s_waitcnt lgkmcnt(0)
s_mov_b32 s14, 4194304
s_mov_b32 s15, 0x00020000
s_mov_b32 s6, 4194304
s_mov_b32 s7, 0x00020000
s_add_u32 s16, s16, 52428800
s_addc_u32 s17, s17, 0
s_mov_b32 s18, 524288
s_mov_b32 s19, 0x00020000
v_add_u32 v13, 0, v11
buffer_load_dwordx2 v[72:73], v13, s[4:7], 0 offen offset:0
buffer_load_dwordx2 v[74:75], v13, s[4:7], 0 offen offset:32
v_mov_b32 v14, 0
v_mov_b32 v15, 0
s_waitcnt vmcnt(0) lgkmcnt(0)
v_accvgpr_read_b32 v104, a0
v_accvgpr_read_b32 v105, a1
v_accvgpr_read_b32 v106, a2
v_accvgpr_read_b32 v107, a3
v_cvt_pk_bf16_f32 v110, v104, v105
v_lshlrev_b32 v104, 16, v110
v_and_b32 v105, 0xffff0000, v110
v_cvt_pk_bf16_f32 v110, v106, v107
v_lshlrev_b32 v106, 16, v110
v_and_b32 v107, 0xffff0000, v110
v_lshlrev_b32 v112, 16, v72
v_and_b32 v113, 0xffff0000, v72
v_lshlrev_b32 v114, 16, v73
v_and_b32 v115, 0xffff0000, v73
v_add_f32 v104, v104, v112
v_add_f32 v105, v105, v113
v_add_f32 v106, v106, v114
v_add_f32 v107, v107, v115
v_cvt_pk_bf16_f32 v108, v104, v105
v_lshlrev_b32 v104, 16, v108
v_and_b32 v105, 0xffff0000, v108
v_cvt_pk_bf16_f32 v109, v106, v107
v_lshlrev_b32 v106, 16, v109
v_and_b32 v107, 0xffff0000, v109
v_add_f32 v14, v14, v104
v_fmac_f32 v15, v104, v104
v_add_f32 v14, v14, v105
v_fmac_f32 v15, v105, v105
v_add_f32 v14, v14, v106
v_fmac_f32 v15, v106, v106
v_add_f32 v14, v14, v107
v_fmac_f32 v15, v107, v107
buffer_store_dwordx2 v[108:109], v13, s[12:15], 0 offen offset:0
s_nop 1
v_accvgpr_read_b32 v104, a4
v_accvgpr_read_b32 v105, a5
v_accvgpr_read_b32 v106, a6
v_accvgpr_read_b32 v107, a7
v_cvt_pk_bf16_f32 v110, v104, v105
v_lshlrev_b32 v104, 16, v110
v_and_b32 v105, 0xffff0000, v110
v_cvt_pk_bf16_f32 v110, v106, v107
v_lshlrev_b32 v106, 16, v110
v_and_b32 v107, 0xffff0000, v110
v_lshlrev_b32 v112, 16, v74
v_and_b32 v113, 0xffff0000, v74
v_lshlrev_b32 v114, 16, v75
v_and_b32 v115, 0xffff0000, v75
v_add_f32 v104, v104, v112
v_add_f32 v105, v105, v113
v_add_f32 v106, v106, v114
v_add_f32 v107, v107, v115
v_cvt_pk_bf16_f32 v108, v104, v105
v_lshlrev_b32 v104, 16, v108
v_and_b32 v105, 0xffff0000, v108
v_cvt_pk_bf16_f32 v109, v106, v107
v_lshlrev_b32 v106, 16, v109
v_and_b32 v107, 0xffff0000, v109
v_add_f32 v14, v14, v104
v_fmac_f32 v15, v104, v104
v_add_f32 v14, v14, v105
v_fmac_f32 v15, v105, v105
v_add_f32 v14, v14, v106
v_fmac_f32 v15, v106, v106
v_add_f32 v14, v14, v107
v_fmac_f32 v15, v107, v107
buffer_store_dwordx2 v[108:109], v13, s[12:15], 0 offen offset:32
s_nop 1
ds_bpermute_b32 v16, v60, v14
ds_bpermute_b32 v17, v60, v15
s_waitcnt lgkmcnt(0)
v_add_f32 v14, v14, v16
v_add_f32 v15, v15, v17
ds_bpermute_b32 v16, v61, v14
ds_bpermute_b32 v17, v61, v15
s_waitcnt lgkmcnt(0)
v_add_f32 v14, v14, v16
v_add_f32 v15, v15, v17
v_add_u32 v16, 0, v9
v_lshlrev_b32 v16, 8, v16
s_lshl_b32 s25, s23, 4
v_add_u32 v16, s25, v16
v_lshl_add_u32 v16, v7, 3, v16
v_cmp_gt_u32 vcc, 16, v1
s_and_saveexec_b64 s[30:31], vcc
buffer_store_dwordx2 v[14:15], v16, s[16:19], 0 offen
s_mov_b64 exec, s[30:31]
s_nop 1
v_add_u32 v13, 32768, v11
buffer_load_dwordx2 v[72:73], v13, s[4:7], 0 offen offset:0
buffer_load_dwordx2 v[74:75], v13, s[4:7], 0 offen offset:32
v_mov_b32 v14, 0
v_mov_b32 v15, 0
s_waitcnt vmcnt(0) lgkmcnt(0)
v_accvgpr_read_b32 v104, a8
v_accvgpr_read_b32 v105, a9
v_accvgpr_read_b32 v106, a10
v_accvgpr_read_b32 v107, a11
v_cvt_pk_bf16_f32 v110, v104, v105
v_lshlrev_b32 v104, 16, v110
v_and_b32 v105, 0xffff0000, v110
v_cvt_pk_bf16_f32 v110, v106, v107
v_lshlrev_b32 v106, 16, v110
v_and_b32 v107, 0xffff0000, v110
v_lshlrev_b32 v112, 16, v72
v_and_b32 v113, 0xffff0000, v72
v_lshlrev_b32 v114, 16, v73
v_and_b32 v115, 0xffff0000, v73
v_add_f32 v104, v104, v112
v_add_f32 v105, v105, v113
v_add_f32 v106, v106, v114
v_add_f32 v107, v107, v115
v_cvt_pk_bf16_f32 v108, v104, v105
v_lshlrev_b32 v104, 16, v108
v_and_b32 v105, 0xffff0000, v108
v_cvt_pk_bf16_f32 v109, v106, v107
v_lshlrev_b32 v106, 16, v109
v_and_b32 v107, 0xffff0000, v109
v_add_f32 v14, v14, v104
v_fmac_f32 v15, v104, v104
v_add_f32 v14, v14, v105
v_fmac_f32 v15, v105, v105
v_add_f32 v14, v14, v106
v_fmac_f32 v15, v106, v106
v_add_f32 v14, v14, v107
v_fmac_f32 v15, v107, v107
buffer_store_dwordx2 v[108:109], v13, s[12:15], 0 offen offset:0
s_nop 1
v_accvgpr_read_b32 v104, a12
v_accvgpr_read_b32 v105, a13
v_accvgpr_read_b32 v106, a14
v_accvgpr_read_b32 v107, a15
v_cvt_pk_bf16_f32 v110, v104, v105
v_lshlrev_b32 v104, 16, v110
v_and_b32 v105, 0xffff0000, v110
v_cvt_pk_bf16_f32 v110, v106, v107
v_lshlrev_b32 v106, 16, v110
v_and_b32 v107, 0xffff0000, v110
v_lshlrev_b32 v112, 16, v74
v_and_b32 v113, 0xffff0000, v74
v_lshlrev_b32 v114, 16, v75
v_and_b32 v115, 0xffff0000, v75
v_add_f32 v104, v104, v112
v_add_f32 v105, v105, v113
v_add_f32 v106, v106, v114
v_add_f32 v107, v107, v115
v_cvt_pk_bf16_f32 v108, v104, v105
v_lshlrev_b32 v104, 16, v108
v_and_b32 v105, 0xffff0000, v108
v_cvt_pk_bf16_f32 v109, v106, v107
v_lshlrev_b32 v106, 16, v109
v_and_b32 v107, 0xffff0000, v109
v_add_f32 v14, v14, v104
v_fmac_f32 v15, v104, v104
v_add_f32 v14, v14, v105
v_fmac_f32 v15, v105, v105
v_add_f32 v14, v14, v106
v_fmac_f32 v15, v106, v106
v_add_f32 v14, v14, v107
v_fmac_f32 v15, v107, v107
buffer_store_dwordx2 v[108:109], v13, s[12:15], 0 offen offset:32
s_nop 1
ds_bpermute_b32 v16, v60, v14
ds_bpermute_b32 v17, v60, v15
s_waitcnt lgkmcnt(0)
v_add_f32 v14, v14, v16
v_add_f32 v15, v15, v17
ds_bpermute_b32 v16, v61, v14
ds_bpermute_b32 v17, v61, v15
s_waitcnt lgkmcnt(0)
v_add_f32 v14, v14, v16
v_add_f32 v15, v15, v17
v_add_u32 v16, 16, v9
v_lshlrev_b32 v16, 8, v16
s_lshl_b32 s25, s23, 4
v_add_u32 v16, s25, v16
v_lshl_add_u32 v16, v7, 3, v16
v_cmp_gt_u32 vcc, 16, v1
s_and_saveexec_b64 s[30:31], vcc
buffer_store_dwordx2 v[14:15], v16, s[16:19], 0 offen
s_mov_b64 exec, s[30:31]
s_nop 1
v_add_u32 v13, 65536, v11
buffer_load_dwordx2 v[72:73], v13, s[4:7], 0 offen offset:0
buffer_load_dwordx2 v[74:75], v13, s[4:7], 0 offen offset:32
v_mov_b32 v14, 0
v_mov_b32 v15, 0
s_waitcnt vmcnt(0) lgkmcnt(0)
v_accvgpr_read_b32 v104, a16
v_accvgpr_read_b32 v105, a17
v_accvgpr_read_b32 v106, a18
v_accvgpr_read_b32 v107, a19
v_cvt_pk_bf16_f32 v110, v104, v105
v_lshlrev_b32 v104, 16, v110
v_and_b32 v105, 0xffff0000, v110
v_cvt_pk_bf16_f32 v110, v106, v107
v_lshlrev_b32 v106, 16, v110
v_and_b32 v107, 0xffff0000, v110
v_lshlrev_b32 v112, 16, v72
v_and_b32 v113, 0xffff0000, v72
v_lshlrev_b32 v114, 16, v73
v_and_b32 v115, 0xffff0000, v73
v_add_f32 v104, v104, v112
v_add_f32 v105, v105, v113
v_add_f32 v106, v106, v114
v_add_f32 v107, v107, v115
v_cvt_pk_bf16_f32 v108, v104, v105
v_lshlrev_b32 v104, 16, v108
v_and_b32 v105, 0xffff0000, v108
v_cvt_pk_bf16_f32 v109, v106, v107
v_lshlrev_b32 v106, 16, v109
v_and_b32 v107, 0xffff0000, v109
v_add_f32 v14, v14, v104
v_fmac_f32 v15, v104, v104
v_add_f32 v14, v14, v105
v_fmac_f32 v15, v105, v105
v_add_f32 v14, v14, v106
v_fmac_f32 v15, v106, v106
v_add_f32 v14, v14, v107
v_fmac_f32 v15, v107, v107
buffer_store_dwordx2 v[108:109], v13, s[12:15], 0 offen offset:0
s_nop 1
v_accvgpr_read_b32 v104, a20
v_accvgpr_read_b32 v105, a21
v_accvgpr_read_b32 v106, a22
v_accvgpr_read_b32 v107, a23
v_cvt_pk_bf16_f32 v110, v104, v105
v_lshlrev_b32 v104, 16, v110
v_and_b32 v105, 0xffff0000, v110
v_cvt_pk_bf16_f32 v110, v106, v107
v_lshlrev_b32 v106, 16, v110
v_and_b32 v107, 0xffff0000, v110
v_lshlrev_b32 v112, 16, v74
v_and_b32 v113, 0xffff0000, v74
v_lshlrev_b32 v114, 16, v75
v_and_b32 v115, 0xffff0000, v75
v_add_f32 v104, v104, v112
v_add_f32 v105, v105, v113
v_add_f32 v106, v106, v114
v_add_f32 v107, v107, v115
v_cvt_pk_bf16_f32 v108, v104, v105
v_lshlrev_b32 v104, 16, v108
v_and_b32 v105, 0xffff0000, v108
v_cvt_pk_bf16_f32 v109, v106, v107
v_lshlrev_b32 v106, 16, v109
v_and_b32 v107, 0xffff0000, v109
v_add_f32 v14, v14, v104
v_fmac_f32 v15, v104, v104
v_add_f32 v14, v14, v105
v_fmac_f32 v15, v105, v105
v_add_f32 v14, v14, v106
v_fmac_f32 v15, v106, v106
v_add_f32 v14, v14, v107
v_fmac_f32 v15, v107, v107
buffer_store_dwordx2 v[108:109], v13, s[12:15], 0 offen offset:32
s_nop 1
ds_bpermute_b32 v16, v60, v14
ds_bpermute_b32 v17, v60, v15
s_waitcnt lgkmcnt(0)
v_add_f32 v14, v14, v16
v_add_f32 v15, v15, v17
ds_bpermute_b32 v16, v61, v14
ds_bpermute_b32 v17, v61, v15
s_waitcnt lgkmcnt(0)
v_add_f32 v14, v14, v16
v_add_f32 v15, v15, v17
v_add_u32 v16, 32, v9
v_lshlrev_b32 v16, 8, v16
s_lshl_b32 s25, s23, 4
v_add_u32 v16, s25, v16
v_lshl_add_u32 v16, v7, 3, v16
v_cmp_gt_u32 vcc, 16, v1
s_and_saveexec_b64 s[30:31], vcc
buffer_store_dwordx2 v[14:15], v16, s[16:19], 0 offen
s_mov_b64 exec, s[30:31]
s_nop 1
v_add_u32 v13, 98304, v11
buffer_load_dwordx2 v[72:73], v13, s[4:7], 0 offen offset:0
buffer_load_dwordx2 v[74:75], v13, s[4:7], 0 offen offset:32
v_mov_b32 v14, 0
v_mov_b32 v15, 0
s_waitcnt vmcnt(0) lgkmcnt(0)
v_accvgpr_read_b32 v104, a24
v_accvgpr_read_b32 v105, a25
v_accvgpr_read_b32 v106, a26
v_accvgpr_read_b32 v107, a27
v_cvt_pk_bf16_f32 v110, v104, v105
v_lshlrev_b32 v104, 16, v110
v_and_b32 v105, 0xffff0000, v110
v_cvt_pk_bf16_f32 v110, v106, v107
v_lshlrev_b32 v106, 16, v110
v_and_b32 v107, 0xffff0000, v110
v_lshlrev_b32 v112, 16, v72
v_and_b32 v113, 0xffff0000, v72
v_lshlrev_b32 v114, 16, v73
v_and_b32 v115, 0xffff0000, v73
v_add_f32 v104, v104, v112
v_add_f32 v105, v105, v113
v_add_f32 v106, v106, v114
v_add_f32 v107, v107, v115
v_cvt_pk_bf16_f32 v108, v104, v105
v_lshlrev_b32 v104, 16, v108
v_and_b32 v105, 0xffff0000, v108
v_cvt_pk_bf16_f32 v109, v106, v107
v_lshlrev_b32 v106, 16, v109
v_and_b32 v107, 0xffff0000, v109
v_add_f32 v14, v14, v104
v_fmac_f32 v15, v104, v104
v_add_f32 v14, v14, v105
v_fmac_f32 v15, v105, v105
v_add_f32 v14, v14, v106
v_fmac_f32 v15, v106, v106
v_add_f32 v14, v14, v107
v_fmac_f32 v15, v107, v107
buffer_store_dwordx2 v[108:109], v13, s[12:15], 0 offen offset:0
s_nop 1
v_accvgpr_read_b32 v104, a28
v_accvgpr_read_b32 v105, a29
v_accvgpr_read_b32 v106, a30
v_accvgpr_read_b32 v107, a31
v_cvt_pk_bf16_f32 v110, v104, v105
v_lshlrev_b32 v104, 16, v110
v_and_b32 v105, 0xffff0000, v110
v_cvt_pk_bf16_f32 v110, v106, v107
v_lshlrev_b32 v106, 16, v110
v_and_b32 v107, 0xffff0000, v110
v_lshlrev_b32 v112, 16, v74
v_and_b32 v113, 0xffff0000, v74
v_lshlrev_b32 v114, 16, v75
v_and_b32 v115, 0xffff0000, v75
v_add_f32 v104, v104, v112
v_add_f32 v105, v105, v113
v_add_f32 v106, v106, v114
v_add_f32 v107, v107, v115
v_cvt_pk_bf16_f32 v108, v104, v105
v_lshlrev_b32 v104, 16, v108
v_and_b32 v105, 0xffff0000, v108
v_cvt_pk_bf16_f32 v109, v106, v107
v_lshlrev_b32 v106, 16, v109
v_and_b32 v107, 0xffff0000, v109
v_add_f32 v14, v14, v104
v_fmac_f32 v15, v104, v104
v_add_f32 v14, v14, v105
v_fmac_f32 v15, v105, v105
v_add_f32 v14, v14, v106
v_fmac_f32 v15, v106, v106
v_add_f32 v14, v14, v107
v_fmac_f32 v15, v107, v107
buffer_store_dwordx2 v[108:109], v13, s[12:15], 0 offen offset:32
s_nop 1
ds_bpermute_b32 v16, v60, v14
ds_bpermute_b32 v17, v60, v15
s_waitcnt lgkmcnt(0)
v_add_f32 v14, v14, v16
v_add_f32 v15, v15, v17
ds_bpermute_b32 v16, v61, v14
ds_bpermute_b32 v17, v61, v15
s_waitcnt lgkmcnt(0)
v_add_f32 v14, v14, v16
v_add_f32 v15, v15, v17
v_add_u32 v16, 48, v9
v_lshlrev_b32 v16, 8, v16
s_lshl_b32 s25, s23, 4
v_add_u32 v16, s25, v16
v_lshl_add_u32 v16, v7, 3, v16
v_cmp_gt_u32 vcc, 16, v1
s_and_saveexec_b64 s[30:31], vcc
buffer_store_dwordx2 v[14:15], v16, s[16:19], 0 offen
s_mov_b64 exec, s[30:31]
s_nop 1
wo_kernel_end:
s_endpgm
.globl w1_kernel
.p2align 8
.type w1_kernel,@function
w1_kernel:
s_cmp_ge_u32 s2, 256
s_cbranch_scc1 w1_kernel_end
s_load_dwordx2 s[4:5], s[0:1], 88
s_load_dwordx2 s[8:9], s[0:1], 40
s_and_b32 s20, s2, 7
s_lshr_b32 s21, s2, 3
s_lshr_b32 s22, s20, 1
s_lshl_b32 s22, s22, 2
s_and_b32 s23, s21, 3
s_add_u32 s22, s22, s23
s_and_b32 s23, s20, 1
s_lshl_b32 s23, s23, 3
s_lshr_b32 s24, s21, 2
s_add_u32 s23, s23, s24
v_and_b32 v1, 63, v0
v_lshrrev_b32 v2, 6, v0
s_waitcnt lgkmcnt(0)
s_mov_b32 s6, 4194304
s_mov_b32 s7, 0x00020000
s_mov_b32 s10, 2097152
s_mov_b32 s11, 0x00020000
v_lshrrev_b32 v3, 3, v1
v_and_b32 v4, 7, v1
v_xor_b32 v4, v4, v3
v_lshlrev_b32 v4, 4, v4
s_lshl_b32 s25, s22, 7
v_lshlrev_b32 v5, 5, v2
v_add_u32 v5, s25, v5
v_add_u32 v5, v5, v3
s_mov_b32 s26, 2048
v_mul_lo_u32 v5, v5, s26
v_add_u32 v10, v5, v4
v_add_u32 v11, 16384, v10
v_add_u32 v12, 32768, v10
v_add_u32 v13, 49152, v10
v_mul_u32_u24 v3, 128, v2
v_add_u32 v3, 0, v3
v_add_u32 v3, v3, v1
v_mul_u32_u24 v4, 8192, v3
v_lshrrev_b32 v4, 16, v4
v_mul_u32_u24 v5, 8, v4
v_sub_u32 v5, v3, v5
v_bfe_u32 v6, v4, 3, 1
v_bfe_u32 v7, v4, 1, 1
v_lshl_or_b32 v6, v7, 1, v6
v_lshlrev_b32 v6, 1, v6
v_xor_b32 v5, v5, v6
s_mul_i32 s25, s23, 128
v_lshlrev_b32 v9, 4, v5
v_add_u32 v9, s25, v9
v_mul_u32_u24 v4, 2048, v4
v_add_u32 v14, v4, v9
v_mul_u32_u24 v3, 128, v2
v_add_u32 v3, 64, v3
v_add_u32 v3, v3, v1
v_mul_u32_u24 v4, 8192, v3
v_lshrrev_b32 v4, 16, v4
v_mul_u32_u24 v5, 8, v4
v_sub_u32 v5, v3, v5
v_bfe_u32 v6, v4, 3, 1
v_bfe_u32 v7, v4, 1, 1
v_lshl_or_b32 v6, v7, 1, v6
v_lshlrev_b32 v6, 1, v6
v_xor_b32 v5, v5, v6
s_mul_i32 s25, s23, 128
v_lshlrev_b32 v9, 4, v5
v_add_u32 v9, s25, v9
v_mul_u32_u24 v4, 2048, v4
v_add_u32 v15, v4, v9
v_lshrrev_b32 v3, 1, v2
v_lshlrev_b32 v3, 6, v3
v_and_b32 v4, 15, v1
v_add_u32 v3, v3, v4
v_lshlrev_b32 v3, 7, v3
v_lshrrev_b32 v5, 4, v1
v_and_b32 v6, 7, v1
v_xor_b32 v5, v5, v6
v_lshlrev_b32 v5, 4, v5
v_add_u32 v21, v3, v5
v_xor_b32 v22, 64, v21
v_lshrrev_b32 v3, 4, v1
v_bfe_u32 v4, v1, 2, 2
v_lshl_add_u32 v5, v3, 3, v4
v_mul_u32_u24 v5, 128, v5
v_and_b32 v6, 3, v1
v_lshl_add_u32 v5, v6, 3, v5
v_add_u32 v5, 16384, v5
v_and_b32 v6, 1, v3
v_bfe_u32 v7, v1, 3, 1
v_lshl_or_b32 v6, v7, 1, v6
v_and_b32 v7, 1, v2
v_mul_u32_u24 v7, 2, v7
v_add_u32 v8, 0, v7
v_xor_b32 v8, v8, v6
v_lshl_add_u32 v25, v8, 5, v5
v_add_u32 v8, 1, v7
v_xor_b32 v8, v8, v6
v_lshl_add_u32 v26, v8, 5, v5
v_accvgpr_write_b32 a0, 0
v_accvgpr_write_b32 a1, 0
v_accvgpr_write_b32 a2, 0
v_accvgpr_write_b32 a3, 0
v_accvgpr_write_b32 a4, 0
v_accvgpr_write_b32 a5, 0
v_accvgpr_write_b32 a6, 0
v_accvgpr_write_b32 a7, 0
v_accvgpr_write_b32 a8, 0
v_accvgpr_write_b32 a9, 0
v_accvgpr_write_b32 a10, 0
v_accvgpr_write_b32 a11, 0
v_accvgpr_write_b32 a12, 0
v_accvgpr_write_b32 a13, 0
v_accvgpr_write_b32 a14, 0
v_accvgpr_write_b32 a15, 0
v_accvgpr_write_b32 a16, 0
v_accvgpr_write_b32 a17, 0
v_accvgpr_write_b32 a18, 0
v_accvgpr_write_b32 a19, 0
v_accvgpr_write_b32 a20, 0
v_accvgpr_write_b32 a21, 0
v_accvgpr_write_b32 a22, 0
v_accvgpr_write_b32 a23, 0
v_accvgpr_write_b32 a24, 0
v_accvgpr_write_b32 a25, 0
v_accvgpr_write_b32 a26, 0
v_accvgpr_write_b32 a27, 0
v_accvgpr_write_b32 a28, 0
v_accvgpr_write_b32 a29, 0
v_accvgpr_write_b32 a30, 0
v_accvgpr_write_b32 a31, 0
v_readfirstlane_b32 s27, v2
s_nop 3
s_mul_i32 s28, s27, 2048
s_lshl_b32 s27, s27, 12
s_mov_b32 s16, 0
s_mov_b32 s17, 0
s_add_u32 m0, s27, 0
s_nop 0
buffer_load_dwordx4 v10, s[4:7], s16 offen lds
s_add_u32 m0, s27, 1024
s_nop 0
buffer_load_dwordx4 v11, s[4:7], s16 offen lds
s_add_u32 m0, s27, 2048
s_nop 0
buffer_load_dwordx4 v12, s[4:7], s16 offen lds
s_add_u32 m0, s27, 3072
s_nop 0
buffer_load_dwordx4 v13, s[4:7], s16 offen lds
s_add_u32 m0, s28, 16384
s_nop 0
buffer_load_dwordx4 v14, s[8:11], s17 offen lds
s_add_u32 m0, s28, 17408
s_nop 0
buffer_load_dwordx4 v15, s[8:11], s17 offen lds
s_mov_b32 s16, 128
s_mov_b32 s17, 131072
s_add_u32 m0, s27, 24576
s_nop 0
buffer_load_dwordx4 v10, s[4:7], s16 offen lds
s_add_u32 m0, s27, 25600
s_nop 0
buffer_load_dwordx4 v11, s[4:7], s16 offen lds
s_add_u32 m0, s27, 26624
s_nop 0
buffer_load_dwordx4 v12, s[4:7], s16 offen lds
s_add_u32 m0, s27, 27648
s_nop 0
buffer_load_dwordx4 v13, s[4:7], s16 offen lds
s_add_u32 m0, s28, 40960
s_nop 0
buffer_load_dwordx4 v14, s[8:11], s17 offen lds
s_add_u32 m0, s28, 41984
s_nop 0
buffer_load_dwordx4 v15, s[8:11], s17 offen lds
s_mov_b32 s16, 256
s_mov_b32 s17, 262144
s_add_u32 m0, s27, 49152
s_nop 0
buffer_load_dwordx4 v10, s[4:7], s16 offen lds
s_add_u32 m0, s27, 50176
s_nop 0
buffer_load_dwordx4 v11, s[4:7], s16 offen lds
s_add_u32 m0, s27, 51200
s_nop 0
buffer_load_dwordx4 v12, s[4:7], s16 offen lds
s_add_u32 m0, s27, 52224
s_nop 0
buffer_load_dwordx4 v13, s[4:7], s16 offen lds
s_add_u32 m0, s28, 65536
s_nop 0
buffer_load_dwordx4 v14, s[8:11], s17 offen lds
s_add_u32 m0, s28, 66560
s_nop 0
buffer_load_dwordx4 v15, s[8:11], s17 offen lds
s_mov_b32 s16, 384
s_mov_b32 s17, 393216
s_add_u32 m0, s27, 73728
s_nop 0
buffer_load_dwordx4 v10, s[4:7], s16 offen lds
s_add_u32 m0, s27, 74752
s_nop 0
buffer_load_dwordx4 v11, s[4:7], s16 offen lds
s_add_u32 m0, s27, 75776
s_nop 0
buffer_load_dwordx4 v12, s[4:7], s16 offen lds
s_add_u32 m0, s27, 76800
s_nop 0
buffer_load_dwordx4 v13, s[4:7], s16 offen lds
s_add_u32 m0, s28, 90112
s_nop 0
buffer_load_dwordx4 v14, s[8:11], s17 offen lds
s_add_u32 m0, s28, 91136
s_nop 0
buffer_load_dwordx4 v15, s[8:11], s17 offen lds
s_load_dwordx2 s[12:13], s[0:1], 88
s_waitcnt lgkmcnt(0)
s_add_u32 s12, s12, 52428800
s_addc_u32 s13, s13, 0
s_mov_b32 s14, 524288
s_mov_b32 s15, 0x00020000
s_lshl_b32 s25, s22, 15
v_lshlrev_b32 v3, 7, v0
v_add_u32 v3, s25, v3
buffer_load_dwordx4 v[128:131], v3, s[12:15], 0 offen offset:0
buffer_load_dwordx4 v[132:135], v3, s[12:15], 0 offen offset:16
buffer_load_dwordx4 v[136:139], v3, s[12:15], 0 offen offset:32
buffer_load_dwordx4 v[140:143], v3, s[12:15], 0 offen offset:48
buffer_load_dwordx4 v[144:147], v3, s[12:15], 0 offen offset:64
buffer_load_dwordx4 v[148:151], v3, s[12:15], 0 offen offset:80
buffer_load_dwordx4 v[152:155], v3, s[12:15], 0 offen offset:96
buffer_load_dwordx4 v[156:159], v3, s[12:15], 0 offen offset:112
s_waitcnt vmcnt(0)
v_add_f32 v128, v128, v130
v_add_f32 v129, v129, v131
v_add_f32 v128, v128, v132
v_add_f32 v129, v129, v133
v_add_f32 v128, v128, v134
v_add_f32 v129, v129, v135
v_add_f32 v128, v128, v136
v_add_f32 v129, v129, v137
v_add_f32 v128, v128, v138
v_add_f32 v129, v129, v139
v_add_f32 v128, v128, v140
v_add_f32 v129, v129, v141
v_add_f32 v128, v128, v142
v_add_f32 v129, v129, v143
v_add_f32 v128, v128, v144
v_add_f32 v129, v129, v145
v_add_f32 v128, v128, v146
v_add_f32 v129, v129, v147
v_add_f32 v128, v128, v148
v_add_f32 v129, v129, v149
v_add_f32 v128, v128, v150
v_add_f32 v129, v129, v151
v_add_f32 v128, v128, v152
v_add_f32 v129, v129, v153
v_add_f32 v128, v128, v154
v_add_f32 v129, v129, v155
v_add_f32 v128, v128, v156
v_add_f32 v129, v129, v157
v_add_f32 v128, v128, v158
v_add_f32 v129, v129, v159
s_nop 1
v_add_f32_dpp v128, v128, v128 quad_perm:[1,0,3,2] row_mask:0xf bank_mask:0xf
v_add_f32_dpp v129, v129, v129 quad_perm:[1,0,3,2] row_mask:0xf bank_mask:0xf
v_mul_f32 v128, 0x3a800000, v128
v_mul_f32 v129, 0x3a800000, v129
v_fma_f32 v129, -v128, v128, v129
v_max_f32 v129, 0, v129
v_add_f32 v130, 0x3727c5ac, v129
v_rsq_f32 v130, v130
s_nop 0
v_mul_f32 v131, v130, v130
v_mul_f32 v131, v131, v129
v_add_f32 v131, 0x3727c5ac, v131
v_rsq_f32 v131, v131
s_nop 0
v_mul_f32 v130, v130, v131
v_mov_b32 v129, v130
v_lshrrev_b32 v3, 1, v0
v_lshlrev_b32 v3, 3, v3
v_add_u32 v3, 122880, v3
ds_write_b64 v3, v[128:129]
s_waitcnt vmcnt(18) lgkmcnt(0)
s_barrier
v_add_u32 v23, 0, v21
v_add_u32 v32, 0, v25
v_add_u32 v33, 0, v26
ds_read_b128 v[40:43], v23 offset:0
ds_read_b128 v[44:47], v23 offset:2048
ds_read_b128 v[48:51], v23 offset:4096
ds_read_b128 v[52:55], v23 offset:6144
ds_read_b64_tr_b16 v[56:57], v32 offset:0
ds_read_b64_tr_b16 v[58:59], v32 offset:512
ds_read_b64_tr_b16 v[60:61], v33 offset:0
ds_read_b64_tr_b16 v[62:63], v33 offset:512
s_waitcnt lgkmcnt(0)
v_mfma_f32_16x16x32_bf16 a[0:3], v[56:59], v[40:43], a[0:3]
v_add_u32 v23, 0, v22
v_mfma_f32_16x16x32_bf16 a[8:11], v[56:59], v[44:47], a[8:11]
v_add_u32 v32, 0, v25
v_mfma_f32_16x16x32_bf16 a[16:19], v[56:59], v[48:51], a[16:19]
v_add_u32 v33, 0, v26
ds_read_b128 v[84:87], v23 offset:0
v_mfma_f32_16x16x32_bf16 a[24:27], v[56:59], v[52:55], a[24:27]
ds_read_b128 v[88:91], v23 offset:2048
v_mfma_f32_16x16x32_bf16 a[4:7], v[60:63], v[40:43], a[4:7]
ds_read_b128 v[92:95], v23 offset:4096
v_mfma_f32_16x16x32_bf16 a[12:15], v[60:63], v[44:47], a[12:15]
ds_read_b128 v[96:99], v23 offset:6144
ds_read_b64_tr_b16 v[100:101], v32 offset:4096
v_mfma_f32_16x16x32_bf16 a[20:23], v[60:63], v[48:51], a[20:23]
ds_read_b64_tr_b16 v[102:103], v32 offset:4608
v_mfma_f32_16x16x32_bf16 a[28:31], v[60:63], v[52:55], a[28:31]
ds_read_b64_tr_b16 v[104:105], v33 offset:4096
ds_read_b64_tr_b16 v[106:107], v33 offset:4608
s_waitcnt vmcnt(12)
s_barrier
s_waitcnt lgkmcnt(0)
v_mfma_f32_16x16x32_bf16 a[0:3], v[100:103], v[84:87], a[0:3]
s_mov_b32 s16, 512
s_mov_b32 s17, 524288
s_add_u32 m0, s27, 98304
v_mfma_f32_16x16x32_bf16 a[8:11], v[100:103], v[88:91], a[8:11]
s_nop 0
buffer_load_dwordx4 v10, s[4:7], s16 offen lds
s_add_u32 m0, s27, 99328
s_nop 0
v_mfma_f32_16x16x32_bf16 a[16:19], v[100:103], v[92:95], a[16:19]
buffer_load_dwordx4 v11, s[4:7], s16 offen lds
s_add_u32 m0, s27, 100352
s_nop 0
buffer_load_dwordx4 v12, s[4:7], s16 offen lds
v_mfma_f32_16x16x32_bf16 a[24:27], v[100:103], v[96:99], a[24:27]
s_add_u32 m0, s27, 101376
s_nop 0
buffer_load_dwordx4 v13, s[4:7], s16 offen lds
s_add_u32 m0, s28, 114688
v_mfma_f32_16x16x32_bf16 a[4:7], v[104:107], v[84:87], a[4:7]
s_nop 0
buffer_load_dwordx4 v14, s[8:11], s17 offen lds
s_add_u32 m0, s28, 115712
s_nop 0
v_mfma_f32_16x16x32_bf16 a[12:15], v[104:107], v[88:91], a[12:15]
buffer_load_dwordx4 v15, s[8:11], s17 offen lds
v_add_u32 v23, 24576, v21
v_add_u32 v32, 24576, v25
v_add_u32 v33, 24576, v26
v_mfma_f32_16x16x32_bf16 a[20:23], v[104:107], v[92:95], a[20:23]
ds_read_b128 v[40:43], v23 offset:0
ds_read_b128 v[44:47], v23 offset:2048
ds_read_b128 v[48:51], v23 offset:4096
ds_read_b128 v[52:55], v23 offset:6144
v_mfma_f32_16x16x32_bf16 a[28:31], v[104:107], v[96:99], a[28:31]
ds_read_b64_tr_b16 v[56:57], v32 offset:0
ds_read_b64_tr_b16 v[58:59], v32 offset:512
ds_read_b64_tr_b16 v[60:61], v33 offset:0
ds_read_b64_tr_b16 v[62:63], v33 offset:512
s_waitcnt lgkmcnt(0)
v_mfma_f32_16x16x32_bf16 a[0:3], v[56:59], v[40:43], a[0:3]
v_add_u32 v23, 24576, v22
v_mfma_f32_16x16x32_bf16 a[8:11], v[56:59], v[44:47], a[8:11]
v_add_u32 v32, 24576, v25
v_mfma_f32_16x16x32_bf16 a[16:19], v[56:59], v[48:51], a[16:19]
v_add_u32 v33, 24576, v26
ds_read_b128 v[84:87], v23 offset:0
v_mfma_f32_16x16x32_bf16 a[24:27], v[56:59], v[52:55], a[24:27]
ds_read_b128 v[88:91], v23 offset:2048
v_mfma_f32_16x16x32_bf16 a[4:7], v[60:63], v[40:43], a[4:7]
ds_read_b128 v[92:95], v23 offset:4096
v_mfma_f32_16x16x32_bf16 a[12:15], v[60:63], v[44:47], a[12:15]
ds_read_b128 v[96:99], v23 offset:6144
ds_read_b64_tr_b16 v[100:101], v32 offset:4096
v_mfma_f32_16x16x32_bf16 a[20:23], v[60:63], v[48:51], a[20:23]
ds_read_b64_tr_b16 v[102:103], v32 offset:4608
v_mfma_f32_16x16x32_bf16 a[28:31], v[60:63], v[52:55], a[28:31]
ds_read_b64_tr_b16 v[104:105], v33 offset:4096
ds_read_b64_tr_b16 v[106:107], v33 offset:4608
s_waitcnt vmcnt(12)
s_barrier
s_waitcnt lgkmcnt(0)
v_mfma_f32_16x16x32_bf16 a[0:3], v[100:103], v[84:87], a[0:3]
s_mov_b32 s16, 640
s_mov_b32 s17, 655360
s_add_u32 m0, s27, 0
v_mfma_f32_16x16x32_bf16 a[8:11], v[100:103], v[88:91], a[8:11]
s_nop 0
buffer_load_dwordx4 v10, s[4:7], s16 offen lds
s_add_u32 m0, s27, 1024
s_nop 0
v_mfma_f32_16x16x32_bf16 a[16:19], v[100:103], v[92:95], a[16:19]
buffer_load_dwordx4 v11, s[4:7], s16 offen lds
s_add_u32 m0, s27, 2048
s_nop 0
buffer_load_dwordx4 v12, s[4:7], s16 offen lds
v_mfma_f32_16x16x32_bf16 a[24:27], v[100:103], v[96:99], a[24:27]
s_add_u32 m0, s27, 3072
s_nop 0
buffer_load_dwordx4 v13, s[4:7], s16 offen lds
s_add_u32 m0, s28, 16384
v_mfma_f32_16x16x32_bf16 a[4:7], v[104:107], v[84:87], a[4:7]
s_nop 0
buffer_load_dwordx4 v14, s[8:11], s17 offen lds
s_add_u32 m0, s28, 17408
s_nop 0
v_mfma_f32_16x16x32_bf16 a[12:15], v[104:107], v[88:91], a[12:15]
buffer_load_dwordx4 v15, s[8:11], s17 offen lds
v_add_u32 v23, 49152, v21
v_add_u32 v32, 49152, v25
v_add_u32 v33, 49152, v26
v_mfma_f32_16x16x32_bf16 a[20:23], v[104:107], v[92:95], a[20:23]
ds_read_b128 v[40:43], v23 offset:0
ds_read_b128 v[44:47], v23 offset:2048
ds_read_b128 v[48:51], v23 offset:4096
ds_read_b128 v[52:55], v23 offset:6144
v_mfma_f32_16x16x32_bf16 a[28:31], v[104:107], v[96:99], a[28:31]
ds_read_b64_tr_b16 v[56:57], v32 offset:0
ds_read_b64_tr_b16 v[58:59], v32 offset:512
ds_read_b64_tr_b16 v[60:61], v33 offset:0
ds_read_b64_tr_b16 v[62:63], v33 offset:512
s_waitcnt lgkmcnt(0)
v_mfma_f32_16x16x32_bf16 a[0:3], v[56:59], v[40:43], a[0:3]
v_add_u32 v23, 49152, v22
v_mfma_f32_16x16x32_bf16 a[8:11], v[56:59], v[44:47], a[8:11]
v_add_u32 v32, 49152, v25
v_mfma_f32_16x16x32_bf16 a[16:19], v[56:59], v[48:51], a[16:19]
v_add_u32 v33, 49152, v26
ds_read_b128 v[84:87], v23 offset:0
v_mfma_f32_16x16x32_bf16 a[24:27], v[56:59], v[52:55], a[24:27]
ds_read_b128 v[88:91], v23 offset:2048
v_mfma_f32_16x16x32_bf16 a[4:7], v[60:63], v[40:43], a[4:7]
ds_read_b128 v[92:95], v23 offset:4096
v_mfma_f32_16x16x32_bf16 a[12:15], v[60:63], v[44:47], a[12:15]
ds_read_b128 v[96:99], v23 offset:6144
ds_read_b64_tr_b16 v[100:101], v32 offset:4096
v_mfma_f32_16x16x32_bf16 a[20:23], v[60:63], v[48:51], a[20:23]
ds_read_b64_tr_b16 v[102:103], v32 offset:4608
v_mfma_f32_16x16x32_bf16 a[28:31], v[60:63], v[52:55], a[28:31]
ds_read_b64_tr_b16 v[104:105], v33 offset:4096
ds_read_b64_tr_b16 v[106:107], v33 offset:4608
s_waitcnt vmcnt(12)
s_barrier
s_waitcnt lgkmcnt(0)
v_mfma_f32_16x16x32_bf16 a[0:3], v[100:103], v[84:87], a[0:3]
s_mov_b32 s16, 768
s_mov_b32 s17, 786432
s_add_u32 m0, s27, 24576
v_mfma_f32_16x16x32_bf16 a[8:11], v[100:103], v[88:91], a[8:11]
s_nop 0
buffer_load_dwordx4 v10, s[4:7], s16 offen lds
s_add_u32 m0, s27, 25600
s_nop 0
v_mfma_f32_16x16x32_bf16 a[16:19], v[100:103], v[92:95], a[16:19]
buffer_load_dwordx4 v11, s[4:7], s16 offen lds
s_add_u32 m0, s27, 26624
s_nop 0
buffer_load_dwordx4 v12, s[4:7], s16 offen lds
v_mfma_f32_16x16x32_bf16 a[24:27], v[100:103], v[96:99], a[24:27]
s_add_u32 m0, s27, 27648
s_nop 0
buffer_load_dwordx4 v13, s[4:7], s16 offen lds
s_add_u32 m0, s28, 40960
v_mfma_f32_16x16x32_bf16 a[4:7], v[104:107], v[84:87], a[4:7]
s_nop 0
buffer_load_dwordx4 v14, s[8:11], s17 offen lds
s_add_u32 m0, s28, 41984
s_nop 0
v_mfma_f32_16x16x32_bf16 a[12:15], v[104:107], v[88:91], a[12:15]
buffer_load_dwordx4 v15, s[8:11], s17 offen lds
v_add_u32 v23, 73728, v21
v_add_u32 v32, 73728, v25
v_add_u32 v33, 73728, v26
v_mfma_f32_16x16x32_bf16 a[20:23], v[104:107], v[92:95], a[20:23]
ds_read_b128 v[40:43], v23 offset:0
ds_read_b128 v[44:47], v23 offset:2048
ds_read_b128 v[48:51], v23 offset:4096
ds_read_b128 v[52:55], v23 offset:6144
v_mfma_f32_16x16x32_bf16 a[28:31], v[104:107], v[96:99], a[28:31]
ds_read_b64_tr_b16 v[56:57], v32 offset:0
ds_read_b64_tr_b16 v[58:59], v32 offset:512
ds_read_b64_tr_b16 v[60:61], v33 offset:0
ds_read_b64_tr_b16 v[62:63], v33 offset:512
s_waitcnt lgkmcnt(0)
v_mfma_f32_16x16x32_bf16 a[0:3], v[56:59], v[40:43], a[0:3]
v_add_u32 v23, 73728, v22
v_mfma_f32_16x16x32_bf16 a[8:11], v[56:59], v[44:47], a[8:11]
v_add_u32 v32, 73728, v25
v_mfma_f32_16x16x32_bf16 a[16:19], v[56:59], v[48:51], a[16:19]
v_add_u32 v33, 73728, v26
ds_read_b128 v[84:87], v23 offset:0
v_mfma_f32_16x16x32_bf16 a[24:27], v[56:59], v[52:55], a[24:27]
ds_read_b128 v[88:91], v23 offset:2048
v_mfma_f32_16x16x32_bf16 a[4:7], v[60:63], v[40:43], a[4:7]
ds_read_b128 v[92:95], v23 offset:4096
v_mfma_f32_16x16x32_bf16 a[12:15], v[60:63], v[44:47], a[12:15]
ds_read_b128 v[96:99], v23 offset:6144
ds_read_b64_tr_b16 v[100:101], v32 offset:4096
v_mfma_f32_16x16x32_bf16 a[20:23], v[60:63], v[48:51], a[20:23]
ds_read_b64_tr_b16 v[102:103], v32 offset:4608
v_mfma_f32_16x16x32_bf16 a[28:31], v[60:63], v[52:55], a[28:31]
ds_read_b64_tr_b16 v[104:105], v33 offset:4096
ds_read_b64_tr_b16 v[106:107], v33 offset:4608
s_waitcnt vmcnt(12)
s_barrier
s_waitcnt lgkmcnt(0)
v_mfma_f32_16x16x32_bf16 a[0:3], v[100:103], v[84:87], a[0:3]
s_mov_b32 s16, 896
s_mov_b32 s17, 917504
s_add_u32 m0, s27, 49152
v_mfma_f32_16x16x32_bf16 a[8:11], v[100:103], v[88:91], a[8:11]
s_nop 0
buffer_load_dwordx4 v10, s[4:7], s16 offen lds
s_add_u32 m0, s27, 50176
s_nop 0
v_mfma_f32_16x16x32_bf16 a[16:19], v[100:103], v[92:95], a[16:19]
buffer_load_dwordx4 v11, s[4:7], s16 offen lds
s_add_u32 m0, s27, 51200
s_nop 0
buffer_load_dwordx4 v12, s[4:7], s16 offen lds
v_mfma_f32_16x16x32_bf16 a[24:27], v[100:103], v[96:99], a[24:27]
s_add_u32 m0, s27, 52224
s_nop 0
buffer_load_dwordx4 v13, s[4:7], s16 offen lds
s_add_u32 m0, s28, 65536
v_mfma_f32_16x16x32_bf16 a[4:7], v[104:107], v[84:87], a[4:7]
s_nop 0
buffer_load_dwordx4 v14, s[8:11], s17 offen lds
s_add_u32 m0, s28, 66560
s_nop 0
v_mfma_f32_16x16x32_bf16 a[12:15], v[104:107], v[88:91], a[12:15]
buffer_load_dwordx4 v15, s[8:11], s17 offen lds
v_add_u32 v23, 98304, v21
v_add_u32 v32, 98304, v25
v_add_u32 v33, 98304, v26
v_mfma_f32_16x16x32_bf16 a[20:23], v[104:107], v[92:95], a[20:23]
ds_read_b128 v[40:43], v23 offset:0
ds_read_b128 v[44:47], v23 offset:2048
ds_read_b128 v[48:51], v23 offset:4096
ds_read_b128 v[52:55], v23 offset:6144
v_mfma_f32_16x16x32_bf16 a[28:31], v[104:107], v[96:99], a[28:31]
ds_read_b64_tr_b16 v[56:57], v32 offset:0
ds_read_b64_tr_b16 v[58:59], v32 offset:512
ds_read_b64_tr_b16 v[60:61], v33 offset:0
ds_read_b64_tr_b16 v[62:63], v33 offset:512
s_waitcnt lgkmcnt(0)
v_mfma_f32_16x16x32_bf16 a[0:3], v[56:59], v[40:43], a[0:3]
v_add_u32 v23, 98304, v22
v_mfma_f32_16x16x32_bf16 a[8:11], v[56:59], v[44:47], a[8:11]
v_add_u32 v32, 98304, v25
v_mfma_f32_16x16x32_bf16 a[16:19], v[56:59], v[48:51], a[16:19]
v_add_u32 v33, 98304, v26
ds_read_b128 v[84:87], v23 offset:0
v_mfma_f32_16x16x32_bf16 a[24:27], v[56:59], v[52:55], a[24:27]
ds_read_b128 v[88:91], v23 offset:2048
v_mfma_f32_16x16x32_bf16 a[4:7], v[60:63], v[40:43], a[4:7]
ds_read_b128 v[92:95], v23 offset:4096
v_mfma_f32_16x16x32_bf16 a[12:15], v[60:63], v[44:47], a[12:15]
ds_read_b128 v[96:99], v23 offset:6144
ds_read_b64_tr_b16 v[100:101], v32 offset:4096
v_mfma_f32_16x16x32_bf16 a[20:23], v[60:63], v[48:51], a[20:23]
ds_read_b64_tr_b16 v[102:103], v32 offset:4608
v_mfma_f32_16x16x32_bf16 a[28:31], v[60:63], v[52:55], a[28:31]
ds_read_b64_tr_b16 v[104:105], v33 offset:4096
ds_read_b64_tr_b16 v[106:107], v33 offset:4608
s_waitcnt vmcnt(12)
s_barrier
s_waitcnt lgkmcnt(0)
v_mfma_f32_16x16x32_bf16 a[0:3], v[100:103], v[84:87], a[0:3]
s_mov_b32 s16, 1024
s_mov_b32 s17, 1048576
s_add_u32 m0, s27, 73728
v_mfma_f32_16x16x32_bf16 a[8:11], v[100:103], v[88:91], a[8:11]
s_nop 0
buffer_load_dwordx4 v10, s[4:7], s16 offen lds
s_add_u32 m0, s27, 74752
s_nop 0
v_mfma_f32_16x16x32_bf16 a[16:19], v[100:103], v[92:95], a[16:19]
buffer_load_dwordx4 v11, s[4:7], s16 offen lds
s_add_u32 m0, s27, 75776
s_nop 0
buffer_load_dwordx4 v12, s[4:7], s16 offen lds
v_mfma_f32_16x16x32_bf16 a[24:27], v[100:103], v[96:99], a[24:27]
s_add_u32 m0, s27, 76800
s_nop 0
buffer_load_dwordx4 v13, s[4:7], s16 offen lds
s_add_u32 m0, s28, 90112
v_mfma_f32_16x16x32_bf16 a[4:7], v[104:107], v[84:87], a[4:7]
s_nop 0
buffer_load_dwordx4 v14, s[8:11], s17 offen lds
s_add_u32 m0, s28, 91136
s_nop 0
v_mfma_f32_16x16x32_bf16 a[12:15], v[104:107], v[88:91], a[12:15]
buffer_load_dwordx4 v15, s[8:11], s17 offen lds
v_add_u32 v23, 0, v21
v_add_u32 v32, 0, v25
v_add_u32 v33, 0, v26
v_mfma_f32_16x16x32_bf16 a[20:23], v[104:107], v[92:95], a[20:23]
ds_read_b128 v[40:43], v23 offset:0
ds_read_b128 v[44:47], v23 offset:2048
ds_read_b128 v[48:51], v23 offset:4096
ds_read_b128 v[52:55], v23 offset:6144
v_mfma_f32_16x16x32_bf16 a[28:31], v[104:107], v[96:99], a[28:31]
ds_read_b64_tr_b16 v[56:57], v32 offset:0
ds_read_b64_tr_b16 v[58:59], v32 offset:512
ds_read_b64_tr_b16 v[60:61], v33 offset:0
ds_read_b64_tr_b16 v[62:63], v33 offset:512
s_waitcnt lgkmcnt(0)
v_mfma_f32_16x16x32_bf16 a[0:3], v[56:59], v[40:43], a[0:3]
v_add_u32 v23, 0, v22
v_mfma_f32_16x16x32_bf16 a[8:11], v[56:59], v[44:47], a[8:11]
v_add_u32 v32, 0, v25
v_mfma_f32_16x16x32_bf16 a[16:19], v[56:59], v[48:51], a[16:19]
v_add_u32 v33, 0, v26
ds_read_b128 v[84:87], v23 offset:0
v_mfma_f32_16x16x32_bf16 a[24:27], v[56:59], v[52:55], a[24:27]
ds_read_b128 v[88:91], v23 offset:2048
v_mfma_f32_16x16x32_bf16 a[4:7], v[60:63], v[40:43], a[4:7]
ds_read_b128 v[92:95], v23 offset:4096
v_mfma_f32_16x16x32_bf16 a[12:15], v[60:63], v[44:47], a[12:15]
ds_read_b128 v[96:99], v23 offset:6144
ds_read_b64_tr_b16 v[100:101], v32 offset:4096
v_mfma_f32_16x16x32_bf16 a[20:23], v[60:63], v[48:51], a[20:23]
ds_read_b64_tr_b16 v[102:103], v32 offset:4608
v_mfma_f32_16x16x32_bf16 a[28:31], v[60:63], v[52:55], a[28:31]
ds_read_b64_tr_b16 v[104:105], v33 offset:4096
ds_read_b64_tr_b16 v[106:107], v33 offset:4608
s_waitcnt vmcnt(12)
s_barrier
s_waitcnt lgkmcnt(0)
v_mfma_f32_16x16x32_bf16 a[0:3], v[100:103], v[84:87], a[0:3]
s_mov_b32 s16, 1152
s_mov_b32 s17, 1179648
s_add_u32 m0, s27, 98304
v_mfma_f32_16x16x32_bf16 a[8:11], v[100:103], v[88:91], a[8:11]
s_nop 0
buffer_load_dwordx4 v10, s[4:7], s16 offen lds
s_add_u32 m0, s27, 99328
s_nop 0
v_mfma_f32_16x16x32_bf16 a[16:19], v[100:103], v[92:95], a[16:19]
buffer_load_dwordx4 v11, s[4:7], s16 offen lds
s_add_u32 m0, s27, 100352
s_nop 0
buffer_load_dwordx4 v12, s[4:7], s16 offen lds
v_mfma_f32_16x16x32_bf16 a[24:27], v[100:103], v[96:99], a[24:27]
s_add_u32 m0, s27, 101376
s_nop 0
buffer_load_dwordx4 v13, s[4:7], s16 offen lds
s_add_u32 m0, s28, 114688
v_mfma_f32_16x16x32_bf16 a[4:7], v[104:107], v[84:87], a[4:7]
s_nop 0
buffer_load_dwordx4 v14, s[8:11], s17 offen lds
s_add_u32 m0, s28, 115712
s_nop 0
v_mfma_f32_16x16x32_bf16 a[12:15], v[104:107], v[88:91], a[12:15]
buffer_load_dwordx4 v15, s[8:11], s17 offen lds
v_add_u32 v23, 24576, v21
v_add_u32 v32, 24576, v25
v_add_u32 v33, 24576, v26
v_mfma_f32_16x16x32_bf16 a[20:23], v[104:107], v[92:95], a[20:23]
ds_read_b128 v[40:43], v23 offset:0
ds_read_b128 v[44:47], v23 offset:2048
ds_read_b128 v[48:51], v23 offset:4096
ds_read_b128 v[52:55], v23 offset:6144
v_mfma_f32_16x16x32_bf16 a[28:31], v[104:107], v[96:99], a[28:31]
ds_read_b64_tr_b16 v[56:57], v32 offset:0
ds_read_b64_tr_b16 v[58:59], v32 offset:512
ds_read_b64_tr_b16 v[60:61], v33 offset:0
ds_read_b64_tr_b16 v[62:63], v33 offset:512
s_waitcnt lgkmcnt(0)
v_mfma_f32_16x16x32_bf16 a[0:3], v[56:59], v[40:43], a[0:3]
v_add_u32 v23, 24576, v22
v_mfma_f32_16x16x32_bf16 a[8:11], v[56:59], v[44:47], a[8:11]
v_add_u32 v32, 24576, v25
v_mfma_f32_16x16x32_bf16 a[16:19], v[56:59], v[48:51], a[16:19]
v_add_u32 v33, 24576, v26
ds_read_b128 v[84:87], v23 offset:0
v_mfma_f32_16x16x32_bf16 a[24:27], v[56:59], v[52:55], a[24:27]
ds_read_b128 v[88:91], v23 offset:2048
v_mfma_f32_16x16x32_bf16 a[4:7], v[60:63], v[40:43], a[4:7]
ds_read_b128 v[92:95], v23 offset:4096
v_mfma_f32_16x16x32_bf16 a[12:15], v[60:63], v[44:47], a[12:15]
ds_read_b128 v[96:99], v23 offset:6144
ds_read_b64_tr_b16 v[100:101], v32 offset:4096
v_mfma_f32_16x16x32_bf16 a[20:23], v[60:63], v[48:51], a[20:23]
ds_read_b64_tr_b16 v[102:103], v32 offset:4608
v_mfma_f32_16x16x32_bf16 a[28:31], v[60:63], v[52:55], a[28:31]
ds_read_b64_tr_b16 v[104:105], v33 offset:4096
ds_read_b64_tr_b16 v[106:107], v33 offset:4608
s_waitcnt vmcnt(12)
s_barrier
s_waitcnt lgkmcnt(0)
v_mfma_f32_16x16x32_bf16 a[0:3], v[100:103], v[84:87], a[0:3]
s_mov_b32 s16, 1280
s_mov_b32 s17, 1310720
s_add_u32 m0, s27, 0
v_mfma_f32_16x16x32_bf16 a[8:11], v[100:103], v[88:91], a[8:11]
s_nop 0
buffer_load_dwordx4 v10, s[4:7], s16 offen lds
s_add_u32 m0, s27, 1024
s_nop 0
v_mfma_f32_16x16x32_bf16 a[16:19], v[100:103], v[92:95], a[16:19]
buffer_load_dwordx4 v11, s[4:7], s16 offen lds
s_add_u32 m0, s27, 2048
s_nop 0
buffer_load_dwordx4 v12, s[4:7], s16 offen lds
v_mfma_f32_16x16x32_bf16 a[24:27], v[100:103], v[96:99], a[24:27]
s_add_u32 m0, s27, 3072
s_nop 0
buffer_load_dwordx4 v13, s[4:7], s16 offen lds
s_add_u32 m0, s28, 16384
v_mfma_f32_16x16x32_bf16 a[4:7], v[104:107], v[84:87], a[4:7]
s_nop 0
buffer_load_dwordx4 v14, s[8:11], s17 offen lds
s_add_u32 m0, s28, 17408
s_nop 0
v_mfma_f32_16x16x32_bf16 a[12:15], v[104:107], v[88:91], a[12:15]
buffer_load_dwordx4 v15, s[8:11], s17 offen lds
v_add_u32 v23, 49152, v21
v_add_u32 v32, 49152, v25
v_add_u32 v33, 49152, v26
v_mfma_f32_16x16x32_bf16 a[20:23], v[104:107], v[92:95], a[20:23]
ds_read_b128 v[40:43], v23 offset:0
ds_read_b128 v[44:47], v23 offset:2048
ds_read_b128 v[48:51], v23 offset:4096
ds_read_b128 v[52:55], v23 offset:6144
v_mfma_f32_16x16x32_bf16 a[28:31], v[104:107], v[96:99], a[28:31]
ds_read_b64_tr_b16 v[56:57], v32 offset:0
ds_read_b64_tr_b16 v[58:59], v32 offset:512
ds_read_b64_tr_b16 v[60:61], v33 offset:0
ds_read_b64_tr_b16 v[62:63], v33 offset:512
s_waitcnt lgkmcnt(0)
v_mfma_f32_16x16x32_bf16 a[0:3], v[56:59], v[40:43], a[0:3]
v_add_u32 v23, 49152, v22
v_mfma_f32_16x16x32_bf16 a[8:11], v[56:59], v[44:47], a[8:11]
v_add_u32 v32, 49152, v25
v_mfma_f32_16x16x32_bf16 a[16:19], v[56:59], v[48:51], a[16:19]
v_add_u32 v33, 49152, v26
ds_read_b128 v[84:87], v23 offset:0
v_mfma_f32_16x16x32_bf16 a[24:27], v[56:59], v[52:55], a[24:27]
ds_read_b128 v[88:91], v23 offset:2048
v_mfma_f32_16x16x32_bf16 a[4:7], v[60:63], v[40:43], a[4:7]
ds_read_b128 v[92:95], v23 offset:4096
v_mfma_f32_16x16x32_bf16 a[12:15], v[60:63], v[44:47], a[12:15]
ds_read_b128 v[96:99], v23 offset:6144
ds_read_b64_tr_b16 v[100:101], v32 offset:4096
v_mfma_f32_16x16x32_bf16 a[20:23], v[60:63], v[48:51], a[20:23]
ds_read_b64_tr_b16 v[102:103], v32 offset:4608
v_mfma_f32_16x16x32_bf16 a[28:31], v[60:63], v[52:55], a[28:31]
ds_read_b64_tr_b16 v[104:105], v33 offset:4096
ds_read_b64_tr_b16 v[106:107], v33 offset:4608
s_waitcnt vmcnt(12)
s_barrier
s_waitcnt lgkmcnt(0)
v_mfma_f32_16x16x32_bf16 a[0:3], v[100:103], v[84:87], a[0:3]
s_mov_b32 s16, 1408
s_mov_b32 s17, 1441792
s_add_u32 m0, s27, 24576
v_mfma_f32_16x16x32_bf16 a[8:11], v[100:103], v[88:91], a[8:11]
s_nop 0
buffer_load_dwordx4 v10, s[4:7], s16 offen lds
s_add_u32 m0, s27, 25600
s_nop 0
v_mfma_f32_16x16x32_bf16 a[16:19], v[100:103], v[92:95], a[16:19]
buffer_load_dwordx4 v11, s[4:7], s16 offen lds
s_add_u32 m0, s27, 26624
s_nop 0
buffer_load_dwordx4 v12, s[4:7], s16 offen lds
v_mfma_f32_16x16x32_bf16 a[24:27], v[100:103], v[96:99], a[24:27]
s_add_u32 m0, s27, 27648
s_nop 0
buffer_load_dwordx4 v13, s[4:7], s16 offen lds
s_add_u32 m0, s28, 40960
v_mfma_f32_16x16x32_bf16 a[4:7], v[104:107], v[84:87], a[4:7]
s_nop 0
buffer_load_dwordx4 v14, s[8:11], s17 offen lds
s_add_u32 m0, s28, 41984
s_nop 0
v_mfma_f32_16x16x32_bf16 a[12:15], v[104:107], v[88:91], a[12:15]
buffer_load_dwordx4 v15, s[8:11], s17 offen lds
v_add_u32 v23, 73728, v21
v_add_u32 v32, 73728, v25
v_add_u32 v33, 73728, v26
v_mfma_f32_16x16x32_bf16 a[20:23], v[104:107], v[92:95], a[20:23]
ds_read_b128 v[40:43], v23 offset:0
ds_read_b128 v[44:47], v23 offset:2048
ds_read_b128 v[48:51], v23 offset:4096
ds_read_b128 v[52:55], v23 offset:6144
v_mfma_f32_16x16x32_bf16 a[28:31], v[104:107], v[96:99], a[28:31]
ds_read_b64_tr_b16 v[56:57], v32 offset:0
ds_read_b64_tr_b16 v[58:59], v32 offset:512
ds_read_b64_tr_b16 v[60:61], v33 offset:0
ds_read_b64_tr_b16 v[62:63], v33 offset:512
s_waitcnt lgkmcnt(0)
v_mfma_f32_16x16x32_bf16 a[0:3], v[56:59], v[40:43], a[0:3]
v_add_u32 v23, 73728, v22
v_mfma_f32_16x16x32_bf16 a[8:11], v[56:59], v[44:47], a[8:11]
v_add_u32 v32, 73728, v25
v_mfma_f32_16x16x32_bf16 a[16:19], v[56:59], v[48:51], a[16:19]
v_add_u32 v33, 73728, v26
ds_read_b128 v[84:87], v23 offset:0
v_mfma_f32_16x16x32_bf16 a[24:27], v[56:59], v[52:55], a[24:27]
ds_read_b128 v[88:91], v23 offset:2048
v_mfma_f32_16x16x32_bf16 a[4:7], v[60:63], v[40:43], a[4:7]
ds_read_b128 v[92:95], v23 offset:4096
v_mfma_f32_16x16x32_bf16 a[12:15], v[60:63], v[44:47], a[12:15]
ds_read_b128 v[96:99], v23 offset:6144
ds_read_b64_tr_b16 v[100:101], v32 offset:4096
v_mfma_f32_16x16x32_bf16 a[20:23], v[60:63], v[48:51], a[20:23]
ds_read_b64_tr_b16 v[102:103], v32 offset:4608
v_mfma_f32_16x16x32_bf16 a[28:31], v[60:63], v[52:55], a[28:31]
ds_read_b64_tr_b16 v[104:105], v33 offset:4096
ds_read_b64_tr_b16 v[106:107], v33 offset:4608
s_waitcnt vmcnt(12)
s_barrier
s_waitcnt lgkmcnt(0)
v_mfma_f32_16x16x32_bf16 a[0:3], v[100:103], v[84:87], a[0:3]
s_mov_b32 s16, 1536
s_mov_b32 s17, 1572864
s_add_u32 m0, s27, 49152
v_mfma_f32_16x16x32_bf16 a[8:11], v[100:103], v[88:91], a[8:11]
s_nop 0
buffer_load_dwordx4 v10, s[4:7], s16 offen lds
s_add_u32 m0, s27, 50176
s_nop 0
v_mfma_f32_16x16x32_bf16 a[16:19], v[100:103], v[92:95], a[16:19]
buffer_load_dwordx4 v11, s[4:7], s16 offen lds
s_add_u32 m0, s27, 51200
s_nop 0
buffer_load_dwordx4 v12, s[4:7], s16 offen lds
v_mfma_f32_16x16x32_bf16 a[24:27], v[100:103], v[96:99], a[24:27]
s_add_u32 m0, s27, 52224
s_nop 0
buffer_load_dwordx4 v13, s[4:7], s16 offen lds
s_add_u32 m0, s28, 65536
v_mfma_f32_16x16x32_bf16 a[4:7], v[104:107], v[84:87], a[4:7]
s_nop 0
buffer_load_dwordx4 v14, s[8:11], s17 offen lds
s_add_u32 m0, s28, 66560
s_nop 0
v_mfma_f32_16x16x32_bf16 a[12:15], v[104:107], v[88:91], a[12:15]
buffer_load_dwordx4 v15, s[8:11], s17 offen lds
v_add_u32 v23, 98304, v21
v_add_u32 v32, 98304, v25
v_add_u32 v33, 98304, v26
v_mfma_f32_16x16x32_bf16 a[20:23], v[104:107], v[92:95], a[20:23]
ds_read_b128 v[40:43], v23 offset:0
ds_read_b128 v[44:47], v23 offset:2048
ds_read_b128 v[48:51], v23 offset:4096
ds_read_b128 v[52:55], v23 offset:6144
v_mfma_f32_16x16x32_bf16 a[28:31], v[104:107], v[96:99], a[28:31]
ds_read_b64_tr_b16 v[56:57], v32 offset:0
ds_read_b64_tr_b16 v[58:59], v32 offset:512
ds_read_b64_tr_b16 v[60:61], v33 offset:0
ds_read_b64_tr_b16 v[62:63], v33 offset:512
s_waitcnt lgkmcnt(0)
v_mfma_f32_16x16x32_bf16 a[0:3], v[56:59], v[40:43], a[0:3]
v_add_u32 v23, 98304, v22
v_mfma_f32_16x16x32_bf16 a[8:11], v[56:59], v[44:47], a[8:11]
v_add_u32 v32, 98304, v25
v_mfma_f32_16x16x32_bf16 a[16:19], v[56:59], v[48:51], a[16:19]
v_add_u32 v33, 98304, v26
ds_read_b128 v[84:87], v23 offset:0
v_mfma_f32_16x16x32_bf16 a[24:27], v[56:59], v[52:55], a[24:27]
ds_read_b128 v[88:91], v23 offset:2048
v_mfma_f32_16x16x32_bf16 a[4:7], v[60:63], v[40:43], a[4:7]
ds_read_b128 v[92:95], v23 offset:4096
v_mfma_f32_16x16x32_bf16 a[12:15], v[60:63], v[44:47], a[12:15]
ds_read_b128 v[96:99], v23 offset:6144
ds_read_b64_tr_b16 v[100:101], v32 offset:4096
v_mfma_f32_16x16x32_bf16 a[20:23], v[60:63], v[48:51], a[20:23]
ds_read_b64_tr_b16 v[102:103], v32 offset:4608
v_mfma_f32_16x16x32_bf16 a[28:31], v[60:63], v[52:55], a[28:31]
ds_read_b64_tr_b16 v[104:105], v33 offset:4096
ds_read_b64_tr_b16 v[106:107], v33 offset:4608
s_waitcnt vmcnt(12)
s_barrier
s_waitcnt lgkmcnt(0)
v_mfma_f32_16x16x32_bf16 a[0:3], v[100:103], v[84:87], a[0:3]
s_mov_b32 s16, 1664
s_mov_b32 s17, 1703936
s_add_u32 m0, s27, 73728
v_mfma_f32_16x16x32_bf16 a[8:11], v[100:103], v[88:91], a[8:11]
s_nop 0
buffer_load_dwordx4 v10, s[4:7], s16 offen lds
s_add_u32 m0, s27, 74752
s_nop 0
v_mfma_f32_16x16x32_bf16 a[16:19], v[100:103], v[92:95], a[16:19]
buffer_load_dwordx4 v11, s[4:7], s16 offen lds
s_add_u32 m0, s27, 75776
s_nop 0
buffer_load_dwordx4 v12, s[4:7], s16 offen lds
v_mfma_f32_16x16x32_bf16 a[24:27], v[100:103], v[96:99], a[24:27]
s_add_u32 m0, s27, 76800
s_nop 0
buffer_load_dwordx4 v13, s[4:7], s16 offen lds
s_add_u32 m0, s28, 90112
v_mfma_f32_16x16x32_bf16 a[4:7], v[104:107], v[84:87], a[4:7]
s_nop 0
buffer_load_dwordx4 v14, s[8:11], s17 offen lds
s_add_u32 m0, s28, 91136
s_nop 0
v_mfma_f32_16x16x32_bf16 a[12:15], v[104:107], v[88:91], a[12:15]
buffer_load_dwordx4 v15, s[8:11], s17 offen lds
v_add_u32 v23, 0, v21
v_add_u32 v32, 0, v25
v_add_u32 v33, 0, v26
v_mfma_f32_16x16x32_bf16 a[20:23], v[104:107], v[92:95], a[20:23]
ds_read_b128 v[40:43], v23 offset:0
ds_read_b128 v[44:47], v23 offset:2048
ds_read_b128 v[48:51], v23 offset:4096
ds_read_b128 v[52:55], v23 offset:6144
v_mfma_f32_16x16x32_bf16 a[28:31], v[104:107], v[96:99], a[28:31]
ds_read_b64_tr_b16 v[56:57], v32 offset:0
ds_read_b64_tr_b16 v[58:59], v32 offset:512
ds_read_b64_tr_b16 v[60:61], v33 offset:0
ds_read_b64_tr_b16 v[62:63], v33 offset:512
s_waitcnt lgkmcnt(0)
v_mfma_f32_16x16x32_bf16 a[0:3], v[56:59], v[40:43], a[0:3]
v_add_u32 v23, 0, v22
v_mfma_f32_16x16x32_bf16 a[8:11], v[56:59], v[44:47], a[8:11]
v_add_u32 v32, 0, v25
v_mfma_f32_16x16x32_bf16 a[16:19], v[56:59], v[48:51], a[16:19]
v_add_u32 v33, 0, v26
ds_read_b128 v[84:87], v23 offset:0
v_mfma_f32_16x16x32_bf16 a[24:27], v[56:59], v[52:55], a[24:27]
ds_read_b128 v[88:91], v23 offset:2048
v_mfma_f32_16x16x32_bf16 a[4:7], v[60:63], v[40:43], a[4:7]
ds_read_b128 v[92:95], v23 offset:4096
v_mfma_f32_16x16x32_bf16 a[12:15], v[60:63], v[44:47], a[12:15]
ds_read_b128 v[96:99], v23 offset:6144
ds_read_b64_tr_b16 v[100:101], v32 offset:4096
v_mfma_f32_16x16x32_bf16 a[20:23], v[60:63], v[48:51], a[20:23]
ds_read_b64_tr_b16 v[102:103], v32 offset:4608
v_mfma_f32_16x16x32_bf16 a[28:31], v[60:63], v[52:55], a[28:31]
ds_read_b64_tr_b16 v[104:105], v33 offset:4096
ds_read_b64_tr_b16 v[106:107], v33 offset:4608
s_waitcnt vmcnt(12)
s_barrier
s_waitcnt lgkmcnt(0)
v_mfma_f32_16x16x32_bf16 a[0:3], v[100:103], v[84:87], a[0:3]
s_mov_b32 s16, 1792
s_mov_b32 s17, 1835008
s_add_u32 m0, s27, 98304
v_mfma_f32_16x16x32_bf16 a[8:11], v[100:103], v[88:91], a[8:11]
s_nop 0
buffer_load_dwordx4 v10, s[4:7], s16 offen lds
s_add_u32 m0, s27, 99328
s_nop 0
v_mfma_f32_16x16x32_bf16 a[16:19], v[100:103], v[92:95], a[16:19]
buffer_load_dwordx4 v11, s[4:7], s16 offen lds
s_add_u32 m0, s27, 100352
s_nop 0
buffer_load_dwordx4 v12, s[4:7], s16 offen lds
v_mfma_f32_16x16x32_bf16 a[24:27], v[100:103], v[96:99], a[24:27]
s_add_u32 m0, s27, 101376
s_nop 0
buffer_load_dwordx4 v13, s[4:7], s16 offen lds
s_add_u32 m0, s28, 114688
v_mfma_f32_16x16x32_bf16 a[4:7], v[104:107], v[84:87], a[4:7]
s_nop 0
buffer_load_dwordx4 v14, s[8:11], s17 offen lds
s_add_u32 m0, s28, 115712
s_nop 0
v_mfma_f32_16x16x32_bf16 a[12:15], v[104:107], v[88:91], a[12:15]
buffer_load_dwordx4 v15, s[8:11], s17 offen lds
v_add_u32 v23, 24576, v21
v_add_u32 v32, 24576, v25
v_add_u32 v33, 24576, v26
v_mfma_f32_16x16x32_bf16 a[20:23], v[104:107], v[92:95], a[20:23]
ds_read_b128 v[40:43], v23 offset:0
ds_read_b128 v[44:47], v23 offset:2048
ds_read_b128 v[48:51], v23 offset:4096
ds_read_b128 v[52:55], v23 offset:6144
v_mfma_f32_16x16x32_bf16 a[28:31], v[104:107], v[96:99], a[28:31]
ds_read_b64_tr_b16 v[56:57], v32 offset:0
ds_read_b64_tr_b16 v[58:59], v32 offset:512
ds_read_b64_tr_b16 v[60:61], v33 offset:0
ds_read_b64_tr_b16 v[62:63], v33 offset:512
s_waitcnt lgkmcnt(0)
v_mfma_f32_16x16x32_bf16 a[0:3], v[56:59], v[40:43], a[0:3]
v_add_u32 v23, 24576, v22
v_mfma_f32_16x16x32_bf16 a[8:11], v[56:59], v[44:47], a[8:11]
v_add_u32 v32, 24576, v25
v_mfma_f32_16x16x32_bf16 a[16:19], v[56:59], v[48:51], a[16:19]
v_add_u32 v33, 24576, v26
ds_read_b128 v[84:87], v23 offset:0
v_mfma_f32_16x16x32_bf16 a[24:27], v[56:59], v[52:55], a[24:27]
ds_read_b128 v[88:91], v23 offset:2048
v_mfma_f32_16x16x32_bf16 a[4:7], v[60:63], v[40:43], a[4:7]
ds_read_b128 v[92:95], v23 offset:4096
v_mfma_f32_16x16x32_bf16 a[12:15], v[60:63], v[44:47], a[12:15]
ds_read_b128 v[96:99], v23 offset:6144
ds_read_b64_tr_b16 v[100:101], v32 offset:4096
v_mfma_f32_16x16x32_bf16 a[20:23], v[60:63], v[48:51], a[20:23]
ds_read_b64_tr_b16 v[102:103], v32 offset:4608
v_mfma_f32_16x16x32_bf16 a[28:31], v[60:63], v[52:55], a[28:31]
ds_read_b64_tr_b16 v[104:105], v33 offset:4096
ds_read_b64_tr_b16 v[106:107], v33 offset:4608
s_waitcnt vmcnt(12)
s_barrier
s_waitcnt lgkmcnt(0)
v_mfma_f32_16x16x32_bf16 a[0:3], v[100:103], v[84:87], a[0:3]
s_mov_b32 s16, 1920
s_mov_b32 s17, 1966080
s_add_u32 m0, s27, 0
v_mfma_f32_16x16x32_bf16 a[8:11], v[100:103], v[88:91], a[8:11]
s_nop 0
buffer_load_dwordx4 v10, s[4:7], s16 offen lds
s_add_u32 m0, s27, 1024
s_nop 0
v_mfma_f32_16x16x32_bf16 a[16:19], v[100:103], v[92:95], a[16:19]
buffer_load_dwordx4 v11, s[4:7], s16 offen lds
s_add_u32 m0, s27, 2048
s_nop 0
buffer_load_dwordx4 v12, s[4:7], s16 offen lds
v_mfma_f32_16x16x32_bf16 a[24:27], v[100:103], v[96:99], a[24:27]
s_add_u32 m0, s27, 3072
s_nop 0
buffer_load_dwordx4 v13, s[4:7], s16 offen lds
s_add_u32 m0, s28, 16384
v_mfma_f32_16x16x32_bf16 a[4:7], v[104:107], v[84:87], a[4:7]
s_nop 0
buffer_load_dwordx4 v14, s[8:11], s17 offen lds
s_add_u32 m0, s28, 17408
s_nop 0
v_mfma_f32_16x16x32_bf16 a[12:15], v[104:107], v[88:91], a[12:15]
buffer_load_dwordx4 v15, s[8:11], s17 offen lds
v_add_u32 v23, 49152, v21
v_add_u32 v32, 49152, v25
v_add_u32 v33, 49152, v26
v_mfma_f32_16x16x32_bf16 a[20:23], v[104:107], v[92:95], a[20:23]
ds_read_b128 v[40:43], v23 offset:0
ds_read_b128 v[44:47], v23 offset:2048
ds_read_b128 v[48:51], v23 offset:4096
ds_read_b128 v[52:55], v23 offset:6144
v_mfma_f32_16x16x32_bf16 a[28:31], v[104:107], v[96:99], a[28:31]
ds_read_b64_tr_b16 v[56:57], v32 offset:0
ds_read_b64_tr_b16 v[58:59], v32 offset:512
ds_read_b64_tr_b16 v[60:61], v33 offset:0
ds_read_b64_tr_b16 v[62:63], v33 offset:512
s_waitcnt lgkmcnt(0)
v_mfma_f32_16x16x32_bf16 a[0:3], v[56:59], v[40:43], a[0:3]
v_add_u32 v23, 49152, v22
v_mfma_f32_16x16x32_bf16 a[8:11], v[56:59], v[44:47], a[8:11]
v_add_u32 v32, 49152, v25
v_mfma_f32_16x16x32_bf16 a[16:19], v[56:59], v[48:51], a[16:19]
v_add_u32 v33, 49152, v26
ds_read_b128 v[84:87], v23 offset:0
v_mfma_f32_16x16x32_bf16 a[24:27], v[56:59], v[52:55], a[24:27]
ds_read_b128 v[88:91], v23 offset:2048
v_mfma_f32_16x16x32_bf16 a[4:7], v[60:63], v[40:43], a[4:7]
ds_read_b128 v[92:95], v23 offset:4096
v_mfma_f32_16x16x32_bf16 a[12:15], v[60:63], v[44:47], a[12:15]
ds_read_b128 v[96:99], v23 offset:6144
ds_read_b64_tr_b16 v[100:101], v32 offset:4096
v_mfma_f32_16x16x32_bf16 a[20:23], v[60:63], v[48:51], a[20:23]
ds_read_b64_tr_b16 v[102:103], v32 offset:4608
v_mfma_f32_16x16x32_bf16 a[28:31], v[60:63], v[52:55], a[28:31]
ds_read_b64_tr_b16 v[104:105], v33 offset:4096
ds_read_b64_tr_b16 v[106:107], v33 offset:4608
s_waitcnt vmcnt(12)
s_barrier
s_waitcnt lgkmcnt(0)
v_mfma_f32_16x16x32_bf16 a[0:3], v[100:103], v[84:87], a[0:3]
v_add_u32 v23, 73728, v21
v_mfma_f32_16x16x32_bf16 a[8:11], v[100:103], v[88:91], a[8:11]
v_add_u32 v32, 73728, v25
v_mfma_f32_16x16x32_bf16 a[16:19], v[100:103], v[92:95], a[16:19]
v_add_u32 v33, 73728, v26
ds_read_b128 v[40:43], v23 offset:0
v_mfma_f32_16x16x32_bf16 a[24:27], v[100:103], v[96:99], a[24:27]
ds_read_b128 v[44:47], v23 offset:2048
v_mfma_f32_16x16x32_bf16 a[4:7], v[104:107], v[84:87], a[4:7]
ds_read_b128 v[48:51], v23 offset:4096
v_mfma_f32_16x16x32_bf16 a[12:15], v[104:107], v[88:91], a[12:15]
ds_read_b128 v[52:55], v23 offset:6144
ds_read_b64_tr_b16 v[56:57], v32 offset:0
v_mfma_f32_16x16x32_bf16 a[20:23], v[104:107], v[92:95], a[20:23]
ds_read_b64_tr_b16 v[58:59], v32 offset:512
v_mfma_f32_16x16x32_bf16 a[28:31], v[104:107], v[96:99], a[28:31]
ds_read_b64_tr_b16 v[60:61], v33 offset:0
ds_read_b64_tr_b16 v[62:63], v33 offset:512
s_waitcnt lgkmcnt(0)
v_mfma_f32_16x16x32_bf16 a[0:3], v[56:59], v[40:43], a[0:3]
v_add_u32 v23, 73728, v22
v_mfma_f32_16x16x32_bf16 a[8:11], v[56:59], v[44:47], a[8:11]
v_add_u32 v32, 73728, v25
v_mfma_f32_16x16x32_bf16 a[16:19], v[56:59], v[48:51], a[16:19]
v_add_u32 v33, 73728, v26
ds_read_b128 v[84:87], v23 offset:0
v_mfma_f32_16x16x32_bf16 a[24:27], v[56:59], v[52:55], a[24:27]
ds_read_b128 v[88:91], v23 offset:2048
v_mfma_f32_16x16x32_bf16 a[4:7], v[60:63], v[40:43], a[4:7]
ds_read_b128 v[92:95], v23 offset:4096
v_mfma_f32_16x16x32_bf16 a[12:15], v[60:63], v[44:47], a[12:15]
ds_read_b128 v[96:99], v23 offset:6144
ds_read_b64_tr_b16 v[100:101], v32 offset:4096
v_mfma_f32_16x16x32_bf16 a[20:23], v[60:63], v[48:51], a[20:23]
ds_read_b64_tr_b16 v[102:103], v32 offset:4608
v_mfma_f32_16x16x32_bf16 a[28:31], v[60:63], v[52:55], a[28:31]
ds_read_b64_tr_b16 v[104:105], v33 offset:4096
ds_read_b64_tr_b16 v[106:107], v33 offset:4608
s_waitcnt vmcnt(6)
s_barrier
s_waitcnt lgkmcnt(0)
v_mfma_f32_16x16x32_bf16 a[0:3], v[100:103], v[84:87], a[0:3]
v_add_u32 v23, 98304, v21
v_mfma_f32_16x16x32_bf16 a[8:11], v[100:103], v[88:91], a[8:11]
v_add_u32 v32, 98304, v25
v_mfma_f32_16x16x32_bf16 a[16:19], v[100:103], v[92:95], a[16:19]
v_add_u32 v33, 98304, v26
ds_read_b128 v[40:43], v23 offset:0
v_mfma_f32_16x16x32_bf16 a[24:27], v[100:103], v[96:99], a[24:27]
ds_read_b128 v[44:47], v23 offset:2048
v_mfma_f32_16x16x32_bf16 a[4:7], v[104:107], v[84:87], a[4:7]
ds_read_b128 v[48:51], v23 offset:4096
v_mfma_f32_16x16x32_bf16 a[12:15], v[104:107], v[88:91], a[12:15]
ds_read_b128 v[52:55], v23 offset:6144
ds_read_b64_tr_b16 v[56:57], v32 offset:0
v_mfma_f32_16x16x32_bf16 a[20:23], v[104:107], v[92:95], a[20:23]
ds_read_b64_tr_b16 v[58:59], v32 offset:512
v_mfma_f32_16x16x32_bf16 a[28:31], v[104:107], v[96:99], a[28:31]
ds_read_b64_tr_b16 v[60:61], v33 offset:0
ds_read_b64_tr_b16 v[62:63], v33 offset:512
s_waitcnt lgkmcnt(0)
v_mfma_f32_16x16x32_bf16 a[0:3], v[56:59], v[40:43], a[0:3]
v_add_u32 v23, 98304, v22
v_mfma_f32_16x16x32_bf16 a[8:11], v[56:59], v[44:47], a[8:11]
v_add_u32 v32, 98304, v25
v_mfma_f32_16x16x32_bf16 a[16:19], v[56:59], v[48:51], a[16:19]
v_add_u32 v33, 98304, v26
ds_read_b128 v[84:87], v23 offset:0
v_mfma_f32_16x16x32_bf16 a[24:27], v[56:59], v[52:55], a[24:27]
ds_read_b128 v[88:91], v23 offset:2048
v_mfma_f32_16x16x32_bf16 a[4:7], v[60:63], v[40:43], a[4:7]
ds_read_b128 v[92:95], v23 offset:4096
v_mfma_f32_16x16x32_bf16 a[12:15], v[60:63], v[44:47], a[12:15]
ds_read_b128 v[96:99], v23 offset:6144
ds_read_b64_tr_b16 v[100:101], v32 offset:4096
v_mfma_f32_16x16x32_bf16 a[20:23], v[60:63], v[48:51], a[20:23]
ds_read_b64_tr_b16 v[102:103], v32 offset:4608
v_mfma_f32_16x16x32_bf16 a[28:31], v[60:63], v[52:55], a[28:31]
ds_read_b64_tr_b16 v[104:105], v33 offset:4096
ds_read_b64_tr_b16 v[106:107], v33 offset:4608
s_waitcnt vmcnt(0)
s_barrier
s_waitcnt lgkmcnt(0)
v_mfma_f32_16x16x32_bf16 a[0:3], v[100:103], v[84:87], a[0:3]
v_add_u32 v23, 0, v21
v_mfma_f32_16x16x32_bf16 a[8:11], v[100:103], v[88:91], a[8:11]
v_add_u32 v32, 0, v25
v_mfma_f32_16x16x32_bf16 a[16:19], v[100:103], v[92:95], a[16:19]
v_add_u32 v33, 0, v26
ds_read_b128 v[40:43], v23 offset:0
v_mfma_f32_16x16x32_bf16 a[24:27], v[100:103], v[96:99], a[24:27]
ds_read_b128 v[44:47], v23 offset:2048
v_mfma_f32_16x16x32_bf16 a[4:7], v[104:107], v[84:87], a[4:7]
ds_read_b128 v[48:51], v23 offset:4096
v_mfma_f32_16x16x32_bf16 a[12:15], v[104:107], v[88:91], a[12:15]
ds_read_b128 v[52:55], v23 offset:6144
ds_read_b64_tr_b16 v[56:57], v32 offset:0
v_mfma_f32_16x16x32_bf16 a[20:23], v[104:107], v[92:95], a[20:23]
ds_read_b64_tr_b16 v[58:59], v32 offset:512
v_mfma_f32_16x16x32_bf16 a[28:31], v[104:107], v[96:99], a[28:31]
ds_read_b64_tr_b16 v[60:61], v33 offset:0
ds_read_b64_tr_b16 v[62:63], v33 offset:512
s_waitcnt lgkmcnt(0)
v_mfma_f32_16x16x32_bf16 a[0:3], v[56:59], v[40:43], a[0:3]
v_add_u32 v23, 0, v22
v_mfma_f32_16x16x32_bf16 a[8:11], v[56:59], v[44:47], a[8:11]
v_add_u32 v32, 0, v25
v_mfma_f32_16x16x32_bf16 a[16:19], v[56:59], v[48:51], a[16:19]
v_add_u32 v33, 0, v26
ds_read_b128 v[84:87], v23 offset:0
v_mfma_f32_16x16x32_bf16 a[24:27], v[56:59], v[52:55], a[24:27]
ds_read_b128 v[88:91], v23 offset:2048
v_mfma_f32_16x16x32_bf16 a[4:7], v[60:63], v[40:43], a[4:7]
ds_read_b128 v[92:95], v23 offset:4096
v_mfma_f32_16x16x32_bf16 a[12:15], v[60:63], v[44:47], a[12:15]
ds_read_b128 v[96:99], v23 offset:6144
ds_read_b64_tr_b16 v[100:101], v32 offset:4096
v_mfma_f32_16x16x32_bf16 a[20:23], v[60:63], v[48:51], a[20:23]
ds_read_b64_tr_b16 v[102:103], v32 offset:4608
v_mfma_f32_16x16x32_bf16 a[28:31], v[60:63], v[52:55], a[28:31]
ds_read_b64_tr_b16 v[104:105], v33 offset:4096
ds_read_b64_tr_b16 v[106:107], v33 offset:4608
s_waitcnt vmcnt(0)
s_barrier
s_waitcnt lgkmcnt(0)
v_mfma_f32_16x16x32_bf16 a[0:3], v[100:103], v[84:87], a[0:3]
v_add_u32 v23, 24576, v21
v_mfma_f32_16x16x32_bf16 a[8:11], v[100:103], v[88:91], a[8:11]
v_add_u32 v32, 24576, v25
v_mfma_f32_16x16x32_bf16 a[16:19], v[100:103], v[92:95], a[16:19]
v_add_u32 v33, 24576, v26
ds_read_b128 v[40:43], v23 offset:0
v_mfma_f32_16x16x32_bf16 a[24:27], v[100:103], v[96:99], a[24:27]
ds_read_b128 v[44:47], v23 offset:2048
v_mfma_f32_16x16x32_bf16 a[4:7], v[104:107], v[84:87], a[4:7]
ds_read_b128 v[48:51], v23 offset:4096
v_mfma_f32_16x16x32_bf16 a[12:15], v[104:107], v[88:91], a[12:15]
ds_read_b128 v[52:55], v23 offset:6144
ds_read_b64_tr_b16 v[56:57], v32 offset:0
v_mfma_f32_16x16x32_bf16 a[20:23], v[104:107], v[92:95], a[20:23]
ds_read_b64_tr_b16 v[58:59], v32 offset:512
v_mfma_f32_16x16x32_bf16 a[28:31], v[104:107], v[96:99], a[28:31]
ds_read_b64_tr_b16 v[60:61], v33 offset:0
ds_read_b64_tr_b16 v[62:63], v33 offset:512
s_waitcnt vmcnt(0) lgkmcnt(0)
s_nop 15
s_nop 7
v_and_b32 v4, 15, v1
v_lshrrev_b32 v5, 4, v1
v_lshrrev_b32 v6, 1, v2
v_and_b32 v7, 1, v2
v_lshl_add_u32 v8, v6, 6, v4
s_lshl_b32 s25, s22, 7
v_add_u32 v9, s25, v8
v_xor_b32 v60, 16, v1
v_lshlrev_b32 v60, 2, v60
v_xor_b32 v61, 32, v1
v_lshlrev_b32 v61, 2, v61
v_lshlrev_b32 v3, 3, v8
v_add_u32 v3, 122880, v3
ds_read_b64 v[64:65], v3 offset:0
ds_read_b64 v[66:67], v3 offset:128
ds_read_b64 v[68:69], v3 offset:256
ds_read_b64 v[70:71], v3 offset:384
s_mul_i32 s25, s23, 64
v_mul_u32_u24 v10, 32, v7
v_add_u32 v10, s25, v10
v_lshl_add_u32 v10, v5, 2, v10
s_mov_b32 s26, 1024
v_mul_lo_u32 v11, v9, s26
v_add_u32 v11, v11, v10
v_lshlrev_b32 v11, 1, v11
s_load_dwordx2 s[12:13], s[0:1], 88
s_load_dwordx2 s[4:5], s[0:1], 88
s_waitcnt lgkmcnt(0)
s_add_u32 s12, s12, 16777216
s_addc_u32 s13, s13, 0
s_mov_b32 s14, 4194304
s_mov_b32 s15, 0x00020000
s_add_u32 s4, s4, 54538240
s_addc_u32 s5, s5, 0
s_mov_b32 s6, 110592
s_mov_b32 s7, 0x00020000
v_lshlrev_b32 v12, 2, v10
buffer_load_dwordx4 v[72:75], v12, s[4:7], 0 offen offset:0
buffer_load_dwordx4 v[76:79], v12, s[4:7], 0 offen offset:64
v_add_u32 v13, 30720, v12
buffer_load_dwordx4 v[128:131], v13, s[4:7], 0 offen offset:0
buffer_load_dwordx4 v[132:135], v13, s[4:7], 0 offen offset:64
v_add_u32 v13, 61440, v12
buffer_load_dwordx4 v[156:159], v13, s[4:7], 0 offen offset:0
buffer_load_dwordx4 v[160:163], v13, s[4:7], 0 offen offset:64
v_add_u32 v13, 92160, v12
buffer_load_dwordx4 v[184:187], v13, s[4:7], 0 offen offset:0
buffer_load_dwordx4 v[188:191], v13, s[4:7], 0 offen offset:64
s_waitcnt vmcnt(0)
v_add_f32 v72, v72, v128
v_add_f32 v73, v73, v129
v_add_f32 v74, v74, v130
v_add_f32 v75, v75, v131
v_add_f32 v76, v76, v132
v_add_f32 v77, v77, v133
v_add_f32 v78, v78, v134
v_add_f32 v79, v79, v135
v_add_f32 v72, v72, v156
v_add_f32 v73, v73, v157
v_add_f32 v74, v74, v158
v_add_f32 v75, v75, v159
v_add_f32 v76, v76, v160
v_add_f32 v77, v77, v161
v_add_f32 v78, v78, v162
v_add_f32 v79, v79, v163
v_add_f32 v72, v72, v184
v_add_f32 v73, v73, v185
v_add_f32 v74, v74, v186
v_add_f32 v75, v75, v187
v_add_f32 v76, v76, v188
v_add_f32 v77, v77, v189
v_add_f32 v78, v78, v190
v_add_f32 v79, v79, v191
v_add_u32 v13, 0, v11
s_waitcnt vmcnt(0) lgkmcnt(0)
v_accvgpr_read_b32 v104, a0
v_accvgpr_read_b32 v105, a1
v_accvgpr_read_b32 v106, a2
v_accvgpr_read_b32 v107, a3
v_fma_f32 v104, -v64, v72, v104
v_mul_f32 v104, v104, v65
v_fma_f32 v105, -v64, v73, v105
v_mul_f32 v105, v105, v65
v_fma_f32 v106, -v64, v74, v106
v_mul_f32 v106, v106, v65
v_fma_f32 v107, -v64, v75, v107
v_mul_f32 v107, v107, v65
v_cvt_pk_bf16_f32 v110, v104, v105
v_lshlrev_b32 v104, 16, v110
v_and_b32 v105, 0xffff0000, v110
v_cvt_pk_bf16_f32 v110, v106, v107
v_lshlrev_b32 v106, 16, v110
v_and_b32 v107, 0xffff0000, v110
v_mul_f32 v111, v104, v104
v_mul_f32 v111, 0x3d372713, v111
v_add_f32 v111, 1.0, v111
v_mul_f32 v111, v111, v104
v_mul_f32 v111, 0xc01362dc, v111
v_exp_f32 v111, v111
s_nop 0
v_add_f32 v111, 1.0, v111
v_rcp_f32 v111, v111
s_nop 0
v_mul_f32 v104, v104, v111
v_mul_f32 v111, v105, v105
v_mul_f32 v111, 0x3d372713, v111
v_add_f32 v111, 1.0, v111
v_mul_f32 v111, v111, v105
v_mul_f32 v111, 0xc01362dc, v111
v_exp_f32 v111, v111
s_nop 0
v_add_f32 v111, 1.0, v111
v_rcp_f32 v111, v111
s_nop 0
v_mul_f32 v105, v105, v111
v_mul_f32 v111, v106, v106
v_mul_f32 v111, 0x3d372713, v111
v_add_f32 v111, 1.0, v111
v_mul_f32 v111, v111, v106
v_mul_f32 v111, 0xc01362dc, v111
v_exp_f32 v111, v111
s_nop 0
v_add_f32 v111, 1.0, v111
v_rcp_f32 v111, v111
s_nop 0
v_mul_f32 v106, v106, v111
v_mul_f32 v111, v107, v107
v_mul_f32 v111, 0x3d372713, v111
v_add_f32 v111, 1.0, v111
v_mul_f32 v111, v111, v107
v_mul_f32 v111, 0xc01362dc, v111
v_exp_f32 v111, v111
s_nop 0
v_add_f32 v111, 1.0, v111
v_rcp_f32 v111, v111
s_nop 0
v_mul_f32 v107, v107, v111
v_cvt_pk_bf16_f32 v108, v104, v105
v_cvt_pk_bf16_f32 v109, v106, v107
buffer_store_dwordx2 v[108:109], v13, s[12:15], 0 offen offset:0
s_nop 1
v_accvgpr_read_b32 v104, a4
v_accvgpr_read_b32 v105, a5
v_accvgpr_read_b32 v106, a6
v_accvgpr_read_b32 v107, a7
v_fma_f32 v104, -v64, v76, v104
v_mul_f32 v104, v104, v65
v_fma_f32 v105, -v64, v77, v105
v_mul_f32 v105, v105, v65
v_fma_f32 v106, -v64, v78, v106
v_mul_f32 v106, v106, v65
v_fma_f32 v107, -v64, v79, v107
v_mul_f32 v107, v107, v65
v_cvt_pk_bf16_f32 v110, v104, v105
v_lshlrev_b32 v104, 16, v110
v_and_b32 v105, 0xffff0000, v110
v_cvt_pk_bf16_f32 v110, v106, v107
v_lshlrev_b32 v106, 16, v110
v_and_b32 v107, 0xffff0000, v110
v_mul_f32 v111, v104, v104
v_mul_f32 v111, 0x3d372713, v111
v_add_f32 v111, 1.0, v111
v_mul_f32 v111, v111, v104
v_mul_f32 v111, 0xc01362dc, v111
v_exp_f32 v111, v111
s_nop 0
v_add_f32 v111, 1.0, v111
v_rcp_f32 v111, v111
s_nop 0
v_mul_f32 v104, v104, v111
v_mul_f32 v111, v105, v105
v_mul_f32 v111, 0x3d372713, v111
v_add_f32 v111, 1.0, v111
v_mul_f32 v111, v111, v105
v_mul_f32 v111, 0xc01362dc, v111
v_exp_f32 v111, v111
s_nop 0
v_add_f32 v111, 1.0, v111
v_rcp_f32 v111, v111
s_nop 0
v_mul_f32 v105, v105, v111
v_mul_f32 v111, v106, v106
v_mul_f32 v111, 0x3d372713, v111
v_add_f32 v111, 1.0, v111
v_mul_f32 v111, v111, v106
v_mul_f32 v111, 0xc01362dc, v111
v_exp_f32 v111, v111
s_nop 0
v_add_f32 v111, 1.0, v111
v_rcp_f32 v111, v111
s_nop 0
v_mul_f32 v106, v106, v111
v_mul_f32 v111, v107, v107
v_mul_f32 v111, 0x3d372713, v111
v_add_f32 v111, 1.0, v111
v_mul_f32 v111, v111, v107
v_mul_f32 v111, 0xc01362dc, v111
v_exp_f32 v111, v111
s_nop 0
v_add_f32 v111, 1.0, v111
v_rcp_f32 v111, v111
s_nop 0
v_mul_f32 v107, v107, v111
v_cvt_pk_bf16_f32 v108, v104, v105
v_cvt_pk_bf16_f32 v109, v106, v107
buffer_store_dwordx2 v[108:109], v13, s[12:15], 0 offen offset:32
s_nop 1
v_add_u32 v13, 32768, v11
s_waitcnt vmcnt(0) lgkmcnt(0)
v_accvgpr_read_b32 v104, a8
v_accvgpr_read_b32 v105, a9
v_accvgpr_read_b32 v106, a10
v_accvgpr_read_b32 v107, a11
v_fma_f32 v104, -v66, v72, v104
v_mul_f32 v104, v104, v67
v_fma_f32 v105, -v66, v73, v105
v_mul_f32 v105, v105, v67
v_fma_f32 v106, -v66, v74, v106
v_mul_f32 v106, v106, v67
v_fma_f32 v107, -v66, v75, v107
v_mul_f32 v107, v107, v67
v_cvt_pk_bf16_f32 v110, v104, v105
v_lshlrev_b32 v104, 16, v110
v_and_b32 v105, 0xffff0000, v110
v_cvt_pk_bf16_f32 v110, v106, v107
v_lshlrev_b32 v106, 16, v110
v_and_b32 v107, 0xffff0000, v110
v_mul_f32 v111, v104, v104
v_mul_f32 v111, 0x3d372713, v111
v_add_f32 v111, 1.0, v111
v_mul_f32 v111, v111, v104
v_mul_f32 v111, 0xc01362dc, v111
v_exp_f32 v111, v111
s_nop 0
v_add_f32 v111, 1.0, v111
v_rcp_f32 v111, v111
s_nop 0
v_mul_f32 v104, v104, v111
v_mul_f32 v111, v105, v105
v_mul_f32 v111, 0x3d372713, v111
v_add_f32 v111, 1.0, v111
v_mul_f32 v111, v111, v105
v_mul_f32 v111, 0xc01362dc, v111
v_exp_f32 v111, v111
s_nop 0
v_add_f32 v111, 1.0, v111
v_rcp_f32 v111, v111
s_nop 0
v_mul_f32 v105, v105, v111
v_mul_f32 v111, v106, v106
v_mul_f32 v111, 0x3d372713, v111
v_add_f32 v111, 1.0, v111
v_mul_f32 v111, v111, v106
v_mul_f32 v111, 0xc01362dc, v111
v_exp_f32 v111, v111
s_nop 0
v_add_f32 v111, 1.0, v111
v_rcp_f32 v111, v111
s_nop 0
v_mul_f32 v106, v106, v111
v_mul_f32 v111, v107, v107
v_mul_f32 v111, 0x3d372713, v111
v_add_f32 v111, 1.0, v111
v_mul_f32 v111, v111, v107
v_mul_f32 v111, 0xc01362dc, v111
v_exp_f32 v111, v111
s_nop 0
v_add_f32 v111, 1.0, v111
v_rcp_f32 v111, v111
s_nop 0
v_mul_f32 v107, v107, v111
v_cvt_pk_bf16_f32 v108, v104, v105
v_cvt_pk_bf16_f32 v109, v106, v107
buffer_store_dwordx2 v[108:109], v13, s[12:15], 0 offen offset:0
s_nop 1
v_accvgpr_read_b32 v104, a12
v_accvgpr_read_b32 v105, a13
v_accvgpr_read_b32 v106, a14
v_accvgpr_read_b32 v107, a15
v_fma_f32 v104, -v66, v76, v104
v_mul_f32 v104, v104, v67
v_fma_f32 v105, -v66, v77, v105
v_mul_f32 v105, v105, v67
v_fma_f32 v106, -v66, v78, v106
v_mul_f32 v106, v106, v67
v_fma_f32 v107, -v66, v79, v107
v_mul_f32 v107, v107, v67
v_cvt_pk_bf16_f32 v110, v104, v105
v_lshlrev_b32 v104, 16, v110
v_and_b32 v105, 0xffff0000, v110
v_cvt_pk_bf16_f32 v110, v106, v107
v_lshlrev_b32 v106, 16, v110
v_and_b32 v107, 0xffff0000, v110
v_mul_f32 v111, v104, v104
v_mul_f32 v111, 0x3d372713, v111
v_add_f32 v111, 1.0, v111
v_mul_f32 v111, v111, v104
v_mul_f32 v111, 0xc01362dc, v111
v_exp_f32 v111, v111
s_nop 0
v_add_f32 v111, 1.0, v111
v_rcp_f32 v111, v111
s_nop 0
v_mul_f32 v104, v104, v111
v_mul_f32 v111, v105, v105
v_mul_f32 v111, 0x3d372713, v111
v_add_f32 v111, 1.0, v111
v_mul_f32 v111, v111, v105
v_mul_f32 v111, 0xc01362dc, v111
v_exp_f32 v111, v111
s_nop 0
v_add_f32 v111, 1.0, v111
v_rcp_f32 v111, v111
s_nop 0
v_mul_f32 v105, v105, v111
v_mul_f32 v111, v106, v106
v_mul_f32 v111, 0x3d372713, v111
v_add_f32 v111, 1.0, v111
v_mul_f32 v111, v111, v106
v_mul_f32 v111, 0xc01362dc, v111
v_exp_f32 v111, v111
s_nop 0
v_add_f32 v111, 1.0, v111
v_rcp_f32 v111, v111
s_nop 0
v_mul_f32 v106, v106, v111
v_mul_f32 v111, v107, v107
v_mul_f32 v111, 0x3d372713, v111
v_add_f32 v111, 1.0, v111
v_mul_f32 v111, v111, v107
v_mul_f32 v111, 0xc01362dc, v111
v_exp_f32 v111, v111
s_nop 0
v_add_f32 v111, 1.0, v111
v_rcp_f32 v111, v111
s_nop 0
v_mul_f32 v107, v107, v111
v_cvt_pk_bf16_f32 v108, v104, v105
v_cvt_pk_bf16_f32 v109, v106, v107
buffer_store_dwordx2 v[108:109], v13, s[12:15], 0 offen offset:32
s_nop 1
v_add_u32 v13, 65536, v11
s_waitcnt vmcnt(0) lgkmcnt(0)
v_accvgpr_read_b32 v104, a16
v_accvgpr_read_b32 v105, a17
v_accvgpr_read_b32 v106, a18
v_accvgpr_read_b32 v107, a19
v_fma_f32 v104, -v68, v72, v104
v_mul_f32 v104, v104, v69
v_fma_f32 v105, -v68, v73, v105
v_mul_f32 v105, v105, v69
v_fma_f32 v106, -v68, v74, v106
v_mul_f32 v106, v106, v69
v_fma_f32 v107, -v68, v75, v107
v_mul_f32 v107, v107, v69
v_cvt_pk_bf16_f32 v110, v104, v105
v_lshlrev_b32 v104, 16, v110
v_and_b32 v105, 0xffff0000, v110
v_cvt_pk_bf16_f32 v110, v106, v107
v_lshlrev_b32 v106, 16, v110
v_and_b32 v107, 0xffff0000, v110
v_mul_f32 v111, v104, v104
v_mul_f32 v111, 0x3d372713, v111
v_add_f32 v111, 1.0, v111
v_mul_f32 v111, v111, v104
v_mul_f32 v111, 0xc01362dc, v111
v_exp_f32 v111, v111
s_nop 0
v_add_f32 v111, 1.0, v111
v_rcp_f32 v111, v111
s_nop 0
v_mul_f32 v104, v104, v111
v_mul_f32 v111, v105, v105
v_mul_f32 v111, 0x3d372713, v111
v_add_f32 v111, 1.0, v111
v_mul_f32 v111, v111, v105
v_mul_f32 v111, 0xc01362dc, v111
v_exp_f32 v111, v111
s_nop 0
v_add_f32 v111, 1.0, v111
v_rcp_f32 v111, v111
s_nop 0
v_mul_f32 v105, v105, v111
v_mul_f32 v111, v106, v106
v_mul_f32 v111, 0x3d372713, v111
v_add_f32 v111, 1.0, v111
v_mul_f32 v111, v111, v106
v_mul_f32 v111, 0xc01362dc, v111
v_exp_f32 v111, v111
s_nop 0
v_add_f32 v111, 1.0, v111
v_rcp_f32 v111, v111
s_nop 0
v_mul_f32 v106, v106, v111
v_mul_f32 v111, v107, v107
v_mul_f32 v111, 0x3d372713, v111
v_add_f32 v111, 1.0, v111
v_mul_f32 v111, v111, v107
v_mul_f32 v111, 0xc01362dc, v111
v_exp_f32 v111, v111
s_nop 0
v_add_f32 v111, 1.0, v111
v_rcp_f32 v111, v111
s_nop 0
v_mul_f32 v107, v107, v111
v_cvt_pk_bf16_f32 v108, v104, v105
v_cvt_pk_bf16_f32 v109, v106, v107
buffer_store_dwordx2 v[108:109], v13, s[12:15], 0 offen offset:0
s_nop 1
v_accvgpr_read_b32 v104, a20
v_accvgpr_read_b32 v105, a21
v_accvgpr_read_b32 v106, a22
v_accvgpr_read_b32 v107, a23
v_fma_f32 v104, -v68, v76, v104
v_mul_f32 v104, v104, v69
v_fma_f32 v105, -v68, v77, v105
v_mul_f32 v105, v105, v69
v_fma_f32 v106, -v68, v78, v106
v_mul_f32 v106, v106, v69
v_fma_f32 v107, -v68, v79, v107
v_mul_f32 v107, v107, v69
v_cvt_pk_bf16_f32 v110, v104, v105
v_lshlrev_b32 v104, 16, v110
v_and_b32 v105, 0xffff0000, v110
v_cvt_pk_bf16_f32 v110, v106, v107
v_lshlrev_b32 v106, 16, v110
v_and_b32 v107, 0xffff0000, v110
v_mul_f32 v111, v104, v104
v_mul_f32 v111, 0x3d372713, v111
v_add_f32 v111, 1.0, v111
v_mul_f32 v111, v111, v104
v_mul_f32 v111, 0xc01362dc, v111
v_exp_f32 v111, v111
s_nop 0
v_add_f32 v111, 1.0, v111
v_rcp_f32 v111, v111
s_nop 0
v_mul_f32 v104, v104, v111
v_mul_f32 v111, v105, v105
v_mul_f32 v111, 0x3d372713, v111
v_add_f32 v111, 1.0, v111
v_mul_f32 v111, v111, v105
v_mul_f32 v111, 0xc01362dc, v111
v_exp_f32 v111, v111
s_nop 0
v_add_f32 v111, 1.0, v111
v_rcp_f32 v111, v111
s_nop 0
v_mul_f32 v105, v105, v111
v_mul_f32 v111, v106, v106
v_mul_f32 v111, 0x3d372713, v111
v_add_f32 v111, 1.0, v111
v_mul_f32 v111, v111, v106
v_mul_f32 v111, 0xc01362dc, v111
v_exp_f32 v111, v111
s_nop 0
v_add_f32 v111, 1.0, v111
v_rcp_f32 v111, v111
s_nop 0
v_mul_f32 v106, v106, v111
v_mul_f32 v111, v107, v107
v_mul_f32 v111, 0x3d372713, v111
v_add_f32 v111, 1.0, v111
v_mul_f32 v111, v111, v107
v_mul_f32 v111, 0xc01362dc, v111
v_exp_f32 v111, v111
s_nop 0
v_add_f32 v111, 1.0, v111
v_rcp_f32 v111, v111
s_nop 0
v_mul_f32 v107, v107, v111
v_cvt_pk_bf16_f32 v108, v104, v105
v_cvt_pk_bf16_f32 v109, v106, v107
buffer_store_dwordx2 v[108:109], v13, s[12:15], 0 offen offset:32
s_nop 1
v_add_u32 v13, 98304, v11
s_waitcnt vmcnt(0) lgkmcnt(0)
v_accvgpr_read_b32 v104, a24
v_accvgpr_read_b32 v105, a25
v_accvgpr_read_b32 v106, a26
v_accvgpr_read_b32 v107, a27
v_fma_f32 v104, -v70, v72, v104
v_mul_f32 v104, v104, v71
v_fma_f32 v105, -v70, v73, v105
v_mul_f32 v105, v105, v71
v_fma_f32 v106, -v70, v74, v106
v_mul_f32 v106, v106, v71
v_fma_f32 v107, -v70, v75, v107
v_mul_f32 v107, v107, v71
v_cvt_pk_bf16_f32 v110, v104, v105
v_lshlrev_b32 v104, 16, v110
v_and_b32 v105, 0xffff0000, v110
v_cvt_pk_bf16_f32 v110, v106, v107
v_lshlrev_b32 v106, 16, v110
v_and_b32 v107, 0xffff0000, v110
v_mul_f32 v111, v104, v104
v_mul_f32 v111, 0x3d372713, v111
v_add_f32 v111, 1.0, v111
v_mul_f32 v111, v111, v104
v_mul_f32 v111, 0xc01362dc, v111
v_exp_f32 v111, v111
s_nop 0
v_add_f32 v111, 1.0, v111
v_rcp_f32 v111, v111
s_nop 0
v_mul_f32 v104, v104, v111
v_mul_f32 v111, v105, v105
v_mul_f32 v111, 0x3d372713, v111
v_add_f32 v111, 1.0, v111
v_mul_f32 v111, v111, v105
v_mul_f32 v111, 0xc01362dc, v111
v_exp_f32 v111, v111
s_nop 0
v_add_f32 v111, 1.0, v111
v_rcp_f32 v111, v111
s_nop 0
v_mul_f32 v105, v105, v111
v_mul_f32 v111, v106, v106
v_mul_f32 v111, 0x3d372713, v111
v_add_f32 v111, 1.0, v111
v_mul_f32 v111, v111, v106
v_mul_f32 v111, 0xc01362dc, v111
v_exp_f32 v111, v111
s_nop 0
v_add_f32 v111, 1.0, v111
v_rcp_f32 v111, v111
s_nop 0
v_mul_f32 v106, v106, v111
v_mul_f32 v111, v107, v107
v_mul_f32 v111, 0x3d372713, v111
v_add_f32 v111, 1.0, v111
v_mul_f32 v111, v111, v107
v_mul_f32 v111, 0xc01362dc, v111
v_exp_f32 v111, v111
s_nop 0
v_add_f32 v111, 1.0, v111
v_rcp_f32 v111, v111
s_nop 0
v_mul_f32 v107, v107, v111
v_cvt_pk_bf16_f32 v108, v104, v105
v_cvt_pk_bf16_f32 v109, v106, v107
buffer_store_dwordx2 v[108:109], v13, s[12:15], 0 offen offset:0
s_nop 1
v_accvgpr_read_b32 v104, a28
v_accvgpr_read_b32 v105, a29
v_accvgpr_read_b32 v106, a30
v_accvgpr_read_b32 v107, a31
v_fma_f32 v104, -v70, v76, v104
v_mul_f32 v104, v104, v71
v_fma_f32 v105, -v70, v77, v105
v_mul_f32 v105, v105, v71
v_fma_f32 v106, -v70, v78, v106
v_mul_f32 v106, v106, v71
v_fma_f32 v107, -v70, v79, v107
v_mul_f32 v107, v107, v71
v_cvt_pk_bf16_f32 v110, v104, v105
v_lshlrev_b32 v104, 16, v110
v_and_b32 v105, 0xffff0000, v110
v_cvt_pk_bf16_f32 v110, v106, v107
v_lshlrev_b32 v106, 16, v110
v_and_b32 v107, 0xffff0000, v110
v_mul_f32 v111, v104, v104
v_mul_f32 v111, 0x3d372713, v111
v_add_f32 v111, 1.0, v111
v_mul_f32 v111, v111, v104
v_mul_f32 v111, 0xc01362dc, v111
v_exp_f32 v111, v111
s_nop 0
v_add_f32 v111, 1.0, v111
v_rcp_f32 v111, v111
s_nop 0
v_mul_f32 v104, v104, v111
v_mul_f32 v111, v105, v105
v_mul_f32 v111, 0x3d372713, v111
v_add_f32 v111, 1.0, v111
v_mul_f32 v111, v111, v105
v_mul_f32 v111, 0xc01362dc, v111
v_exp_f32 v111, v111
s_nop 0
v_add_f32 v111, 1.0, v111
v_rcp_f32 v111, v111
s_nop 0
v_mul_f32 v105, v105, v111
v_mul_f32 v111, v106, v106
v_mul_f32 v111, 0x3d372713, v111
v_add_f32 v111, 1.0, v111
v_mul_f32 v111, v111, v106
v_mul_f32 v111, 0xc01362dc, v111
v_exp_f32 v111, v111
s_nop 0
v_add_f32 v111, 1.0, v111
v_rcp_f32 v111, v111
s_nop 0
v_mul_f32 v106, v106, v111
v_mul_f32 v111, v107, v107
v_mul_f32 v111, 0x3d372713, v111
v_add_f32 v111, 1.0, v111
v_mul_f32 v111, v111, v107
v_mul_f32 v111, 0xc01362dc, v111
v_exp_f32 v111, v111
s_nop 0
v_add_f32 v111, 1.0, v111
v_rcp_f32 v111, v111
s_nop 0
v_mul_f32 v107, v107, v111
v_cvt_pk_bf16_f32 v108, v104, v105
v_cvt_pk_bf16_f32 v109, v106, v107
buffer_store_dwordx2 v[108:109], v13, s[12:15], 0 offen offset:32
s_nop 1
w1_kernel_end:
s_endpgm
.globl w2_kernel
.p2align 8
.type w2_kernel,@function
w2_kernel:
s_cmp_ge_u32 s2, 256
s_cbranch_scc1 w2_kernel_end
s_load_dwordx2 s[4:5], s[0:1], 88
s_load_dwordx2 s[8:9], s[0:1], 48
s_and_b32 s20, s2, 7
s_lshr_b32 s21, s2, 3
s_lshr_b32 s22, s20, 1
s_lshl_b32 s22, s22, 2
s_and_b32 s23, s21, 3
s_add_u32 s22, s22, s23
s_and_b32 s23, s20, 1
s_lshl_b32 s23, s23, 3
s_lshr_b32 s24, s21, 2
s_add_u32 s23, s23, s24
v_and_b32 v1, 63, v0
v_lshrrev_b32 v2, 6, v0
s_waitcnt lgkmcnt(0)
s_add_u32 s4, s4, 16777216
s_addc_u32 s5, s5, 0
s_mov_b32 s6, 4194304
s_mov_b32 s7, 0x00020000
s_mov_b32 s10, 2097152
s_mov_b32 s11, 0x00020000
v_lshrrev_b32 v3, 3, v1
v_and_b32 v4, 7, v1
v_xor_b32 v4, v4, v3
v_lshlrev_b32 v4, 4, v4
s_lshl_b32 s25, s22, 7
v_lshlrev_b32 v5, 5, v2
v_add_u32 v5, s25, v5
v_add_u32 v5, v5, v3
s_mov_b32 s26, 2048
v_mul_lo_u32 v5, v5, s26
v_add_u32 v10, v5, v4
v_add_u32 v11, 16384, v10
v_add_u32 v12, 32768, v10
v_add_u32 v13, 49152, v10
v_mul_u32_u24 v3, 128, v2
v_add_u32 v3, 0, v3
v_add_u32 v3, v3, v1
v_mul_u32_u24 v4, 8192, v3
v_lshrrev_b32 v4, 16, v4
v_mul_u32_u24 v5, 8, v4
v_sub_u32 v5, v3, v5
v_bfe_u32 v6, v4, 3, 1
v_bfe_u32 v7, v4, 1, 1
v_lshl_or_b32 v6, v7, 1, v6
v_lshlrev_b32 v6, 1, v6
v_xor_b32 v5, v5, v6
s_mul_i32 s25, s23, 128
v_lshlrev_b32 v9, 4, v5
v_add_u32 v9, s25, v9
v_mul_u32_u24 v4, 2048, v4
v_add_u32 v14, v4, v9
v_mul_u32_u24 v3, 128, v2
v_add_u32 v3, 64, v3
v_add_u32 v3, v3, v1
v_mul_u32_u24 v4, 8192, v3
v_lshrrev_b32 v4, 16, v4
v_mul_u32_u24 v5, 8, v4
v_sub_u32 v5, v3, v5
v_bfe_u32 v6, v4, 3, 1
v_bfe_u32 v7, v4, 1, 1
v_lshl_or_b32 v6, v7, 1, v6
v_lshlrev_b32 v6, 1, v6
v_xor_b32 v5, v5, v6
s_mul_i32 s25, s23, 128
v_lshlrev_b32 v9, 4, v5
v_add_u32 v9, s25, v9
v_mul_u32_u24 v4, 2048, v4
v_add_u32 v15, v4, v9
v_lshrrev_b32 v3, 1, v2
v_lshlrev_b32 v3, 6, v3
v_and_b32 v4, 15, v1
v_add_u32 v3, v3, v4
v_lshlrev_b32 v3, 7, v3
v_lshrrev_b32 v5, 4, v1
v_and_b32 v6, 7, v1
v_xor_b32 v5, v5, v6
v_lshlrev_b32 v5, 4, v5
v_add_u32 v21, v3, v5
v_xor_b32 v22, 64, v21
v_lshrrev_b32 v3, 4, v1
v_bfe_u32 v4, v1, 2, 2
v_lshl_add_u32 v5, v3, 3, v4
v_mul_u32_u24 v5, 128, v5
v_and_b32 v6, 3, v1
v_lshl_add_u32 v5, v6, 3, v5
v_add_u32 v5, 16384, v5
v_and_b32 v6, 1, v3
v_bfe_u32 v7, v1, 3, 1
v_lshl_or_b32 v6, v7, 1, v6
v_and_b32 v7, 1, v2
v_mul_u32_u24 v7, 2, v7
v_add_u32 v8, 0, v7
v_xor_b32 v8, v8, v6
v_lshl_add_u32 v25, v8, 5, v5
v_add_u32 v8, 1, v7
v_xor_b32 v8, v8, v6
v_lshl_add_u32 v26, v8, 5, v5
v_accvgpr_write_b32 a0, 0
v_accvgpr_write_b32 a1, 0
v_accvgpr_write_b32 a2, 0
v_accvgpr_write_b32 a3, 0
v_accvgpr_write_b32 a4, 0
v_accvgpr_write_b32 a5, 0
v_accvgpr_write_b32 a6, 0
v_accvgpr_write_b32 a7, 0
v_accvgpr_write_b32 a8, 0
v_accvgpr_write_b32 a9, 0
v_accvgpr_write_b32 a10, 0
v_accvgpr_write_b32 a11, 0
v_accvgpr_write_b32 a12, 0
v_accvgpr_write_b32 a13, 0
v_accvgpr_write_b32 a14, 0
v_accvgpr_write_b32 a15, 0
v_accvgpr_write_b32 a16, 0
v_accvgpr_write_b32 a17, 0
v_accvgpr_write_b32 a18, 0
v_accvgpr_write_b32 a19, 0
v_accvgpr_write_b32 a20, 0
v_accvgpr_write_b32 a21, 0
v_accvgpr_write_b32 a22, 0
v_accvgpr_write_b32 a23, 0
v_accvgpr_write_b32 a24, 0
v_accvgpr_write_b32 a25, 0
v_accvgpr_write_b32 a26, 0
v_accvgpr_write_b32 a27, 0
v_accvgpr_write_b32 a28, 0
v_accvgpr_write_b32 a29, 0
v_accvgpr_write_b32 a30, 0
v_accvgpr_write_b32 a31, 0
v_readfirstlane_b32 s27, v2
s_nop 3
s_mul_i32 s28, s27, 2048
s_lshl_b32 s27, s27, 12
s_mov_b32 s16, 0
s_mov_b32 s17, 0
v_add_u32 v10, 4294965248, v10
v_add_u32 v11, 4294965248, v11
v_add_u32 v12, 4294965248, v12
v_add_u32 v13, 4294965248, v13
s_add_u32 m0, s27, 0
s_nop 0
buffer_load_dwordx4 v10, s[4:7], s16 offen lds
s_add_u32 m0, s27, 1024
s_nop 0
buffer_load_dwordx4 v11, s[4:7], s16 offen lds
s_add_u32 m0, s27, 2048
s_nop 0
buffer_load_dwordx4 v12, s[4:7], s16 offen lds
s_add_u32 m0, s27, 3072
s_nop 0
buffer_load_dwordx4 v13, s[4:7], s16 offen lds
s_add_u32 m0, s28, 16384
s_nop 0
buffer_load_dwordx4 v14, s[8:11], s17 offen lds
s_add_u32 m0, s28, 17408
s_nop 0
buffer_load_dwordx4 v15, s[8:11], s17 offen lds
s_mov_b32 s16, 128
s_mov_b32 s17, 131072
s_add_u32 m0, s27, 24576
s_nop 0
buffer_load_dwordx4 v10, s[4:7], s16 offen lds
s_add_u32 m0, s27, 25600
s_nop 0
buffer_load_dwordx4 v11, s[4:7], s16 offen lds
s_add_u32 m0, s27, 26624
s_nop 0
buffer_load_dwordx4 v12, s[4:7], s16 offen lds
s_add_u32 m0, s27, 27648
s_nop 0
buffer_load_dwordx4 v13, s[4:7], s16 offen lds
s_add_u32 m0, s28, 40960
s_nop 0
buffer_load_dwordx4 v14, s[8:11], s17 offen lds
s_add_u32 m0, s28, 41984
s_nop 0
buffer_load_dwordx4 v15, s[8:11], s17 offen lds
s_mov_b32 s16, 256
s_mov_b32 s17, 262144
s_add_u32 m0, s27, 49152
s_nop 0
buffer_load_dwordx4 v10, s[4:7], s16 offen lds
s_add_u32 m0, s27, 50176
s_nop 0
buffer_load_dwordx4 v11, s[4:7], s16 offen lds
s_add_u32 m0, s27, 51200
s_nop 0
buffer_load_dwordx4 v12, s[4:7], s16 offen lds
s_add_u32 m0, s27, 52224
s_nop 0
buffer_load_dwordx4 v13, s[4:7], s16 offen lds
s_add_u32 m0, s28, 65536
s_nop 0
buffer_load_dwordx4 v14, s[8:11], s17 offen lds
s_add_u32 m0, s28, 66560
s_nop 0
buffer_load_dwordx4 v15, s[8:11], s17 offen lds
s_mov_b32 s16, 384
s_mov_b32 s17, 393216
s_add_u32 m0, s27, 73728
s_nop 0
buffer_load_dwordx4 v10, s[4:7], s16 offen lds
s_add_u32 m0, s27, 74752
s_nop 0
buffer_load_dwordx4 v11, s[4:7], s16 offen lds
s_add_u32 m0, s27, 75776
s_nop 0
buffer_load_dwordx4 v12, s[4:7], s16 offen lds
s_add_u32 m0, s27, 76800
s_nop 0
buffer_load_dwordx4 v13, s[4:7], s16 offen lds
s_add_u32 m0, s28, 90112
s_nop 0
buffer_load_dwordx4 v14, s[8:11], s17 offen lds
s_add_u32 m0, s28, 91136
s_nop 0
buffer_load_dwordx4 v15, s[8:11], s17 offen lds
s_load_dwordx2 s[12:13], s[0:1], 88
s_waitcnt lgkmcnt(0)
s_add_u32 s12, s12, 52428800
s_addc_u32 s13, s13, 0
s_mov_b32 s14, 524288
s_mov_b32 s15, 0x00020000
s_lshl_b32 s25, s22, 15
v_lshlrev_b32 v3, 7, v0
v_add_u32 v3, s25, v3
buffer_load_dwordx4 v[128:131], v3, s[12:15], 0 offen offset:0
buffer_load_dwordx4 v[132:135], v3, s[12:15], 0 offen offset:16
buffer_load_dwordx4 v[136:139], v3, s[12:15], 0 offen offset:32
buffer_load_dwordx4 v[140:143], v3, s[12:15], 0 offen offset:48
buffer_load_dwordx4 v[144:147], v3, s[12:15], 0 offen offset:64
buffer_load_dwordx4 v[148:151], v3, s[12:15], 0 offen offset:80
buffer_load_dwordx4 v[152:155], v3, s[12:15], 0 offen offset:96
buffer_load_dwordx4 v[156:159], v3, s[12:15], 0 offen offset:112
s_waitcnt vmcnt(0)
v_add_f32 v128, v128, v130
v_add_f32 v129, v129, v131
v_add_f32 v128, v128, v132
v_add_f32 v129, v129, v133
v_add_f32 v128, v128, v134
v_add_f32 v129, v129, v135
v_add_f32 v128, v128, v136
v_add_f32 v129, v129, v137
v_add_f32 v128, v128, v138
v_add_f32 v129, v129, v139
v_add_f32 v128, v128, v140
v_add_f32 v129, v129, v141
v_add_f32 v128, v128, v142
v_add_f32 v129, v129, v143
v_add_f32 v128, v128, v144
v_add_f32 v129, v129, v145
v_add_f32 v128, v128, v146
v_add_f32 v129, v129, v147
v_add_f32 v128, v128, v148
v_add_f32 v129, v129, v149
v_add_f32 v128, v128, v150
v_add_f32 v129, v129, v151
v_add_f32 v128, v128, v152
v_add_f32 v129, v129, v153
v_add_f32 v128, v128, v154
v_add_f32 v129, v129, v155
v_add_f32 v128, v128, v156
v_add_f32 v129, v129, v157
v_add_f32 v128, v128, v158
v_add_f32 v129, v129, v159
s_nop 1
v_add_f32_dpp v128, v128, v128 quad_perm:[1,0,3,2] row_mask:0xf bank_mask:0xf
v_add_f32_dpp v129, v129, v129 quad_perm:[1,0,3,2] row_mask:0xf bank_mask:0xf
v_mul_f32 v128, 0x3a800000, v128
v_mul_f32 v129, 0x3a800000, v129
v_fma_f32 v129, -v128, v128, v129
v_max_f32 v129, 0, v129
v_add_f32 v130, 0x3727c5ac, v129
v_rsq_f32 v130, v130
s_nop 0
v_mov_b32 v129, v130
v_lshrrev_b32 v3, 1, v0
v_lshlrev_b32 v3, 3, v3
v_add_u32 v3, 122880, v3
ds_write_b64 v3, v[128:129]
s_waitcnt vmcnt(18) lgkmcnt(0)
s_barrier
v_add_u32 v23, 0, v21
v_add_u32 v32, 0, v25
v_add_u32 v33, 0, v26
ds_read_b128 v[40:43], v23 offset:0
ds_read_b128 v[44:47], v23 offset:2048
ds_read_b128 v[48:51], v23 offset:4096
ds_read_b128 v[52:55], v23 offset:6144
ds_read_b64_tr_b16 v[56:57], v32 offset:0
ds_read_b64_tr_b16 v[58:59], v32 offset:512
ds_read_b64_tr_b16 v[60:61], v33 offset:0
ds_read_b64_tr_b16 v[62:63], v33 offset:512
s_waitcnt lgkmcnt(0)
v_mfma_f32_16x16x32_bf16 a[0:3], v[56:59], v[40:43], a[0:3]
v_add_u32 v23, 0, v22
v_mfma_f32_16x16x32_bf16 a[8:11], v[56:59], v[44:47], a[8:11]
v_add_u32 v32, 0, v25
v_mfma_f32_16x16x32_bf16 a[16:19], v[56:59], v[48:51], a[16:19]
v_add_u32 v33, 0, v26
ds_read_b128 v[84:87], v23 offset:0
v_mfma_f32_16x16x32_bf16 a[24:27], v[56:59], v[52:55], a[24:27]
ds_read_b128 v[88:91], v23 offset:2048
v_mfma_f32_16x16x32_bf16 a[4:7], v[60:63], v[40:43], a[4:7]
ds_read_b128 v[92:95], v23 offset:4096
v_mfma_f32_16x16x32_bf16 a[12:15], v[60:63], v[44:47], a[12:15]
ds_read_b128 v[96:99], v23 offset:6144
ds_read_b64_tr_b16 v[100:101], v32 offset:4096
v_mfma_f32_16x16x32_bf16 a[20:23], v[60:63], v[48:51], a[20:23]
ds_read_b64_tr_b16 v[102:103], v32 offset:4608
v_mfma_f32_16x16x32_bf16 a[28:31], v[60:63], v[52:55], a[28:31]
ds_read_b64_tr_b16 v[104:105], v33 offset:4096
ds_read_b64_tr_b16 v[106:107], v33 offset:4608
s_waitcnt vmcnt(12)
s_barrier
s_waitcnt lgkmcnt(0)
v_mfma_f32_16x16x32_bf16 a[0:3], v[100:103], v[84:87], a[0:3]
s_mov_b32 s16, 512
s_mov_b32 s17, 524288
v_add_u32 v10, 4096, v10
v_add_u32 v11, 4096, v11
v_mfma_f32_16x16x32_bf16 a[8:11], v[100:103], v[88:91], a[8:11]
v_add_u32 v12, 4096, v12
v_add_u32 v13, 4096, v13
s_add_u32 m0, s27, 98304
s_nop 0
v_mfma_f32_16x16x32_bf16 a[16:19], v[100:103], v[92:95], a[16:19]
buffer_load_dwordx4 v10, s[4:7], s16 offen lds
s_add_u32 m0, s27, 99328
s_nop 0
buffer_load_dwordx4 v11, s[4:7], s16 offen lds
s_add_u32 m0, s27, 100352
v_mfma_f32_16x16x32_bf16 a[24:27], v[100:103], v[96:99], a[24:27]
s_nop 0
buffer_load_dwordx4 v12, s[4:7], s16 offen lds
s_add_u32 m0, s27, 101376
s_nop 0
v_mfma_f32_16x16x32_bf16 a[4:7], v[104:107], v[84:87], a[4:7]
buffer_load_dwordx4 v13, s[4:7], s16 offen lds
s_add_u32 m0, s28, 114688
s_nop 0
buffer_load_dwordx4 v14, s[8:11], s17 offen lds
v_mfma_f32_16x16x32_bf16 a[12:15], v[104:107], v[88:91], a[12:15]
s_add_u32 m0, s28, 115712
s_nop 0
buffer_load_dwordx4 v15, s[8:11], s17 offen lds
v_add_u32 v23, 24576, v21
v_add_u32 v32, 24576, v25
v_mfma_f32_16x16x32_bf16 a[20:23], v[104:107], v[92:95], a[20:23]
v_add_u32 v33, 24576, v26
ds_read_b128 v[40:43], v23 offset:0
ds_read_b128 v[44:47], v23 offset:2048
ds_read_b128 v[48:51], v23 offset:4096
v_mfma_f32_16x16x32_bf16 a[28:31], v[104:107], v[96:99], a[28:31]
ds_read_b128 v[52:55], v23 offset:6144
ds_read_b64_tr_b16 v[56:57], v32 offset:0
ds_read_b64_tr_b16 v[58:59], v32 offset:512
ds_read_b64_tr_b16 v[60:61], v33 offset:0
ds_read_b64_tr_b16 v[62:63], v33 offset:512
s_waitcnt lgkmcnt(0)
v_mfma_f32_16x16x32_bf16 a[0:3], v[56:59], v[40:43], a[0:3]
v_add_u32 v23, 24576, v22
v_mfma_f32_16x16x32_bf16 a[8:11], v[56:59], v[44:47], a[8:11]
v_add_u32 v32, 24576, v25
v_mfma_f32_16x16x32_bf16 a[16:19], v[56:59], v[48:51], a[16:19]
v_add_u32 v33, 24576, v26
ds_read_b128 v[84:87], v23 offset:0
v_mfma_f32_16x16x32_bf16 a[24:27], v[56:59], v[52:55], a[24:27]
ds_read_b128 v[88:91], v23 offset:2048
v_mfma_f32_16x16x32_bf16 a[4:7], v[60:63], v[40:43], a[4:7]
ds_read_b128 v[92:95], v23 offset:4096
v_mfma_f32_16x16x32_bf16 a[12:15], v[60:63], v[44:47], a[12:15]
ds_read_b128 v[96:99], v23 offset:6144
ds_read_b64_tr_b16 v[100:101], v32 offset:4096
v_mfma_f32_16x16x32_bf16 a[20:23], v[60:63], v[48:51], a[20:23]
ds_read_b64_tr_b16 v[102:103], v32 offset:4608
v_mfma_f32_16x16x32_bf16 a[28:31], v[60:63], v[52:55], a[28:31]
ds_read_b64_tr_b16 v[104:105], v33 offset:4096
ds_read_b64_tr_b16 v[106:107], v33 offset:4608
s_waitcnt vmcnt(12)
s_barrier
s_waitcnt lgkmcnt(0)
v_mfma_f32_16x16x32_bf16 a[0:3], v[100:103], v[84:87], a[0:3]
s_mov_b32 s16, 640
s_mov_b32 s17, 655360
s_add_u32 m0, s27, 0
v_mfma_f32_16x16x32_bf16 a[8:11], v[100:103], v[88:91], a[8:11]
s_nop 0
buffer_load_dwordx4 v10, s[4:7], s16 offen lds
s_add_u32 m0, s27, 1024
s_nop 0
v_mfma_f32_16x16x32_bf16 a[16:19], v[100:103], v[92:95], a[16:19]
buffer_load_dwordx4 v11, s[4:7], s16 offen lds
s_add_u32 m0, s27, 2048
s_nop 0
buffer_load_dwordx4 v12, s[4:7], s16 offen lds
v_mfma_f32_16x16x32_bf16 a[24:27], v[100:103], v[96:99], a[24:27]
s_add_u32 m0, s27, 3072
s_nop 0
buffer_load_dwordx4 v13, s[4:7], s16 offen lds
s_add_u32 m0, s28, 16384
v_mfma_f32_16x16x32_bf16 a[4:7], v[104:107], v[84:87], a[4:7]
s_nop 0
buffer_load_dwordx4 v14, s[8:11], s17 offen lds
s_add_u32 m0, s28, 17408
s_nop 0
v_mfma_f32_16x16x32_bf16 a[12:15], v[104:107], v[88:91], a[12:15]
buffer_load_dwordx4 v15, s[8:11], s17 offen lds
v_add_u32 v23, 49152, v21
v_add_u32 v32, 49152, v25
v_add_u32 v33, 49152, v26
v_mfma_f32_16x16x32_bf16 a[20:23], v[104:107], v[92:95], a[20:23]
ds_read_b128 v[40:43], v23 offset:0
ds_read_b128 v[44:47], v23 offset:2048
ds_read_b128 v[48:51], v23 offset:4096
ds_read_b128 v[52:55], v23 offset:6144
v_mfma_f32_16x16x32_bf16 a[28:31], v[104:107], v[96:99], a[28:31]
ds_read_b64_tr_b16 v[56:57], v32 offset:0
ds_read_b64_tr_b16 v[58:59], v32 offset:512
ds_read_b64_tr_b16 v[60:61], v33 offset:0
ds_read_b64_tr_b16 v[62:63], v33 offset:512
s_waitcnt lgkmcnt(0)
v_mfma_f32_16x16x32_bf16 a[0:3], v[56:59], v[40:43], a[0:3]
v_add_u32 v23, 49152, v22
v_mfma_f32_16x16x32_bf16 a[8:11], v[56:59], v[44:47], a[8:11]
v_add_u32 v32, 49152, v25
v_mfma_f32_16x16x32_bf16 a[16:19], v[56:59], v[48:51], a[16:19]
v_add_u32 v33, 49152, v26
ds_read_b128 v[84:87], v23 offset:0
v_mfma_f32_16x16x32_bf16 a[24:27], v[56:59], v[52:55], a[24:27]
ds_read_b128 v[88:91], v23 offset:2048
v_mfma_f32_16x16x32_bf16 a[4:7], v[60:63], v[40:43], a[4:7]
ds_read_b128 v[92:95], v23 offset:4096
v_mfma_f32_16x16x32_bf16 a[12:15], v[60:63], v[44:47], a[12:15]
ds_read_b128 v[96:99], v23 offset:6144
ds_read_b64_tr_b16 v[100:101], v32 offset:4096
v_mfma_f32_16x16x32_bf16 a[20:23], v[60:63], v[48:51], a[20:23]
ds_read_b64_tr_b16 v[102:103], v32 offset:4608
v_mfma_f32_16x16x32_bf16 a[28:31], v[60:63], v[52:55], a[28:31]
ds_read_b64_tr_b16 v[104:105], v33 offset:4096
ds_read_b64_tr_b16 v[106:107], v33 offset:4608
s_waitcnt vmcnt(12)
s_barrier
s_waitcnt lgkmcnt(0)
v_mfma_f32_16x16x32_bf16 a[0:3], v[100:103], v[84:87], a[0:3]
s_mov_b32 s16, 768
s_mov_b32 s17, 786432
s_add_u32 m0, s27, 24576
v_mfma_f32_16x16x32_bf16 a[8:11], v[100:103], v[88:91], a[8:11]
s_nop 0
buffer_load_dwordx4 v10, s[4:7], s16 offen lds
s_add_u32 m0, s27, 25600
s_nop 0
v_mfma_f32_16x16x32_bf16 a[16:19], v[100:103], v[92:95], a[16:19]
buffer_load_dwordx4 v11, s[4:7], s16 offen lds
s_add_u32 m0, s27, 26624
s_nop 0
buffer_load_dwordx4 v12, s[4:7], s16 offen lds
v_mfma_f32_16x16x32_bf16 a[24:27], v[100:103], v[96:99], a[24:27]
s_add_u32 m0, s27, 27648
s_nop 0
buffer_load_dwordx4 v13, s[4:7], s16 offen lds
s_add_u32 m0, s28, 40960
v_mfma_f32_16x16x32_bf16 a[4:7], v[104:107], v[84:87], a[4:7]
s_nop 0
buffer_load_dwordx4 v14, s[8:11], s17 offen lds
s_add_u32 m0, s28, 41984
s_nop 0
v_mfma_f32_16x16x32_bf16 a[12:15], v[104:107], v[88:91], a[12:15]
buffer_load_dwordx4 v15, s[8:11], s17 offen lds
v_add_u32 v23, 73728, v21
v_add_u32 v32, 73728, v25
v_add_u32 v33, 73728, v26
v_mfma_f32_16x16x32_bf16 a[20:23], v[104:107], v[92:95], a[20:23]
ds_read_b128 v[40:43], v23 offset:0
ds_read_b128 v[44:47], v23 offset:2048
ds_read_b128 v[48:51], v23 offset:4096
ds_read_b128 v[52:55], v23 offset:6144
v_mfma_f32_16x16x32_bf16 a[28:31], v[104:107], v[96:99], a[28:31]
ds_read_b64_tr_b16 v[56:57], v32 offset:0
ds_read_b64_tr_b16 v[58:59], v32 offset:512
ds_read_b64_tr_b16 v[60:61], v33 offset:0
ds_read_b64_tr_b16 v[62:63], v33 offset:512
s_waitcnt lgkmcnt(0)
v_mfma_f32_16x16x32_bf16 a[0:3], v[56:59], v[40:43], a[0:3]
v_add_u32 v23, 73728, v22
v_mfma_f32_16x16x32_bf16 a[8:11], v[56:59], v[44:47], a[8:11]
v_add_u32 v32, 73728, v25
v_mfma_f32_16x16x32_bf16 a[16:19], v[56:59], v[48:51], a[16:19]
v_add_u32 v33, 73728, v26
ds_read_b128 v[84:87], v23 offset:0
v_mfma_f32_16x16x32_bf16 a[24:27], v[56:59], v[52:55], a[24:27]
ds_read_b128 v[88:91], v23 offset:2048
v_mfma_f32_16x16x32_bf16 a[4:7], v[60:63], v[40:43], a[4:7]
ds_read_b128 v[92:95], v23 offset:4096
v_mfma_f32_16x16x32_bf16 a[12:15], v[60:63], v[44:47], a[12:15]
ds_read_b128 v[96:99], v23 offset:6144
ds_read_b64_tr_b16 v[100:101], v32 offset:4096
v_mfma_f32_16x16x32_bf16 a[20:23], v[60:63], v[48:51], a[20:23]
ds_read_b64_tr_b16 v[102:103], v32 offset:4608
v_mfma_f32_16x16x32_bf16 a[28:31], v[60:63], v[52:55], a[28:31]
ds_read_b64_tr_b16 v[104:105], v33 offset:4096
ds_read_b64_tr_b16 v[106:107], v33 offset:4608
s_waitcnt vmcnt(12)
s_barrier
s_waitcnt lgkmcnt(0)
v_mfma_f32_16x16x32_bf16 a[0:3], v[100:103], v[84:87], a[0:3]
s_mov_b32 s16, 896
s_mov_b32 s17, 917504
s_add_u32 m0, s27, 49152
v_mfma_f32_16x16x32_bf16 a[8:11], v[100:103], v[88:91], a[8:11]
s_nop 0
buffer_load_dwordx4 v10, s[4:7], s16 offen lds
s_add_u32 m0, s27, 50176
s_nop 0
v_mfma_f32_16x16x32_bf16 a[16:19], v[100:103], v[92:95], a[16:19]
buffer_load_dwordx4 v11, s[4:7], s16 offen lds
s_add_u32 m0, s27, 51200
s_nop 0
buffer_load_dwordx4 v12, s[4:7], s16 offen lds
v_mfma_f32_16x16x32_bf16 a[24:27], v[100:103], v[96:99], a[24:27]
s_add_u32 m0, s27, 52224
s_nop 0
buffer_load_dwordx4 v13, s[4:7], s16 offen lds
s_add_u32 m0, s28, 65536
v_mfma_f32_16x16x32_bf16 a[4:7], v[104:107], v[84:87], a[4:7]
s_nop 0
buffer_load_dwordx4 v14, s[8:11], s17 offen lds
s_add_u32 m0, s28, 66560
s_nop 0
v_mfma_f32_16x16x32_bf16 a[12:15], v[104:107], v[88:91], a[12:15]
buffer_load_dwordx4 v15, s[8:11], s17 offen lds
v_add_u32 v23, 98304, v21
v_add_u32 v32, 98304, v25
v_add_u32 v33, 98304, v26
v_mfma_f32_16x16x32_bf16 a[20:23], v[104:107], v[92:95], a[20:23]
ds_read_b128 v[40:43], v23 offset:0
ds_read_b128 v[44:47], v23 offset:2048
ds_read_b128 v[48:51], v23 offset:4096
ds_read_b128 v[52:55], v23 offset:6144
v_mfma_f32_16x16x32_bf16 a[28:31], v[104:107], v[96:99], a[28:31]
ds_read_b64_tr_b16 v[56:57], v32 offset:0
ds_read_b64_tr_b16 v[58:59], v32 offset:512
ds_read_b64_tr_b16 v[60:61], v33 offset:0
ds_read_b64_tr_b16 v[62:63], v33 offset:512
s_waitcnt lgkmcnt(0)
v_mfma_f32_16x16x32_bf16 a[0:3], v[56:59], v[40:43], a[0:3]
v_add_u32 v23, 98304, v22
v_mfma_f32_16x16x32_bf16 a[8:11], v[56:59], v[44:47], a[8:11]
v_add_u32 v32, 98304, v25
v_mfma_f32_16x16x32_bf16 a[16:19], v[56:59], v[48:51], a[16:19]
v_add_u32 v33, 98304, v26
ds_read_b128 v[84:87], v23 offset:0
v_mfma_f32_16x16x32_bf16 a[24:27], v[56:59], v[52:55], a[24:27]
ds_read_b128 v[88:91], v23 offset:2048
v_mfma_f32_16x16x32_bf16 a[4:7], v[60:63], v[40:43], a[4:7]
ds_read_b128 v[92:95], v23 offset:4096
v_mfma_f32_16x16x32_bf16 a[12:15], v[60:63], v[44:47], a[12:15]
ds_read_b128 v[96:99], v23 offset:6144
ds_read_b64_tr_b16 v[100:101], v32 offset:4096
v_mfma_f32_16x16x32_bf16 a[20:23], v[60:63], v[48:51], a[20:23]
ds_read_b64_tr_b16 v[102:103], v32 offset:4608
v_mfma_f32_16x16x32_bf16 a[28:31], v[60:63], v[52:55], a[28:31]
ds_read_b64_tr_b16 v[104:105], v33 offset:4096
ds_read_b64_tr_b16 v[106:107], v33 offset:4608
s_waitcnt vmcnt(12)
s_barrier
s_waitcnt lgkmcnt(0)
v_mfma_f32_16x16x32_bf16 a[0:3], v[100:103], v[84:87], a[0:3]
s_mov_b32 s16, 1024
s_mov_b32 s17, 1048576
v_add_u32 v10, 4294961152, v10
v_add_u32 v11, 4294961152, v11
v_mfma_f32_16x16x32_bf16 a[8:11], v[100:103], v[88:91], a[8:11]
v_add_u32 v12, 4294961152, v12
v_add_u32 v13, 4294961152, v13
s_add_u32 m0, s27, 73728
s_nop 0
v_mfma_f32_16x16x32_bf16 a[16:19], v[100:103], v[92:95], a[16:19]
buffer_load_dwordx4 v10, s[4:7], s16 offen lds
s_add_u32 m0, s27, 74752
s_nop 0
buffer_load_dwordx4 v11, s[4:7], s16 offen lds
s_add_u32 m0, s27, 75776
v_mfma_f32_16x16x32_bf16 a[24:27], v[100:103], v[96:99], a[24:27]
s_nop 0
buffer_load_dwordx4 v12, s[4:7], s16 offen lds
s_add_u32 m0, s27, 76800
s_nop 0
v_mfma_f32_16x16x32_bf16 a[4:7], v[104:107], v[84:87], a[4:7]
buffer_load_dwordx4 v13, s[4:7], s16 offen lds
s_add_u32 m0, s28, 90112
s_nop 0
buffer_load_dwordx4 v14, s[8:11], s17 offen lds
v_mfma_f32_16x16x32_bf16 a[12:15], v[104:107], v[88:91], a[12:15]
s_add_u32 m0, s28, 91136
s_nop 0
buffer_load_dwordx4 v15, s[8:11], s17 offen lds
v_add_u32 v23, 0, v21
v_add_u32 v32, 0, v25
v_mfma_f32_16x16x32_bf16 a[20:23], v[104:107], v[92:95], a[20:23]
v_add_u32 v33, 0, v26
ds_read_b128 v[40:43], v23 offset:0
ds_read_b128 v[44:47], v23 offset:2048
ds_read_b128 v[48:51], v23 offset:4096
v_mfma_f32_16x16x32_bf16 a[28:31], v[104:107], v[96:99], a[28:31]
ds_read_b128 v[52:55], v23 offset:6144
ds_read_b64_tr_b16 v[56:57], v32 offset:0
ds_read_b64_tr_b16 v[58:59], v32 offset:512
ds_read_b64_tr_b16 v[60:61], v33 offset:0
ds_read_b64_tr_b16 v[62:63], v33 offset:512
s_waitcnt lgkmcnt(0)
v_mfma_f32_16x16x32_bf16 a[0:3], v[56:59], v[40:43], a[0:3]
v_add_u32 v23, 0, v22
v_mfma_f32_16x16x32_bf16 a[8:11], v[56:59], v[44:47], a[8:11]
v_add_u32 v32, 0, v25
v_mfma_f32_16x16x32_bf16 a[16:19], v[56:59], v[48:51], a[16:19]
v_add_u32 v33, 0, v26
ds_read_b128 v[84:87], v23 offset:0
v_mfma_f32_16x16x32_bf16 a[24:27], v[56:59], v[52:55], a[24:27]
ds_read_b128 v[88:91], v23 offset:2048
v_mfma_f32_16x16x32_bf16 a[4:7], v[60:63], v[40:43], a[4:7]
ds_read_b128 v[92:95], v23 offset:4096
v_mfma_f32_16x16x32_bf16 a[12:15], v[60:63], v[44:47], a[12:15]
ds_read_b128 v[96:99], v23 offset:6144
ds_read_b64_tr_b16 v[100:101], v32 offset:4096
v_mfma_f32_16x16x32_bf16 a[20:23], v[60:63], v[48:51], a[20:23]
ds_read_b64_tr_b16 v[102:103], v32 offset:4608
v_mfma_f32_16x16x32_bf16 a[28:31], v[60:63], v[52:55], a[28:31]
ds_read_b64_tr_b16 v[104:105], v33 offset:4096
ds_read_b64_tr_b16 v[106:107], v33 offset:4608
s_waitcnt vmcnt(12)
s_barrier
s_waitcnt lgkmcnt(0)
v_mfma_f32_16x16x32_bf16 a[0:3], v[100:103], v[84:87], a[0:3]
s_mov_b32 s16, 1152
s_mov_b32 s17, 1179648
s_add_u32 m0, s27, 98304
v_mfma_f32_16x16x32_bf16 a[8:11], v[100:103], v[88:91], a[8:11]
s_nop 0
buffer_load_dwordx4 v10, s[4:7], s16 offen lds
s_add_u32 m0, s27, 99328
s_nop 0
v_mfma_f32_16x16x32_bf16 a[16:19], v[100:103], v[92:95], a[16:19]
buffer_load_dwordx4 v11, s[4:7], s16 offen lds
s_add_u32 m0, s27, 100352
s_nop 0
buffer_load_dwordx4 v12, s[4:7], s16 offen lds
v_mfma_f32_16x16x32_bf16 a[24:27], v[100:103], v[96:99], a[24:27]
s_add_u32 m0, s27, 101376
s_nop 0
buffer_load_dwordx4 v13, s[4:7], s16 offen lds
s_add_u32 m0, s28, 114688
v_mfma_f32_16x16x32_bf16 a[4:7], v[104:107], v[84:87], a[4:7]
s_nop 0
buffer_load_dwordx4 v14, s[8:11], s17 offen lds
s_add_u32 m0, s28, 115712
s_nop 0
v_mfma_f32_16x16x32_bf16 a[12:15], v[104:107], v[88:91], a[12:15]
buffer_load_dwordx4 v15, s[8:11], s17 offen lds
v_add_u32 v23, 24576, v21
v_add_u32 v32, 24576, v25
v_add_u32 v33, 24576, v26
v_mfma_f32_16x16x32_bf16 a[20:23], v[104:107], v[92:95], a[20:23]
ds_read_b128 v[40:43], v23 offset:0
ds_read_b128 v[44:47], v23 offset:2048
ds_read_b128 v[48:51], v23 offset:4096
ds_read_b128 v[52:55], v23 offset:6144
v_mfma_f32_16x16x32_bf16 a[28:31], v[104:107], v[96:99], a[28:31]
ds_read_b64_tr_b16 v[56:57], v32 offset:0
ds_read_b64_tr_b16 v[58:59], v32 offset:512
ds_read_b64_tr_b16 v[60:61], v33 offset:0
ds_read_b64_tr_b16 v[62:63], v33 offset:512
s_waitcnt lgkmcnt(0)
v_mfma_f32_16x16x32_bf16 a[0:3], v[56:59], v[40:43], a[0:3]
v_add_u32 v23, 24576, v22
v_mfma_f32_16x16x32_bf16 a[8:11], v[56:59], v[44:47], a[8:11]
v_add_u32 v32, 24576, v25
v_mfma_f32_16x16x32_bf16 a[16:19], v[56:59], v[48:51], a[16:19]
v_add_u32 v33, 24576, v26
ds_read_b128 v[84:87], v23 offset:0
v_mfma_f32_16x16x32_bf16 a[24:27], v[56:59], v[52:55], a[24:27]
ds_read_b128 v[88:91], v23 offset:2048
v_mfma_f32_16x16x32_bf16 a[4:7], v[60:63], v[40:43], a[4:7]
ds_read_b128 v[92:95], v23 offset:4096
v_mfma_f32_16x16x32_bf16 a[12:15], v[60:63], v[44:47], a[12:15]
ds_read_b128 v[96:99], v23 offset:6144
ds_read_b64_tr_b16 v[100:101], v32 offset:4096
v_mfma_f32_16x16x32_bf16 a[20:23], v[60:63], v[48:51], a[20:23]
ds_read_b64_tr_b16 v[102:103], v32 offset:4608
v_mfma_f32_16x16x32_bf16 a[28:31], v[60:63], v[52:55], a[28:31]
ds_read_b64_tr_b16 v[104:105], v33 offset:4096
ds_read_b64_tr_b16 v[106:107], v33 offset:4608
s_waitcnt vmcnt(12)
s_barrier
s_waitcnt lgkmcnt(0)
v_mfma_f32_16x16x32_bf16 a[0:3], v[100:103], v[84:87], a[0:3]
s_mov_b32 s16, 1280
s_mov_b32 s17, 1310720
s_add_u32 m0, s27, 0
v_mfma_f32_16x16x32_bf16 a[8:11], v[100:103], v[88:91], a[8:11]
s_nop 0
buffer_load_dwordx4 v10, s[4:7], s16 offen lds
s_add_u32 m0, s27, 1024
s_nop 0
v_mfma_f32_16x16x32_bf16 a[16:19], v[100:103], v[92:95], a[16:19]
buffer_load_dwordx4 v11, s[4:7], s16 offen lds
s_add_u32 m0, s27, 2048
s_nop 0
buffer_load_dwordx4 v12, s[4:7], s16 offen lds
v_mfma_f32_16x16x32_bf16 a[24:27], v[100:103], v[96:99], a[24:27]
s_add_u32 m0, s27, 3072
s_nop 0
buffer_load_dwordx4 v13, s[4:7], s16 offen lds
s_add_u32 m0, s28, 16384
v_mfma_f32_16x16x32_bf16 a[4:7], v[104:107], v[84:87], a[4:7]
s_nop 0
buffer_load_dwordx4 v14, s[8:11], s17 offen lds
s_add_u32 m0, s28, 17408
s_nop 0
v_mfma_f32_16x16x32_bf16 a[12:15], v[104:107], v[88:91], a[12:15]
buffer_load_dwordx4 v15, s[8:11], s17 offen lds
v_add_u32 v23, 49152, v21
v_add_u32 v32, 49152, v25
v_add_u32 v33, 49152, v26
v_mfma_f32_16x16x32_bf16 a[20:23], v[104:107], v[92:95], a[20:23]
ds_read_b128 v[40:43], v23 offset:0
ds_read_b128 v[44:47], v23 offset:2048
ds_read_b128 v[48:51], v23 offset:4096
ds_read_b128 v[52:55], v23 offset:6144
v_mfma_f32_16x16x32_bf16 a[28:31], v[104:107], v[96:99], a[28:31]
ds_read_b64_tr_b16 v[56:57], v32 offset:0
ds_read_b64_tr_b16 v[58:59], v32 offset:512
ds_read_b64_tr_b16 v[60:61], v33 offset:0
ds_read_b64_tr_b16 v[62:63], v33 offset:512
s_waitcnt lgkmcnt(0)
v_mfma_f32_16x16x32_bf16 a[0:3], v[56:59], v[40:43], a[0:3]
v_add_u32 v23, 49152, v22
v_mfma_f32_16x16x32_bf16 a[8:11], v[56:59], v[44:47], a[8:11]
v_add_u32 v32, 49152, v25
v_mfma_f32_16x16x32_bf16 a[16:19], v[56:59], v[48:51], a[16:19]
v_add_u32 v33, 49152, v26
ds_read_b128 v[84:87], v23 offset:0
v_mfma_f32_16x16x32_bf16 a[24:27], v[56:59], v[52:55], a[24:27]
ds_read_b128 v[88:91], v23 offset:2048
v_mfma_f32_16x16x32_bf16 a[4:7], v[60:63], v[40:43], a[4:7]
ds_read_b128 v[92:95], v23 offset:4096
v_mfma_f32_16x16x32_bf16 a[12:15], v[60:63], v[44:47], a[12:15]
ds_read_b128 v[96:99], v23 offset:6144
ds_read_b64_tr_b16 v[100:101], v32 offset:4096
v_mfma_f32_16x16x32_bf16 a[20:23], v[60:63], v[48:51], a[20:23]
ds_read_b64_tr_b16 v[102:103], v32 offset:4608
v_mfma_f32_16x16x32_bf16 a[28:31], v[60:63], v[52:55], a[28:31]
ds_read_b64_tr_b16 v[104:105], v33 offset:4096
ds_read_b64_tr_b16 v[106:107], v33 offset:4608
s_waitcnt vmcnt(12)
s_barrier
s_waitcnt lgkmcnt(0)
v_mfma_f32_16x16x32_bf16 a[0:3], v[100:103], v[84:87], a[0:3]
s_mov_b32 s16, 1408
s_mov_b32 s17, 1441792
s_add_u32 m0, s27, 24576
v_mfma_f32_16x16x32_bf16 a[8:11], v[100:103], v[88:91], a[8:11]
s_nop 0
buffer_load_dwordx4 v10, s[4:7], s16 offen lds
s_add_u32 m0, s27, 25600
s_nop 0
v_mfma_f32_16x16x32_bf16 a[16:19], v[100:103], v[92:95], a[16:19]
buffer_load_dwordx4 v11, s[4:7], s16 offen lds
s_add_u32 m0, s27, 26624
s_nop 0
buffer_load_dwordx4 v12, s[4:7], s16 offen lds
v_mfma_f32_16x16x32_bf16 a[24:27], v[100:103], v[96:99], a[24:27]
s_add_u32 m0, s27, 27648
s_nop 0
buffer_load_dwordx4 v13, s[4:7], s16 offen lds
s_add_u32 m0, s28, 40960
v_mfma_f32_16x16x32_bf16 a[4:7], v[104:107], v[84:87], a[4:7]
s_nop 0
buffer_load_dwordx4 v14, s[8:11], s17 offen lds
s_add_u32 m0, s28, 41984
s_nop 0
v_mfma_f32_16x16x32_bf16 a[12:15], v[104:107], v[88:91], a[12:15]
buffer_load_dwordx4 v15, s[8:11], s17 offen lds
v_add_u32 v23, 73728, v21
v_add_u32 v32, 73728, v25
v_add_u32 v33, 73728, v26
v_mfma_f32_16x16x32_bf16 a[20:23], v[104:107], v[92:95], a[20:23]
ds_read_b128 v[40:43], v23 offset:0
ds_read_b128 v[44:47], v23 offset:2048
ds_read_b128 v[48:51], v23 offset:4096
ds_read_b128 v[52:55], v23 offset:6144
v_mfma_f32_16x16x32_bf16 a[28:31], v[104:107], v[96:99], a[28:31]
ds_read_b64_tr_b16 v[56:57], v32 offset:0
ds_read_b64_tr_b16 v[58:59], v32 offset:512
ds_read_b64_tr_b16 v[60:61], v33 offset:0
ds_read_b64_tr_b16 v[62:63], v33 offset:512
s_waitcnt lgkmcnt(0)
v_mfma_f32_16x16x32_bf16 a[0:3], v[56:59], v[40:43], a[0:3]
v_add_u32 v23, 73728, v22
v_mfma_f32_16x16x32_bf16 a[8:11], v[56:59], v[44:47], a[8:11]
v_add_u32 v32, 73728, v25
v_mfma_f32_16x16x32_bf16 a[16:19], v[56:59], v[48:51], a[16:19]
v_add_u32 v33, 73728, v26
ds_read_b128 v[84:87], v23 offset:0
v_mfma_f32_16x16x32_bf16 a[24:27], v[56:59], v[52:55], a[24:27]
ds_read_b128 v[88:91], v23 offset:2048
v_mfma_f32_16x16x32_bf16 a[4:7], v[60:63], v[40:43], a[4:7]
ds_read_b128 v[92:95], v23 offset:4096
v_mfma_f32_16x16x32_bf16 a[12:15], v[60:63], v[44:47], a[12:15]
ds_read_b128 v[96:99], v23 offset:6144
ds_read_b64_tr_b16 v[100:101], v32 offset:4096
v_mfma_f32_16x16x32_bf16 a[20:23], v[60:63], v[48:51], a[20:23]
ds_read_b64_tr_b16 v[102:103], v32 offset:4608
v_mfma_f32_16x16x32_bf16 a[28:31], v[60:63], v[52:55], a[28:31]
ds_read_b64_tr_b16 v[104:105], v33 offset:4096
ds_read_b64_tr_b16 v[106:107], v33 offset:4608
s_waitcnt vmcnt(12)
s_barrier
s_waitcnt lgkmcnt(0)
v_mfma_f32_16x16x32_bf16 a[0:3], v[100:103], v[84:87], a[0:3]
s_mov_b32 s16, 1536
s_mov_b32 s17, 1572864
v_add_u32 v10, 8192, v10
v_add_u32 v11, 8192, v11
v_mfma_f32_16x16x32_bf16 a[8:11], v[100:103], v[88:91], a[8:11]
v_add_u32 v12, 8192, v12
v_add_u32 v13, 8192, v13
s_add_u32 m0, s27, 49152
s_nop 0
v_mfma_f32_16x16x32_bf16 a[16:19], v[100:103], v[92:95], a[16:19]
buffer_load_dwordx4 v10, s[4:7], s16 offen lds
s_add_u32 m0, s27, 50176
s_nop 0
buffer_load_dwordx4 v11, s[4:7], s16 offen lds
s_add_u32 m0, s27, 51200
v_mfma_f32_16x16x32_bf16 a[24:27], v[100:103], v[96:99], a[24:27]
s_nop 0
buffer_load_dwordx4 v12, s[4:7], s16 offen lds
s_add_u32 m0, s27, 52224
s_nop 0
v_mfma_f32_16x16x32_bf16 a[4:7], v[104:107], v[84:87], a[4:7]
buffer_load_dwordx4 v13, s[4:7], s16 offen lds
s_add_u32 m0, s28, 65536
s_nop 0
buffer_load_dwordx4 v14, s[8:11], s17 offen lds
v_mfma_f32_16x16x32_bf16 a[12:15], v[104:107], v[88:91], a[12:15]
s_add_u32 m0, s28, 66560
s_nop 0
buffer_load_dwordx4 v15, s[8:11], s17 offen lds
v_add_u32 v23, 98304, v21
v_add_u32 v32, 98304, v25
v_mfma_f32_16x16x32_bf16 a[20:23], v[104:107], v[92:95], a[20:23]
v_add_u32 v33, 98304, v26
ds_read_b128 v[40:43], v23 offset:0
ds_read_b128 v[44:47], v23 offset:2048
ds_read_b128 v[48:51], v23 offset:4096
v_mfma_f32_16x16x32_bf16 a[28:31], v[104:107], v[96:99], a[28:31]
ds_read_b128 v[52:55], v23 offset:6144
ds_read_b64_tr_b16 v[56:57], v32 offset:0
ds_read_b64_tr_b16 v[58:59], v32 offset:512
ds_read_b64_tr_b16 v[60:61], v33 offset:0
ds_read_b64_tr_b16 v[62:63], v33 offset:512
s_waitcnt lgkmcnt(0)
v_mfma_f32_16x16x32_bf16 a[0:3], v[56:59], v[40:43], a[0:3]
v_add_u32 v23, 98304, v22
v_mfma_f32_16x16x32_bf16 a[8:11], v[56:59], v[44:47], a[8:11]
v_add_u32 v32, 98304, v25
v_mfma_f32_16x16x32_bf16 a[16:19], v[56:59], v[48:51], a[16:19]
v_add_u32 v33, 98304, v26
ds_read_b128 v[84:87], v23 offset:0
v_mfma_f32_16x16x32_bf16 a[24:27], v[56:59], v[52:55], a[24:27]
ds_read_b128 v[88:91], v23 offset:2048
v_mfma_f32_16x16x32_bf16 a[4:7], v[60:63], v[40:43], a[4:7]
ds_read_b128 v[92:95], v23 offset:4096
v_mfma_f32_16x16x32_bf16 a[12:15], v[60:63], v[44:47], a[12:15]
ds_read_b128 v[96:99], v23 offset:6144
ds_read_b64_tr_b16 v[100:101], v32 offset:4096
v_mfma_f32_16x16x32_bf16 a[20:23], v[60:63], v[48:51], a[20:23]
ds_read_b64_tr_b16 v[102:103], v32 offset:4608
v_mfma_f32_16x16x32_bf16 a[28:31], v[60:63], v[52:55], a[28:31]
ds_read_b64_tr_b16 v[104:105], v33 offset:4096
ds_read_b64_tr_b16 v[106:107], v33 offset:4608
s_waitcnt vmcnt(12)
s_barrier
s_waitcnt lgkmcnt(0)
v_mfma_f32_16x16x32_bf16 a[0:3], v[100:103], v[84:87], a[0:3]
s_mov_b32 s16, 1664
s_mov_b32 s17, 1703936
s_add_u32 m0, s27, 73728
v_mfma_f32_16x16x32_bf16 a[8:11], v[100:103], v[88:91], a[8:11]
s_nop 0
buffer_load_dwordx4 v10, s[4:7], s16 offen lds
s_add_u32 m0, s27, 74752
s_nop 0
v_mfma_f32_16x16x32_bf16 a[16:19], v[100:103], v[92:95], a[16:19]
buffer_load_dwordx4 v11, s[4:7], s16 offen lds
s_add_u32 m0, s27, 75776
s_nop 0
buffer_load_dwordx4 v12, s[4:7], s16 offen lds
v_mfma_f32_16x16x32_bf16 a[24:27], v[100:103], v[96:99], a[24:27]
s_add_u32 m0, s27, 76800
s_nop 0
buffer_load_dwordx4 v13, s[4:7], s16 offen lds
s_add_u32 m0, s28, 90112
v_mfma_f32_16x16x32_bf16 a[4:7], v[104:107], v[84:87], a[4:7]
s_nop 0
buffer_load_dwordx4 v14, s[8:11], s17 offen lds
s_add_u32 m0, s28, 91136
s_nop 0
v_mfma_f32_16x16x32_bf16 a[12:15], v[104:107], v[88:91], a[12:15]
buffer_load_dwordx4 v15, s[8:11], s17 offen lds
v_add_u32 v23, 0, v21
v_add_u32 v32, 0, v25
v_add_u32 v33, 0, v26
v_mfma_f32_16x16x32_bf16 a[20:23], v[104:107], v[92:95], a[20:23]
ds_read_b128 v[40:43], v23 offset:0
ds_read_b128 v[44:47], v23 offset:2048
ds_read_b128 v[48:51], v23 offset:4096
ds_read_b128 v[52:55], v23 offset:6144
v_mfma_f32_16x16x32_bf16 a[28:31], v[104:107], v[96:99], a[28:31]
ds_read_b64_tr_b16 v[56:57], v32 offset:0
ds_read_b64_tr_b16 v[58:59], v32 offset:512
ds_read_b64_tr_b16 v[60:61], v33 offset:0
ds_read_b64_tr_b16 v[62:63], v33 offset:512
s_waitcnt lgkmcnt(0)
v_mfma_f32_16x16x32_bf16 a[0:3], v[56:59], v[40:43], a[0:3]
v_add_u32 v23, 0, v22
v_mfma_f32_16x16x32_bf16 a[8:11], v[56:59], v[44:47], a[8:11]
v_add_u32 v32, 0, v25
v_mfma_f32_16x16x32_bf16 a[16:19], v[56:59], v[48:51], a[16:19]
v_add_u32 v33, 0, v26
ds_read_b128 v[84:87], v23 offset:0
v_mfma_f32_16x16x32_bf16 a[24:27], v[56:59], v[52:55], a[24:27]
ds_read_b128 v[88:91], v23 offset:2048
v_mfma_f32_16x16x32_bf16 a[4:7], v[60:63], v[40:43], a[4:7]
ds_read_b128 v[92:95], v23 offset:4096
v_mfma_f32_16x16x32_bf16 a[12:15], v[60:63], v[44:47], a[12:15]
ds_read_b128 v[96:99], v23 offset:6144
ds_read_b64_tr_b16 v[100:101], v32 offset:4096
v_mfma_f32_16x16x32_bf16 a[20:23], v[60:63], v[48:51], a[20:23]
ds_read_b64_tr_b16 v[102:103], v32 offset:4608
v_mfma_f32_16x16x32_bf16 a[28:31], v[60:63], v[52:55], a[28:31]
ds_read_b64_tr_b16 v[104:105], v33 offset:4096
ds_read_b64_tr_b16 v[106:107], v33 offset:4608
s_waitcnt vmcnt(12)
s_barrier
s_waitcnt lgkmcnt(0)
v_mfma_f32_16x16x32_bf16 a[0:3], v[100:103], v[84:87], a[0:3]
s_mov_b32 s16, 1792
s_mov_b32 s17, 1835008
s_add_u32 m0, s27, 98304
v_mfma_f32_16x16x32_bf16 a[8:11], v[100:103], v[88:91], a[8:11]
s_nop 0
buffer_load_dwordx4 v10, s[4:7], s16 offen lds
s_add_u32 m0, s27, 99328
s_nop 0
v_mfma_f32_16x16x32_bf16 a[16:19], v[100:103], v[92:95], a[16:19]
buffer_load_dwordx4 v11, s[4:7], s16 offen lds
s_add_u32 m0, s27, 100352
s_nop 0
buffer_load_dwordx4 v12, s[4:7], s16 offen lds
v_mfma_f32_16x16x32_bf16 a[24:27], v[100:103], v[96:99], a[24:27]
s_add_u32 m0, s27, 101376
s_nop 0
buffer_load_dwordx4 v13, s[4:7], s16 offen lds
s_add_u32 m0, s28, 114688
v_mfma_f32_16x16x32_bf16 a[4:7], v[104:107], v[84:87], a[4:7]
s_nop 0
buffer_load_dwordx4 v14, s[8:11], s17 offen lds
s_add_u32 m0, s28, 115712
s_nop 0
v_mfma_f32_16x16x32_bf16 a[12:15], v[104:107], v[88:91], a[12:15]
buffer_load_dwordx4 v15, s[8:11], s17 offen lds
v_add_u32 v23, 24576, v21
v_add_u32 v32, 24576, v25
v_add_u32 v33, 24576, v26
v_mfma_f32_16x16x32_bf16 a[20:23], v[104:107], v[92:95], a[20:23]
ds_read_b128 v[40:43], v23 offset:0
ds_read_b128 v[44:47], v23 offset:2048
ds_read_b128 v[48:51], v23 offset:4096
ds_read_b128 v[52:55], v23 offset:6144
v_mfma_f32_16x16x32_bf16 a[28:31], v[104:107], v[96:99], a[28:31]
ds_read_b64_tr_b16 v[56:57], v32 offset:0
ds_read_b64_tr_b16 v[58:59], v32 offset:512
ds_read_b64_tr_b16 v[60:61], v33 offset:0
ds_read_b64_tr_b16 v[62:63], v33 offset:512
s_waitcnt lgkmcnt(0)
v_mfma_f32_16x16x32_bf16 a[0:3], v[56:59], v[40:43], a[0:3]
v_add_u32 v23, 24576, v22
v_mfma_f32_16x16x32_bf16 a[8:11], v[56:59], v[44:47], a[8:11]
v_add_u32 v32, 24576, v25
v_mfma_f32_16x16x32_bf16 a[16:19], v[56:59], v[48:51], a[16:19]
v_add_u32 v33, 24576, v26
ds_read_b128 v[84:87], v23 offset:0
v_mfma_f32_16x16x32_bf16 a[24:27], v[56:59], v[52:55], a[24:27]
ds_read_b128 v[88:91], v23 offset:2048
v_mfma_f32_16x16x32_bf16 a[4:7], v[60:63], v[40:43], a[4:7]
ds_read_b128 v[92:95], v23 offset:4096
v_mfma_f32_16x16x32_bf16 a[12:15], v[60:63], v[44:47], a[12:15]
ds_read_b128 v[96:99], v23 offset:6144
ds_read_b64_tr_b16 v[100:101], v32 offset:4096
v_mfma_f32_16x16x32_bf16 a[20:23], v[60:63], v[48:51], a[20:23]
ds_read_b64_tr_b16 v[102:103], v32 offset:4608
v_mfma_f32_16x16x32_bf16 a[28:31], v[60:63], v[52:55], a[28:31]
ds_read_b64_tr_b16 v[104:105], v33 offset:4096
ds_read_b64_tr_b16 v[106:107], v33 offset:4608
s_waitcnt vmcnt(12)
s_barrier
s_waitcnt lgkmcnt(0)
v_mfma_f32_16x16x32_bf16 a[0:3], v[100:103], v[84:87], a[0:3]
s_mov_b32 s16, 1920
s_mov_b32 s17, 1966080
s_add_u32 m0, s27, 0
v_mfma_f32_16x16x32_bf16 a[8:11], v[100:103], v[88:91], a[8:11]
s_nop 0
buffer_load_dwordx4 v10, s[4:7], s16 offen lds
s_add_u32 m0, s27, 1024
s_nop 0
v_mfma_f32_16x16x32_bf16 a[16:19], v[100:103], v[92:95], a[16:19]
buffer_load_dwordx4 v11, s[4:7], s16 offen lds
s_add_u32 m0, s27, 2048
s_nop 0
buffer_load_dwordx4 v12, s[4:7], s16 offen lds
v_mfma_f32_16x16x32_bf16 a[24:27], v[100:103], v[96:99], a[24:27]
s_add_u32 m0, s27, 3072
s_nop 0
buffer_load_dwordx4 v13, s[4:7], s16 offen lds
s_add_u32 m0, s28, 16384
v_mfma_f32_16x16x32_bf16 a[4:7], v[104:107], v[84:87], a[4:7]
s_nop 0
buffer_load_dwordx4 v14, s[8:11], s17 offen lds
s_add_u32 m0, s28, 17408
s_nop 0
v_mfma_f32_16x16x32_bf16 a[12:15], v[104:107], v[88:91], a[12:15]
buffer_load_dwordx4 v15, s[8:11], s17 offen lds
v_add_u32 v23, 49152, v21
v_add_u32 v32, 49152, v25
v_add_u32 v33, 49152, v26
v_mfma_f32_16x16x32_bf16 a[20:23], v[104:107], v[92:95], a[20:23]
ds_read_b128 v[40:43], v23 offset:0
ds_read_b128 v[44:47], v23 offset:2048
ds_read_b128 v[48:51], v23 offset:4096
ds_read_b128 v[52:55], v23 offset:6144
v_mfma_f32_16x16x32_bf16 a[28:31], v[104:107], v[96:99], a[28:31]
ds_read_b64_tr_b16 v[56:57], v32 offset:0
ds_read_b64_tr_b16 v[58:59], v32 offset:512
ds_read_b64_tr_b16 v[60:61], v33 offset:0
ds_read_b64_tr_b16 v[62:63], v33 offset:512
s_waitcnt lgkmcnt(0)
v_mfma_f32_16x16x32_bf16 a[0:3], v[56:59], v[40:43], a[0:3]
v_add_u32 v23, 49152, v22
v_mfma_f32_16x16x32_bf16 a[8:11], v[56:59], v[44:47], a[8:11]
v_add_u32 v32, 49152, v25
v_mfma_f32_16x16x32_bf16 a[16:19], v[56:59], v[48:51], a[16:19]
v_add_u32 v33, 49152, v26
ds_read_b128 v[84:87], v23 offset:0
v_mfma_f32_16x16x32_bf16 a[24:27], v[56:59], v[52:55], a[24:27]
ds_read_b128 v[88:91], v23 offset:2048
v_mfma_f32_16x16x32_bf16 a[4:7], v[60:63], v[40:43], a[4:7]
ds_read_b128 v[92:95], v23 offset:4096
v_mfma_f32_16x16x32_bf16 a[12:15], v[60:63], v[44:47], a[12:15]
ds_read_b128 v[96:99], v23 offset:6144
ds_read_b64_tr_b16 v[100:101], v32 offset:4096
v_mfma_f32_16x16x32_bf16 a[20:23], v[60:63], v[48:51], a[20:23]
ds_read_b64_tr_b16 v[102:103], v32 offset:4608
v_mfma_f32_16x16x32_bf16 a[28:31], v[60:63], v[52:55], a[28:31]
ds_read_b64_tr_b16 v[104:105], v33 offset:4096
ds_read_b64_tr_b16 v[106:107], v33 offset:4608
s_waitcnt vmcnt(12)
s_barrier
s_waitcnt lgkmcnt(0)
v_mfma_f32_16x16x32_bf16 a[0:3], v[100:103], v[84:87], a[0:3]
v_add_u32 v23, 73728, v21
v_mfma_f32_16x16x32_bf16 a[8:11], v[100:103], v[88:91], a[8:11]
v_add_u32 v32, 73728, v25
v_mfma_f32_16x16x32_bf16 a[16:19], v[100:103], v[92:95], a[16:19]
v_add_u32 v33, 73728, v26
ds_read_b128 v[40:43], v23 offset:0
v_mfma_f32_16x16x32_bf16 a[24:27], v[100:103], v[96:99], a[24:27]
ds_read_b128 v[44:47], v23 offset:2048
v_mfma_f32_16x16x32_bf16 a[4:7], v[104:107], v[84:87], a[4:7]
ds_read_b128 v[48:51], v23 offset:4096
v_mfma_f32_16x16x32_bf16 a[12:15], v[104:107], v[88:91], a[12:15]
ds_read_b128 v[52:55], v23 offset:6144
ds_read_b64_tr_b16 v[56:57], v32 offset:0
v_mfma_f32_16x16x32_bf16 a[20:23], v[104:107], v[92:95], a[20:23]
ds_read_b64_tr_b16 v[58:59], v32 offset:512
v_mfma_f32_16x16x32_bf16 a[28:31], v[104:107], v[96:99], a[28:31]
ds_read_b64_tr_b16 v[60:61], v33 offset:0
ds_read_b64_tr_b16 v[62:63], v33 offset:512
s_waitcnt lgkmcnt(0)
v_mfma_f32_16x16x32_bf16 a[0:3], v[56:59], v[40:43], a[0:3]
v_add_u32 v23, 73728, v22
v_mfma_f32_16x16x32_bf16 a[8:11], v[56:59], v[44:47], a[8:11]
v_add_u32 v32, 73728, v25
v_mfma_f32_16x16x32_bf16 a[16:19], v[56:59], v[48:51], a[16:19]
v_add_u32 v33, 73728, v26
ds_read_b128 v[84:87], v23 offset:0
v_mfma_f32_16x16x32_bf16 a[24:27], v[56:59], v[52:55], a[24:27]
ds_read_b128 v[88:91], v23 offset:2048
v_mfma_f32_16x16x32_bf16 a[4:7], v[60:63], v[40:43], a[4:7]
ds_read_b128 v[92:95], v23 offset:4096
v_mfma_f32_16x16x32_bf16 a[12:15], v[60:63], v[44:47], a[12:15]
ds_read_b128 v[96:99], v23 offset:6144
ds_read_b64_tr_b16 v[100:101], v32 offset:4096
v_mfma_f32_16x16x32_bf16 a[20:23], v[60:63], v[48:51], a[20:23]
ds_read_b64_tr_b16 v[102:103], v32 offset:4608
v_mfma_f32_16x16x32_bf16 a[28:31], v[60:63], v[52:55], a[28:31]
ds_read_b64_tr_b16 v[104:105], v33 offset:4096
ds_read_b64_tr_b16 v[106:107], v33 offset:4608
s_waitcnt vmcnt(6)
s_barrier
s_waitcnt lgkmcnt(0)
v_mfma_f32_16x16x32_bf16 a[0:3], v[100:103], v[84:87], a[0:3]
v_add_u32 v23, 98304, v21
v_mfma_f32_16x16x32_bf16 a[8:11], v[100:103], v[88:91], a[8:11]
v_add_u32 v32, 98304, v25
v_mfma_f32_16x16x32_bf16 a[16:19], v[100:103], v[92:95], a[16:19]
v_add_u32 v33, 98304, v26
ds_read_b128 v[40:43], v23 offset:0
v_mfma_f32_16x16x32_bf16 a[24:27], v[100:103], v[96:99], a[24:27]
ds_read_b128 v[44:47], v23 offset:2048
v_mfma_f32_16x16x32_bf16 a[4:7], v[104:107], v[84:87], a[4:7]
ds_read_b128 v[48:51], v23 offset:4096
v_mfma_f32_16x16x32_bf16 a[12:15], v[104:107], v[88:91], a[12:15]
ds_read_b128 v[52:55], v23 offset:6144
ds_read_b64_tr_b16 v[56:57], v32 offset:0
v_mfma_f32_16x16x32_bf16 a[20:23], v[104:107], v[92:95], a[20:23]
ds_read_b64_tr_b16 v[58:59], v32 offset:512
v_mfma_f32_16x16x32_bf16 a[28:31], v[104:107], v[96:99], a[28:31]
ds_read_b64_tr_b16 v[60:61], v33 offset:0
ds_read_b64_tr_b16 v[62:63], v33 offset:512
s_waitcnt lgkmcnt(0)
v_mfma_f32_16x16x32_bf16 a[0:3], v[56:59], v[40:43], a[0:3]
v_add_u32 v23, 98304, v22
v_mfma_f32_16x16x32_bf16 a[8:11], v[56:59], v[44:47], a[8:11]
v_add_u32 v32, 98304, v25
v_mfma_f32_16x16x32_bf16 a[16:19], v[56:59], v[48:51], a[16:19]
v_add_u32 v33, 98304, v26
ds_read_b128 v[84:87], v23 offset:0
v_mfma_f32_16x16x32_bf16 a[24:27], v[56:59], v[52:55], a[24:27]
ds_read_b128 v[88:91], v23 offset:2048
v_mfma_f32_16x16x32_bf16 a[4:7], v[60:63], v[40:43], a[4:7]
ds_read_b128 v[92:95], v23 offset:4096
v_mfma_f32_16x16x32_bf16 a[12:15], v[60:63], v[44:47], a[12:15]
ds_read_b128 v[96:99], v23 offset:6144
ds_read_b64_tr_b16 v[100:101], v32 offset:4096
v_mfma_f32_16x16x32_bf16 a[20:23], v[60:63], v[48:51], a[20:23]
ds_read_b64_tr_b16 v[102:103], v32 offset:4608
v_mfma_f32_16x16x32_bf16 a[28:31], v[60:63], v[52:55], a[28:31]
ds_read_b64_tr_b16 v[104:105], v33 offset:4096
ds_read_b64_tr_b16 v[106:107], v33 offset:4608
s_waitcnt vmcnt(0)
s_barrier
s_waitcnt lgkmcnt(0)
v_mfma_f32_16x16x32_bf16 a[0:3], v[100:103], v[84:87], a[0:3]
v_add_u32 v23, 0, v21
v_mfma_f32_16x16x32_bf16 a[8:11], v[100:103], v[88:91], a[8:11]
v_add_u32 v32, 0, v25
v_mfma_f32_16x16x32_bf16 a[16:19], v[100:103], v[92:95], a[16:19]
v_add_u32 v33, 0, v26
ds_read_b128 v[40:43], v23 offset:0
v_mfma_f32_16x16x32_bf16 a[24:27], v[100:103], v[96:99], a[24:27]
ds_read_b128 v[44:47], v23 offset:2048
v_mfma_f32_16x16x32_bf16 a[4:7], v[104:107], v[84:87], a[4:7]
ds_read_b128 v[48:51], v23 offset:4096
v_mfma_f32_16x16x32_bf16 a[12:15], v[104:107], v[88:91], a[12:15]
ds_read_b128 v[52:55], v23 offset:6144
ds_read_b64_tr_b16 v[56:57], v32 offset:0
v_mfma_f32_16x16x32_bf16 a[20:23], v[104:107], v[92:95], a[20:23]
ds_read_b64_tr_b16 v[58:59], v32 offset:512
v_mfma_f32_16x16x32_bf16 a[28:31], v[104:107], v[96:99], a[28:31]
ds_read_b64_tr_b16 v[60:61], v33 offset:0
ds_read_b64_tr_b16 v[62:63], v33 offset:512
s_waitcnt lgkmcnt(0)
v_mfma_f32_16x16x32_bf16 a[0:3], v[56:59], v[40:43], a[0:3]
v_add_u32 v23, 0, v22
v_mfma_f32_16x16x32_bf16 a[8:11], v[56:59], v[44:47], a[8:11]
v_add_u32 v32, 0, v25
v_mfma_f32_16x16x32_bf16 a[16:19], v[56:59], v[48:51], a[16:19]
v_add_u32 v33, 0, v26
ds_read_b128 v[84:87], v23 offset:0
v_mfma_f32_16x16x32_bf16 a[24:27], v[56:59], v[52:55], a[24:27]
ds_read_b128 v[88:91], v23 offset:2048
v_mfma_f32_16x16x32_bf16 a[4:7], v[60:63], v[40:43], a[4:7]
ds_read_b128 v[92:95], v23 offset:4096
v_mfma_f32_16x16x32_bf16 a[12:15], v[60:63], v[44:47], a[12:15]
ds_read_b128 v[96:99], v23 offset:6144
ds_read_b64_tr_b16 v[100:101], v32 offset:4096
v_mfma_f32_16x16x32_bf16 a[20:23], v[60:63], v[48:51], a[20:23]
ds_read_b64_tr_b16 v[102:103], v32 offset:4608
v_mfma_f32_16x16x32_bf16 a[28:31], v[60:63], v[52:55], a[28:31]
ds_read_b64_tr_b16 v[104:105], v33 offset:4096
ds_read_b64_tr_b16 v[106:107], v33 offset:4608
s_waitcnt vmcnt(0)
s_barrier
s_waitcnt lgkmcnt(0)
v_mfma_f32_16x16x32_bf16 a[0:3], v[100:103], v[84:87], a[0:3]
v_add_u32 v23, 24576, v21
v_mfma_f32_16x16x32_bf16 a[8:11], v[100:103], v[88:91], a[8:11]
v_add_u32 v32, 24576, v25
v_mfma_f32_16x16x32_bf16 a[16:19], v[100:103], v[92:95], a[16:19]
v_add_u32 v33, 24576, v26
ds_read_b128 v[40:43], v23 offset:0
v_mfma_f32_16x16x32_bf16 a[24:27], v[100:103], v[96:99], a[24:27]
ds_read_b128 v[44:47], v23 offset:2048
v_mfma_f32_16x16x32_bf16 a[4:7], v[104:107], v[84:87], a[4:7]
ds_read_b128 v[48:51], v23 offset:4096
v_mfma_f32_16x16x32_bf16 a[12:15], v[104:107], v[88:91], a[12:15]
ds_read_b128 v[52:55], v23 offset:6144
ds_read_b64_tr_b16 v[56:57], v32 offset:0
v_mfma_f32_16x16x32_bf16 a[20:23], v[104:107], v[92:95], a[20:23]
ds_read_b64_tr_b16 v[58:59], v32 offset:512
v_mfma_f32_16x16x32_bf16 a[28:31], v[104:107], v[96:99], a[28:31]
ds_read_b64_tr_b16 v[60:61], v33 offset:0
ds_read_b64_tr_b16 v[62:63], v33 offset:512
s_waitcnt vmcnt(0) lgkmcnt(0)
s_nop 15
s_nop 7
v_and_b32 v4, 15, v1
v_lshrrev_b32 v5, 4, v1
v_lshrrev_b32 v6, 1, v2
v_and_b32 v7, 1, v2
v_lshl_add_u32 v8, v6, 6, v4
s_lshl_b32 s25, s22, 7
v_add_u32 v9, s25, v8
v_xor_b32 v60, 16, v1
v_lshlrev_b32 v60, 2, v60
v_xor_b32 v61, 32, v1
v_lshlrev_b32 v61, 2, v61
v_lshlrev_b32 v3, 3, v8
v_add_u32 v3, 122880, v3
ds_read_b64 v[64:65], v3 offset:0
ds_read_b64 v[66:67], v3 offset:128
ds_read_b64 v[68:69], v3 offset:256
ds_read_b64 v[70:71], v3 offset:384
s_mul_i32 s25, s23, 64
v_mul_u32_u24 v10, 32, v7
v_add_u32 v10, s25, v10
v_lshl_add_u32 v10, v5, 2, v10
s_mov_b32 s26, 1024
v_mul_lo_u32 v11, v9, s26
v_add_u32 v11, v11, v10
v_lshlrev_b32 v11, 1, v11
s_load_dwordx2 s[12:13], s[0:1], 88
s_load_dwordx2 s[4:5], s[0:1], 88
s_load_dwordx2 s[16:17], s[0:1], 88
s_waitcnt lgkmcnt(0)
s_add_u32 s12, s12, 20971520
s_addc_u32 s13, s13, 0
s_mov_b32 s14, 4194304
s_mov_b32 s15, 0x00020000
s_mov_b32 s6, 4194304
s_mov_b32 s7, 0x00020000
s_add_u32 s16, s16, 53477376
s_addc_u32 s17, s17, 0
s_mov_b32 s18, 524288
s_mov_b32 s19, 0x00020000
v_add_u32 v13, 0, v11
buffer_load_dwordx2 v[72:73], v13, s[4:7], 0 offen offset:0
buffer_load_dwordx2 v[74:75], v13, s[4:7], 0 offen offset:32
v_mov_b32 v14, 0
v_mov_b32 v15, 0
s_waitcnt vmcnt(0) lgkmcnt(0)
v_accvgpr_read_b32 v104, a0
v_accvgpr_read_b32 v105, a1
v_accvgpr_read_b32 v106, a2
v_accvgpr_read_b32 v107, a3
v_cvt_pk_bf16_f32 v110, v104, v105
v_lshlrev_b32 v104, 16, v110
v_and_b32 v105, 0xffff0000, v110
v_cvt_pk_bf16_f32 v110, v106, v107
v_lshlrev_b32 v106, 16, v110
v_and_b32 v107, 0xffff0000, v110
v_lshlrev_b32 v112, 16, v72
v_and_b32 v113, 0xffff0000, v72
v_lshlrev_b32 v114, 16, v73
v_and_b32 v115, 0xffff0000, v73
v_sub_f32 v112, v112, v64
v_mul_f32 v112, v112, v65
v_sub_f32 v113, v113, v64
v_mul_f32 v113, v113, v65
v_sub_f32 v114, v114, v64
v_mul_f32 v114, v114, v65
v_sub_f32 v115, v115, v64
v_mul_f32 v115, v115, v65
v_cvt_pk_bf16_f32 v110, v112, v113
v_lshlrev_b32 v112, 16, v110
v_and_b32 v113, 0xffff0000, v110
v_cvt_pk_bf16_f32 v110, v114, v115
v_lshlrev_b32 v114, 16, v110
v_and_b32 v115, 0xffff0000, v110
v_add_f32 v104, v104, v112
v_add_f32 v105, v105, v113
v_add_f32 v106, v106, v114
v_add_f32 v107, v107, v115
v_cvt_pk_bf16_f32 v108, v104, v105
v_lshlrev_b32 v104, 16, v108
v_and_b32 v105, 0xffff0000, v108
v_cvt_pk_bf16_f32 v109, v106, v107
v_lshlrev_b32 v106, 16, v109
v_and_b32 v107, 0xffff0000, v109
v_add_f32 v14, v14, v104
v_fmac_f32 v15, v104, v104
v_add_f32 v14, v14, v105
v_fmac_f32 v15, v105, v105
v_add_f32 v14, v14, v106
v_fmac_f32 v15, v106, v106
v_add_f32 v14, v14, v107
v_fmac_f32 v15, v107, v107
buffer_store_dwordx2 v[108:109], v13, s[12:15], 0 offen offset:0
s_nop 1
v_accvgpr_read_b32 v104, a4
v_accvgpr_read_b32 v105, a5
v_accvgpr_read_b32 v106, a6
v_accvgpr_read_b32 v107, a7
v_cvt_pk_bf16_f32 v110, v104, v105
v_lshlrev_b32 v104, 16, v110
v_and_b32 v105, 0xffff0000, v110
v_cvt_pk_bf16_f32 v110, v106, v107
v_lshlrev_b32 v106, 16, v110
v_and_b32 v107, 0xffff0000, v110
v_lshlrev_b32 v112, 16, v74
v_and_b32 v113, 0xffff0000, v74
v_lshlrev_b32 v114, 16, v75
v_and_b32 v115, 0xffff0000, v75
v_sub_f32 v112, v112, v64
v_mul_f32 v112, v112, v65
v_sub_f32 v113, v113, v64
v_mul_f32 v113, v113, v65
v_sub_f32 v114, v114, v64
v_mul_f32 v114, v114, v65
v_sub_f32 v115, v115, v64
v_mul_f32 v115, v115, v65
v_cvt_pk_bf16_f32 v110, v112, v113
v_lshlrev_b32 v112, 16, v110
v_and_b32 v113, 0xffff0000, v110
v_cvt_pk_bf16_f32 v110, v114, v115
v_lshlrev_b32 v114, 16, v110
v_and_b32 v115, 0xffff0000, v110
v_add_f32 v104, v104, v112
v_add_f32 v105, v105, v113
v_add_f32 v106, v106, v114
v_add_f32 v107, v107, v115
v_cvt_pk_bf16_f32 v108, v104, v105
v_lshlrev_b32 v104, 16, v108
v_and_b32 v105, 0xffff0000, v108
v_cvt_pk_bf16_f32 v109, v106, v107
v_lshlrev_b32 v106, 16, v109
v_and_b32 v107, 0xffff0000, v109
v_add_f32 v14, v14, v104
v_fmac_f32 v15, v104, v104
v_add_f32 v14, v14, v105
v_fmac_f32 v15, v105, v105
v_add_f32 v14, v14, v106
v_fmac_f32 v15, v106, v106
v_add_f32 v14, v14, v107
v_fmac_f32 v15, v107, v107
buffer_store_dwordx2 v[108:109], v13, s[12:15], 0 offen offset:32
s_nop 1
ds_bpermute_b32 v16, v60, v14
ds_bpermute_b32 v17, v60, v15
s_waitcnt lgkmcnt(0)
v_add_f32 v14, v14, v16
v_add_f32 v15, v15, v17
ds_bpermute_b32 v16, v61, v14
ds_bpermute_b32 v17, v61, v15
s_waitcnt lgkmcnt(0)
v_add_f32 v14, v14, v16
v_add_f32 v15, v15, v17
v_add_u32 v16, 0, v9
v_lshlrev_b32 v16, 8, v16
s_lshl_b32 s25, s23, 4
v_add_u32 v16, s25, v16
v_lshl_add_u32 v16, v7, 3, v16
v_cmp_gt_u32 vcc, 16, v1
s_and_saveexec_b64 s[30:31], vcc
buffer_store_dwordx2 v[14:15], v16, s[16:19], 0 offen
s_mov_b64 exec, s[30:31]
s_nop 1
v_add_u32 v13, 32768, v11
buffer_load_dwordx2 v[72:73], v13, s[4:7], 0 offen offset:0
buffer_load_dwordx2 v[74:75], v13, s[4:7], 0 offen offset:32
v_mov_b32 v14, 0
v_mov_b32 v15, 0
s_waitcnt vmcnt(0) lgkmcnt(0)
v_accvgpr_read_b32 v104, a8
v_accvgpr_read_b32 v105, a9
v_accvgpr_read_b32 v106, a10
v_accvgpr_read_b32 v107, a11
v_cvt_pk_bf16_f32 v110, v104, v105
v_lshlrev_b32 v104, 16, v110
v_and_b32 v105, 0xffff0000, v110
v_cvt_pk_bf16_f32 v110, v106, v107
v_lshlrev_b32 v106, 16, v110
v_and_b32 v107, 0xffff0000, v110
v_lshlrev_b32 v112, 16, v72
v_and_b32 v113, 0xffff0000, v72
v_lshlrev_b32 v114, 16, v73
v_and_b32 v115, 0xffff0000, v73
v_sub_f32 v112, v112, v66
v_mul_f32 v112, v112, v67
v_sub_f32 v113, v113, v66
v_mul_f32 v113, v113, v67
v_sub_f32 v114, v114, v66
v_mul_f32 v114, v114, v67
v_sub_f32 v115, v115, v66
v_mul_f32 v115, v115, v67
v_cvt_pk_bf16_f32 v110, v112, v113
v_lshlrev_b32 v112, 16, v110
v_and_b32 v113, 0xffff0000, v110
v_cvt_pk_bf16_f32 v110, v114, v115
v_lshlrev_b32 v114, 16, v110
v_and_b32 v115, 0xffff0000, v110
v_add_f32 v104, v104, v112
v_add_f32 v105, v105, v113
v_add_f32 v106, v106, v114
v_add_f32 v107, v107, v115
v_cvt_pk_bf16_f32 v108, v104, v105
v_lshlrev_b32 v104, 16, v108
v_and_b32 v105, 0xffff0000, v108
v_cvt_pk_bf16_f32 v109, v106, v107
v_lshlrev_b32 v106, 16, v109
v_and_b32 v107, 0xffff0000, v109
v_add_f32 v14, v14, v104
v_fmac_f32 v15, v104, v104
v_add_f32 v14, v14, v105
v_fmac_f32 v15, v105, v105
v_add_f32 v14, v14, v106
v_fmac_f32 v15, v106, v106
v_add_f32 v14, v14, v107
v_fmac_f32 v15, v107, v107
buffer_store_dwordx2 v[108:109], v13, s[12:15], 0 offen offset:0
s_nop 1
v_accvgpr_read_b32 v104, a12
v_accvgpr_read_b32 v105, a13
v_accvgpr_read_b32 v106, a14
v_accvgpr_read_b32 v107, a15
v_cvt_pk_bf16_f32 v110, v104, v105
v_lshlrev_b32 v104, 16, v110
v_and_b32 v105, 0xffff0000, v110
v_cvt_pk_bf16_f32 v110, v106, v107
v_lshlrev_b32 v106, 16, v110
v_and_b32 v107, 0xffff0000, v110
v_lshlrev_b32 v112, 16, v74
v_and_b32 v113, 0xffff0000, v74
v_lshlrev_b32 v114, 16, v75
v_and_b32 v115, 0xffff0000, v75
v_sub_f32 v112, v112, v66
v_mul_f32 v112, v112, v67
v_sub_f32 v113, v113, v66
v_mul_f32 v113, v113, v67
v_sub_f32 v114, v114, v66
v_mul_f32 v114, v114, v67
v_sub_f32 v115, v115, v66
v_mul_f32 v115, v115, v67
v_cvt_pk_bf16_f32 v110, v112, v113
v_lshlrev_b32 v112, 16, v110
v_and_b32 v113, 0xffff0000, v110
v_cvt_pk_bf16_f32 v110, v114, v115
v_lshlrev_b32 v114, 16, v110
v_and_b32 v115, 0xffff0000, v110
v_add_f32 v104, v104, v112
v_add_f32 v105, v105, v113
v_add_f32 v106, v106, v114
v_add_f32 v107, v107, v115
v_cvt_pk_bf16_f32 v108, v104, v105
v_lshlrev_b32 v104, 16, v108
v_and_b32 v105, 0xffff0000, v108
v_cvt_pk_bf16_f32 v109, v106, v107
v_lshlrev_b32 v106, 16, v109
v_and_b32 v107, 0xffff0000, v109
v_add_f32 v14, v14, v104
v_fmac_f32 v15, v104, v104
v_add_f32 v14, v14, v105
v_fmac_f32 v15, v105, v105
v_add_f32 v14, v14, v106
v_fmac_f32 v15, v106, v106
v_add_f32 v14, v14, v107
v_fmac_f32 v15, v107, v107
buffer_store_dwordx2 v[108:109], v13, s[12:15], 0 offen offset:32
s_nop 1
ds_bpermute_b32 v16, v60, v14
ds_bpermute_b32 v17, v60, v15
s_waitcnt lgkmcnt(0)
v_add_f32 v14, v14, v16
v_add_f32 v15, v15, v17
ds_bpermute_b32 v16, v61, v14
ds_bpermute_b32 v17, v61, v15
s_waitcnt lgkmcnt(0)
v_add_f32 v14, v14, v16
v_add_f32 v15, v15, v17
v_add_u32 v16, 16, v9
v_lshlrev_b32 v16, 8, v16
s_lshl_b32 s25, s23, 4
v_add_u32 v16, s25, v16
v_lshl_add_u32 v16, v7, 3, v16
v_cmp_gt_u32 vcc, 16, v1
s_and_saveexec_b64 s[30:31], vcc
buffer_store_dwordx2 v[14:15], v16, s[16:19], 0 offen
s_mov_b64 exec, s[30:31]
s_nop 1
v_add_u32 v13, 65536, v11
buffer_load_dwordx2 v[72:73], v13, s[4:7], 0 offen offset:0
buffer_load_dwordx2 v[74:75], v13, s[4:7], 0 offen offset:32
v_mov_b32 v14, 0
v_mov_b32 v15, 0
s_waitcnt vmcnt(0) lgkmcnt(0)
v_accvgpr_read_b32 v104, a16
v_accvgpr_read_b32 v105, a17
v_accvgpr_read_b32 v106, a18
v_accvgpr_read_b32 v107, a19
v_cvt_pk_bf16_f32 v110, v104, v105
v_lshlrev_b32 v104, 16, v110
v_and_b32 v105, 0xffff0000, v110
v_cvt_pk_bf16_f32 v110, v106, v107
v_lshlrev_b32 v106, 16, v110
v_and_b32 v107, 0xffff0000, v110
v_lshlrev_b32 v112, 16, v72
v_and_b32 v113, 0xffff0000, v72
v_lshlrev_b32 v114, 16, v73
v_and_b32 v115, 0xffff0000, v73
v_sub_f32 v112, v112, v68
v_mul_f32 v112, v112, v69
v_sub_f32 v113, v113, v68
v_mul_f32 v113, v113, v69
v_sub_f32 v114, v114, v68
v_mul_f32 v114, v114, v69
v_sub_f32 v115, v115, v68
v_mul_f32 v115, v115, v69
v_cvt_pk_bf16_f32 v110, v112, v113
v_lshlrev_b32 v112, 16, v110
v_and_b32 v113, 0xffff0000, v110
v_cvt_pk_bf16_f32 v110, v114, v115
v_lshlrev_b32 v114, 16, v110
v_and_b32 v115, 0xffff0000, v110
v_add_f32 v104, v104, v112
v_add_f32 v105, v105, v113
v_add_f32 v106, v106, v114
v_add_f32 v107, v107, v115
v_cvt_pk_bf16_f32 v108, v104, v105
v_lshlrev_b32 v104, 16, v108
v_and_b32 v105, 0xffff0000, v108
v_cvt_pk_bf16_f32 v109, v106, v107
v_lshlrev_b32 v106, 16, v109
v_and_b32 v107, 0xffff0000, v109
v_add_f32 v14, v14, v104
v_fmac_f32 v15, v104, v104
v_add_f32 v14, v14, v105
v_fmac_f32 v15, v105, v105
v_add_f32 v14, v14, v106
v_fmac_f32 v15, v106, v106
v_add_f32 v14, v14, v107
v_fmac_f32 v15, v107, v107
buffer_store_dwordx2 v[108:109], v13, s[12:15], 0 offen offset:0
s_nop 1
v_accvgpr_read_b32 v104, a20
v_accvgpr_read_b32 v105, a21
v_accvgpr_read_b32 v106, a22
v_accvgpr_read_b32 v107, a23
v_cvt_pk_bf16_f32 v110, v104, v105
v_lshlrev_b32 v104, 16, v110
v_and_b32 v105, 0xffff0000, v110
v_cvt_pk_bf16_f32 v110, v106, v107
v_lshlrev_b32 v106, 16, v110
v_and_b32 v107, 0xffff0000, v110
v_lshlrev_b32 v112, 16, v74
v_and_b32 v113, 0xffff0000, v74
v_lshlrev_b32 v114, 16, v75
v_and_b32 v115, 0xffff0000, v75
v_sub_f32 v112, v112, v68
v_mul_f32 v112, v112, v69
v_sub_f32 v113, v113, v68
v_mul_f32 v113, v113, v69
v_sub_f32 v114, v114, v68
v_mul_f32 v114, v114, v69
v_sub_f32 v115, v115, v68
v_mul_f32 v115, v115, v69
v_cvt_pk_bf16_f32 v110, v112, v113
v_lshlrev_b32 v112, 16, v110
v_and_b32 v113, 0xffff0000, v110
v_cvt_pk_bf16_f32 v110, v114, v115
v_lshlrev_b32 v114, 16, v110
v_and_b32 v115, 0xffff0000, v110
v_add_f32 v104, v104, v112
v_add_f32 v105, v105, v113
v_add_f32 v106, v106, v114
v_add_f32 v107, v107, v115
v_cvt_pk_bf16_f32 v108, v104, v105
v_lshlrev_b32 v104, 16, v108
v_and_b32 v105, 0xffff0000, v108
v_cvt_pk_bf16_f32 v109, v106, v107
v_lshlrev_b32 v106, 16, v109
v_and_b32 v107, 0xffff0000, v109
v_add_f32 v14, v14, v104
v_fmac_f32 v15, v104, v104
v_add_f32 v14, v14, v105
v_fmac_f32 v15, v105, v105
v_add_f32 v14, v14, v106
v_fmac_f32 v15, v106, v106
v_add_f32 v14, v14, v107
v_fmac_f32 v15, v107, v107
buffer_store_dwordx2 v[108:109], v13, s[12:15], 0 offen offset:32
s_nop 1
ds_bpermute_b32 v16, v60, v14
ds_bpermute_b32 v17, v60, v15
s_waitcnt lgkmcnt(0)
v_add_f32 v14, v14, v16
v_add_f32 v15, v15, v17
ds_bpermute_b32 v16, v61, v14
ds_bpermute_b32 v17, v61, v15
s_waitcnt lgkmcnt(0)
v_add_f32 v14, v14, v16
v_add_f32 v15, v15, v17
v_add_u32 v16, 32, v9
v_lshlrev_b32 v16, 8, v16
s_lshl_b32 s25, s23, 4
v_add_u32 v16, s25, v16
v_lshl_add_u32 v16, v7, 3, v16
v_cmp_gt_u32 vcc, 16, v1
s_and_saveexec_b64 s[30:31], vcc
buffer_store_dwordx2 v[14:15], v16, s[16:19], 0 offen
s_mov_b64 exec, s[30:31]
s_nop 1
v_add_u32 v13, 98304, v11
buffer_load_dwordx2 v[72:73], v13, s[4:7], 0 offen offset:0
buffer_load_dwordx2 v[74:75], v13, s[4:7], 0 offen offset:32
v_mov_b32 v14, 0
v_mov_b32 v15, 0
s_waitcnt vmcnt(0) lgkmcnt(0)
v_accvgpr_read_b32 v104, a24
v_accvgpr_read_b32 v105, a25
v_accvgpr_read_b32 v106, a26
v_accvgpr_read_b32 v107, a27
v_cvt_pk_bf16_f32 v110, v104, v105
v_lshlrev_b32 v104, 16, v110
v_and_b32 v105, 0xffff0000, v110
v_cvt_pk_bf16_f32 v110, v106, v107
v_lshlrev_b32 v106, 16, v110
v_and_b32 v107, 0xffff0000, v110
v_lshlrev_b32 v112, 16, v72
v_and_b32 v113, 0xffff0000, v72
v_lshlrev_b32 v114, 16, v73
v_and_b32 v115, 0xffff0000, v73
v_sub_f32 v112, v112, v70
v_mul_f32 v112, v112, v71
v_sub_f32 v113, v113, v70
v_mul_f32 v113, v113, v71
v_sub_f32 v114, v114, v70
v_mul_f32 v114, v114, v71
v_sub_f32 v115, v115, v70
v_mul_f32 v115, v115, v71
v_cvt_pk_bf16_f32 v110, v112, v113
v_lshlrev_b32 v112, 16, v110
v_and_b32 v113, 0xffff0000, v110
v_cvt_pk_bf16_f32 v110, v114, v115
v_lshlrev_b32 v114, 16, v110
v_and_b32 v115, 0xffff0000, v110
v_add_f32 v104, v104, v112
v_add_f32 v105, v105, v113
v_add_f32 v106, v106, v114
v_add_f32 v107, v107, v115
v_cvt_pk_bf16_f32 v108, v104, v105
v_lshlrev_b32 v104, 16, v108
v_and_b32 v105, 0xffff0000, v108
v_cvt_pk_bf16_f32 v109, v106, v107
v_lshlrev_b32 v106, 16, v109
v_and_b32 v107, 0xffff0000, v109
v_add_f32 v14, v14, v104
v_fmac_f32 v15, v104, v104
v_add_f32 v14, v14, v105
v_fmac_f32 v15, v105, v105
v_add_f32 v14, v14, v106
v_fmac_f32 v15, v106, v106
v_add_f32 v14, v14, v107
v_fmac_f32 v15, v107, v107
buffer_store_dwordx2 v[108:109], v13, s[12:15], 0 offen offset:0
s_nop 1
v_accvgpr_read_b32 v104, a28
v_accvgpr_read_b32 v105, a29
v_accvgpr_read_b32 v106, a30
v_accvgpr_read_b32 v107, a31
v_cvt_pk_bf16_f32 v110, v104, v105
v_lshlrev_b32 v104, 16, v110
v_and_b32 v105, 0xffff0000, v110
v_cvt_pk_bf16_f32 v110, v106, v107
v_lshlrev_b32 v106, 16, v110
v_and_b32 v107, 0xffff0000, v110
v_lshlrev_b32 v112, 16, v74
v_and_b32 v113, 0xffff0000, v74
v_lshlrev_b32 v114, 16, v75
v_and_b32 v115, 0xffff0000, v75
v_sub_f32 v112, v112, v70
v_mul_f32 v112, v112, v71
v_sub_f32 v113, v113, v70
v_mul_f32 v113, v113, v71
v_sub_f32 v114, v114, v70
v_mul_f32 v114, v114, v71
v_sub_f32 v115, v115, v70
v_mul_f32 v115, v115, v71
v_cvt_pk_bf16_f32 v110, v112, v113
v_lshlrev_b32 v112, 16, v110
v_and_b32 v113, 0xffff0000, v110
v_cvt_pk_bf16_f32 v110, v114, v115
v_lshlrev_b32 v114, 16, v110
v_and_b32 v115, 0xffff0000, v110
v_add_f32 v104, v104, v112
v_add_f32 v105, v105, v113
v_add_f32 v106, v106, v114
v_add_f32 v107, v107, v115
v_cvt_pk_bf16_f32 v108, v104, v105
v_lshlrev_b32 v104, 16, v108
v_and_b32 v105, 0xffff0000, v108
v_cvt_pk_bf16_f32 v109, v106, v107
v_lshlrev_b32 v106, 16, v109
v_and_b32 v107, 0xffff0000, v109
v_add_f32 v14, v14, v104
v_fmac_f32 v15, v104, v104
v_add_f32 v14, v14, v105
v_fmac_f32 v15, v105, v105
v_add_f32 v14, v14, v106
v_fmac_f32 v15, v106, v106
v_add_f32 v14, v14, v107
v_fmac_f32 v15, v107, v107
buffer_store_dwordx2 v[108:109], v13, s[12:15], 0 offen offset:32
s_nop 1
ds_bpermute_b32 v16, v60, v14
ds_bpermute_b32 v17, v60, v15
s_waitcnt lgkmcnt(0)
v_add_f32 v14, v14, v16
v_add_f32 v15, v15, v17
ds_bpermute_b32 v16, v61, v14
ds_bpermute_b32 v17, v61, v15
s_waitcnt lgkmcnt(0)
v_add_f32 v14, v14, v16
v_add_f32 v15, v15, v17
v_add_u32 v16, 48, v9
v_lshlrev_b32 v16, 8, v16
s_lshl_b32 s25, s23, 4
v_add_u32 v16, s25, v16
v_lshl_add_u32 v16, v7, 3, v16
v_cmp_gt_u32 vcc, 16, v1
s_and_saveexec_b64 s[30:31], vcc
buffer_store_dwordx2 v[14:15], v16, s[16:19], 0 offen
s_mov_b64 exec, s[30:31]
s_nop 1
w2_kernel_end:
s_endpgm
.globl w3_kernel
.p2align 8
.type w3_kernel,@function
w3_kernel:
s_cmp_ge_u32 s2, 256
s_cbranch_scc1 w3_kernel_end
s_load_dwordx2 s[4:5], s[0:1], 88
s_load_dwordx2 s[8:9], s[0:1], 56
s_and_b32 s20, s2, 7
s_lshr_b32 s21, s2, 3
s_lshr_b32 s22, s20, 1
s_lshl_b32 s22, s22, 2
s_and_b32 s23, s21, 3
s_add_u32 s22, s22, s23
s_and_b32 s23, s20, 1
s_lshl_b32 s23, s23, 3
s_lshr_b32 s24, s21, 2
s_add_u32 s23, s23, s24
v_and_b32 v1, 63, v0
v_lshrrev_b32 v2, 6, v0
s_waitcnt lgkmcnt(0)
s_add_u32 s4, s4, 20971520
s_addc_u32 s5, s5, 0
s_mov_b32 s6, 4194304
s_mov_b32 s7, 0x00020000
s_mov_b32 s10, 7340032
s_mov_b32 s11, 0x00020000
v_lshrrev_b32 v3, 3, v1
v_and_b32 v4, 7, v1
v_xor_b32 v4, v4, v3
v_lshlrev_b32 v4, 4, v4
s_lshl_b32 s25, s22, 7
v_lshlrev_b32 v5, 5, v2
v_add_u32 v5, s25, v5
v_add_u32 v5, v5, v3
s_mov_b32 s26, 2048
v_mul_lo_u32 v5, v5, s26
v_add_u32 v10, v5, v4
v_add_u32 v11, 16384, v10
v_add_u32 v12, 32768, v10
v_add_u32 v13, 49152, v10
v_mul_u32_u24 v3, 448, v2
v_add_u32 v3, 0, v3
v_add_u32 v3, v3, v1
v_mul_u32_u24 v4, 2341, v3
v_lshrrev_b32 v4, 16, v4
v_mul_u32_u24 v5, 28, v4
v_sub_u32 v5, v3, v5
v_bfe_u32 v6, v4, 3, 1
v_lshlrev_b32 v6, 1, v6
v_xor_b32 v5, v5, v6
s_mul_i32 s25, s23, 448
v_lshlrev_b32 v9, 4, v5
v_add_u32 v9, s25, v9
v_mul_u32_u24 v4, 7168, v4
v_add_u32 v14, v4, v9
v_mul_u32_u24 v3, 448, v2
v_add_u32 v3, 64, v3
v_add_u32 v3, v3, v1
v_mul_u32_u24 v4, 2341, v3
v_lshrrev_b32 v4, 16, v4
v_mul_u32_u24 v5, 28, v4
v_sub_u32 v5, v3, v5
v_bfe_u32 v6, v4, 3, 1
v_lshlrev_b32 v6, 1, v6
v_xor_b32 v5, v5, v6
s_mul_i32 s25, s23, 448
v_lshlrev_b32 v9, 4, v5
v_add_u32 v9, s25, v9
v_mul_u32_u24 v4, 7168, v4
v_add_u32 v15, v4, v9
v_mul_u32_u24 v3, 448, v2
v_add_u32 v3, 128, v3
v_add_u32 v3, v3, v1
v_mul_u32_u24 v4, 2341, v3
v_lshrrev_b32 v4, 16, v4
v_mul_u32_u24 v5, 28, v4
v_sub_u32 v5, v3, v5
v_bfe_u32 v6, v4, 3, 1
v_lshlrev_b32 v6, 1, v6
v_xor_b32 v5, v5, v6
s_mul_i32 s25, s23, 448
v_lshlrev_b32 v9, 4, v5
v_add_u32 v9, s25, v9
v_mul_u32_u24 v4, 7168, v4
v_add_u32 v16, v4, v9
v_mul_u32_u24 v3, 448, v2
v_add_u32 v3, 192, v3
v_add_u32 v3, v3, v1
v_mul_u32_u24 v4, 2341, v3
v_lshrrev_b32 v4, 16, v4
v_mul_u32_u24 v5, 28, v4
v_sub_u32 v5, v3, v5
v_bfe_u32 v6, v4, 3, 1
v_lshlrev_b32 v6, 1, v6
v_xor_b32 v5, v5, v6
s_mul_i32 s25, s23, 448
v_lshlrev_b32 v9, 4, v5
v_add_u32 v9, s25, v9
v_mul_u32_u24 v4, 7168, v4
v_add_u32 v17, v4, v9
v_mul_u32_u24 v3, 448, v2
v_add_u32 v3, 256, v3
v_add_u32 v3, v3, v1
v_mul_u32_u24 v4, 2341, v3
v_lshrrev_b32 v4, 16, v4
v_mul_u32_u24 v5, 28, v4
v_sub_u32 v5, v3, v5
v_bfe_u32 v6, v4, 3, 1
v_lshlrev_b32 v6, 1, v6
v_xor_b32 v5, v5, v6
s_mul_i32 s25, s23, 448
v_lshlrev_b32 v9, 4, v5
v_add_u32 v9, s25, v9
v_mul_u32_u24 v4, 7168, v4
v_add_u32 v18, v4, v9
v_mul_u32_u24 v3, 448, v2
v_add_u32 v3, 320, v3
v_add_u32 v3, v3, v1
v_mul_u32_u24 v4, 2341, v3
v_lshrrev_b32 v4, 16, v4
v_mul_u32_u24 v5, 28, v4
v_sub_u32 v5, v3, v5
v_bfe_u32 v6, v4, 3, 1
v_lshlrev_b32 v6, 1, v6
v_xor_b32 v5, v5, v6
s_mul_i32 s25, s23, 448
v_lshlrev_b32 v9, 4, v5
v_add_u32 v9, s25, v9
v_mul_u32_u24 v4, 7168, v4
v_add_u32 v19, v4, v9
v_mul_u32_u24 v3, 448, v2
v_add_u32 v3, 384, v3
v_add_u32 v3, v3, v1
v_mul_u32_u24 v4, 2341, v3
v_lshrrev_b32 v4, 16, v4
v_mul_u32_u24 v5, 28, v4
v_sub_u32 v5, v3, v5
v_bfe_u32 v6, v4, 3, 1
v_lshlrev_b32 v6, 1, v6
v_xor_b32 v5, v5, v6
s_mul_i32 s25, s23, 448
v_lshlrev_b32 v9, 4, v5
v_add_u32 v9, s25, v9
v_mul_u32_u24 v4, 7168, v4
v_add_u32 v20, v4, v9
v_lshrrev_b32 v3, 1, v2
v_lshlrev_b32 v3, 6, v3
v_and_b32 v4, 15, v1
v_add_u32 v3, v3, v4
v_lshlrev_b32 v3, 7, v3
v_lshrrev_b32 v5, 4, v1
v_and_b32 v6, 7, v1
v_xor_b32 v5, v5, v6
v_lshlrev_b32 v5, 4, v5
v_add_u32 v21, v3, v5
v_xor_b32 v22, 64, v21
v_lshrrev_b32 v3, 4, v1
v_bfe_u32 v4, v1, 2, 2
v_lshl_add_u32 v5, v3, 3, v4
v_mul_u32_u24 v5, 448, v5
v_and_b32 v6, 3, v1
v_lshl_add_u32 v5, v6, 3, v5
v_add_u32 v5, 16384, v5
v_and_b32 v6, 1, v3
v_and_b32 v7, 1, v2
v_mul_u32_u24 v7, 7, v7
v_add_u32 v8, 0, v7
v_xor_b32 v8, v8, v6
v_lshl_add_u32 v25, v8, 5, v5
v_add_u32 v8, 1, v7
v_xor_b32 v8, v8, v6
v_lshl_add_u32 v26, v8, 5, v5
v_add_u32 v8, 2, v7
v_xor_b32 v8, v8, v6
v_lshl_add_u32 v27, v8, 5, v5
v_add_u32 v8, 3, v7
v_xor_b32 v8, v8, v6
v_lshl_add_u32 v28, v8, 5, v5
v_add_u32 v8, 4, v7
v_xor_b32 v8, v8, v6
v_lshl_add_u32 v29, v8, 5, v5
v_add_u32 v8, 5, v7
v_xor_b32 v8, v8, v6
v_lshl_add_u32 v30, v8, 5, v5
v_add_u32 v8, 6, v7
v_xor_b32 v8, v8, v6
v_lshl_add_u32 v31, v8, 5, v5
v_accvgpr_write_b32 a0, 0
v_accvgpr_write_b32 a1, 0
v_accvgpr_write_b32 a2, 0
v_accvgpr_write_b32 a3, 0
v_accvgpr_write_b32 a4, 0
v_accvgpr_write_b32 a5, 0
v_accvgpr_write_b32 a6, 0
v_accvgpr_write_b32 a7, 0
v_accvgpr_write_b32 a8, 0
v_accvgpr_write_b32 a9, 0
v_accvgpr_write_b32 a10, 0
v_accvgpr_write_b32 a11, 0
v_accvgpr_write_b32 a12, 0
v_accvgpr_write_b32 a13, 0
v_accvgpr_write_b32 a14, 0
v_accvgpr_write_b32 a15, 0
v_accvgpr_write_b32 a16, 0
v_accvgpr_write_b32 a17, 0
v_accvgpr_write_b32 a18, 0
v_accvgpr_write_b32 a19, 0
v_accvgpr_write_b32 a20, 0
v_accvgpr_write_b32 a21, 0
v_accvgpr_write_b32 a22, 0
v_accvgpr_write_b32 a23, 0
v_accvgpr_write_b32 a24, 0
v_accvgpr_write_b32 a25, 0
v_accvgpr_write_b32 a26, 0
v_accvgpr_write_b32 a27, 0
v_accvgpr_write_b32 a28, 0
v_accvgpr_write_b32 a29, 0
v_accvgpr_write_b32 a30, 0
v_accvgpr_write_b32 a31, 0
v_accvgpr_write_b32 a32, 0
v_accvgpr_write_b32 a33, 0
v_accvgpr_write_b32 a34, 0
v_accvgpr_write_b32 a35, 0
v_accvgpr_write_b32 a36, 0
v_accvgpr_write_b32 a37, 0
v_accvgpr_write_b32 a38, 0
v_accvgpr_write_b32 a39, 0
v_accvgpr_write_b32 a40, 0
v_accvgpr_write_b32 a41, 0
v_accvgpr_write_b32 a42, 0
v_accvgpr_write_b32 a43, 0
v_accvgpr_write_b32 a44, 0
v_accvgpr_write_b32 a45, 0
v_accvgpr_write_b32 a46, 0
v_accvgpr_write_b32 a47, 0
v_accvgpr_write_b32 a48, 0
v_accvgpr_write_b32 a49, 0
v_accvgpr_write_b32 a50, 0
v_accvgpr_write_b32 a51, 0
v_accvgpr_write_b32 a52, 0
v_accvgpr_write_b32 a53, 0
v_accvgpr_write_b32 a54, 0
v_accvgpr_write_b32 a55, 0
v_accvgpr_write_b32 a56, 0
v_accvgpr_write_b32 a57, 0
v_accvgpr_write_b32 a58, 0
v_accvgpr_write_b32 a59, 0
v_accvgpr_write_b32 a60, 0
v_accvgpr_write_b32 a61, 0
v_accvgpr_write_b32 a62, 0
v_accvgpr_write_b32 a63, 0
v_accvgpr_write_b32 a64, 0
v_accvgpr_write_b32 a65, 0
v_accvgpr_write_b32 a66, 0
v_accvgpr_write_b32 a67, 0
v_accvgpr_write_b32 a68, 0
v_accvgpr_write_b32 a69, 0
v_accvgpr_write_b32 a70, 0
v_accvgpr_write_b32 a71, 0
v_accvgpr_write_b32 a72, 0
v_accvgpr_write_b32 a73, 0
v_accvgpr_write_b32 a74, 0
v_accvgpr_write_b32 a75, 0
v_accvgpr_write_b32 a76, 0
v_accvgpr_write_b32 a77, 0
v_accvgpr_write_b32 a78, 0
v_accvgpr_write_b32 a79, 0
v_accvgpr_write_b32 a80, 0
v_accvgpr_write_b32 a81, 0
v_accvgpr_write_b32 a82, 0
v_accvgpr_write_b32 a83, 0
v_accvgpr_write_b32 a84, 0
v_accvgpr_write_b32 a85, 0
v_accvgpr_write_b32 a86, 0
v_accvgpr_write_b32 a87, 0
v_accvgpr_write_b32 a88, 0
v_accvgpr_write_b32 a89, 0
v_accvgpr_write_b32 a90, 0
v_accvgpr_write_b32 a91, 0
v_accvgpr_write_b32 a92, 0
v_accvgpr_write_b32 a93, 0
v_accvgpr_write_b32 a94, 0
v_accvgpr_write_b32 a95, 0
v_accvgpr_write_b32 a96, 0
v_accvgpr_write_b32 a97, 0
v_accvgpr_write_b32 a98, 0
v_accvgpr_write_b32 a99, 0
v_accvgpr_write_b32 a100, 0
v_accvgpr_write_b32 a101, 0
v_accvgpr_write_b32 a102, 0
v_accvgpr_write_b32 a103, 0
v_accvgpr_write_b32 a104, 0
v_accvgpr_write_b32 a105, 0
v_accvgpr_write_b32 a106, 0
v_accvgpr_write_b32 a107, 0
v_accvgpr_write_b32 a108, 0
v_accvgpr_write_b32 a109, 0
v_accvgpr_write_b32 a110, 0
v_accvgpr_write_b32 a111, 0
v_readfirstlane_b32 s27, v2
s_nop 3
s_mul_i32 s28, s27, 7168
s_lshl_b32 s27, s27, 12
s_mov_b32 s16, 0
s_mov_b32 s17, 0
s_add_u32 m0, s27, 0
s_nop 0
buffer_load_dwordx4 v10, s[4:7], s16 offen lds
s_add_u32 m0, s27, 1024
s_nop 0
buffer_load_dwordx4 v11, s[4:7], s16 offen lds
s_add_u32 m0, s27, 2048
s_nop 0
buffer_load_dwordx4 v12, s[4:7], s16 offen lds
s_add_u32 m0, s27, 3072
s_nop 0
buffer_load_dwordx4 v13, s[4:7], s16 offen lds
s_add_u32 m0, s28, 16384
s_nop 0
buffer_load_dwordx4 v14, s[8:11], s17 offen lds
s_add_u32 m0, s28, 17408
s_nop 0
buffer_load_dwordx4 v15, s[8:11], s17 offen lds
s_add_u32 m0, s28, 18432
s_nop 0
buffer_load_dwordx4 v16, s[8:11], s17 offen lds
s_add_u32 m0, s28, 19456
s_nop 0
buffer_load_dwordx4 v17, s[8:11], s17 offen lds
s_add_u32 m0, s28, 20480
s_nop 0
buffer_load_dwordx4 v18, s[8:11], s17 offen lds
s_add_u32 m0, s28, 21504
s_nop 0
buffer_load_dwordx4 v19, s[8:11], s17 offen lds
s_add_u32 m0, s28, 22528
s_nop 0
buffer_load_dwordx4 v20, s[8:11], s17 offen lds
s_mov_b32 s16, 128
s_mov_b32 s17, 458752
s_add_u32 m0, s27, 45056
s_nop 0
buffer_load_dwordx4 v10, s[4:7], s16 offen lds
s_add_u32 m0, s27, 46080
s_nop 0
buffer_load_dwordx4 v11, s[4:7], s16 offen lds
s_add_u32 m0, s27, 47104
s_nop 0
buffer_load_dwordx4 v12, s[4:7], s16 offen lds
s_add_u32 m0, s27, 48128
s_nop 0
buffer_load_dwordx4 v13, s[4:7], s16 offen lds
s_add_u32 m0, s28, 61440
s_nop 0
buffer_load_dwordx4 v14, s[8:11], s17 offen lds
s_add_u32 m0, s28, 62464
s_nop 0
buffer_load_dwordx4 v15, s[8:11], s17 offen lds
s_add_u32 m0, s28, 63488
s_nop 0
buffer_load_dwordx4 v16, s[8:11], s17 offen lds
s_add_u32 m0, s28, 64512
s_nop 0
buffer_load_dwordx4 v17, s[8:11], s17 offen lds
s_add_u32 m0, s28, 65536
s_nop 0
buffer_load_dwordx4 v18, s[8:11], s17 offen lds
s_add_u32 m0, s28, 66560
s_nop 0
buffer_load_dwordx4 v19, s[8:11], s17 offen lds
s_add_u32 m0, s28, 67584
s_nop 0
buffer_load_dwordx4 v20, s[8:11], s17 offen lds
s_load_dwordx2 s[12:13], s[0:1], 88
s_waitcnt lgkmcnt(0)
s_add_u32 s12, s12, 53477376
s_addc_u32 s13, s13, 0
s_mov_b32 s14, 524288
s_mov_b32 s15, 0x00020000
s_lshl_b32 s25, s22, 15
v_lshlrev_b32 v3, 7, v0
v_add_u32 v3, s25, v3
buffer_load_dwordx4 v[128:131], v3, s[12:15], 0 offen offset:0
buffer_load_dwordx4 v[132:135], v3, s[12:15], 0 offen offset:16
buffer_load_dwordx4 v[136:139], v3, s[12:15], 0 offen offset:32
buffer_load_dwordx4 v[140:143], v3, s[12:15], 0 offen offset:48
buffer_load_dwordx4 v[144:147], v3, s[12:15], 0 offen offset:64
buffer_load_dwordx4 v[148:151], v3, s[12:15], 0 offen offset:80
buffer_load_dwordx4 v[152:155], v3, s[12:15], 0 offen offset:96
buffer_load_dwordx4 v[156:159], v3, s[12:15], 0 offen offset:112
s_waitcnt vmcnt(0)
v_add_f32 v128, v128, v130
v_add_f32 v129, v129, v131
v_add_f32 v128, v128, v132
v_add_f32 v129, v129, v133
v_add_f32 v128, v128, v134
v_add_f32 v129, v129, v135
v_add_f32 v128, v128, v136
v_add_f32 v129, v129, v137
v_add_f32 v128, v128, v138
v_add_f32 v129, v129, v139
v_add_f32 v128, v128, v140
v_add_f32 v129, v129, v141
v_add_f32 v128, v128, v142
v_add_f32 v129, v129, v143
v_add_f32 v128, v128, v144
v_add_f32 v129, v129, v145
v_add_f32 v128, v128, v146
v_add_f32 v129, v129, v147
v_add_f32 v128, v128, v148
v_add_f32 v129, v129, v149
v_add_f32 v128, v128, v150
v_add_f32 v129, v129, v151
v_add_f32 v128, v128, v152
v_add_f32 v129, v129, v153
v_add_f32 v128, v128, v154
v_add_f32 v129, v129, v155
v_add_f32 v128, v128, v156
v_add_f32 v129, v129, v157
v_add_f32 v128, v128, v158
v_add_f32 v129, v129, v159
s_nop 1
v_add_f32_dpp v128, v128, v128 quad_perm:[1,0,3,2] row_mask:0xf bank_mask:0xf
v_add_f32_dpp v129, v129, v129 quad_perm:[1,0,3,2] row_mask:0xf bank_mask:0xf
v_mul_f32 v128, 0x3a800000, v128
v_mul_f32 v129, 0x3a800000, v129
v_fma_f32 v129, -v128, v128, v129
v_max_f32 v129, 0, v129
v_add_f32 v130, 0x3727c5ac, v129
v_rsq_f32 v130, v130
s_nop 0
v_mov_b32 v129, v130
v_lshrrev_b32 v3, 1, v0
v_lshlrev_b32 v3, 3, v3
v_add_u32 v3, 135168, v3
ds_write_b64 v3, v[128:129]
s_waitcnt vmcnt(11) lgkmcnt(0)
s_barrier
v_add_u32 v23, 0, v21
v_add_u32 v32, 0, v25
v_add_u32 v33, 0, v26
v_add_u32 v34, 0, v27
v_add_u32 v35, 0, v28
v_add_u32 v36, 0, v29
v_add_u32 v37, 0, v30
v_add_u32 v38, 0, v31
ds_read_b128 v[40:43], v23 offset:0
ds_read_b128 v[44:47], v23 offset:2048
ds_read_b128 v[48:51], v23 offset:4096
ds_read_b128 v[52:55], v23 offset:6144
ds_read_b64_tr_b16 v[56:57], v32 offset:0
ds_read_b64_tr_b16 v[58:59], v32 offset:1792
ds_read_b64_tr_b16 v[60:61], v33 offset:0
ds_read_b64_tr_b16 v[62:63], v33 offset:1792
ds_read_b64_tr_b16 v[64:65], v34 offset:0
ds_read_b64_tr_b16 v[66:67], v34 offset:1792
ds_read_b64_tr_b16 v[68:69], v35 offset:0
ds_read_b64_tr_b16 v[70:71], v35 offset:1792
ds_read_b64_tr_b16 v[72:73], v36 offset:0
ds_read_b64_tr_b16 v[74:75], v36 offset:1792
ds_read_b64_tr_b16 v[76:77], v37 offset:0
ds_read_b64_tr_b16 v[78:79], v37 offset:1792
ds_read_b64_tr_b16 v[80:81], v38 offset:0
ds_read_b64_tr_b16 v[82:83], v38 offset:1792
s_waitcnt lgkmcnt(0)
v_mfma_f32_16x16x32_bf16 a[0:3], v[56:59], v[40:43], a[0:3]
v_mfma_f32_16x16x32_bf16 a[28:31], v[56:59], v[44:47], a[28:31]
v_add_u32 v23, 0, v22
v_mfma_f32_16x16x32_bf16 a[56:59], v[56:59], v[48:51], a[56:59]
v_add_u32 v32, 0, v25
v_mfma_f32_16x16x32_bf16 a[84:87], v[56:59], v[52:55], a[84:87]
v_add_u32 v33, 0, v26
v_mfma_f32_16x16x32_bf16 a[4:7], v[60:63], v[40:43], a[4:7]
v_add_u32 v34, 0, v27
v_mfma_f32_16x16x32_bf16 a[32:35], v[60:63], v[44:47], a[32:35]
v_add_u32 v35, 0, v28
v_mfma_f32_16x16x32_bf16 a[60:63], v[60:63], v[48:51], a[60:63]
v_add_u32 v36, 0, v29
v_mfma_f32_16x16x32_bf16 a[88:91], v[60:63], v[52:55], a[88:91]
v_add_u32 v37, 0, v30
v_mfma_f32_16x16x32_bf16 a[8:11], v[64:67], v[40:43], a[8:11]
v_add_u32 v38, 0, v31
v_mfma_f32_16x16x32_bf16 a[36:39], v[64:67], v[44:47], a[36:39]
ds_read_b128 v[84:87], v23 offset:0
v_mfma_f32_16x16x32_bf16 a[64:67], v[64:67], v[48:51], a[64:67]
ds_read_b128 v[88:91], v23 offset:2048
v_mfma_f32_16x16x32_bf16 a[92:95], v[64:67], v[52:55], a[92:95]
ds_read_b128 v[92:95], v23 offset:4096
v_mfma_f32_16x16x32_bf16 a[12:15], v[68:71], v[40:43], a[12:15]
ds_read_b128 v[96:99], v23 offset:6144
v_mfma_f32_16x16x32_bf16 a[40:43], v[68:71], v[44:47], a[40:43]
ds_read_b64_tr_b16 v[100:101], v32 offset:14336
v_mfma_f32_16x16x32_bf16 a[68:71], v[68:71], v[48:51], a[68:71]
v_mfma_f32_16x16x32_bf16 a[96:99], v[68:71], v[52:55], a[96:99]
ds_read_b64_tr_b16 v[102:103], v32 offset:16128
v_mfma_f32_16x16x32_bf16 a[16:19], v[72:75], v[40:43], a[16:19]
ds_read_b64_tr_b16 v[104:105], v33 offset:14336
v_mfma_f32_16x16x32_bf16 a[44:47], v[72:75], v[44:47], a[44:47]
ds_read_b64_tr_b16 v[106:107], v33 offset:16128
v_mfma_f32_16x16x32_bf16 a[72:75], v[72:75], v[48:51], a[72:75]
ds_read_b64_tr_b16 v[108:109], v34 offset:14336
v_mfma_f32_16x16x32_bf16 a[100:103], v[72:75], v[52:55], a[100:103]
ds_read_b64_tr_b16 v[110:111], v34 offset:16128
v_mfma_f32_16x16x32_bf16 a[20:23], v[76:79], v[40:43], a[20:23]
ds_read_b64_tr_b16 v[112:113], v35 offset:14336
v_mfma_f32_16x16x32_bf16 a[48:51], v[76:79], v[44:47], a[48:51]
ds_read_b64_tr_b16 v[114:115], v35 offset:16128
v_mfma_f32_16x16x32_bf16 a[76:79], v[76:79], v[48:51], a[76:79]
ds_read_b64_tr_b16 v[116:117], v36 offset:14336
v_mfma_f32_16x16x32_bf16 a[104:107], v[76:79], v[52:55], a[104:107]
ds_read_b64_tr_b16 v[118:119], v36 offset:16128
v_mfma_f32_16x16x32_bf16 a[24:27], v[80:83], v[40:43], a[24:27]
ds_read_b64_tr_b16 v[120:121], v37 offset:14336
v_mfma_f32_16x16x32_bf16 a[52:55], v[80:83], v[44:47], a[52:55]
ds_read_b64_tr_b16 v[122:123], v37 offset:16128
v_mfma_f32_16x16x32_bf16 a[80:83], v[80:83], v[48:51], a[80:83]
ds_read_b64_tr_b16 v[124:125], v38 offset:14336
v_mfma_f32_16x16x32_bf16 a[108:111], v[80:83], v[52:55], a[108:111]
ds_read_b64_tr_b16 v[126:127], v38 offset:16128
s_waitcnt vmcnt(0)
s_barrier
s_waitcnt lgkmcnt(0)
v_mfma_f32_16x16x32_bf16 a[0:3], v[100:103], v[84:87], a[0:3]
s_mov_b32 s16, 256
s_mov_b32 s17, 917504
v_mfma_f32_16x16x32_bf16 a[28:31], v[100:103], v[88:91], a[28:31]
s_add_u32 m0, s27, 90112
s_nop 0
v_mfma_f32_16x16x32_bf16 a[56:59], v[100:103], v[92:95], a[56:59]
buffer_load_dwordx4 v10, s[4:7], s16 offen lds
s_add_u32 m0, s27, 91136
v_mfma_f32_16x16x32_bf16 a[84:87], v[100:103], v[96:99], a[84:87]
s_nop 0
buffer_load_dwordx4 v11, s[4:7], s16 offen lds
v_mfma_f32_16x16x32_bf16 a[4:7], v[104:107], v[84:87], a[4:7]
s_add_u32 m0, s27, 92160
s_nop 0
v_mfma_f32_16x16x32_bf16 a[32:35], v[104:107], v[88:91], a[32:35]
buffer_load_dwordx4 v12, s[4:7], s16 offen lds
s_add_u32 m0, s27, 93184
s_nop 0
v_mfma_f32_16x16x32_bf16 a[60:63], v[104:107], v[92:95], a[60:63]
buffer_load_dwordx4 v13, s[4:7], s16 offen lds
s_add_u32 m0, s28, 106496
v_mfma_f32_16x16x32_bf16 a[88:91], v[104:107], v[96:99], a[88:91]
s_nop 0
buffer_load_dwordx4 v14, s[8:11], s17 offen lds
v_mfma_f32_16x16x32_bf16 a[8:11], v[108:111], v[84:87], a[8:11]
s_add_u32 m0, s28, 107520
s_nop 0
v_mfma_f32_16x16x32_bf16 a[36:39], v[108:111], v[88:91], a[36:39]
buffer_load_dwordx4 v15, s[8:11], s17 offen lds
s_add_u32 m0, s28, 108544
v_mfma_f32_16x16x32_bf16 a[64:67], v[108:111], v[92:95], a[64:67]
s_nop 0
buffer_load_dwordx4 v16, s[8:11], s17 offen lds
v_mfma_f32_16x16x32_bf16 a[92:95], v[108:111], v[96:99], a[92:95]
s_add_u32 m0, s28, 109568
s_nop 0
buffer_load_dwordx4 v17, s[8:11], s17 offen lds
v_mfma_f32_16x16x32_bf16 a[12:15], v[112:115], v[84:87], a[12:15]
s_add_u32 m0, s28, 110592
s_nop 0
v_mfma_f32_16x16x32_bf16 a[40:43], v[112:115], v[88:91], a[40:43]
buffer_load_dwordx4 v18, s[8:11], s17 offen lds
s_add_u32 m0, s28, 111616
v_mfma_f32_16x16x32_bf16 a[68:71], v[112:115], v[92:95], a[68:71]
s_nop 0
buffer_load_dwordx4 v19, s[8:11], s17 offen lds
v_mfma_f32_16x16x32_bf16 a[96:99], v[112:115], v[96:99], a[96:99]
s_add_u32 m0, s28, 112640
s_nop 0
v_mfma_f32_16x16x32_bf16 a[16:19], v[116:119], v[84:87], a[16:19]
buffer_load_dwordx4 v20, s[8:11], s17 offen lds
v_add_u32 v23, 45056, v21
v_add_u32 v32, 45056, v25
v_mfma_f32_16x16x32_bf16 a[44:47], v[116:119], v[88:91], a[44:47]
v_add_u32 v33, 45056, v26
v_add_u32 v34, 45056, v27
v_mfma_f32_16x16x32_bf16 a[72:75], v[116:119], v[92:95], a[72:75]
v_add_u32 v35, 45056, v28
v_add_u32 v36, 45056, v29
v_mfma_f32_16x16x32_bf16 a[100:103], v[116:119], v[96:99], a[100:103]
v_add_u32 v37, 45056, v30
v_add_u32 v38, 45056, v31
v_mfma_f32_16x16x32_bf16 a[20:23], v[120:123], v[84:87], a[20:23]
ds_read_b128 v[40:43], v23 offset:0
ds_read_b128 v[44:47], v23 offset:2048
v_mfma_f32_16x16x32_bf16 a[48:51], v[120:123], v[88:91], a[48:51]
ds_read_b128 v[48:51], v23 offset:4096
ds_read_b128 v[52:55], v23 offset:6144
v_mfma_f32_16x16x32_bf16 a[76:79], v[120:123], v[92:95], a[76:79]
ds_read_b64_tr_b16 v[56:57], v32 offset:0
ds_read_b64_tr_b16 v[58:59], v32 offset:1792
ds_read_b64_tr_b16 v[60:61], v33 offset:0
v_mfma_f32_16x16x32_bf16 a[104:107], v[120:123], v[96:99], a[104:107]
ds_read_b64_tr_b16 v[62:63], v33 offset:1792
ds_read_b64_tr_b16 v[64:65], v34 offset:0
v_mfma_f32_16x16x32_bf16 a[24:27], v[124:127], v[84:87], a[24:27]
ds_read_b64_tr_b16 v[66:67], v34 offset:1792
ds_read_b64_tr_b16 v[68:69], v35 offset:0
v_mfma_f32_16x16x32_bf16 a[52:55], v[124:127], v[88:91], a[52:55]
ds_read_b64_tr_b16 v[70:71], v35 offset:1792
ds_read_b64_tr_b16 v[72:73], v36 offset:0
v_mfma_f32_16x16x32_bf16 a[80:83], v[124:127], v[92:95], a[80:83]
ds_read_b64_tr_b16 v[74:75], v36 offset:1792
ds_read_b64_tr_b16 v[76:77], v37 offset:0
v_mfma_f32_16x16x32_bf16 a[108:111], v[124:127], v[96:99], a[108:111]
ds_read_b64_tr_b16 v[78:79], v37 offset:1792
ds_read_b64_tr_b16 v[80:81], v38 offset:0
ds_read_b64_tr_b16 v[82:83], v38 offset:1792
s_waitcnt lgkmcnt(0)
v_mfma_f32_16x16x32_bf16 a[0:3], v[56:59], v[40:43], a[0:3]
v_mfma_f32_16x16x32_bf16 a[28:31], v[56:59], v[44:47], a[28:31]
v_add_u32 v23, 45056, v22
v_mfma_f32_16x16x32_bf16 a[56:59], v[56:59], v[48:51], a[56:59]
v_add_u32 v32, 45056, v25
v_mfma_f32_16x16x32_bf16 a[84:87], v[56:59], v[52:55], a[84:87]
v_add_u32 v33, 45056, v26
v_mfma_f32_16x16x32_bf16 a[4:7], v[60:63], v[40:43], a[4:7]
v_add_u32 v34, 45056, v27
v_mfma_f32_16x16x32_bf16 a[32:35], v[60:63], v[44:47], a[32:35]
v_add_u32 v35, 45056, v28
v_mfma_f32_16x16x32_bf16 a[60:63], v[60:63], v[48:51], a[60:63]
v_add_u32 v36, 45056, v29
v_mfma_f32_16x16x32_bf16 a[88:91], v[60:63], v[52:55], a[88:91]
v_add_u32 v37, 45056, v30
v_mfma_f32_16x16x32_bf16 a[8:11], v[64:67], v[40:43], a[8:11]
v_add_u32 v38, 45056, v31
v_mfma_f32_16x16x32_bf16 a[36:39], v[64:67], v[44:47], a[36:39]
ds_read_b128 v[84:87], v23 offset:0
v_mfma_f32_16x16x32_bf16 a[64:67], v[64:67], v[48:51], a[64:67]
ds_read_b128 v[88:91], v23 offset:2048
v_mfma_f32_16x16x32_bf16 a[92:95], v[64:67], v[52:55], a[92:95]
ds_read_b128 v[92:95], v23 offset:4096
v_mfma_f32_16x16x32_bf16 a[12:15], v[68:71], v[40:43], a[12:15]
ds_read_b128 v[96:99], v23 offset:6144
v_mfma_f32_16x16x32_bf16 a[40:43], v[68:71], v[44:47], a[40:43]
ds_read_b64_tr_b16 v[100:101], v32 offset:14336
v_mfma_f32_16x16x32_bf16 a[68:71], v[68:71], v[48:51], a[68:71]
v_mfma_f32_16x16x32_bf16 a[96:99], v[68:71], v[52:55], a[96:99]
ds_read_b64_tr_b16 v[102:103], v32 offset:16128
v_mfma_f32_16x16x32_bf16 a[16:19], v[72:75], v[40:43], a[16:19]
ds_read_b64_tr_b16 v[104:105], v33 offset:14336
v_mfma_f32_16x16x32_bf16 a[44:47], v[72:75], v[44:47], a[44:47]
ds_read_b64_tr_b16 v[106:107], v33 offset:16128
v_mfma_f32_16x16x32_bf16 a[72:75], v[72:75], v[48:51], a[72:75]
ds_read_b64_tr_b16 v[108:109], v34 offset:14336
v_mfma_f32_16x16x32_bf16 a[100:103], v[72:75], v[52:55], a[100:103]
ds_read_b64_tr_b16 v[110:111], v34 offset:16128
v_mfma_f32_16x16x32_bf16 a[20:23], v[76:79], v[40:43], a[20:23]
ds_read_b64_tr_b16 v[112:113], v35 offset:14336
v_mfma_f32_16x16x32_bf16 a[48:51], v[76:79], v[44:47], a[48:51]
ds_read_b64_tr_b16 v[114:115], v35 offset:16128
v_mfma_f32_16x16x32_bf16 a[76:79], v[76:79], v[48:51], a[76:79]
ds_read_b64_tr_b16 v[116:117], v36 offset:14336
v_mfma_f32_16x16x32_bf16 a[104:107], v[76:79], v[52:55], a[104:107]
ds_read_b64_tr_b16 v[118:119], v36 offset:16128
v_mfma_f32_16x16x32_bf16 a[24:27], v[80:83], v[40:43], a[24:27]
ds_read_b64_tr_b16 v[120:121], v37 offset:14336
v_mfma_f32_16x16x32_bf16 a[52:55], v[80:83], v[44:47], a[52:55]
ds_read_b64_tr_b16 v[122:123], v37 offset:16128
v_mfma_f32_16x16x32_bf16 a[80:83], v[80:83], v[48:51], a[80:83]
ds_read_b64_tr_b16 v[124:125], v38 offset:14336
v_mfma_f32_16x16x32_bf16 a[108:111], v[80:83], v[52:55], a[108:111]
ds_read_b64_tr_b16 v[126:127], v38 offset:16128
s_waitcnt vmcnt(0)
s_barrier
s_waitcnt lgkmcnt(0)
v_mfma_f32_16x16x32_bf16 a[0:3], v[100:103], v[84:87], a[0:3]
s_mov_b32 s16, 384
s_mov_b32 s17, 1376256
v_mfma_f32_16x16x32_bf16 a[28:31], v[100:103], v[88:91], a[28:31]
s_add_u32 m0, s27, 0
s_nop 0
v_mfma_f32_16x16x32_bf16 a[56:59], v[100:103], v[92:95], a[56:59]
buffer_load_dwordx4 v10, s[4:7], s16 offen lds
s_add_u32 m0, s27, 1024
v_mfma_f32_16x16x32_bf16 a[84:87], v[100:103], v[96:99], a[84:87]
s_nop 0
buffer_load_dwordx4 v11, s[4:7], s16 offen lds
v_mfma_f32_16x16x32_bf16 a[4:7], v[104:107], v[84:87], a[4:7]
s_add_u32 m0, s27, 2048
s_nop 0
v_mfma_f32_16x16x32_bf16 a[32:35], v[104:107], v[88:91], a[32:35]
buffer_load_dwordx4 v12, s[4:7], s16 offen lds
s_add_u32 m0, s27, 3072
s_nop 0
v_mfma_f32_16x16x32_bf16 a[60:63], v[104:107], v[92:95], a[60:63]
buffer_load_dwordx4 v13, s[4:7], s16 offen lds
s_add_u32 m0, s28, 16384
v_mfma_f32_16x16x32_bf16 a[88:91], v[104:107], v[96:99], a[88:91]
s_nop 0
buffer_load_dwordx4 v14, s[8:11], s17 offen lds
v_mfma_f32_16x16x32_bf16 a[8:11], v[108:111], v[84:87], a[8:11]
s_add_u32 m0, s28, 17408
s_nop 0
v_mfma_f32_16x16x32_bf16 a[36:39], v[108:111], v[88:91], a[36:39]
buffer_load_dwordx4 v15, s[8:11], s17 offen lds
s_add_u32 m0, s28, 18432
v_mfma_f32_16x16x32_bf16 a[64:67], v[108:111], v[92:95], a[64:67]
s_nop 0
buffer_load_dwordx4 v16, s[8:11], s17 offen lds
v_mfma_f32_16x16x32_bf16 a[92:95], v[108:111], v[96:99], a[92:95]
s_add_u32 m0, s28, 19456
s_nop 0
buffer_load_dwordx4 v17, s[8:11], s17 offen lds
v_mfma_f32_16x16x32_bf16 a[12:15], v[112:115], v[84:87], a[12:15]
s_add_u32 m0, s28, 20480
s_nop 0
v_mfma_f32_16x16x32_bf16 a[40:43], v[112:115], v[88:91], a[40:43]
buffer_load_dwordx4 v18, s[8:11], s17 offen lds
s_add_u32 m0, s28, 21504
v_mfma_f32_16x16x32_bf16 a[68:71], v[112:115], v[92:95], a[68:71]
s_nop 0
buffer_load_dwordx4 v19, s[8:11], s17 offen lds
v_mfma_f32_16x16x32_bf16 a[96:99], v[112:115], v[96:99], a[96:99]
s_add_u32 m0, s28, 22528
s_nop 0
v_mfma_f32_16x16x32_bf16 a[16:19], v[116:119], v[84:87], a[16:19]
buffer_load_dwordx4 v20, s[8:11], s17 offen lds
v_add_u32 v23, 90112, v21
v_add_u32 v32, 90112, v25
v_mfma_f32_16x16x32_bf16 a[44:47], v[116:119], v[88:91], a[44:47]
v_add_u32 v33, 90112, v26
v_add_u32 v34, 90112, v27
v_mfma_f32_16x16x32_bf16 a[72:75], v[116:119], v[92:95], a[72:75]
v_add_u32 v35, 90112, v28
v_add_u32 v36, 90112, v29
v_mfma_f32_16x16x32_bf16 a[100:103], v[116:119], v[96:99], a[100:103]
v_add_u32 v37, 90112, v30
v_add_u32 v38, 90112, v31
v_mfma_f32_16x16x32_bf16 a[20:23], v[120:123], v[84:87], a[20:23]
ds_read_b128 v[40:43], v23 offset:0
ds_read_b128 v[44:47], v23 offset:2048
v_mfma_f32_16x16x32_bf16 a[48:51], v[120:123], v[88:91], a[48:51]
ds_read_b128 v[48:51], v23 offset:4096
ds_read_b128 v[52:55], v23 offset:6144
v_mfma_f32_16x16x32_bf16 a[76:79], v[120:123], v[92:95], a[76:79]
ds_read_b64_tr_b16 v[56:57], v32 offset:0
ds_read_b64_tr_b16 v[58:59], v32 offset:1792
ds_read_b64_tr_b16 v[60:61], v33 offset:0
v_mfma_f32_16x16x32_bf16 a[104:107], v[120:123], v[96:99], a[104:107]
ds_read_b64_tr_b16 v[62:63], v33 offset:1792
ds_read_b64_tr_b16 v[64:65], v34 offset:0
v_mfma_f32_16x16x32_bf16 a[24:27], v[124:127], v[84:87], a[24:27]
ds_read_b64_tr_b16 v[66:67], v34 offset:1792
ds_read_b64_tr_b16 v[68:69], v35 offset:0
v_mfma_f32_16x16x32_bf16 a[52:55], v[124:127], v[88:91], a[52:55]
ds_read_b64_tr_b16 v[70:71], v35 offset:1792
ds_read_b64_tr_b16 v[72:73], v36 offset:0
v_mfma_f32_16x16x32_bf16 a[80:83], v[124:127], v[92:95], a[80:83]
ds_read_b64_tr_b16 v[74:75], v36 offset:1792
ds_read_b64_tr_b16 v[76:77], v37 offset:0
v_mfma_f32_16x16x32_bf16 a[108:111], v[124:127], v[96:99], a[108:111]
ds_read_b64_tr_b16 v[78:79], v37 offset:1792
ds_read_b64_tr_b16 v[80:81], v38 offset:0
ds_read_b64_tr_b16 v[82:83], v38 offset:1792
s_waitcnt lgkmcnt(0)
v_mfma_f32_16x16x32_bf16 a[0:3], v[56:59], v[40:43], a[0:3]
v_mfma_f32_16x16x32_bf16 a[28:31], v[56:59], v[44:47], a[28:31]
v_add_u32 v23, 90112, v22
v_mfma_f32_16x16x32_bf16 a[56:59], v[56:59], v[48:51], a[56:59]
v_add_u32 v32, 90112, v25
v_mfma_f32_16x16x32_bf16 a[84:87], v[56:59], v[52:55], a[84:87]
v_add_u32 v33, 90112, v26
v_mfma_f32_16x16x32_bf16 a[4:7], v[60:63], v[40:43], a[4:7]
v_add_u32 v34, 90112, v27
v_mfma_f32_16x16x32_bf16 a[32:35], v[60:63], v[44:47], a[32:35]
v_add_u32 v35, 90112, v28
v_mfma_f32_16x16x32_bf16 a[60:63], v[60:63], v[48:51], a[60:63]
v_add_u32 v36, 90112, v29
v_mfma_f32_16x16x32_bf16 a[88:91], v[60:63], v[52:55], a[88:91]
v_add_u32 v37, 90112, v30
v_mfma_f32_16x16x32_bf16 a[8:11], v[64:67], v[40:43], a[8:11]
v_add_u32 v38, 90112, v31
v_mfma_f32_16x16x32_bf16 a[36:39], v[64:67], v[44:47], a[36:39]
ds_read_b128 v[84:87], v23 offset:0
v_mfma_f32_16x16x32_bf16 a[64:67], v[64:67], v[48:51], a[64:67]
ds_read_b128 v[88:91], v23 offset:2048
v_mfma_f32_16x16x32_bf16 a[92:95], v[64:67], v[52:55], a[92:95]
ds_read_b128 v[92:95], v23 offset:4096
v_mfma_f32_16x16x32_bf16 a[12:15], v[68:71], v[40:43], a[12:15]
ds_read_b128 v[96:99], v23 offset:6144
v_mfma_f32_16x16x32_bf16 a[40:43], v[68:71], v[44:47], a[40:43]
ds_read_b64_tr_b16 v[100:101], v32 offset:14336
v_mfma_f32_16x16x32_bf16 a[68:71], v[68:71], v[48:51], a[68:71]
v_mfma_f32_16x16x32_bf16 a[96:99], v[68:71], v[52:55], a[96:99]
ds_read_b64_tr_b16 v[102:103], v32 offset:16128
v_mfma_f32_16x16x32_bf16 a[16:19], v[72:75], v[40:43], a[16:19]
ds_read_b64_tr_b16 v[104:105], v33 offset:14336
v_mfma_f32_16x16x32_bf16 a[44:47], v[72:75], v[44:47], a[44:47]
ds_read_b64_tr_b16 v[106:107], v33 offset:16128
v_mfma_f32_16x16x32_bf16 a[72:75], v[72:75], v[48:51], a[72:75]
ds_read_b64_tr_b16 v[108:109], v34 offset:14336
v_mfma_f32_16x16x32_bf16 a[100:103], v[72:75], v[52:55], a[100:103]
ds_read_b64_tr_b16 v[110:111], v34 offset:16128
v_mfma_f32_16x16x32_bf16 a[20:23], v[76:79], v[40:43], a[20:23]
ds_read_b64_tr_b16 v[112:113], v35 offset:14336
v_mfma_f32_16x16x32_bf16 a[48:51], v[76:79], v[44:47], a[48:51]
ds_read_b64_tr_b16 v[114:115], v35 offset:16128
v_mfma_f32_16x16x32_bf16 a[76:79], v[76:79], v[48:51], a[76:79]
ds_read_b64_tr_b16 v[116:117], v36 offset:14336
v_mfma_f32_16x16x32_bf16 a[104:107], v[76:79], v[52:55], a[104:107]
ds_read_b64_tr_b16 v[118:119], v36 offset:16128
v_mfma_f32_16x16x32_bf16 a[24:27], v[80:83], v[40:43], a[24:27]
ds_read_b64_tr_b16 v[120:121], v37 offset:14336
v_mfma_f32_16x16x32_bf16 a[52:55], v[80:83], v[44:47], a[52:55]
ds_read_b64_tr_b16 v[122:123], v37 offset:16128
v_mfma_f32_16x16x32_bf16 a[80:83], v[80:83], v[48:51], a[80:83]
ds_read_b64_tr_b16 v[124:125], v38 offset:14336
v_mfma_f32_16x16x32_bf16 a[108:111], v[80:83], v[52:55], a[108:111]
ds_read_b64_tr_b16 v[126:127], v38 offset:16128
s_waitcnt vmcnt(0)
s_barrier
s_waitcnt lgkmcnt(0)
v_mfma_f32_16x16x32_bf16 a[0:3], v[100:103], v[84:87], a[0:3]
s_mov_b32 s16, 512
s_mov_b32 s17, 1835008
v_mfma_f32_16x16x32_bf16 a[28:31], v[100:103], v[88:91], a[28:31]
s_add_u32 m0, s27, 45056
s_nop 0
v_mfma_f32_16x16x32_bf16 a[56:59], v[100:103], v[92:95], a[56:59]
buffer_load_dwordx4 v10, s[4:7], s16 offen lds
s_add_u32 m0, s27, 46080
v_mfma_f32_16x16x32_bf16 a[84:87], v[100:103], v[96:99], a[84:87]
s_nop 0
buffer_load_dwordx4 v11, s[4:7], s16 offen lds
v_mfma_f32_16x16x32_bf16 a[4:7], v[104:107], v[84:87], a[4:7]
s_add_u32 m0, s27, 47104
s_nop 0
v_mfma_f32_16x16x32_bf16 a[32:35], v[104:107], v[88:91], a[32:35]
buffer_load_dwordx4 v12, s[4:7], s16 offen lds
s_add_u32 m0, s27, 48128
s_nop 0
v_mfma_f32_16x16x32_bf16 a[60:63], v[104:107], v[92:95], a[60:63]
buffer_load_dwordx4 v13, s[4:7], s16 offen lds
s_add_u32 m0, s28, 61440
v_mfma_f32_16x16x32_bf16 a[88:91], v[104:107], v[96:99], a[88:91]
s_nop 0
buffer_load_dwordx4 v14, s[8:11], s17 offen lds
v_mfma_f32_16x16x32_bf16 a[8:11], v[108:111], v[84:87], a[8:11]
s_add_u32 m0, s28, 62464
s_nop 0
v_mfma_f32_16x16x32_bf16 a[36:39], v[108:111], v[88:91], a[36:39]
buffer_load_dwordx4 v15, s[8:11], s17 offen lds
s_add_u32 m0, s28, 63488
v_mfma_f32_16x16x32_bf16 a[64:67], v[108:111], v[92:95], a[64:67]
s_nop 0
buffer_load_dwordx4 v16, s[8:11], s17 offen lds
v_mfma_f32_16x16x32_bf16 a[92:95], v[108:111], v[96:99], a[92:95]
s_add_u32 m0, s28, 64512
s_nop 0
buffer_load_dwordx4 v17, s[8:11], s17 offen lds
v_mfma_f32_16x16x32_bf16 a[12:15], v[112:115], v[84:87], a[12:15]
s_add_u32 m0, s28, 65536
s_nop 0
v_mfma_f32_16x16x32_bf16 a[40:43], v[112:115], v[88:91], a[40:43]
buffer_load_dwordx4 v18, s[8:11], s17 offen lds
s_add_u32 m0, s28, 66560
v_mfma_f32_16x16x32_bf16 a[68:71], v[112:115], v[92:95], a[68:71]
s_nop 0
buffer_load_dwordx4 v19, s[8:11], s17 offen lds
v_mfma_f32_16x16x32_bf16 a[96:99], v[112:115], v[96:99], a[96:99]
s_add_u32 m0, s28, 67584
s_nop 0
v_mfma_f32_16x16x32_bf16 a[16:19], v[116:119], v[84:87], a[16:19]
buffer_load_dwordx4 v20, s[8:11], s17 offen lds
v_add_u32 v23, 0, v21
v_add_u32 v32, 0, v25
v_mfma_f32_16x16x32_bf16 a[44:47], v[116:119], v[88:91], a[44:47]
v_add_u32 v33, 0, v26
v_add_u32 v34, 0, v27
v_mfma_f32_16x16x32_bf16 a[72:75], v[116:119], v[92:95], a[72:75]
v_add_u32 v35, 0, v28
v_add_u32 v36, 0, v29
v_mfma_f32_16x16x32_bf16 a[100:103], v[116:119], v[96:99], a[100:103]
v_add_u32 v37, 0, v30
v_add_u32 v38, 0, v31
v_mfma_f32_16x16x32_bf16 a[20:23], v[120:123], v[84:87], a[20:23]
ds_read_b128 v[40:43], v23 offset:0
ds_read_b128 v[44:47], v23 offset:2048
v_mfma_f32_16x16x32_bf16 a[48:51], v[120:123], v[88:91], a[48:51]
ds_read_b128 v[48:51], v23 offset:4096
ds_read_b128 v[52:55], v23 offset:6144
v_mfma_f32_16x16x32_bf16 a[76:79], v[120:123], v[92:95], a[76:79]
ds_read_b64_tr_b16 v[56:57], v32 offset:0
ds_read_b64_tr_b16 v[58:59], v32 offset:1792
ds_read_b64_tr_b16 v[60:61], v33 offset:0
v_mfma_f32_16x16x32_bf16 a[104:107], v[120:123], v[96:99], a[104:107]
ds_read_b64_tr_b16 v[62:63], v33 offset:1792
ds_read_b64_tr_b16 v[64:65], v34 offset:0
v_mfma_f32_16x16x32_bf16 a[24:27], v[124:127], v[84:87], a[24:27]
ds_read_b64_tr_b16 v[66:67], v34 offset:1792
ds_read_b64_tr_b16 v[68:69], v35 offset:0
v_mfma_f32_16x16x32_bf16 a[52:55], v[124:127], v[88:91], a[52:55]
ds_read_b64_tr_b16 v[70:71], v35 offset:1792
ds_read_b64_tr_b16 v[72:73], v36 offset:0
v_mfma_f32_16x16x32_bf16 a[80:83], v[124:127], v[92:95], a[80:83]
ds_read_b64_tr_b16 v[74:75], v36 offset:1792
ds_read_b64_tr_b16 v[76:77], v37 offset:0
v_mfma_f32_16x16x32_bf16 a[108:111], v[124:127], v[96:99], a[108:111]
ds_read_b64_tr_b16 v[78:79], v37 offset:1792
ds_read_b64_tr_b16 v[80:81], v38 offset:0
ds_read_b64_tr_b16 v[82:83], v38 offset:1792
s_waitcnt lgkmcnt(0)
v_mfma_f32_16x16x32_bf16 a[0:3], v[56:59], v[40:43], a[0:3]
v_mfma_f32_16x16x32_bf16 a[28:31], v[56:59], v[44:47], a[28:31]
v_add_u32 v23, 0, v22
v_mfma_f32_16x16x32_bf16 a[56:59], v[56:59], v[48:51], a[56:59]
v_add_u32 v32, 0, v25
v_mfma_f32_16x16x32_bf16 a[84:87], v[56:59], v[52:55], a[84:87]
v_add_u32 v33, 0, v26
v_mfma_f32_16x16x32_bf16 a[4:7], v[60:63], v[40:43], a[4:7]
v_add_u32 v34, 0, v27
v_mfma_f32_16x16x32_bf16 a[32:35], v[60:63], v[44:47], a[32:35]
v_add_u32 v35, 0, v28
v_mfma_f32_16x16x32_bf16 a[60:63], v[60:63], v[48:51], a[60:63]
v_add_u32 v36, 0, v29
v_mfma_f32_16x16x32_bf16 a[88:91], v[60:63], v[52:55], a[88:91]
v_add_u32 v37, 0, v30
v_mfma_f32_16x16x32_bf16 a[8:11], v[64:67], v[40:43], a[8:11]
v_add_u32 v38, 0, v31
v_mfma_f32_16x16x32_bf16 a[36:39], v[64:67], v[44:47], a[36:39]
ds_read_b128 v[84:87], v23 offset:0
v_mfma_f32_16x16x32_bf16 a[64:67], v[64:67], v[48:51], a[64:67]
ds_read_b128 v[88:91], v23 offset:2048
v_mfma_f32_16x16x32_bf16 a[92:95], v[64:67], v[52:55], a[92:95]
ds_read_b128 v[92:95], v23 offset:4096
v_mfma_f32_16x16x32_bf16 a[12:15], v[68:71], v[40:43], a[12:15]
ds_read_b128 v[96:99], v23 offset:6144
v_mfma_f32_16x16x32_bf16 a[40:43], v[68:71], v[44:47], a[40:43]
ds_read_b64_tr_b16 v[100:101], v32 offset:14336
v_mfma_f32_16x16x32_bf16 a[68:71], v[68:71], v[48:51], a[68:71]
v_mfma_f32_16x16x32_bf16 a[96:99], v[68:71], v[52:55], a[96:99]
ds_read_b64_tr_b16 v[102:103], v32 offset:16128
v_mfma_f32_16x16x32_bf16 a[16:19], v[72:75], v[40:43], a[16:19]
ds_read_b64_tr_b16 v[104:105], v33 offset:14336
v_mfma_f32_16x16x32_bf16 a[44:47], v[72:75], v[44:47], a[44:47]
ds_read_b64_tr_b16 v[106:107], v33 offset:16128
v_mfma_f32_16x16x32_bf16 a[72:75], v[72:75], v[48:51], a[72:75]
ds_read_b64_tr_b16 v[108:109], v34 offset:14336
v_mfma_f32_16x16x32_bf16 a[100:103], v[72:75], v[52:55], a[100:103]
ds_read_b64_tr_b16 v[110:111], v34 offset:16128
v_mfma_f32_16x16x32_bf16 a[20:23], v[76:79], v[40:43], a[20:23]
ds_read_b64_tr_b16 v[112:113], v35 offset:14336
v_mfma_f32_16x16x32_bf16 a[48:51], v[76:79], v[44:47], a[48:51]
ds_read_b64_tr_b16 v[114:115], v35 offset:16128
v_mfma_f32_16x16x32_bf16 a[76:79], v[76:79], v[48:51], a[76:79]
ds_read_b64_tr_b16 v[116:117], v36 offset:14336
v_mfma_f32_16x16x32_bf16 a[104:107], v[76:79], v[52:55], a[104:107]
ds_read_b64_tr_b16 v[118:119], v36 offset:16128
v_mfma_f32_16x16x32_bf16 a[24:27], v[80:83], v[40:43], a[24:27]
ds_read_b64_tr_b16 v[120:121], v37 offset:14336
v_mfma_f32_16x16x32_bf16 a[52:55], v[80:83], v[44:47], a[52:55]
ds_read_b64_tr_b16 v[122:123], v37 offset:16128
v_mfma_f32_16x16x32_bf16 a[80:83], v[80:83], v[48:51], a[80:83]
ds_read_b64_tr_b16 v[124:125], v38 offset:14336
v_mfma_f32_16x16x32_bf16 a[108:111], v[80:83], v[52:55], a[108:111]
ds_read_b64_tr_b16 v[126:127], v38 offset:16128
s_waitcnt vmcnt(0)
s_barrier
s_waitcnt lgkmcnt(0)
v_mfma_f32_16x16x32_bf16 a[0:3], v[100:103], v[84:87], a[0:3]
s_mov_b32 s16, 640
s_mov_b32 s17, 2293760
v_mfma_f32_16x16x32_bf16 a[28:31], v[100:103], v[88:91], a[28:31]
s_add_u32 m0, s27, 90112
s_nop 0
v_mfma_f32_16x16x32_bf16 a[56:59], v[100:103], v[92:95], a[56:59]
buffer_load_dwordx4 v10, s[4:7], s16 offen lds
s_add_u32 m0, s27, 91136
v_mfma_f32_16x16x32_bf16 a[84:87], v[100:103], v[96:99], a[84:87]
s_nop 0
buffer_load_dwordx4 v11, s[4:7], s16 offen lds
v_mfma_f32_16x16x32_bf16 a[4:7], v[104:107], v[84:87], a[4:7]
s_add_u32 m0, s27, 92160
s_nop 0
v_mfma_f32_16x16x32_bf16 a[32:35], v[104:107], v[88:91], a[32:35]
buffer_load_dwordx4 v12, s[4:7], s16 offen lds
s_add_u32 m0, s27, 93184
s_nop 0
v_mfma_f32_16x16x32_bf16 a[60:63], v[104:107], v[92:95], a[60:63]
buffer_load_dwordx4 v13, s[4:7], s16 offen lds
s_add_u32 m0, s28, 106496
v_mfma_f32_16x16x32_bf16 a[88:91], v[104:107], v[96:99], a[88:91]
s_nop 0
buffer_load_dwordx4 v14, s[8:11], s17 offen lds
v_mfma_f32_16x16x32_bf16 a[8:11], v[108:111], v[84:87], a[8:11]
s_add_u32 m0, s28, 107520
s_nop 0
v_mfma_f32_16x16x32_bf16 a[36:39], v[108:111], v[88:91], a[36:39]
buffer_load_dwordx4 v15, s[8:11], s17 offen lds
s_add_u32 m0, s28, 108544
v_mfma_f32_16x16x32_bf16 a[64:67], v[108:111], v[92:95], a[64:67]
s_nop 0
buffer_load_dwordx4 v16, s[8:11], s17 offen lds
v_mfma_f32_16x16x32_bf16 a[92:95], v[108:111], v[96:99], a[92:95]
s_add_u32 m0, s28, 109568
s_nop 0
buffer_load_dwordx4 v17, s[8:11], s17 offen lds
v_mfma_f32_16x16x32_bf16 a[12:15], v[112:115], v[84:87], a[12:15]
s_add_u32 m0, s28, 110592
s_nop 0
v_mfma_f32_16x16x32_bf16 a[40:43], v[112:115], v[88:91], a[40:43]
buffer_load_dwordx4 v18, s[8:11], s17 offen lds
s_add_u32 m0, s28, 111616
v_mfma_f32_16x16x32_bf16 a[68:71], v[112:115], v[92:95], a[68:71]
s_nop 0
buffer_load_dwordx4 v19, s[8:11], s17 offen lds
v_mfma_f32_16x16x32_bf16 a[96:99], v[112:115], v[96:99], a[96:99]
s_add_u32 m0, s28, 112640
s_nop 0
v_mfma_f32_16x16x32_bf16 a[16:19], v[116:119], v[84:87], a[16:19]
buffer_load_dwordx4 v20, s[8:11], s17 offen lds
v_add_u32 v23, 45056, v21
v_add_u32 v32, 45056, v25
v_mfma_f32_16x16x32_bf16 a[44:47], v[116:119], v[88:91], a[44:47]
v_add_u32 v33, 45056, v26
v_add_u32 v34, 45056, v27
v_mfma_f32_16x16x32_bf16 a[72:75], v[116:119], v[92:95], a[72:75]
v_add_u32 v35, 45056, v28
v_add_u32 v36, 45056, v29
v_mfma_f32_16x16x32_bf16 a[100:103], v[116:119], v[96:99], a[100:103]
v_add_u32 v37, 45056, v30
v_add_u32 v38, 45056, v31
v_mfma_f32_16x16x32_bf16 a[20:23], v[120:123], v[84:87], a[20:23]
ds_read_b128 v[40:43], v23 offset:0
ds_read_b128 v[44:47], v23 offset:2048
v_mfma_f32_16x16x32_bf16 a[48:51], v[120:123], v[88:91], a[48:51]
ds_read_b128 v[48:51], v23 offset:4096
ds_read_b128 v[52:55], v23 offset:6144
v_mfma_f32_16x16x32_bf16 a[76:79], v[120:123], v[92:95], a[76:79]
ds_read_b64_tr_b16 v[56:57], v32 offset:0
ds_read_b64_tr_b16 v[58:59], v32 offset:1792
ds_read_b64_tr_b16 v[60:61], v33 offset:0
v_mfma_f32_16x16x32_bf16 a[104:107], v[120:123], v[96:99], a[104:107]
ds_read_b64_tr_b16 v[62:63], v33 offset:1792
ds_read_b64_tr_b16 v[64:65], v34 offset:0
v_mfma_f32_16x16x32_bf16 a[24:27], v[124:127], v[84:87], a[24:27]
ds_read_b64_tr_b16 v[66:67], v34 offset:1792
ds_read_b64_tr_b16 v[68:69], v35 offset:0
v_mfma_f32_16x16x32_bf16 a[52:55], v[124:127], v[88:91], a[52:55]
ds_read_b64_tr_b16 v[70:71], v35 offset:1792
ds_read_b64_tr_b16 v[72:73], v36 offset:0
v_mfma_f32_16x16x32_bf16 a[80:83], v[124:127], v[92:95], a[80:83]
ds_read_b64_tr_b16 v[74:75], v36 offset:1792
ds_read_b64_tr_b16 v[76:77], v37 offset:0
v_mfma_f32_16x16x32_bf16 a[108:111], v[124:127], v[96:99], a[108:111]
ds_read_b64_tr_b16 v[78:79], v37 offset:1792
ds_read_b64_tr_b16 v[80:81], v38 offset:0
ds_read_b64_tr_b16 v[82:83], v38 offset:1792
s_waitcnt lgkmcnt(0)
v_mfma_f32_16x16x32_bf16 a[0:3], v[56:59], v[40:43], a[0:3]
v_mfma_f32_16x16x32_bf16 a[28:31], v[56:59], v[44:47], a[28:31]
v_add_u32 v23, 45056, v22
v_mfma_f32_16x16x32_bf16 a[56:59], v[56:59], v[48:51], a[56:59]
v_add_u32 v32, 45056, v25
v_mfma_f32_16x16x32_bf16 a[84:87], v[56:59], v[52:55], a[84:87]
v_add_u32 v33, 45056, v26
v_mfma_f32_16x16x32_bf16 a[4:7], v[60:63], v[40:43], a[4:7]
v_add_u32 v34, 45056, v27
v_mfma_f32_16x16x32_bf16 a[32:35], v[60:63], v[44:47], a[32:35]
v_add_u32 v35, 45056, v28
v_mfma_f32_16x16x32_bf16 a[60:63], v[60:63], v[48:51], a[60:63]
v_add_u32 v36, 45056, v29
v_mfma_f32_16x16x32_bf16 a[88:91], v[60:63], v[52:55], a[88:91]
v_add_u32 v37, 45056, v30
v_mfma_f32_16x16x32_bf16 a[8:11], v[64:67], v[40:43], a[8:11]
v_add_u32 v38, 45056, v31
v_mfma_f32_16x16x32_bf16 a[36:39], v[64:67], v[44:47], a[36:39]
ds_read_b128 v[84:87], v23 offset:0
v_mfma_f32_16x16x32_bf16 a[64:67], v[64:67], v[48:51], a[64:67]
ds_read_b128 v[88:91], v23 offset:2048
v_mfma_f32_16x16x32_bf16 a[92:95], v[64:67], v[52:55], a[92:95]
ds_read_b128 v[92:95], v23 offset:4096
v_mfma_f32_16x16x32_bf16 a[12:15], v[68:71], v[40:43], a[12:15]
ds_read_b128 v[96:99], v23 offset:6144
v_mfma_f32_16x16x32_bf16 a[40:43], v[68:71], v[44:47], a[40:43]
ds_read_b64_tr_b16 v[100:101], v32 offset:14336
v_mfma_f32_16x16x32_bf16 a[68:71], v[68:71], v[48:51], a[68:71]
v_mfma_f32_16x16x32_bf16 a[96:99], v[68:71], v[52:55], a[96:99]
ds_read_b64_tr_b16 v[102:103], v32 offset:16128
v_mfma_f32_16x16x32_bf16 a[16:19], v[72:75], v[40:43], a[16:19]
ds_read_b64_tr_b16 v[104:105], v33 offset:14336
v_mfma_f32_16x16x32_bf16 a[44:47], v[72:75], v[44:47], a[44:47]
ds_read_b64_tr_b16 v[106:107], v33 offset:16128
v_mfma_f32_16x16x32_bf16 a[72:75], v[72:75], v[48:51], a[72:75]
ds_read_b64_tr_b16 v[108:109], v34 offset:14336
v_mfma_f32_16x16x32_bf16 a[100:103], v[72:75], v[52:55], a[100:103]
ds_read_b64_tr_b16 v[110:111], v34 offset:16128
v_mfma_f32_16x16x32_bf16 a[20:23], v[76:79], v[40:43], a[20:23]
ds_read_b64_tr_b16 v[112:113], v35 offset:14336
v_mfma_f32_16x16x32_bf16 a[48:51], v[76:79], v[44:47], a[48:51]
ds_read_b64_tr_b16 v[114:115], v35 offset:16128
v_mfma_f32_16x16x32_bf16 a[76:79], v[76:79], v[48:51], a[76:79]
ds_read_b64_tr_b16 v[116:117], v36 offset:14336
v_mfma_f32_16x16x32_bf16 a[104:107], v[76:79], v[52:55], a[104:107]
ds_read_b64_tr_b16 v[118:119], v36 offset:16128
v_mfma_f32_16x16x32_bf16 a[24:27], v[80:83], v[40:43], a[24:27]
ds_read_b64_tr_b16 v[120:121], v37 offset:14336
v_mfma_f32_16x16x32_bf16 a[52:55], v[80:83], v[44:47], a[52:55]
ds_read_b64_tr_b16 v[122:123], v37 offset:16128
v_mfma_f32_16x16x32_bf16 a[80:83], v[80:83], v[48:51], a[80:83]
ds_read_b64_tr_b16 v[124:125], v38 offset:14336
v_mfma_f32_16x16x32_bf16 a[108:111], v[80:83], v[52:55], a[108:111]
ds_read_b64_tr_b16 v[126:127], v38 offset:16128
s_waitcnt vmcnt(0)
s_barrier
s_waitcnt lgkmcnt(0)
v_mfma_f32_16x16x32_bf16 a[0:3], v[100:103], v[84:87], a[0:3]
s_mov_b32 s16, 768
s_mov_b32 s17, 2752512
v_mfma_f32_16x16x32_bf16 a[28:31], v[100:103], v[88:91], a[28:31]
s_add_u32 m0, s27, 0
s_nop 0
v_mfma_f32_16x16x32_bf16 a[56:59], v[100:103], v[92:95], a[56:59]
buffer_load_dwordx4 v10, s[4:7], s16 offen lds
s_add_u32 m0, s27, 1024
v_mfma_f32_16x16x32_bf16 a[84:87], v[100:103], v[96:99], a[84:87]
s_nop 0
buffer_load_dwordx4 v11, s[4:7], s16 offen lds
v_mfma_f32_16x16x32_bf16 a[4:7], v[104:107], v[84:87], a[4:7]
s_add_u32 m0, s27, 2048
s_nop 0
v_mfma_f32_16x16x32_bf16 a[32:35], v[104:107], v[88:91], a[32:35]
buffer_load_dwordx4 v12, s[4:7], s16 offen lds
s_add_u32 m0, s27, 3072
s_nop 0
v_mfma_f32_16x16x32_bf16 a[60:63], v[104:107], v[92:95], a[60:63]
buffer_load_dwordx4 v13, s[4:7], s16 offen lds
s_add_u32 m0, s28, 16384
v_mfma_f32_16x16x32_bf16 a[88:91], v[104:107], v[96:99], a[88:91]
s_nop 0
buffer_load_dwordx4 v14, s[8:11], s17 offen lds
v_mfma_f32_16x16x32_bf16 a[8:11], v[108:111], v[84:87], a[8:11]
s_add_u32 m0, s28, 17408
s_nop 0
v_mfma_f32_16x16x32_bf16 a[36:39], v[108:111], v[88:91], a[36:39]
buffer_load_dwordx4 v15, s[8:11], s17 offen lds
s_add_u32 m0, s28, 18432
v_mfma_f32_16x16x32_bf16 a[64:67], v[108:111], v[92:95], a[64:67]
s_nop 0
buffer_load_dwordx4 v16, s[8:11], s17 offen lds
v_mfma_f32_16x16x32_bf16 a[92:95], v[108:111], v[96:99], a[92:95]
s_add_u32 m0, s28, 19456
s_nop 0
buffer_load_dwordx4 v17, s[8:11], s17 offen lds
v_mfma_f32_16x16x32_bf16 a[12:15], v[112:115], v[84:87], a[12:15]
s_add_u32 m0, s28, 20480
s_nop 0
v_mfma_f32_16x16x32_bf16 a[40:43], v[112:115], v[88:91], a[40:43]
buffer_load_dwordx4 v18, s[8:11], s17 offen lds
s_add_u32 m0, s28, 21504
v_mfma_f32_16x16x32_bf16 a[68:71], v[112:115], v[92:95], a[68:71]
s_nop 0
buffer_load_dwordx4 v19, s[8:11], s17 offen lds
v_mfma_f32_16x16x32_bf16 a[96:99], v[112:115], v[96:99], a[96:99]
s_add_u32 m0, s28, 22528
s_nop 0
v_mfma_f32_16x16x32_bf16 a[16:19], v[116:119], v[84:87], a[16:19]
buffer_load_dwordx4 v20, s[8:11], s17 offen lds
v_add_u32 v23, 90112, v21
v_add_u32 v32, 90112, v25
v_mfma_f32_16x16x32_bf16 a[44:47], v[116:119], v[88:91], a[44:47]
v_add_u32 v33, 90112, v26
v_add_u32 v34, 90112, v27
v_mfma_f32_16x16x32_bf16 a[72:75], v[116:119], v[92:95], a[72:75]
v_add_u32 v35, 90112, v28
v_add_u32 v36, 90112, v29
v_mfma_f32_16x16x32_bf16 a[100:103], v[116:119], v[96:99], a[100:103]
v_add_u32 v37, 90112, v30
v_add_u32 v38, 90112, v31
v_mfma_f32_16x16x32_bf16 a[20:23], v[120:123], v[84:87], a[20:23]
ds_read_b128 v[40:43], v23 offset:0
ds_read_b128 v[44:47], v23 offset:2048
v_mfma_f32_16x16x32_bf16 a[48:51], v[120:123], v[88:91], a[48:51]
ds_read_b128 v[48:51], v23 offset:4096
ds_read_b128 v[52:55], v23 offset:6144
v_mfma_f32_16x16x32_bf16 a[76:79], v[120:123], v[92:95], a[76:79]
ds_read_b64_tr_b16 v[56:57], v32 offset:0
ds_read_b64_tr_b16 v[58:59], v32 offset:1792
ds_read_b64_tr_b16 v[60:61], v33 offset:0
v_mfma_f32_16x16x32_bf16 a[104:107], v[120:123], v[96:99], a[104:107]
ds_read_b64_tr_b16 v[62:63], v33 offset:1792
ds_read_b64_tr_b16 v[64:65], v34 offset:0
v_mfma_f32_16x16x32_bf16 a[24:27], v[124:127], v[84:87], a[24:27]
ds_read_b64_tr_b16 v[66:67], v34 offset:1792
ds_read_b64_tr_b16 v[68:69], v35 offset:0
v_mfma_f32_16x16x32_bf16 a[52:55], v[124:127], v[88:91], a[52:55]
ds_read_b64_tr_b16 v[70:71], v35 offset:1792
ds_read_b64_tr_b16 v[72:73], v36 offset:0
v_mfma_f32_16x16x32_bf16 a[80:83], v[124:127], v[92:95], a[80:83]
ds_read_b64_tr_b16 v[74:75], v36 offset:1792
ds_read_b64_tr_b16 v[76:77], v37 offset:0
v_mfma_f32_16x16x32_bf16 a[108:111], v[124:127], v[96:99], a[108:111]
ds_read_b64_tr_b16 v[78:79], v37 offset:1792
ds_read_b64_tr_b16 v[80:81], v38 offset:0
ds_read_b64_tr_b16 v[82:83], v38 offset:1792
s_waitcnt lgkmcnt(0)
v_mfma_f32_16x16x32_bf16 a[0:3], v[56:59], v[40:43], a[0:3]
v_mfma_f32_16x16x32_bf16 a[28:31], v[56:59], v[44:47], a[28:31]
v_add_u32 v23, 90112, v22
v_mfma_f32_16x16x32_bf16 a[56:59], v[56:59], v[48:51], a[56:59]
v_add_u32 v32, 90112, v25
v_mfma_f32_16x16x32_bf16 a[84:87], v[56:59], v[52:55], a[84:87]
v_add_u32 v33, 90112, v26
v_mfma_f32_16x16x32_bf16 a[4:7], v[60:63], v[40:43], a[4:7]
v_add_u32 v34, 90112, v27
v_mfma_f32_16x16x32_bf16 a[32:35], v[60:63], v[44:47], a[32:35]
v_add_u32 v35, 90112, v28
v_mfma_f32_16x16x32_bf16 a[60:63], v[60:63], v[48:51], a[60:63]
v_add_u32 v36, 90112, v29
v_mfma_f32_16x16x32_bf16 a[88:91], v[60:63], v[52:55], a[88:91]
v_add_u32 v37, 90112, v30
v_mfma_f32_16x16x32_bf16 a[8:11], v[64:67], v[40:43], a[8:11]
v_add_u32 v38, 90112, v31
v_mfma_f32_16x16x32_bf16 a[36:39], v[64:67], v[44:47], a[36:39]
ds_read_b128 v[84:87], v23 offset:0
v_mfma_f32_16x16x32_bf16 a[64:67], v[64:67], v[48:51], a[64:67]
ds_read_b128 v[88:91], v23 offset:2048
v_mfma_f32_16x16x32_bf16 a[92:95], v[64:67], v[52:55], a[92:95]
ds_read_b128 v[92:95], v23 offset:4096
v_mfma_f32_16x16x32_bf16 a[12:15], v[68:71], v[40:43], a[12:15]
ds_read_b128 v[96:99], v23 offset:6144
v_mfma_f32_16x16x32_bf16 a[40:43], v[68:71], v[44:47], a[40:43]
ds_read_b64_tr_b16 v[100:101], v32 offset:14336
v_mfma_f32_16x16x32_bf16 a[68:71], v[68:71], v[48:51], a[68:71]
v_mfma_f32_16x16x32_bf16 a[96:99], v[68:71], v[52:55], a[96:99]
ds_read_b64_tr_b16 v[102:103], v32 offset:16128
v_mfma_f32_16x16x32_bf16 a[16:19], v[72:75], v[40:43], a[16:19]
ds_read_b64_tr_b16 v[104:105], v33 offset:14336
v_mfma_f32_16x16x32_bf16 a[44:47], v[72:75], v[44:47], a[44:47]
ds_read_b64_tr_b16 v[106:107], v33 offset:16128
v_mfma_f32_16x16x32_bf16 a[72:75], v[72:75], v[48:51], a[72:75]
ds_read_b64_tr_b16 v[108:109], v34 offset:14336
v_mfma_f32_16x16x32_bf16 a[100:103], v[72:75], v[52:55], a[100:103]
ds_read_b64_tr_b16 v[110:111], v34 offset:16128
v_mfma_f32_16x16x32_bf16 a[20:23], v[76:79], v[40:43], a[20:23]
ds_read_b64_tr_b16 v[112:113], v35 offset:14336
v_mfma_f32_16x16x32_bf16 a[48:51], v[76:79], v[44:47], a[48:51]
ds_read_b64_tr_b16 v[114:115], v35 offset:16128
v_mfma_f32_16x16x32_bf16 a[76:79], v[76:79], v[48:51], a[76:79]
ds_read_b64_tr_b16 v[116:117], v36 offset:14336
v_mfma_f32_16x16x32_bf16 a[104:107], v[76:79], v[52:55], a[104:107]
ds_read_b64_tr_b16 v[118:119], v36 offset:16128
v_mfma_f32_16x16x32_bf16 a[24:27], v[80:83], v[40:43], a[24:27]
ds_read_b64_tr_b16 v[120:121], v37 offset:14336
v_mfma_f32_16x16x32_bf16 a[52:55], v[80:83], v[44:47], a[52:55]
ds_read_b64_tr_b16 v[122:123], v37 offset:16128
v_mfma_f32_16x16x32_bf16 a[80:83], v[80:83], v[48:51], a[80:83]
ds_read_b64_tr_b16 v[124:125], v38 offset:14336
v_mfma_f32_16x16x32_bf16 a[108:111], v[80:83], v[52:55], a[108:111]
ds_read_b64_tr_b16 v[126:127], v38 offset:16128
s_waitcnt vmcnt(0)
s_barrier
s_waitcnt lgkmcnt(0)
v_mfma_f32_16x16x32_bf16 a[0:3], v[100:103], v[84:87], a[0:3]
s_mov_b32 s16, 896
s_mov_b32 s17, 3211264
v_mfma_f32_16x16x32_bf16 a[28:31], v[100:103], v[88:91], a[28:31]
s_add_u32 m0, s27, 45056
s_nop 0
v_mfma_f32_16x16x32_bf16 a[56:59], v[100:103], v[92:95], a[56:59]
buffer_load_dwordx4 v10, s[4:7], s16 offen lds
s_add_u32 m0, s27, 46080
v_mfma_f32_16x16x32_bf16 a[84:87], v[100:103], v[96:99], a[84:87]
s_nop 0
buffer_load_dwordx4 v11, s[4:7], s16 offen lds
v_mfma_f32_16x16x32_bf16 a[4:7], v[104:107], v[84:87], a[4:7]
s_add_u32 m0, s27, 47104
s_nop 0
v_mfma_f32_16x16x32_bf16 a[32:35], v[104:107], v[88:91], a[32:35]
buffer_load_dwordx4 v12, s[4:7], s16 offen lds
s_add_u32 m0, s27, 48128
s_nop 0
v_mfma_f32_16x16x32_bf16 a[60:63], v[104:107], v[92:95], a[60:63]
buffer_load_dwordx4 v13, s[4:7], s16 offen lds
s_add_u32 m0, s28, 61440
v_mfma_f32_16x16x32_bf16 a[88:91], v[104:107], v[96:99], a[88:91]
s_nop 0
buffer_load_dwordx4 v14, s[8:11], s17 offen lds
v_mfma_f32_16x16x32_bf16 a[8:11], v[108:111], v[84:87], a[8:11]
s_add_u32 m0, s28, 62464
s_nop 0
v_mfma_f32_16x16x32_bf16 a[36:39], v[108:111], v[88:91], a[36:39]
buffer_load_dwordx4 v15, s[8:11], s17 offen lds
s_add_u32 m0, s28, 63488
v_mfma_f32_16x16x32_bf16 a[64:67], v[108:111], v[92:95], a[64:67]
s_nop 0
buffer_load_dwordx4 v16, s[8:11], s17 offen lds
v_mfma_f32_16x16x32_bf16 a[92:95], v[108:111], v[96:99], a[92:95]
s_add_u32 m0, s28, 64512
s_nop 0
buffer_load_dwordx4 v17, s[8:11], s17 offen lds
v_mfma_f32_16x16x32_bf16 a[12:15], v[112:115], v[84:87], a[12:15]
s_add_u32 m0, s28, 65536
s_nop 0
v_mfma_f32_16x16x32_bf16 a[40:43], v[112:115], v[88:91], a[40:43]
buffer_load_dwordx4 v18, s[8:11], s17 offen lds
s_add_u32 m0, s28, 66560
v_mfma_f32_16x16x32_bf16 a[68:71], v[112:115], v[92:95], a[68:71]
s_nop 0
buffer_load_dwordx4 v19, s[8:11], s17 offen lds
v_mfma_f32_16x16x32_bf16 a[96:99], v[112:115], v[96:99], a[96:99]
s_add_u32 m0, s28, 67584
s_nop 0
v_mfma_f32_16x16x32_bf16 a[16:19], v[116:119], v[84:87], a[16:19]
buffer_load_dwordx4 v20, s[8:11], s17 offen lds
v_add_u32 v23, 0, v21
v_add_u32 v32, 0, v25
v_mfma_f32_16x16x32_bf16 a[44:47], v[116:119], v[88:91], a[44:47]
v_add_u32 v33, 0, v26
v_add_u32 v34, 0, v27
v_mfma_f32_16x16x32_bf16 a[72:75], v[116:119], v[92:95], a[72:75]
v_add_u32 v35, 0, v28
v_add_u32 v36, 0, v29
v_mfma_f32_16x16x32_bf16 a[100:103], v[116:119], v[96:99], a[100:103]
v_add_u32 v37, 0, v30
v_add_u32 v38, 0, v31
v_mfma_f32_16x16x32_bf16 a[20:23], v[120:123], v[84:87], a[20:23]
ds_read_b128 v[40:43], v23 offset:0
ds_read_b128 v[44:47], v23 offset:2048
v_mfma_f32_16x16x32_bf16 a[48:51], v[120:123], v[88:91], a[48:51]
ds_read_b128 v[48:51], v23 offset:4096
ds_read_b128 v[52:55], v23 offset:6144
v_mfma_f32_16x16x32_bf16 a[76:79], v[120:123], v[92:95], a[76:79]
ds_read_b64_tr_b16 v[56:57], v32 offset:0
ds_read_b64_tr_b16 v[58:59], v32 offset:1792
ds_read_b64_tr_b16 v[60:61], v33 offset:0
v_mfma_f32_16x16x32_bf16 a[104:107], v[120:123], v[96:99], a[104:107]
ds_read_b64_tr_b16 v[62:63], v33 offset:1792
ds_read_b64_tr_b16 v[64:65], v34 offset:0
v_mfma_f32_16x16x32_bf16 a[24:27], v[124:127], v[84:87], a[24:27]
ds_read_b64_tr_b16 v[66:67], v34 offset:1792
ds_read_b64_tr_b16 v[68:69], v35 offset:0
v_mfma_f32_16x16x32_bf16 a[52:55], v[124:127], v[88:91], a[52:55]
ds_read_b64_tr_b16 v[70:71], v35 offset:1792
ds_read_b64_tr_b16 v[72:73], v36 offset:0
v_mfma_f32_16x16x32_bf16 a[80:83], v[124:127], v[92:95], a[80:83]
ds_read_b64_tr_b16 v[74:75], v36 offset:1792
ds_read_b64_tr_b16 v[76:77], v37 offset:0
v_mfma_f32_16x16x32_bf16 a[108:111], v[124:127], v[96:99], a[108:111]
ds_read_b64_tr_b16 v[78:79], v37 offset:1792
ds_read_b64_tr_b16 v[80:81], v38 offset:0
ds_read_b64_tr_b16 v[82:83], v38 offset:1792
s_waitcnt lgkmcnt(0)
v_mfma_f32_16x16x32_bf16 a[0:3], v[56:59], v[40:43], a[0:3]
v_mfma_f32_16x16x32_bf16 a[28:31], v[56:59], v[44:47], a[28:31]
v_add_u32 v23, 0, v22
v_mfma_f32_16x16x32_bf16 a[56:59], v[56:59], v[48:51], a[56:59]
v_add_u32 v32, 0, v25
v_mfma_f32_16x16x32_bf16 a[84:87], v[56:59], v[52:55], a[84:87]
v_add_u32 v33, 0, v26
v_mfma_f32_16x16x32_bf16 a[4:7], v[60:63], v[40:43], a[4:7]
v_add_u32 v34, 0, v27
v_mfma_f32_16x16x32_bf16 a[32:35], v[60:63], v[44:47], a[32:35]
v_add_u32 v35, 0, v28
v_mfma_f32_16x16x32_bf16 a[60:63], v[60:63], v[48:51], a[60:63]
v_add_u32 v36, 0, v29
v_mfma_f32_16x16x32_bf16 a[88:91], v[60:63], v[52:55], a[88:91]
v_add_u32 v37, 0, v30
v_mfma_f32_16x16x32_bf16 a[8:11], v[64:67], v[40:43], a[8:11]
v_add_u32 v38, 0, v31
v_mfma_f32_16x16x32_bf16 a[36:39], v[64:67], v[44:47], a[36:39]
ds_read_b128 v[84:87], v23 offset:0
v_mfma_f32_16x16x32_bf16 a[64:67], v[64:67], v[48:51], a[64:67]
ds_read_b128 v[88:91], v23 offset:2048
v_mfma_f32_16x16x32_bf16 a[92:95], v[64:67], v[52:55], a[92:95]
ds_read_b128 v[92:95], v23 offset:4096
v_mfma_f32_16x16x32_bf16 a[12:15], v[68:71], v[40:43], a[12:15]
ds_read_b128 v[96:99], v23 offset:6144
v_mfma_f32_16x16x32_bf16 a[40:43], v[68:71], v[44:47], a[40:43]
ds_read_b64_tr_b16 v[100:101], v32 offset:14336
v_mfma_f32_16x16x32_bf16 a[68:71], v[68:71], v[48:51], a[68:71]
v_mfma_f32_16x16x32_bf16 a[96:99], v[68:71], v[52:55], a[96:99]
ds_read_b64_tr_b16 v[102:103], v32 offset:16128
v_mfma_f32_16x16x32_bf16 a[16:19], v[72:75], v[40:43], a[16:19]
ds_read_b64_tr_b16 v[104:105], v33 offset:14336
v_mfma_f32_16x16x32_bf16 a[44:47], v[72:75], v[44:47], a[44:47]
ds_read_b64_tr_b16 v[106:107], v33 offset:16128
v_mfma_f32_16x16x32_bf16 a[72:75], v[72:75], v[48:51], a[72:75]
ds_read_b64_tr_b16 v[108:109], v34 offset:14336
v_mfma_f32_16x16x32_bf16 a[100:103], v[72:75], v[52:55], a[100:103]
ds_read_b64_tr_b16 v[110:111], v34 offset:16128
v_mfma_f32_16x16x32_bf16 a[20:23], v[76:79], v[40:43], a[20:23]
ds_read_b64_tr_b16 v[112:113], v35 offset:14336
v_mfma_f32_16x16x32_bf16 a[48:51], v[76:79], v[44:47], a[48:51]
ds_read_b64_tr_b16 v[114:115], v35 offset:16128
v_mfma_f32_16x16x32_bf16 a[76:79], v[76:79], v[48:51], a[76:79]
ds_read_b64_tr_b16 v[116:117], v36 offset:14336
v_mfma_f32_16x16x32_bf16 a[104:107], v[76:79], v[52:55], a[104:107]
ds_read_b64_tr_b16 v[118:119], v36 offset:16128
v_mfma_f32_16x16x32_bf16 a[24:27], v[80:83], v[40:43], a[24:27]
ds_read_b64_tr_b16 v[120:121], v37 offset:14336
v_mfma_f32_16x16x32_bf16 a[52:55], v[80:83], v[44:47], a[52:55]
ds_read_b64_tr_b16 v[122:123], v37 offset:16128
v_mfma_f32_16x16x32_bf16 a[80:83], v[80:83], v[48:51], a[80:83]
ds_read_b64_tr_b16 v[124:125], v38 offset:14336
v_mfma_f32_16x16x32_bf16 a[108:111], v[80:83], v[52:55], a[108:111]
ds_read_b64_tr_b16 v[126:127], v38 offset:16128
s_waitcnt vmcnt(0)
s_barrier
s_waitcnt lgkmcnt(0)
v_mfma_f32_16x16x32_bf16 a[0:3], v[100:103], v[84:87], a[0:3]
s_mov_b32 s16, 1024
s_mov_b32 s17, 3670016
v_mfma_f32_16x16x32_bf16 a[28:31], v[100:103], v[88:91], a[28:31]
s_add_u32 m0, s27, 90112
s_nop 0
v_mfma_f32_16x16x32_bf16 a[56:59], v[100:103], v[92:95], a[56:59]
buffer_load_dwordx4 v10, s[4:7], s16 offen lds
s_add_u32 m0, s27, 91136
v_mfma_f32_16x16x32_bf16 a[84:87], v[100:103], v[96:99], a[84:87]
s_nop 0
buffer_load_dwordx4 v11, s[4:7], s16 offen lds
v_mfma_f32_16x16x32_bf16 a[4:7], v[104:107], v[84:87], a[4:7]
s_add_u32 m0, s27, 92160
s_nop 0
v_mfma_f32_16x16x32_bf16 a[32:35], v[104:107], v[88:91], a[32:35]
buffer_load_dwordx4 v12, s[4:7], s16 offen lds
s_add_u32 m0, s27, 93184
s_nop 0
v_mfma_f32_16x16x32_bf16 a[60:63], v[104:107], v[92:95], a[60:63]
buffer_load_dwordx4 v13, s[4:7], s16 offen lds
s_add_u32 m0, s28, 106496
v_mfma_f32_16x16x32_bf16 a[88:91], v[104:107], v[96:99], a[88:91]
s_nop 0
buffer_load_dwordx4 v14, s[8:11], s17 offen lds
v_mfma_f32_16x16x32_bf16 a[8:11], v[108:111], v[84:87], a[8:11]
s_add_u32 m0, s28, 107520
s_nop 0
v_mfma_f32_16x16x32_bf16 a[36:39], v[108:111], v[88:91], a[36:39]
buffer_load_dwordx4 v15, s[8:11], s17 offen lds
s_add_u32 m0, s28, 108544
v_mfma_f32_16x16x32_bf16 a[64:67], v[108:111], v[92:95], a[64:67]
s_nop 0
buffer_load_dwordx4 v16, s[8:11], s17 offen lds
v_mfma_f32_16x16x32_bf16 a[92:95], v[108:111], v[96:99], a[92:95]
s_add_u32 m0, s28, 109568
s_nop 0
buffer_load_dwordx4 v17, s[8:11], s17 offen lds
v_mfma_f32_16x16x32_bf16 a[12:15], v[112:115], v[84:87], a[12:15]
s_add_u32 m0, s28, 110592
s_nop 0
v_mfma_f32_16x16x32_bf16 a[40:43], v[112:115], v[88:91], a[40:43]
buffer_load_dwordx4 v18, s[8:11], s17 offen lds
s_add_u32 m0, s28, 111616
v_mfma_f32_16x16x32_bf16 a[68:71], v[112:115], v[92:95], a[68:71]
s_nop 0
buffer_load_dwordx4 v19, s[8:11], s17 offen lds
v_mfma_f32_16x16x32_bf16 a[96:99], v[112:115], v[96:99], a[96:99]
s_add_u32 m0, s28, 112640
s_nop 0
v_mfma_f32_16x16x32_bf16 a[16:19], v[116:119], v[84:87], a[16:19]
buffer_load_dwordx4 v20, s[8:11], s17 offen lds
v_add_u32 v23, 45056, v21
v_add_u32 v32, 45056, v25
v_mfma_f32_16x16x32_bf16 a[44:47], v[116:119], v[88:91], a[44:47]
v_add_u32 v33, 45056, v26
v_add_u32 v34, 45056, v27
v_mfma_f32_16x16x32_bf16 a[72:75], v[116:119], v[92:95], a[72:75]
v_add_u32 v35, 45056, v28
v_add_u32 v36, 45056, v29
v_mfma_f32_16x16x32_bf16 a[100:103], v[116:119], v[96:99], a[100:103]
v_add_u32 v37, 45056, v30
v_add_u32 v38, 45056, v31
v_mfma_f32_16x16x32_bf16 a[20:23], v[120:123], v[84:87], a[20:23]
ds_read_b128 v[40:43], v23 offset:0
ds_read_b128 v[44:47], v23 offset:2048
v_mfma_f32_16x16x32_bf16 a[48:51], v[120:123], v[88:91], a[48:51]
ds_read_b128 v[48:51], v23 offset:4096
ds_read_b128 v[52:55], v23 offset:6144
v_mfma_f32_16x16x32_bf16 a[76:79], v[120:123], v[92:95], a[76:79]
ds_read_b64_tr_b16 v[56:57], v32 offset:0
ds_read_b64_tr_b16 v[58:59], v32 offset:1792
ds_read_b64_tr_b16 v[60:61], v33 offset:0
v_mfma_f32_16x16x32_bf16 a[104:107], v[120:123], v[96:99], a[104:107]
ds_read_b64_tr_b16 v[62:63], v33 offset:1792
ds_read_b64_tr_b16 v[64:65], v34 offset:0
v_mfma_f32_16x16x32_bf16 a[24:27], v[124:127], v[84:87], a[24:27]
ds_read_b64_tr_b16 v[66:67], v34 offset:1792
ds_read_b64_tr_b16 v[68:69], v35 offset:0
v_mfma_f32_16x16x32_bf16 a[52:55], v[124:127], v[88:91], a[52:55]
ds_read_b64_tr_b16 v[70:71], v35 offset:1792
ds_read_b64_tr_b16 v[72:73], v36 offset:0
v_mfma_f32_16x16x32_bf16 a[80:83], v[124:127], v[92:95], a[80:83]
ds_read_b64_tr_b16 v[74:75], v36 offset:1792
ds_read_b64_tr_b16 v[76:77], v37 offset:0
v_mfma_f32_16x16x32_bf16 a[108:111], v[124:127], v[96:99], a[108:111]
ds_read_b64_tr_b16 v[78:79], v37 offset:1792
ds_read_b64_tr_b16 v[80:81], v38 offset:0
ds_read_b64_tr_b16 v[82:83], v38 offset:1792
s_waitcnt lgkmcnt(0)
v_mfma_f32_16x16x32_bf16 a[0:3], v[56:59], v[40:43], a[0:3]
v_mfma_f32_16x16x32_bf16 a[28:31], v[56:59], v[44:47], a[28:31]
v_add_u32 v23, 45056, v22
v_mfma_f32_16x16x32_bf16 a[56:59], v[56:59], v[48:51], a[56:59]
v_add_u32 v32, 45056, v25
v_mfma_f32_16x16x32_bf16 a[84:87], v[56:59], v[52:55], a[84:87]
v_add_u32 v33, 45056, v26
v_mfma_f32_16x16x32_bf16 a[4:7], v[60:63], v[40:43], a[4:7]
v_add_u32 v34, 45056, v27
v_mfma_f32_16x16x32_bf16 a[32:35], v[60:63], v[44:47], a[32:35]
v_add_u32 v35, 45056, v28
v_mfma_f32_16x16x32_bf16 a[60:63], v[60:63], v[48:51], a[60:63]
v_add_u32 v36, 45056, v29
v_mfma_f32_16x16x32_bf16 a[88:91], v[60:63], v[52:55], a[88:91]
v_add_u32 v37, 45056, v30
v_mfma_f32_16x16x32_bf16 a[8:11], v[64:67], v[40:43], a[8:11]
v_add_u32 v38, 45056, v31
v_mfma_f32_16x16x32_bf16 a[36:39], v[64:67], v[44:47], a[36:39]
ds_read_b128 v[84:87], v23 offset:0
v_mfma_f32_16x16x32_bf16 a[64:67], v[64:67], v[48:51], a[64:67]
ds_read_b128 v[88:91], v23 offset:2048
v_mfma_f32_16x16x32_bf16 a[92:95], v[64:67], v[52:55], a[92:95]
ds_read_b128 v[92:95], v23 offset:4096
v_mfma_f32_16x16x32_bf16 a[12:15], v[68:71], v[40:43], a[12:15]
ds_read_b128 v[96:99], v23 offset:6144
v_mfma_f32_16x16x32_bf16 a[40:43], v[68:71], v[44:47], a[40:43]
ds_read_b64_tr_b16 v[100:101], v32 offset:14336
v_mfma_f32_16x16x32_bf16 a[68:71], v[68:71], v[48:51], a[68:71]
v_mfma_f32_16x16x32_bf16 a[96:99], v[68:71], v[52:55], a[96:99]
ds_read_b64_tr_b16 v[102:103], v32 offset:16128
v_mfma_f32_16x16x32_bf16 a[16:19], v[72:75], v[40:43], a[16:19]
ds_read_b64_tr_b16 v[104:105], v33 offset:14336
v_mfma_f32_16x16x32_bf16 a[44:47], v[72:75], v[44:47], a[44:47]
ds_read_b64_tr_b16 v[106:107], v33 offset:16128
v_mfma_f32_16x16x32_bf16 a[72:75], v[72:75], v[48:51], a[72:75]
ds_read_b64_tr_b16 v[108:109], v34 offset:14336
v_mfma_f32_16x16x32_bf16 a[100:103], v[72:75], v[52:55], a[100:103]
ds_read_b64_tr_b16 v[110:111], v34 offset:16128
v_mfma_f32_16x16x32_bf16 a[20:23], v[76:79], v[40:43], a[20:23]
ds_read_b64_tr_b16 v[112:113], v35 offset:14336
v_mfma_f32_16x16x32_bf16 a[48:51], v[76:79], v[44:47], a[48:51]
ds_read_b64_tr_b16 v[114:115], v35 offset:16128
v_mfma_f32_16x16x32_bf16 a[76:79], v[76:79], v[48:51], a[76:79]
ds_read_b64_tr_b16 v[116:117], v36 offset:14336
v_mfma_f32_16x16x32_bf16 a[104:107], v[76:79], v[52:55], a[104:107]
ds_read_b64_tr_b16 v[118:119], v36 offset:16128
v_mfma_f32_16x16x32_bf16 a[24:27], v[80:83], v[40:43], a[24:27]
ds_read_b64_tr_b16 v[120:121], v37 offset:14336
v_mfma_f32_16x16x32_bf16 a[52:55], v[80:83], v[44:47], a[52:55]
ds_read_b64_tr_b16 v[122:123], v37 offset:16128
v_mfma_f32_16x16x32_bf16 a[80:83], v[80:83], v[48:51], a[80:83]
ds_read_b64_tr_b16 v[124:125], v38 offset:14336
v_mfma_f32_16x16x32_bf16 a[108:111], v[80:83], v[52:55], a[108:111]
ds_read_b64_tr_b16 v[126:127], v38 offset:16128
s_waitcnt vmcnt(0)
s_barrier
s_waitcnt lgkmcnt(0)
v_mfma_f32_16x16x32_bf16 a[0:3], v[100:103], v[84:87], a[0:3]
s_mov_b32 s16, 1152
s_mov_b32 s17, 4128768
v_mfma_f32_16x16x32_bf16 a[28:31], v[100:103], v[88:91], a[28:31]
s_add_u32 m0, s27, 0
s_nop 0
v_mfma_f32_16x16x32_bf16 a[56:59], v[100:103], v[92:95], a[56:59]
buffer_load_dwordx4 v10, s[4:7], s16 offen lds
s_add_u32 m0, s27, 1024
v_mfma_f32_16x16x32_bf16 a[84:87], v[100:103], v[96:99], a[84:87]
s_nop 0
buffer_load_dwordx4 v11, s[4:7], s16 offen lds
v_mfma_f32_16x16x32_bf16 a[4:7], v[104:107], v[84:87], a[4:7]
s_add_u32 m0, s27, 2048
s_nop 0
v_mfma_f32_16x16x32_bf16 a[32:35], v[104:107], v[88:91], a[32:35]
buffer_load_dwordx4 v12, s[4:7], s16 offen lds
s_add_u32 m0, s27, 3072
s_nop 0
v_mfma_f32_16x16x32_bf16 a[60:63], v[104:107], v[92:95], a[60:63]
buffer_load_dwordx4 v13, s[4:7], s16 offen lds
s_add_u32 m0, s28, 16384
v_mfma_f32_16x16x32_bf16 a[88:91], v[104:107], v[96:99], a[88:91]
s_nop 0
buffer_load_dwordx4 v14, s[8:11], s17 offen lds
v_mfma_f32_16x16x32_bf16 a[8:11], v[108:111], v[84:87], a[8:11]
s_add_u32 m0, s28, 17408
s_nop 0
v_mfma_f32_16x16x32_bf16 a[36:39], v[108:111], v[88:91], a[36:39]
buffer_load_dwordx4 v15, s[8:11], s17 offen lds
s_add_u32 m0, s28, 18432
v_mfma_f32_16x16x32_bf16 a[64:67], v[108:111], v[92:95], a[64:67]
s_nop 0
buffer_load_dwordx4 v16, s[8:11], s17 offen lds
v_mfma_f32_16x16x32_bf16 a[92:95], v[108:111], v[96:99], a[92:95]
s_add_u32 m0, s28, 19456
s_nop 0
buffer_load_dwordx4 v17, s[8:11], s17 offen lds
v_mfma_f32_16x16x32_bf16 a[12:15], v[112:115], v[84:87], a[12:15]
s_add_u32 m0, s28, 20480
s_nop 0
v_mfma_f32_16x16x32_bf16 a[40:43], v[112:115], v[88:91], a[40:43]
buffer_load_dwordx4 v18, s[8:11], s17 offen lds
s_add_u32 m0, s28, 21504
v_mfma_f32_16x16x32_bf16 a[68:71], v[112:115], v[92:95], a[68:71]
s_nop 0
buffer_load_dwordx4 v19, s[8:11], s17 offen lds
v_mfma_f32_16x16x32_bf16 a[96:99], v[112:115], v[96:99], a[96:99]
s_add_u32 m0, s28, 22528
s_nop 0
v_mfma_f32_16x16x32_bf16 a[16:19], v[116:119], v[84:87], a[16:19]
buffer_load_dwordx4 v20, s[8:11], s17 offen lds
v_add_u32 v23, 90112, v21
v_add_u32 v32, 90112, v25
v_mfma_f32_16x16x32_bf16 a[44:47], v[116:119], v[88:91], a[44:47]
v_add_u32 v33, 90112, v26
v_add_u32 v34, 90112, v27
v_mfma_f32_16x16x32_bf16 a[72:75], v[116:119], v[92:95], a[72:75]
v_add_u32 v35, 90112, v28
v_add_u32 v36, 90112, v29
v_mfma_f32_16x16x32_bf16 a[100:103], v[116:119], v[96:99], a[100:103]
v_add_u32 v37, 90112, v30
v_add_u32 v38, 90112, v31
v_mfma_f32_16x16x32_bf16 a[20:23], v[120:123], v[84:87], a[20:23]
ds_read_b128 v[40:43], v23 offset:0
ds_read_b128 v[44:47], v23 offset:2048
v_mfma_f32_16x16x32_bf16 a[48:51], v[120:123], v[88:91], a[48:51]
ds_read_b128 v[48:51], v23 offset:4096
ds_read_b128 v[52:55], v23 offset:6144
v_mfma_f32_16x16x32_bf16 a[76:79], v[120:123], v[92:95], a[76:79]
ds_read_b64_tr_b16 v[56:57], v32 offset:0
ds_read_b64_tr_b16 v[58:59], v32 offset:1792
ds_read_b64_tr_b16 v[60:61], v33 offset:0
v_mfma_f32_16x16x32_bf16 a[104:107], v[120:123], v[96:99], a[104:107]
ds_read_b64_tr_b16 v[62:63], v33 offset:1792
ds_read_b64_tr_b16 v[64:65], v34 offset:0
v_mfma_f32_16x16x32_bf16 a[24:27], v[124:127], v[84:87], a[24:27]
ds_read_b64_tr_b16 v[66:67], v34 offset:1792
ds_read_b64_tr_b16 v[68:69], v35 offset:0
v_mfma_f32_16x16x32_bf16 a[52:55], v[124:127], v[88:91], a[52:55]
ds_read_b64_tr_b16 v[70:71], v35 offset:1792
ds_read_b64_tr_b16 v[72:73], v36 offset:0
v_mfma_f32_16x16x32_bf16 a[80:83], v[124:127], v[92:95], a[80:83]
ds_read_b64_tr_b16 v[74:75], v36 offset:1792
ds_read_b64_tr_b16 v[76:77], v37 offset:0
v_mfma_f32_16x16x32_bf16 a[108:111], v[124:127], v[96:99], a[108:111]
ds_read_b64_tr_b16 v[78:79], v37 offset:1792
ds_read_b64_tr_b16 v[80:81], v38 offset:0
ds_read_b64_tr_b16 v[82:83], v38 offset:1792
s_waitcnt lgkmcnt(0)
v_mfma_f32_16x16x32_bf16 a[0:3], v[56:59], v[40:43], a[0:3]
v_mfma_f32_16x16x32_bf16 a[28:31], v[56:59], v[44:47], a[28:31]
v_add_u32 v23, 90112, v22
v_mfma_f32_16x16x32_bf16 a[56:59], v[56:59], v[48:51], a[56:59]
v_add_u32 v32, 90112, v25
v_mfma_f32_16x16x32_bf16 a[84:87], v[56:59], v[52:55], a[84:87]
v_add_u32 v33, 90112, v26
v_mfma_f32_16x16x32_bf16 a[4:7], v[60:63], v[40:43], a[4:7]
v_add_u32 v34, 90112, v27
v_mfma_f32_16x16x32_bf16 a[32:35], v[60:63], v[44:47], a[32:35]
v_add_u32 v35, 90112, v28
v_mfma_f32_16x16x32_bf16 a[60:63], v[60:63], v[48:51], a[60:63]
v_add_u32 v36, 90112, v29
v_mfma_f32_16x16x32_bf16 a[88:91], v[60:63], v[52:55], a[88:91]
v_add_u32 v37, 90112, v30
v_mfma_f32_16x16x32_bf16 a[8:11], v[64:67], v[40:43], a[8:11]
v_add_u32 v38, 90112, v31
v_mfma_f32_16x16x32_bf16 a[36:39], v[64:67], v[44:47], a[36:39]
ds_read_b128 v[84:87], v23 offset:0
v_mfma_f32_16x16x32_bf16 a[64:67], v[64:67], v[48:51], a[64:67]
ds_read_b128 v[88:91], v23 offset:2048
v_mfma_f32_16x16x32_bf16 a[92:95], v[64:67], v[52:55], a[92:95]
ds_read_b128 v[92:95], v23 offset:4096
v_mfma_f32_16x16x32_bf16 a[12:15], v[68:71], v[40:43], a[12:15]
ds_read_b128 v[96:99], v23 offset:6144
v_mfma_f32_16x16x32_bf16 a[40:43], v[68:71], v[44:47], a[40:43]
ds_read_b64_tr_b16 v[100:101], v32 offset:14336
v_mfma_f32_16x16x32_bf16 a[68:71], v[68:71], v[48:51], a[68:71]
v_mfma_f32_16x16x32_bf16 a[96:99], v[68:71], v[52:55], a[96:99]
ds_read_b64_tr_b16 v[102:103], v32 offset:16128
v_mfma_f32_16x16x32_bf16 a[16:19], v[72:75], v[40:43], a[16:19]
ds_read_b64_tr_b16 v[104:105], v33 offset:14336
v_mfma_f32_16x16x32_bf16 a[44:47], v[72:75], v[44:47], a[44:47]
ds_read_b64_tr_b16 v[106:107], v33 offset:16128
v_mfma_f32_16x16x32_bf16 a[72:75], v[72:75], v[48:51], a[72:75]
ds_read_b64_tr_b16 v[108:109], v34 offset:14336
v_mfma_f32_16x16x32_bf16 a[100:103], v[72:75], v[52:55], a[100:103]
ds_read_b64_tr_b16 v[110:111], v34 offset:16128
v_mfma_f32_16x16x32_bf16 a[20:23], v[76:79], v[40:43], a[20:23]
ds_read_b64_tr_b16 v[112:113], v35 offset:14336
v_mfma_f32_16x16x32_bf16 a[48:51], v[76:79], v[44:47], a[48:51]
ds_read_b64_tr_b16 v[114:115], v35 offset:16128
v_mfma_f32_16x16x32_bf16 a[76:79], v[76:79], v[48:51], a[76:79]
ds_read_b64_tr_b16 v[116:117], v36 offset:14336
v_mfma_f32_16x16x32_bf16 a[104:107], v[76:79], v[52:55], a[104:107]
ds_read_b64_tr_b16 v[118:119], v36 offset:16128
v_mfma_f32_16x16x32_bf16 a[24:27], v[80:83], v[40:43], a[24:27]
ds_read_b64_tr_b16 v[120:121], v37 offset:14336
v_mfma_f32_16x16x32_bf16 a[52:55], v[80:83], v[44:47], a[52:55]
ds_read_b64_tr_b16 v[122:123], v37 offset:16128
v_mfma_f32_16x16x32_bf16 a[80:83], v[80:83], v[48:51], a[80:83]
ds_read_b64_tr_b16 v[124:125], v38 offset:14336
v_mfma_f32_16x16x32_bf16 a[108:111], v[80:83], v[52:55], a[108:111]
ds_read_b64_tr_b16 v[126:127], v38 offset:16128
s_waitcnt vmcnt(0)
s_barrier
s_waitcnt lgkmcnt(0)
v_mfma_f32_16x16x32_bf16 a[0:3], v[100:103], v[84:87], a[0:3]
s_mov_b32 s16, 1280
s_mov_b32 s17, 4587520
v_mfma_f32_16x16x32_bf16 a[28:31], v[100:103], v[88:91], a[28:31]
s_add_u32 m0, s27, 45056
s_nop 0
v_mfma_f32_16x16x32_bf16 a[56:59], v[100:103], v[92:95], a[56:59]
buffer_load_dwordx4 v10, s[4:7], s16 offen lds
s_add_u32 m0, s27, 46080
v_mfma_f32_16x16x32_bf16 a[84:87], v[100:103], v[96:99], a[84:87]
s_nop 0
buffer_load_dwordx4 v11, s[4:7], s16 offen lds
v_mfma_f32_16x16x32_bf16 a[4:7], v[104:107], v[84:87], a[4:7]
s_add_u32 m0, s27, 47104
s_nop 0
v_mfma_f32_16x16x32_bf16 a[32:35], v[104:107], v[88:91], a[32:35]
buffer_load_dwordx4 v12, s[4:7], s16 offen lds
s_add_u32 m0, s27, 48128
s_nop 0
v_mfma_f32_16x16x32_bf16 a[60:63], v[104:107], v[92:95], a[60:63]
buffer_load_dwordx4 v13, s[4:7], s16 offen lds
s_add_u32 m0, s28, 61440
v_mfma_f32_16x16x32_bf16 a[88:91], v[104:107], v[96:99], a[88:91]
s_nop 0
buffer_load_dwordx4 v14, s[8:11], s17 offen lds
v_mfma_f32_16x16x32_bf16 a[8:11], v[108:111], v[84:87], a[8:11]
s_add_u32 m0, s28, 62464
s_nop 0
v_mfma_f32_16x16x32_bf16 a[36:39], v[108:111], v[88:91], a[36:39]
buffer_load_dwordx4 v15, s[8:11], s17 offen lds
s_add_u32 m0, s28, 63488
v_mfma_f32_16x16x32_bf16 a[64:67], v[108:111], v[92:95], a[64:67]
s_nop 0
buffer_load_dwordx4 v16, s[8:11], s17 offen lds
v_mfma_f32_16x16x32_bf16 a[92:95], v[108:111], v[96:99], a[92:95]
s_add_u32 m0, s28, 64512
s_nop 0
buffer_load_dwordx4 v17, s[8:11], s17 offen lds
v_mfma_f32_16x16x32_bf16 a[12:15], v[112:115], v[84:87], a[12:15]
s_add_u32 m0, s28, 65536
s_nop 0
v_mfma_f32_16x16x32_bf16 a[40:43], v[112:115], v[88:91], a[40:43]
buffer_load_dwordx4 v18, s[8:11], s17 offen lds
s_add_u32 m0, s28, 66560
v_mfma_f32_16x16x32_bf16 a[68:71], v[112:115], v[92:95], a[68:71]
s_nop 0
buffer_load_dwordx4 v19, s[8:11], s17 offen lds
v_mfma_f32_16x16x32_bf16 a[96:99], v[112:115], v[96:99], a[96:99]
s_add_u32 m0, s28, 67584
s_nop 0
v_mfma_f32_16x16x32_bf16 a[16:19], v[116:119], v[84:87], a[16:19]
buffer_load_dwordx4 v20, s[8:11], s17 offen lds
v_add_u32 v23, 0, v21
v_add_u32 v32, 0, v25
v_mfma_f32_16x16x32_bf16 a[44:47], v[116:119], v[88:91], a[44:47]
v_add_u32 v33, 0, v26
v_add_u32 v34, 0, v27
v_mfma_f32_16x16x32_bf16 a[72:75], v[116:119], v[92:95], a[72:75]
v_add_u32 v35, 0, v28
v_add_u32 v36, 0, v29
v_mfma_f32_16x16x32_bf16 a[100:103], v[116:119], v[96:99], a[100:103]
v_add_u32 v37, 0, v30
v_add_u32 v38, 0, v31
v_mfma_f32_16x16x32_bf16 a[20:23], v[120:123], v[84:87], a[20:23]
ds_read_b128 v[40:43], v23 offset:0
ds_read_b128 v[44:47], v23 offset:2048
v_mfma_f32_16x16x32_bf16 a[48:51], v[120:123], v[88:91], a[48:51]
ds_read_b128 v[48:51], v23 offset:4096
ds_read_b128 v[52:55], v23 offset:6144
v_mfma_f32_16x16x32_bf16 a[76:79], v[120:123], v[92:95], a[76:79]
ds_read_b64_tr_b16 v[56:57], v32 offset:0
ds_read_b64_tr_b16 v[58:59], v32 offset:1792
ds_read_b64_tr_b16 v[60:61], v33 offset:0
v_mfma_f32_16x16x32_bf16 a[104:107], v[120:123], v[96:99], a[104:107]
ds_read_b64_tr_b16 v[62:63], v33 offset:1792
ds_read_b64_tr_b16 v[64:65], v34 offset:0
v_mfma_f32_16x16x32_bf16 a[24:27], v[124:127], v[84:87], a[24:27]
ds_read_b64_tr_b16 v[66:67], v34 offset:1792
ds_read_b64_tr_b16 v[68:69], v35 offset:0
v_mfma_f32_16x16x32_bf16 a[52:55], v[124:127], v[88:91], a[52:55]
ds_read_b64_tr_b16 v[70:71], v35 offset:1792
ds_read_b64_tr_b16 v[72:73], v36 offset:0
v_mfma_f32_16x16x32_bf16 a[80:83], v[124:127], v[92:95], a[80:83]
ds_read_b64_tr_b16 v[74:75], v36 offset:1792
ds_read_b64_tr_b16 v[76:77], v37 offset:0
v_mfma_f32_16x16x32_bf16 a[108:111], v[124:127], v[96:99], a[108:111]
ds_read_b64_tr_b16 v[78:79], v37 offset:1792
ds_read_b64_tr_b16 v[80:81], v38 offset:0
ds_read_b64_tr_b16 v[82:83], v38 offset:1792
s_waitcnt lgkmcnt(0)
v_mfma_f32_16x16x32_bf16 a[0:3], v[56:59], v[40:43], a[0:3]
v_mfma_f32_16x16x32_bf16 a[28:31], v[56:59], v[44:47], a[28:31]
v_add_u32 v23, 0, v22
v_mfma_f32_16x16x32_bf16 a[56:59], v[56:59], v[48:51], a[56:59]
v_add_u32 v32, 0, v25
v_mfma_f32_16x16x32_bf16 a[84:87], v[56:59], v[52:55], a[84:87]
v_add_u32 v33, 0, v26
v_mfma_f32_16x16x32_bf16 a[4:7], v[60:63], v[40:43], a[4:7]
v_add_u32 v34, 0, v27
v_mfma_f32_16x16x32_bf16 a[32:35], v[60:63], v[44:47], a[32:35]
v_add_u32 v35, 0, v28
v_mfma_f32_16x16x32_bf16 a[60:63], v[60:63], v[48:51], a[60:63]
v_add_u32 v36, 0, v29
v_mfma_f32_16x16x32_bf16 a[88:91], v[60:63], v[52:55], a[88:91]
v_add_u32 v37, 0, v30
v_mfma_f32_16x16x32_bf16 a[8:11], v[64:67], v[40:43], a[8:11]
v_add_u32 v38, 0, v31
v_mfma_f32_16x16x32_bf16 a[36:39], v[64:67], v[44:47], a[36:39]
ds_read_b128 v[84:87], v23 offset:0
v_mfma_f32_16x16x32_bf16 a[64:67], v[64:67], v[48:51], a[64:67]
ds_read_b128 v[88:91], v23 offset:2048
v_mfma_f32_16x16x32_bf16 a[92:95], v[64:67], v[52:55], a[92:95]
ds_read_b128 v[92:95], v23 offset:4096
v_mfma_f32_16x16x32_bf16 a[12:15], v[68:71], v[40:43], a[12:15]
ds_read_b128 v[96:99], v23 offset:6144
v_mfma_f32_16x16x32_bf16 a[40:43], v[68:71], v[44:47], a[40:43]
ds_read_b64_tr_b16 v[100:101], v32 offset:14336
v_mfma_f32_16x16x32_bf16 a[68:71], v[68:71], v[48:51], a[68:71]
v_mfma_f32_16x16x32_bf16 a[96:99], v[68:71], v[52:55], a[96:99]
ds_read_b64_tr_b16 v[102:103], v32 offset:16128
v_mfma_f32_16x16x32_bf16 a[16:19], v[72:75], v[40:43], a[16:19]
ds_read_b64_tr_b16 v[104:105], v33 offset:14336
v_mfma_f32_16x16x32_bf16 a[44:47], v[72:75], v[44:47], a[44:47]
ds_read_b64_tr_b16 v[106:107], v33 offset:16128
v_mfma_f32_16x16x32_bf16 a[72:75], v[72:75], v[48:51], a[72:75]
ds_read_b64_tr_b16 v[108:109], v34 offset:14336
v_mfma_f32_16x16x32_bf16 a[100:103], v[72:75], v[52:55], a[100:103]
ds_read_b64_tr_b16 v[110:111], v34 offset:16128
v_mfma_f32_16x16x32_bf16 a[20:23], v[76:79], v[40:43], a[20:23]
ds_read_b64_tr_b16 v[112:113], v35 offset:14336
v_mfma_f32_16x16x32_bf16 a[48:51], v[76:79], v[44:47], a[48:51]
ds_read_b64_tr_b16 v[114:115], v35 offset:16128
v_mfma_f32_16x16x32_bf16 a[76:79], v[76:79], v[48:51], a[76:79]
ds_read_b64_tr_b16 v[116:117], v36 offset:14336
v_mfma_f32_16x16x32_bf16 a[104:107], v[76:79], v[52:55], a[104:107]
ds_read_b64_tr_b16 v[118:119], v36 offset:16128
v_mfma_f32_16x16x32_bf16 a[24:27], v[80:83], v[40:43], a[24:27]
ds_read_b64_tr_b16 v[120:121], v37 offset:14336
v_mfma_f32_16x16x32_bf16 a[52:55], v[80:83], v[44:47], a[52:55]
ds_read_b64_tr_b16 v[122:123], v37 offset:16128
v_mfma_f32_16x16x32_bf16 a[80:83], v[80:83], v[48:51], a[80:83]
ds_read_b64_tr_b16 v[124:125], v38 offset:14336
v_mfma_f32_16x16x32_bf16 a[108:111], v[80:83], v[52:55], a[108:111]
ds_read_b64_tr_b16 v[126:127], v38 offset:16128
s_waitcnt vmcnt(0)
s_barrier
s_waitcnt lgkmcnt(0)
v_mfma_f32_16x16x32_bf16 a[0:3], v[100:103], v[84:87], a[0:3]
s_mov_b32 s16, 1408
s_mov_b32 s17, 5046272
v_mfma_f32_16x16x32_bf16 a[28:31], v[100:103], v[88:91], a[28:31]
s_add_u32 m0, s27, 90112
s_nop 0
v_mfma_f32_16x16x32_bf16 a[56:59], v[100:103], v[92:95], a[56:59]
buffer_load_dwordx4 v10, s[4:7], s16 offen lds
s_add_u32 m0, s27, 91136
v_mfma_f32_16x16x32_bf16 a[84:87], v[100:103], v[96:99], a[84:87]
s_nop 0
buffer_load_dwordx4 v11, s[4:7], s16 offen lds
v_mfma_f32_16x16x32_bf16 a[4:7], v[104:107], v[84:87], a[4:7]
s_add_u32 m0, s27, 92160
s_nop 0
v_mfma_f32_16x16x32_bf16 a[32:35], v[104:107], v[88:91], a[32:35]
buffer_load_dwordx4 v12, s[4:7], s16 offen lds
s_add_u32 m0, s27, 93184
s_nop 0
v_mfma_f32_16x16x32_bf16 a[60:63], v[104:107], v[92:95], a[60:63]
buffer_load_dwordx4 v13, s[4:7], s16 offen lds
s_add_u32 m0, s28, 106496
v_mfma_f32_16x16x32_bf16 a[88:91], v[104:107], v[96:99], a[88:91]
s_nop 0
buffer_load_dwordx4 v14, s[8:11], s17 offen lds
v_mfma_f32_16x16x32_bf16 a[8:11], v[108:111], v[84:87], a[8:11]
s_add_u32 m0, s28, 107520
s_nop 0
v_mfma_f32_16x16x32_bf16 a[36:39], v[108:111], v[88:91], a[36:39]
buffer_load_dwordx4 v15, s[8:11], s17 offen lds
s_add_u32 m0, s28, 108544
v_mfma_f32_16x16x32_bf16 a[64:67], v[108:111], v[92:95], a[64:67]
s_nop 0
buffer_load_dwordx4 v16, s[8:11], s17 offen lds
v_mfma_f32_16x16x32_bf16 a[92:95], v[108:111], v[96:99], a[92:95]
s_add_u32 m0, s28, 109568
s_nop 0
buffer_load_dwordx4 v17, s[8:11], s17 offen lds
v_mfma_f32_16x16x32_bf16 a[12:15], v[112:115], v[84:87], a[12:15]
s_add_u32 m0, s28, 110592
s_nop 0
v_mfma_f32_16x16x32_bf16 a[40:43], v[112:115], v[88:91], a[40:43]
buffer_load_dwordx4 v18, s[8:11], s17 offen lds
s_add_u32 m0, s28, 111616
v_mfma_f32_16x16x32_bf16 a[68:71], v[112:115], v[92:95], a[68:71]
s_nop 0
buffer_load_dwordx4 v19, s[8:11], s17 offen lds
v_mfma_f32_16x16x32_bf16 a[96:99], v[112:115], v[96:99], a[96:99]
s_add_u32 m0, s28, 112640
s_nop 0
v_mfma_f32_16x16x32_bf16 a[16:19], v[116:119], v[84:87], a[16:19]
buffer_load_dwordx4 v20, s[8:11], s17 offen lds
v_add_u32 v23, 45056, v21
v_add_u32 v32, 45056, v25
v_mfma_f32_16x16x32_bf16 a[44:47], v[116:119], v[88:91], a[44:47]
v_add_u32 v33, 45056, v26
v_add_u32 v34, 45056, v27
v_mfma_f32_16x16x32_bf16 a[72:75], v[116:119], v[92:95], a[72:75]
v_add_u32 v35, 45056, v28
v_add_u32 v36, 45056, v29
v_mfma_f32_16x16x32_bf16 a[100:103], v[116:119], v[96:99], a[100:103]
v_add_u32 v37, 45056, v30
v_add_u32 v38, 45056, v31
v_mfma_f32_16x16x32_bf16 a[20:23], v[120:123], v[84:87], a[20:23]
ds_read_b128 v[40:43], v23 offset:0
ds_read_b128 v[44:47], v23 offset:2048
v_mfma_f32_16x16x32_bf16 a[48:51], v[120:123], v[88:91], a[48:51]
ds_read_b128 v[48:51], v23 offset:4096
ds_read_b128 v[52:55], v23 offset:6144
v_mfma_f32_16x16x32_bf16 a[76:79], v[120:123], v[92:95], a[76:79]
ds_read_b64_tr_b16 v[56:57], v32 offset:0
ds_read_b64_tr_b16 v[58:59], v32 offset:1792
ds_read_b64_tr_b16 v[60:61], v33 offset:0
v_mfma_f32_16x16x32_bf16 a[104:107], v[120:123], v[96:99], a[104:107]
ds_read_b64_tr_b16 v[62:63], v33 offset:1792
ds_read_b64_tr_b16 v[64:65], v34 offset:0
v_mfma_f32_16x16x32_bf16 a[24:27], v[124:127], v[84:87], a[24:27]
ds_read_b64_tr_b16 v[66:67], v34 offset:1792
ds_read_b64_tr_b16 v[68:69], v35 offset:0
v_mfma_f32_16x16x32_bf16 a[52:55], v[124:127], v[88:91], a[52:55]
ds_read_b64_tr_b16 v[70:71], v35 offset:1792
ds_read_b64_tr_b16 v[72:73], v36 offset:0
v_mfma_f32_16x16x32_bf16 a[80:83], v[124:127], v[92:95], a[80:83]
ds_read_b64_tr_b16 v[74:75], v36 offset:1792
ds_read_b64_tr_b16 v[76:77], v37 offset:0
v_mfma_f32_16x16x32_bf16 a[108:111], v[124:127], v[96:99], a[108:111]
ds_read_b64_tr_b16 v[78:79], v37 offset:1792
ds_read_b64_tr_b16 v[80:81], v38 offset:0
ds_read_b64_tr_b16 v[82:83], v38 offset:1792
s_waitcnt lgkmcnt(0)
v_mfma_f32_16x16x32_bf16 a[0:3], v[56:59], v[40:43], a[0:3]
v_mfma_f32_16x16x32_bf16 a[28:31], v[56:59], v[44:47], a[28:31]
v_add_u32 v23, 45056, v22
v_mfma_f32_16x16x32_bf16 a[56:59], v[56:59], v[48:51], a[56:59]
v_add_u32 v32, 45056, v25
v_mfma_f32_16x16x32_bf16 a[84:87], v[56:59], v[52:55], a[84:87]
v_add_u32 v33, 45056, v26
v_mfma_f32_16x16x32_bf16 a[4:7], v[60:63], v[40:43], a[4:7]
v_add_u32 v34, 45056, v27
v_mfma_f32_16x16x32_bf16 a[32:35], v[60:63], v[44:47], a[32:35]
v_add_u32 v35, 45056, v28
v_mfma_f32_16x16x32_bf16 a[60:63], v[60:63], v[48:51], a[60:63]
v_add_u32 v36, 45056, v29
v_mfma_f32_16x16x32_bf16 a[88:91], v[60:63], v[52:55], a[88:91]
v_add_u32 v37, 45056, v30
v_mfma_f32_16x16x32_bf16 a[8:11], v[64:67], v[40:43], a[8:11]
v_add_u32 v38, 45056, v31
v_mfma_f32_16x16x32_bf16 a[36:39], v[64:67], v[44:47], a[36:39]
ds_read_b128 v[84:87], v23 offset:0
v_mfma_f32_16x16x32_bf16 a[64:67], v[64:67], v[48:51], a[64:67]
ds_read_b128 v[88:91], v23 offset:2048
v_mfma_f32_16x16x32_bf16 a[92:95], v[64:67], v[52:55], a[92:95]
ds_read_b128 v[92:95], v23 offset:4096
v_mfma_f32_16x16x32_bf16 a[12:15], v[68:71], v[40:43], a[12:15]
ds_read_b128 v[96:99], v23 offset:6144
v_mfma_f32_16x16x32_bf16 a[40:43], v[68:71], v[44:47], a[40:43]
ds_read_b64_tr_b16 v[100:101], v32 offset:14336
v_mfma_f32_16x16x32_bf16 a[68:71], v[68:71], v[48:51], a[68:71]
v_mfma_f32_16x16x32_bf16 a[96:99], v[68:71], v[52:55], a[96:99]
ds_read_b64_tr_b16 v[102:103], v32 offset:16128
v_mfma_f32_16x16x32_bf16 a[16:19], v[72:75], v[40:43], a[16:19]
ds_read_b64_tr_b16 v[104:105], v33 offset:14336
v_mfma_f32_16x16x32_bf16 a[44:47], v[72:75], v[44:47], a[44:47]
ds_read_b64_tr_b16 v[106:107], v33 offset:16128
v_mfma_f32_16x16x32_bf16 a[72:75], v[72:75], v[48:51], a[72:75]
ds_read_b64_tr_b16 v[108:109], v34 offset:14336
v_mfma_f32_16x16x32_bf16 a[100:103], v[72:75], v[52:55], a[100:103]
ds_read_b64_tr_b16 v[110:111], v34 offset:16128
v_mfma_f32_16x16x32_bf16 a[20:23], v[76:79], v[40:43], a[20:23]
ds_read_b64_tr_b16 v[112:113], v35 offset:14336
v_mfma_f32_16x16x32_bf16 a[48:51], v[76:79], v[44:47], a[48:51]
ds_read_b64_tr_b16 v[114:115], v35 offset:16128
v_mfma_f32_16x16x32_bf16 a[76:79], v[76:79], v[48:51], a[76:79]
ds_read_b64_tr_b16 v[116:117], v36 offset:14336
v_mfma_f32_16x16x32_bf16 a[104:107], v[76:79], v[52:55], a[104:107]
ds_read_b64_tr_b16 v[118:119], v36 offset:16128
v_mfma_f32_16x16x32_bf16 a[24:27], v[80:83], v[40:43], a[24:27]
ds_read_b64_tr_b16 v[120:121], v37 offset:14336
v_mfma_f32_16x16x32_bf16 a[52:55], v[80:83], v[44:47], a[52:55]
ds_read_b64_tr_b16 v[122:123], v37 offset:16128
v_mfma_f32_16x16x32_bf16 a[80:83], v[80:83], v[48:51], a[80:83]
ds_read_b64_tr_b16 v[124:125], v38 offset:14336
v_mfma_f32_16x16x32_bf16 a[108:111], v[80:83], v[52:55], a[108:111]
ds_read_b64_tr_b16 v[126:127], v38 offset:16128
s_waitcnt vmcnt(0)
s_barrier
s_waitcnt lgkmcnt(0)
v_mfma_f32_16x16x32_bf16 a[0:3], v[100:103], v[84:87], a[0:3]
s_mov_b32 s16, 1536
s_mov_b32 s17, 5505024
v_mfma_f32_16x16x32_bf16 a[28:31], v[100:103], v[88:91], a[28:31]
s_add_u32 m0, s27, 0
s_nop 0
v_mfma_f32_16x16x32_bf16 a[56:59], v[100:103], v[92:95], a[56:59]
buffer_load_dwordx4 v10, s[4:7], s16 offen lds
s_add_u32 m0, s27, 1024
v_mfma_f32_16x16x32_bf16 a[84:87], v[100:103], v[96:99], a[84:87]
s_nop 0
buffer_load_dwordx4 v11, s[4:7], s16 offen lds
v_mfma_f32_16x16x32_bf16 a[4:7], v[104:107], v[84:87], a[4:7]
s_add_u32 m0, s27, 2048
s_nop 0
v_mfma_f32_16x16x32_bf16 a[32:35], v[104:107], v[88:91], a[32:35]
buffer_load_dwordx4 v12, s[4:7], s16 offen lds
s_add_u32 m0, s27, 3072
s_nop 0
v_mfma_f32_16x16x32_bf16 a[60:63], v[104:107], v[92:95], a[60:63]
buffer_load_dwordx4 v13, s[4:7], s16 offen lds
s_add_u32 m0, s28, 16384
v_mfma_f32_16x16x32_bf16 a[88:91], v[104:107], v[96:99], a[88:91]
s_nop 0
buffer_load_dwordx4 v14, s[8:11], s17 offen lds
v_mfma_f32_16x16x32_bf16 a[8:11], v[108:111], v[84:87], a[8:11]
s_add_u32 m0, s28, 17408
s_nop 0
v_mfma_f32_16x16x32_bf16 a[36:39], v[108:111], v[88:91], a[36:39]
buffer_load_dwordx4 v15, s[8:11], s17 offen lds
s_add_u32 m0, s28, 18432
v_mfma_f32_16x16x32_bf16 a[64:67], v[108:111], v[92:95], a[64:67]
s_nop 0
buffer_load_dwordx4 v16, s[8:11], s17 offen lds
v_mfma_f32_16x16x32_bf16 a[92:95], v[108:111], v[96:99], a[92:95]
s_add_u32 m0, s28, 19456
s_nop 0
buffer_load_dwordx4 v17, s[8:11], s17 offen lds
v_mfma_f32_16x16x32_bf16 a[12:15], v[112:115], v[84:87], a[12:15]
s_add_u32 m0, s28, 20480
s_nop 0
v_mfma_f32_16x16x32_bf16 a[40:43], v[112:115], v[88:91], a[40:43]
buffer_load_dwordx4 v18, s[8:11], s17 offen lds
s_add_u32 m0, s28, 21504
v_mfma_f32_16x16x32_bf16 a[68:71], v[112:115], v[92:95], a[68:71]
s_nop 0
buffer_load_dwordx4 v19, s[8:11], s17 offen lds
v_mfma_f32_16x16x32_bf16 a[96:99], v[112:115], v[96:99], a[96:99]
s_add_u32 m0, s28, 22528
s_nop 0
v_mfma_f32_16x16x32_bf16 a[16:19], v[116:119], v[84:87], a[16:19]
buffer_load_dwordx4 v20, s[8:11], s17 offen lds
v_add_u32 v23, 90112, v21
v_add_u32 v32, 90112, v25
v_mfma_f32_16x16x32_bf16 a[44:47], v[116:119], v[88:91], a[44:47]
v_add_u32 v33, 90112, v26
v_add_u32 v34, 90112, v27
v_mfma_f32_16x16x32_bf16 a[72:75], v[116:119], v[92:95], a[72:75]
v_add_u32 v35, 90112, v28
v_add_u32 v36, 90112, v29
v_mfma_f32_16x16x32_bf16 a[100:103], v[116:119], v[96:99], a[100:103]
v_add_u32 v37, 90112, v30
v_add_u32 v38, 90112, v31
v_mfma_f32_16x16x32_bf16 a[20:23], v[120:123], v[84:87], a[20:23]
ds_read_b128 v[40:43], v23 offset:0
ds_read_b128 v[44:47], v23 offset:2048
v_mfma_f32_16x16x32_bf16 a[48:51], v[120:123], v[88:91], a[48:51]
ds_read_b128 v[48:51], v23 offset:4096
ds_read_b128 v[52:55], v23 offset:6144
v_mfma_f32_16x16x32_bf16 a[76:79], v[120:123], v[92:95], a[76:79]
ds_read_b64_tr_b16 v[56:57], v32 offset:0
ds_read_b64_tr_b16 v[58:59], v32 offset:1792
ds_read_b64_tr_b16 v[60:61], v33 offset:0
v_mfma_f32_16x16x32_bf16 a[104:107], v[120:123], v[96:99], a[104:107]
ds_read_b64_tr_b16 v[62:63], v33 offset:1792
ds_read_b64_tr_b16 v[64:65], v34 offset:0
v_mfma_f32_16x16x32_bf16 a[24:27], v[124:127], v[84:87], a[24:27]
ds_read_b64_tr_b16 v[66:67], v34 offset:1792
ds_read_b64_tr_b16 v[68:69], v35 offset:0
v_mfma_f32_16x16x32_bf16 a[52:55], v[124:127], v[88:91], a[52:55]
ds_read_b64_tr_b16 v[70:71], v35 offset:1792
ds_read_b64_tr_b16 v[72:73], v36 offset:0
v_mfma_f32_16x16x32_bf16 a[80:83], v[124:127], v[92:95], a[80:83]
ds_read_b64_tr_b16 v[74:75], v36 offset:1792
ds_read_b64_tr_b16 v[76:77], v37 offset:0
v_mfma_f32_16x16x32_bf16 a[108:111], v[124:127], v[96:99], a[108:111]
ds_read_b64_tr_b16 v[78:79], v37 offset:1792
ds_read_b64_tr_b16 v[80:81], v38 offset:0
ds_read_b64_tr_b16 v[82:83], v38 offset:1792
s_waitcnt lgkmcnt(0)
v_mfma_f32_16x16x32_bf16 a[0:3], v[56:59], v[40:43], a[0:3]
v_mfma_f32_16x16x32_bf16 a[28:31], v[56:59], v[44:47], a[28:31]
v_add_u32 v23, 90112, v22
v_mfma_f32_16x16x32_bf16 a[56:59], v[56:59], v[48:51], a[56:59]
v_add_u32 v32, 90112, v25
v_mfma_f32_16x16x32_bf16 a[84:87], v[56:59], v[52:55], a[84:87]
v_add_u32 v33, 90112, v26
v_mfma_f32_16x16x32_bf16 a[4:7], v[60:63], v[40:43], a[4:7]
v_add_u32 v34, 90112, v27
v_mfma_f32_16x16x32_bf16 a[32:35], v[60:63], v[44:47], a[32:35]
v_add_u32 v35, 90112, v28
v_mfma_f32_16x16x32_bf16 a[60:63], v[60:63], v[48:51], a[60:63]
v_add_u32 v36, 90112, v29
v_mfma_f32_16x16x32_bf16 a[88:91], v[60:63], v[52:55], a[88:91]
v_add_u32 v37, 90112, v30
v_mfma_f32_16x16x32_bf16 a[8:11], v[64:67], v[40:43], a[8:11]
v_add_u32 v38, 90112, v31
v_mfma_f32_16x16x32_bf16 a[36:39], v[64:67], v[44:47], a[36:39]
ds_read_b128 v[84:87], v23 offset:0
v_mfma_f32_16x16x32_bf16 a[64:67], v[64:67], v[48:51], a[64:67]
ds_read_b128 v[88:91], v23 offset:2048
v_mfma_f32_16x16x32_bf16 a[92:95], v[64:67], v[52:55], a[92:95]
ds_read_b128 v[92:95], v23 offset:4096
v_mfma_f32_16x16x32_bf16 a[12:15], v[68:71], v[40:43], a[12:15]
ds_read_b128 v[96:99], v23 offset:6144
v_mfma_f32_16x16x32_bf16 a[40:43], v[68:71], v[44:47], a[40:43]
ds_read_b64_tr_b16 v[100:101], v32 offset:14336
v_mfma_f32_16x16x32_bf16 a[68:71], v[68:71], v[48:51], a[68:71]
v_mfma_f32_16x16x32_bf16 a[96:99], v[68:71], v[52:55], a[96:99]
ds_read_b64_tr_b16 v[102:103], v32 offset:16128
v_mfma_f32_16x16x32_bf16 a[16:19], v[72:75], v[40:43], a[16:19]
ds_read_b64_tr_b16 v[104:105], v33 offset:14336
v_mfma_f32_16x16x32_bf16 a[44:47], v[72:75], v[44:47], a[44:47]
ds_read_b64_tr_b16 v[106:107], v33 offset:16128
v_mfma_f32_16x16x32_bf16 a[72:75], v[72:75], v[48:51], a[72:75]
ds_read_b64_tr_b16 v[108:109], v34 offset:14336
v_mfma_f32_16x16x32_bf16 a[100:103], v[72:75], v[52:55], a[100:103]
ds_read_b64_tr_b16 v[110:111], v34 offset:16128
v_mfma_f32_16x16x32_bf16 a[20:23], v[76:79], v[40:43], a[20:23]
ds_read_b64_tr_b16 v[112:113], v35 offset:14336
v_mfma_f32_16x16x32_bf16 a[48:51], v[76:79], v[44:47], a[48:51]
ds_read_b64_tr_b16 v[114:115], v35 offset:16128
v_mfma_f32_16x16x32_bf16 a[76:79], v[76:79], v[48:51], a[76:79]
ds_read_b64_tr_b16 v[116:117], v36 offset:14336
v_mfma_f32_16x16x32_bf16 a[104:107], v[76:79], v[52:55], a[104:107]
ds_read_b64_tr_b16 v[118:119], v36 offset:16128
v_mfma_f32_16x16x32_bf16 a[24:27], v[80:83], v[40:43], a[24:27]
ds_read_b64_tr_b16 v[120:121], v37 offset:14336
v_mfma_f32_16x16x32_bf16 a[52:55], v[80:83], v[44:47], a[52:55]
ds_read_b64_tr_b16 v[122:123], v37 offset:16128
v_mfma_f32_16x16x32_bf16 a[80:83], v[80:83], v[48:51], a[80:83]
ds_read_b64_tr_b16 v[124:125], v38 offset:14336
v_mfma_f32_16x16x32_bf16 a[108:111], v[80:83], v[52:55], a[108:111]
ds_read_b64_tr_b16 v[126:127], v38 offset:16128
s_waitcnt vmcnt(0)
s_barrier
s_waitcnt lgkmcnt(0)
v_mfma_f32_16x16x32_bf16 a[0:3], v[100:103], v[84:87], a[0:3]
s_mov_b32 s16, 1664
s_mov_b32 s17, 5963776
v_mfma_f32_16x16x32_bf16 a[28:31], v[100:103], v[88:91], a[28:31]
s_add_u32 m0, s27, 45056
s_nop 0
v_mfma_f32_16x16x32_bf16 a[56:59], v[100:103], v[92:95], a[56:59]
buffer_load_dwordx4 v10, s[4:7], s16 offen lds
s_add_u32 m0, s27, 46080
v_mfma_f32_16x16x32_bf16 a[84:87], v[100:103], v[96:99], a[84:87]
s_nop 0
buffer_load_dwordx4 v11, s[4:7], s16 offen lds
v_mfma_f32_16x16x32_bf16 a[4:7], v[104:107], v[84:87], a[4:7]
s_add_u32 m0, s27, 47104
s_nop 0
v_mfma_f32_16x16x32_bf16 a[32:35], v[104:107], v[88:91], a[32:35]
buffer_load_dwordx4 v12, s[4:7], s16 offen lds
s_add_u32 m0, s27, 48128
s_nop 0
v_mfma_f32_16x16x32_bf16 a[60:63], v[104:107], v[92:95], a[60:63]
buffer_load_dwordx4 v13, s[4:7], s16 offen lds
s_add_u32 m0, s28, 61440
v_mfma_f32_16x16x32_bf16 a[88:91], v[104:107], v[96:99], a[88:91]
s_nop 0
buffer_load_dwordx4 v14, s[8:11], s17 offen lds
v_mfma_f32_16x16x32_bf16 a[8:11], v[108:111], v[84:87], a[8:11]
s_add_u32 m0, s28, 62464
s_nop 0
v_mfma_f32_16x16x32_bf16 a[36:39], v[108:111], v[88:91], a[36:39]
buffer_load_dwordx4 v15, s[8:11], s17 offen lds
s_add_u32 m0, s28, 63488
v_mfma_f32_16x16x32_bf16 a[64:67], v[108:111], v[92:95], a[64:67]
s_nop 0
buffer_load_dwordx4 v16, s[8:11], s17 offen lds
v_mfma_f32_16x16x32_bf16 a[92:95], v[108:111], v[96:99], a[92:95]
s_add_u32 m0, s28, 64512
s_nop 0
buffer_load_dwordx4 v17, s[8:11], s17 offen lds
v_mfma_f32_16x16x32_bf16 a[12:15], v[112:115], v[84:87], a[12:15]
s_add_u32 m0, s28, 65536
s_nop 0
v_mfma_f32_16x16x32_bf16 a[40:43], v[112:115], v[88:91], a[40:43]
buffer_load_dwordx4 v18, s[8:11], s17 offen lds
s_add_u32 m0, s28, 66560
v_mfma_f32_16x16x32_bf16 a[68:71], v[112:115], v[92:95], a[68:71]
s_nop 0
buffer_load_dwordx4 v19, s[8:11], s17 offen lds
v_mfma_f32_16x16x32_bf16 a[96:99], v[112:115], v[96:99], a[96:99]
s_add_u32 m0, s28, 67584
s_nop 0
v_mfma_f32_16x16x32_bf16 a[16:19], v[116:119], v[84:87], a[16:19]
buffer_load_dwordx4 v20, s[8:11], s17 offen lds
v_add_u32 v23, 0, v21
v_add_u32 v32, 0, v25
v_mfma_f32_16x16x32_bf16 a[44:47], v[116:119], v[88:91], a[44:47]
v_add_u32 v33, 0, v26
v_add_u32 v34, 0, v27
v_mfma_f32_16x16x32_bf16 a[72:75], v[116:119], v[92:95], a[72:75]
v_add_u32 v35, 0, v28
v_add_u32 v36, 0, v29
v_mfma_f32_16x16x32_bf16 a[100:103], v[116:119], v[96:99], a[100:103]
v_add_u32 v37, 0, v30
v_add_u32 v38, 0, v31
v_mfma_f32_16x16x32_bf16 a[20:23], v[120:123], v[84:87], a[20:23]
ds_read_b128 v[40:43], v23 offset:0
ds_read_b128 v[44:47], v23 offset:2048
v_mfma_f32_16x16x32_bf16 a[48:51], v[120:123], v[88:91], a[48:51]
ds_read_b128 v[48:51], v23 offset:4096
ds_read_b128 v[52:55], v23 offset:6144
v_mfma_f32_16x16x32_bf16 a[76:79], v[120:123], v[92:95], a[76:79]
ds_read_b64_tr_b16 v[56:57], v32 offset:0
ds_read_b64_tr_b16 v[58:59], v32 offset:1792
ds_read_b64_tr_b16 v[60:61], v33 offset:0
v_mfma_f32_16x16x32_bf16 a[104:107], v[120:123], v[96:99], a[104:107]
ds_read_b64_tr_b16 v[62:63], v33 offset:1792
ds_read_b64_tr_b16 v[64:65], v34 offset:0
v_mfma_f32_16x16x32_bf16 a[24:27], v[124:127], v[84:87], a[24:27]
ds_read_b64_tr_b16 v[66:67], v34 offset:1792
ds_read_b64_tr_b16 v[68:69], v35 offset:0
v_mfma_f32_16x16x32_bf16 a[52:55], v[124:127], v[88:91], a[52:55]
ds_read_b64_tr_b16 v[70:71], v35 offset:1792
ds_read_b64_tr_b16 v[72:73], v36 offset:0
v_mfma_f32_16x16x32_bf16 a[80:83], v[124:127], v[92:95], a[80:83]
ds_read_b64_tr_b16 v[74:75], v36 offset:1792
ds_read_b64_tr_b16 v[76:77], v37 offset:0
v_mfma_f32_16x16x32_bf16 a[108:111], v[124:127], v[96:99], a[108:111]
ds_read_b64_tr_b16 v[78:79], v37 offset:1792
ds_read_b64_tr_b16 v[80:81], v38 offset:0
ds_read_b64_tr_b16 v[82:83], v38 offset:1792
s_waitcnt lgkmcnt(0)
v_mfma_f32_16x16x32_bf16 a[0:3], v[56:59], v[40:43], a[0:3]
v_mfma_f32_16x16x32_bf16 a[28:31], v[56:59], v[44:47], a[28:31]
v_add_u32 v23, 0, v22
v_mfma_f32_16x16x32_bf16 a[56:59], v[56:59], v[48:51], a[56:59]
v_add_u32 v32, 0, v25
v_mfma_f32_16x16x32_bf16 a[84:87], v[56:59], v[52:55], a[84:87]
v_add_u32 v33, 0, v26
v_mfma_f32_16x16x32_bf16 a[4:7], v[60:63], v[40:43], a[4:7]
v_add_u32 v34, 0, v27
v_mfma_f32_16x16x32_bf16 a[32:35], v[60:63], v[44:47], a[32:35]
v_add_u32 v35, 0, v28
v_mfma_f32_16x16x32_bf16 a[60:63], v[60:63], v[48:51], a[60:63]
v_add_u32 v36, 0, v29
v_mfma_f32_16x16x32_bf16 a[88:91], v[60:63], v[52:55], a[88:91]
v_add_u32 v37, 0, v30
v_mfma_f32_16x16x32_bf16 a[8:11], v[64:67], v[40:43], a[8:11]
v_add_u32 v38, 0, v31
v_mfma_f32_16x16x32_bf16 a[36:39], v[64:67], v[44:47], a[36:39]
ds_read_b128 v[84:87], v23 offset:0
v_mfma_f32_16x16x32_bf16 a[64:67], v[64:67], v[48:51], a[64:67]
ds_read_b128 v[88:91], v23 offset:2048
v_mfma_f32_16x16x32_bf16 a[92:95], v[64:67], v[52:55], a[92:95]
ds_read_b128 v[92:95], v23 offset:4096
v_mfma_f32_16x16x32_bf16 a[12:15], v[68:71], v[40:43], a[12:15]
ds_read_b128 v[96:99], v23 offset:6144
v_mfma_f32_16x16x32_bf16 a[40:43], v[68:71], v[44:47], a[40:43]
ds_read_b64_tr_b16 v[100:101], v32 offset:14336
v_mfma_f32_16x16x32_bf16 a[68:71], v[68:71], v[48:51], a[68:71]
v_mfma_f32_16x16x32_bf16 a[96:99], v[68:71], v[52:55], a[96:99]
ds_read_b64_tr_b16 v[102:103], v32 offset:16128
v_mfma_f32_16x16x32_bf16 a[16:19], v[72:75], v[40:43], a[16:19]
ds_read_b64_tr_b16 v[104:105], v33 offset:14336
v_mfma_f32_16x16x32_bf16 a[44:47], v[72:75], v[44:47], a[44:47]
ds_read_b64_tr_b16 v[106:107], v33 offset:16128
v_mfma_f32_16x16x32_bf16 a[72:75], v[72:75], v[48:51], a[72:75]
ds_read_b64_tr_b16 v[108:109], v34 offset:14336
v_mfma_f32_16x16x32_bf16 a[100:103], v[72:75], v[52:55], a[100:103]
ds_read_b64_tr_b16 v[110:111], v34 offset:16128
v_mfma_f32_16x16x32_bf16 a[20:23], v[76:79], v[40:43], a[20:23]
ds_read_b64_tr_b16 v[112:113], v35 offset:14336
v_mfma_f32_16x16x32_bf16 a[48:51], v[76:79], v[44:47], a[48:51]
ds_read_b64_tr_b16 v[114:115], v35 offset:16128
v_mfma_f32_16x16x32_bf16 a[76:79], v[76:79], v[48:51], a[76:79]
ds_read_b64_tr_b16 v[116:117], v36 offset:14336
v_mfma_f32_16x16x32_bf16 a[104:107], v[76:79], v[52:55], a[104:107]
ds_read_b64_tr_b16 v[118:119], v36 offset:16128
v_mfma_f32_16x16x32_bf16 a[24:27], v[80:83], v[40:43], a[24:27]
ds_read_b64_tr_b16 v[120:121], v37 offset:14336
v_mfma_f32_16x16x32_bf16 a[52:55], v[80:83], v[44:47], a[52:55]
ds_read_b64_tr_b16 v[122:123], v37 offset:16128
v_mfma_f32_16x16x32_bf16 a[80:83], v[80:83], v[48:51], a[80:83]
ds_read_b64_tr_b16 v[124:125], v38 offset:14336
v_mfma_f32_16x16x32_bf16 a[108:111], v[80:83], v[52:55], a[108:111]
ds_read_b64_tr_b16 v[126:127], v38 offset:16128
s_waitcnt vmcnt(0)
s_barrier
s_waitcnt lgkmcnt(0)
v_mfma_f32_16x16x32_bf16 a[0:3], v[100:103], v[84:87], a[0:3]
s_mov_b32 s16, 1792
s_mov_b32 s17, 6422528
v_mfma_f32_16x16x32_bf16 a[28:31], v[100:103], v[88:91], a[28:31]
s_add_u32 m0, s27, 90112
s_nop 0
v_mfma_f32_16x16x32_bf16 a[56:59], v[100:103], v[92:95], a[56:59]
buffer_load_dwordx4 v10, s[4:7], s16 offen lds
s_add_u32 m0, s27, 91136
v_mfma_f32_16x16x32_bf16 a[84:87], v[100:103], v[96:99], a[84:87]
s_nop 0
buffer_load_dwordx4 v11, s[4:7], s16 offen lds
v_mfma_f32_16x16x32_bf16 a[4:7], v[104:107], v[84:87], a[4:7]
s_add_u32 m0, s27, 92160
s_nop 0
v_mfma_f32_16x16x32_bf16 a[32:35], v[104:107], v[88:91], a[32:35]
buffer_load_dwordx4 v12, s[4:7], s16 offen lds
s_add_u32 m0, s27, 93184
s_nop 0
v_mfma_f32_16x16x32_bf16 a[60:63], v[104:107], v[92:95], a[60:63]
buffer_load_dwordx4 v13, s[4:7], s16 offen lds
s_add_u32 m0, s28, 106496
v_mfma_f32_16x16x32_bf16 a[88:91], v[104:107], v[96:99], a[88:91]
s_nop 0
buffer_load_dwordx4 v14, s[8:11], s17 offen lds
v_mfma_f32_16x16x32_bf16 a[8:11], v[108:111], v[84:87], a[8:11]
s_add_u32 m0, s28, 107520
s_nop 0
v_mfma_f32_16x16x32_bf16 a[36:39], v[108:111], v[88:91], a[36:39]
buffer_load_dwordx4 v15, s[8:11], s17 offen lds
s_add_u32 m0, s28, 108544
v_mfma_f32_16x16x32_bf16 a[64:67], v[108:111], v[92:95], a[64:67]
s_nop 0
buffer_load_dwordx4 v16, s[8:11], s17 offen lds
v_mfma_f32_16x16x32_bf16 a[92:95], v[108:111], v[96:99], a[92:95]
s_add_u32 m0, s28, 109568
s_nop 0
buffer_load_dwordx4 v17, s[8:11], s17 offen lds
v_mfma_f32_16x16x32_bf16 a[12:15], v[112:115], v[84:87], a[12:15]
s_add_u32 m0, s28, 110592
s_nop 0
v_mfma_f32_16x16x32_bf16 a[40:43], v[112:115], v[88:91], a[40:43]
buffer_load_dwordx4 v18, s[8:11], s17 offen lds
s_add_u32 m0, s28, 111616
v_mfma_f32_16x16x32_bf16 a[68:71], v[112:115], v[92:95], a[68:71]
s_nop 0
buffer_load_dwordx4 v19, s[8:11], s17 offen lds
v_mfma_f32_16x16x32_bf16 a[96:99], v[112:115], v[96:99], a[96:99]
s_add_u32 m0, s28, 112640
s_nop 0
v_mfma_f32_16x16x32_bf16 a[16:19], v[116:119], v[84:87], a[16:19]
buffer_load_dwordx4 v20, s[8:11], s17 offen lds
v_add_u32 v23, 45056, v21
v_add_u32 v32, 45056, v25
v_mfma_f32_16x16x32_bf16 a[44:47], v[116:119], v[88:91], a[44:47]
v_add_u32 v33, 45056, v26
v_add_u32 v34, 45056, v27
v_mfma_f32_16x16x32_bf16 a[72:75], v[116:119], v[92:95], a[72:75]
v_add_u32 v35, 45056, v28
v_add_u32 v36, 45056, v29
v_mfma_f32_16x16x32_bf16 a[100:103], v[116:119], v[96:99], a[100:103]
v_add_u32 v37, 45056, v30
v_add_u32 v38, 45056, v31
v_mfma_f32_16x16x32_bf16 a[20:23], v[120:123], v[84:87], a[20:23]
ds_read_b128 v[40:43], v23 offset:0
ds_read_b128 v[44:47], v23 offset:2048
v_mfma_f32_16x16x32_bf16 a[48:51], v[120:123], v[88:91], a[48:51]
ds_read_b128 v[48:51], v23 offset:4096
ds_read_b128 v[52:55], v23 offset:6144
v_mfma_f32_16x16x32_bf16 a[76:79], v[120:123], v[92:95], a[76:79]
ds_read_b64_tr_b16 v[56:57], v32 offset:0
ds_read_b64_tr_b16 v[58:59], v32 offset:1792
ds_read_b64_tr_b16 v[60:61], v33 offset:0
v_mfma_f32_16x16x32_bf16 a[104:107], v[120:123], v[96:99], a[104:107]
ds_read_b64_tr_b16 v[62:63], v33 offset:1792
ds_read_b64_tr_b16 v[64:65], v34 offset:0
v_mfma_f32_16x16x32_bf16 a[24:27], v[124:127], v[84:87], a[24:27]
ds_read_b64_tr_b16 v[66:67], v34 offset:1792
ds_read_b64_tr_b16 v[68:69], v35 offset:0
v_mfma_f32_16x16x32_bf16 a[52:55], v[124:127], v[88:91], a[52:55]
ds_read_b64_tr_b16 v[70:71], v35 offset:1792
ds_read_b64_tr_b16 v[72:73], v36 offset:0
v_mfma_f32_16x16x32_bf16 a[80:83], v[124:127], v[92:95], a[80:83]
ds_read_b64_tr_b16 v[74:75], v36 offset:1792
ds_read_b64_tr_b16 v[76:77], v37 offset:0
v_mfma_f32_16x16x32_bf16 a[108:111], v[124:127], v[96:99], a[108:111]
ds_read_b64_tr_b16 v[78:79], v37 offset:1792
ds_read_b64_tr_b16 v[80:81], v38 offset:0
ds_read_b64_tr_b16 v[82:83], v38 offset:1792
s_waitcnt lgkmcnt(0)
v_mfma_f32_16x16x32_bf16 a[0:3], v[56:59], v[40:43], a[0:3]
v_mfma_f32_16x16x32_bf16 a[28:31], v[56:59], v[44:47], a[28:31]
v_add_u32 v23, 45056, v22
v_mfma_f32_16x16x32_bf16 a[56:59], v[56:59], v[48:51], a[56:59]
v_add_u32 v32, 45056, v25
v_mfma_f32_16x16x32_bf16 a[84:87], v[56:59], v[52:55], a[84:87]
v_add_u32 v33, 45056, v26
v_mfma_f32_16x16x32_bf16 a[4:7], v[60:63], v[40:43], a[4:7]
v_add_u32 v34, 45056, v27
v_mfma_f32_16x16x32_bf16 a[32:35], v[60:63], v[44:47], a[32:35]
v_add_u32 v35, 45056, v28
v_mfma_f32_16x16x32_bf16 a[60:63], v[60:63], v[48:51], a[60:63]
v_add_u32 v36, 45056, v29
v_mfma_f32_16x16x32_bf16 a[88:91], v[60:63], v[52:55], a[88:91]
v_add_u32 v37, 45056, v30
v_mfma_f32_16x16x32_bf16 a[8:11], v[64:67], v[40:43], a[8:11]
v_add_u32 v38, 45056, v31
v_mfma_f32_16x16x32_bf16 a[36:39], v[64:67], v[44:47], a[36:39]
ds_read_b128 v[84:87], v23 offset:0
v_mfma_f32_16x16x32_bf16 a[64:67], v[64:67], v[48:51], a[64:67]
ds_read_b128 v[88:91], v23 offset:2048
v_mfma_f32_16x16x32_bf16 a[92:95], v[64:67], v[52:55], a[92:95]
ds_read_b128 v[92:95], v23 offset:4096
v_mfma_f32_16x16x32_bf16 a[12:15], v[68:71], v[40:43], a[12:15]
ds_read_b128 v[96:99], v23 offset:6144
v_mfma_f32_16x16x32_bf16 a[40:43], v[68:71], v[44:47], a[40:43]
ds_read_b64_tr_b16 v[100:101], v32 offset:14336
v_mfma_f32_16x16x32_bf16 a[68:71], v[68:71], v[48:51], a[68:71]
v_mfma_f32_16x16x32_bf16 a[96:99], v[68:71], v[52:55], a[96:99]
ds_read_b64_tr_b16 v[102:103], v32 offset:16128
v_mfma_f32_16x16x32_bf16 a[16:19], v[72:75], v[40:43], a[16:19]
ds_read_b64_tr_b16 v[104:105], v33 offset:14336
v_mfma_f32_16x16x32_bf16 a[44:47], v[72:75], v[44:47], a[44:47]
ds_read_b64_tr_b16 v[106:107], v33 offset:16128
v_mfma_f32_16x16x32_bf16 a[72:75], v[72:75], v[48:51], a[72:75]
ds_read_b64_tr_b16 v[108:109], v34 offset:14336
v_mfma_f32_16x16x32_bf16 a[100:103], v[72:75], v[52:55], a[100:103]
ds_read_b64_tr_b16 v[110:111], v34 offset:16128
v_mfma_f32_16x16x32_bf16 a[20:23], v[76:79], v[40:43], a[20:23]
ds_read_b64_tr_b16 v[112:113], v35 offset:14336
v_mfma_f32_16x16x32_bf16 a[48:51], v[76:79], v[44:47], a[48:51]
ds_read_b64_tr_b16 v[114:115], v35 offset:16128
v_mfma_f32_16x16x32_bf16 a[76:79], v[76:79], v[48:51], a[76:79]
ds_read_b64_tr_b16 v[116:117], v36 offset:14336
v_mfma_f32_16x16x32_bf16 a[104:107], v[76:79], v[52:55], a[104:107]
ds_read_b64_tr_b16 v[118:119], v36 offset:16128
v_mfma_f32_16x16x32_bf16 a[24:27], v[80:83], v[40:43], a[24:27]
ds_read_b64_tr_b16 v[120:121], v37 offset:14336
v_mfma_f32_16x16x32_bf16 a[52:55], v[80:83], v[44:47], a[52:55]
ds_read_b64_tr_b16 v[122:123], v37 offset:16128
v_mfma_f32_16x16x32_bf16 a[80:83], v[80:83], v[48:51], a[80:83]
ds_read_b64_tr_b16 v[124:125], v38 offset:14336
v_mfma_f32_16x16x32_bf16 a[108:111], v[80:83], v[52:55], a[108:111]
ds_read_b64_tr_b16 v[126:127], v38 offset:16128
s_waitcnt vmcnt(0)
s_barrier
s_waitcnt lgkmcnt(0)
v_mfma_f32_16x16x32_bf16 a[0:3], v[100:103], v[84:87], a[0:3]
s_mov_b32 s16, 1920
s_mov_b32 s17, 6881280
v_mfma_f32_16x16x32_bf16 a[28:31], v[100:103], v[88:91], a[28:31]
s_add_u32 m0, s27, 0
s_nop 0
v_mfma_f32_16x16x32_bf16 a[56:59], v[100:103], v[92:95], a[56:59]
buffer_load_dwordx4 v10, s[4:7], s16 offen lds
s_add_u32 m0, s27, 1024
v_mfma_f32_16x16x32_bf16 a[84:87], v[100:103], v[96:99], a[84:87]
s_nop 0
buffer_load_dwordx4 v11, s[4:7], s16 offen lds
v_mfma_f32_16x16x32_bf16 a[4:7], v[104:107], v[84:87], a[4:7]
s_add_u32 m0, s27, 2048
s_nop 0
v_mfma_f32_16x16x32_bf16 a[32:35], v[104:107], v[88:91], a[32:35]
buffer_load_dwordx4 v12, s[4:7], s16 offen lds
s_add_u32 m0, s27, 3072
s_nop 0
v_mfma_f32_16x16x32_bf16 a[60:63], v[104:107], v[92:95], a[60:63]
buffer_load_dwordx4 v13, s[4:7], s16 offen lds
s_add_u32 m0, s28, 16384
v_mfma_f32_16x16x32_bf16 a[88:91], v[104:107], v[96:99], a[88:91]
s_nop 0
buffer_load_dwordx4 v14, s[8:11], s17 offen lds
v_mfma_f32_16x16x32_bf16 a[8:11], v[108:111], v[84:87], a[8:11]
s_add_u32 m0, s28, 17408
s_nop 0
v_mfma_f32_16x16x32_bf16 a[36:39], v[108:111], v[88:91], a[36:39]
buffer_load_dwordx4 v15, s[8:11], s17 offen lds
s_add_u32 m0, s28, 18432
v_mfma_f32_16x16x32_bf16 a[64:67], v[108:111], v[92:95], a[64:67]
s_nop 0
buffer_load_dwordx4 v16, s[8:11], s17 offen lds
v_mfma_f32_16x16x32_bf16 a[92:95], v[108:111], v[96:99], a[92:95]
s_add_u32 m0, s28, 19456
s_nop 0
buffer_load_dwordx4 v17, s[8:11], s17 offen lds
v_mfma_f32_16x16x32_bf16 a[12:15], v[112:115], v[84:87], a[12:15]
s_add_u32 m0, s28, 20480
s_nop 0
v_mfma_f32_16x16x32_bf16 a[40:43], v[112:115], v[88:91], a[40:43]
buffer_load_dwordx4 v18, s[8:11], s17 offen lds
s_add_u32 m0, s28, 21504
v_mfma_f32_16x16x32_bf16 a[68:71], v[112:115], v[92:95], a[68:71]
s_nop 0
buffer_load_dwordx4 v19, s[8:11], s17 offen lds
v_mfma_f32_16x16x32_bf16 a[96:99], v[112:115], v[96:99], a[96:99]
s_add_u32 m0, s28, 22528
s_nop 0
v_mfma_f32_16x16x32_bf16 a[16:19], v[116:119], v[84:87], a[16:19]
buffer_load_dwordx4 v20, s[8:11], s17 offen lds
v_add_u32 v23, 90112, v21
v_add_u32 v32, 90112, v25
v_mfma_f32_16x16x32_bf16 a[44:47], v[116:119], v[88:91], a[44:47]
v_add_u32 v33, 90112, v26
v_add_u32 v34, 90112, v27
v_mfma_f32_16x16x32_bf16 a[72:75], v[116:119], v[92:95], a[72:75]
v_add_u32 v35, 90112, v28
v_add_u32 v36, 90112, v29
v_mfma_f32_16x16x32_bf16 a[100:103], v[116:119], v[96:99], a[100:103]
v_add_u32 v37, 90112, v30
v_add_u32 v38, 90112, v31
v_mfma_f32_16x16x32_bf16 a[20:23], v[120:123], v[84:87], a[20:23]
ds_read_b128 v[40:43], v23 offset:0
ds_read_b128 v[44:47], v23 offset:2048
v_mfma_f32_16x16x32_bf16 a[48:51], v[120:123], v[88:91], a[48:51]
ds_read_b128 v[48:51], v23 offset:4096
ds_read_b128 v[52:55], v23 offset:6144
v_mfma_f32_16x16x32_bf16 a[76:79], v[120:123], v[92:95], a[76:79]
ds_read_b64_tr_b16 v[56:57], v32 offset:0
ds_read_b64_tr_b16 v[58:59], v32 offset:1792
ds_read_b64_tr_b16 v[60:61], v33 offset:0
v_mfma_f32_16x16x32_bf16 a[104:107], v[120:123], v[96:99], a[104:107]
ds_read_b64_tr_b16 v[62:63], v33 offset:1792
ds_read_b64_tr_b16 v[64:65], v34 offset:0
v_mfma_f32_16x16x32_bf16 a[24:27], v[124:127], v[84:87], a[24:27]
ds_read_b64_tr_b16 v[66:67], v34 offset:1792
ds_read_b64_tr_b16 v[68:69], v35 offset:0
v_mfma_f32_16x16x32_bf16 a[52:55], v[124:127], v[88:91], a[52:55]
ds_read_b64_tr_b16 v[70:71], v35 offset:1792
ds_read_b64_tr_b16 v[72:73], v36 offset:0
v_mfma_f32_16x16x32_bf16 a[80:83], v[124:127], v[92:95], a[80:83]
ds_read_b64_tr_b16 v[74:75], v36 offset:1792
ds_read_b64_tr_b16 v[76:77], v37 offset:0
v_mfma_f32_16x16x32_bf16 a[108:111], v[124:127], v[96:99], a[108:111]
ds_read_b64_tr_b16 v[78:79], v37 offset:1792
ds_read_b64_tr_b16 v[80:81], v38 offset:0
ds_read_b64_tr_b16 v[82:83], v38 offset:1792
s_waitcnt lgkmcnt(0)
v_mfma_f32_16x16x32_bf16 a[0:3], v[56:59], v[40:43], a[0:3]
v_mfma_f32_16x16x32_bf16 a[28:31], v[56:59], v[44:47], a[28:31]
v_add_u32 v23, 90112, v22
v_mfma_f32_16x16x32_bf16 a[56:59], v[56:59], v[48:51], a[56:59]
v_add_u32 v32, 90112, v25
v_mfma_f32_16x16x32_bf16 a[84:87], v[56:59], v[52:55], a[84:87]
v_add_u32 v33, 90112, v26
v_mfma_f32_16x16x32_bf16 a[4:7], v[60:63], v[40:43], a[4:7]
v_add_u32 v34, 90112, v27
v_mfma_f32_16x16x32_bf16 a[32:35], v[60:63], v[44:47], a[32:35]
v_add_u32 v35, 90112, v28
v_mfma_f32_16x16x32_bf16 a[60:63], v[60:63], v[48:51], a[60:63]
v_add_u32 v36, 90112, v29
v_mfma_f32_16x16x32_bf16 a[88:91], v[60:63], v[52:55], a[88:91]
v_add_u32 v37, 90112, v30
v_mfma_f32_16x16x32_bf16 a[8:11], v[64:67], v[40:43], a[8:11]
v_add_u32 v38, 90112, v31
v_mfma_f32_16x16x32_bf16 a[36:39], v[64:67], v[44:47], a[36:39]
ds_read_b128 v[84:87], v23 offset:0
v_mfma_f32_16x16x32_bf16 a[64:67], v[64:67], v[48:51], a[64:67]
ds_read_b128 v[88:91], v23 offset:2048
v_mfma_f32_16x16x32_bf16 a[92:95], v[64:67], v[52:55], a[92:95]
ds_read_b128 v[92:95], v23 offset:4096
v_mfma_f32_16x16x32_bf16 a[12:15], v[68:71], v[40:43], a[12:15]
ds_read_b128 v[96:99], v23 offset:6144
v_mfma_f32_16x16x32_bf16 a[40:43], v[68:71], v[44:47], a[40:43]
ds_read_b64_tr_b16 v[100:101], v32 offset:14336
v_mfma_f32_16x16x32_bf16 a[68:71], v[68:71], v[48:51], a[68:71]
v_mfma_f32_16x16x32_bf16 a[96:99], v[68:71], v[52:55], a[96:99]
ds_read_b64_tr_b16 v[102:103], v32 offset:16128
v_mfma_f32_16x16x32_bf16 a[16:19], v[72:75], v[40:43], a[16:19]
ds_read_b64_tr_b16 v[104:105], v33 offset:14336
v_mfma_f32_16x16x32_bf16 a[44:47], v[72:75], v[44:47], a[44:47]
ds_read_b64_tr_b16 v[106:107], v33 offset:16128
v_mfma_f32_16x16x32_bf16 a[72:75], v[72:75], v[48:51], a[72:75]
ds_read_b64_tr_b16 v[108:109], v34 offset:14336
v_mfma_f32_16x16x32_bf16 a[100:103], v[72:75], v[52:55], a[100:103]
ds_read_b64_tr_b16 v[110:111], v34 offset:16128
v_mfma_f32_16x16x32_bf16 a[20:23], v[76:79], v[40:43], a[20:23]
ds_read_b64_tr_b16 v[112:113], v35 offset:14336
v_mfma_f32_16x16x32_bf16 a[48:51], v[76:79], v[44:47], a[48:51]
ds_read_b64_tr_b16 v[114:115], v35 offset:16128
v_mfma_f32_16x16x32_bf16 a[76:79], v[76:79], v[48:51], a[76:79]
ds_read_b64_tr_b16 v[116:117], v36 offset:14336
v_mfma_f32_16x16x32_bf16 a[104:107], v[76:79], v[52:55], a[104:107]
ds_read_b64_tr_b16 v[118:119], v36 offset:16128
v_mfma_f32_16x16x32_bf16 a[24:27], v[80:83], v[40:43], a[24:27]
ds_read_b64_tr_b16 v[120:121], v37 offset:14336
v_mfma_f32_16x16x32_bf16 a[52:55], v[80:83], v[44:47], a[52:55]
ds_read_b64_tr_b16 v[122:123], v37 offset:16128
v_mfma_f32_16x16x32_bf16 a[80:83], v[80:83], v[48:51], a[80:83]
ds_read_b64_tr_b16 v[124:125], v38 offset:14336
v_mfma_f32_16x16x32_bf16 a[108:111], v[80:83], v[52:55], a[108:111]
ds_read_b64_tr_b16 v[126:127], v38 offset:16128
s_waitcnt vmcnt(0)
s_barrier
s_waitcnt lgkmcnt(0)
v_mfma_f32_16x16x32_bf16 a[0:3], v[100:103], v[84:87], a[0:3]
v_mfma_f32_16x16x32_bf16 a[28:31], v[100:103], v[88:91], a[28:31]
v_add_u32 v23, 0, v21
v_mfma_f32_16x16x32_bf16 a[56:59], v[100:103], v[92:95], a[56:59]
v_add_u32 v32, 0, v25
v_mfma_f32_16x16x32_bf16 a[84:87], v[100:103], v[96:99], a[84:87]
v_add_u32 v33, 0, v26
v_mfma_f32_16x16x32_bf16 a[4:7], v[104:107], v[84:87], a[4:7]
v_add_u32 v34, 0, v27
v_mfma_f32_16x16x32_bf16 a[32:35], v[104:107], v[88:91], a[32:35]
v_add_u32 v35, 0, v28
v_mfma_f32_16x16x32_bf16 a[60:63], v[104:107], v[92:95], a[60:63]
v_add_u32 v36, 0, v29
v_mfma_f32_16x16x32_bf16 a[88:91], v[104:107], v[96:99], a[88:91]
v_add_u32 v37, 0, v30
v_mfma_f32_16x16x32_bf16 a[8:11], v[108:111], v[84:87], a[8:11]
v_add_u32 v38, 0, v31
v_mfma_f32_16x16x32_bf16 a[36:39], v[108:111], v[88:91], a[36:39]
ds_read_b128 v[40:43], v23 offset:0
v_mfma_f32_16x16x32_bf16 a[64:67], v[108:111], v[92:95], a[64:67]
ds_read_b128 v[44:47], v23 offset:2048
v_mfma_f32_16x16x32_bf16 a[92:95], v[108:111], v[96:99], a[92:95]
ds_read_b128 v[48:51], v23 offset:4096
v_mfma_f32_16x16x32_bf16 a[12:15], v[112:115], v[84:87], a[12:15]
ds_read_b128 v[52:55], v23 offset:6144
v_mfma_f32_16x16x32_bf16 a[40:43], v[112:115], v[88:91], a[40:43]
ds_read_b64_tr_b16 v[56:57], v32 offset:0
v_mfma_f32_16x16x32_bf16 a[68:71], v[112:115], v[92:95], a[68:71]
v_mfma_f32_16x16x32_bf16 a[96:99], v[112:115], v[96:99], a[96:99]
ds_read_b64_tr_b16 v[58:59], v32 offset:1792
v_mfma_f32_16x16x32_bf16 a[16:19], v[116:119], v[84:87], a[16:19]
ds_read_b64_tr_b16 v[60:61], v33 offset:0
v_mfma_f32_16x16x32_bf16 a[44:47], v[116:119], v[88:91], a[44:47]
ds_read_b64_tr_b16 v[62:63], v33 offset:1792
v_mfma_f32_16x16x32_bf16 a[72:75], v[116:119], v[92:95], a[72:75]
ds_read_b64_tr_b16 v[64:65], v34 offset:0
v_mfma_f32_16x16x32_bf16 a[100:103], v[116:119], v[96:99], a[100:103]
ds_read_b64_tr_b16 v[66:67], v34 offset:1792
v_mfma_f32_16x16x32_bf16 a[20:23], v[120:123], v[84:87], a[20:23]
ds_read_b64_tr_b16 v[68:69], v35 offset:0
v_mfma_f32_16x16x32_bf16 a[48:51], v[120:123], v[88:91], a[48:51]
ds_read_b64_tr_b16 v[70:71], v35 offset:1792
v_mfma_f32_16x16x32_bf16 a[76:79], v[120:123], v[92:95], a[76:79]
ds_read_b64_tr_b16 v[72:73], v36 offset:0
v_mfma_f32_16x16x32_bf16 a[104:107], v[120:123], v[96:99], a[104:107]
ds_read_b64_tr_b16 v[74:75], v36 offset:1792
v_mfma_f32_16x16x32_bf16 a[24:27], v[124:127], v[84:87], a[24:27]
ds_read_b64_tr_b16 v[76:77], v37 offset:0
v_mfma_f32_16x16x32_bf16 a[52:55], v[124:127], v[88:91], a[52:55]
ds_read_b64_tr_b16 v[78:79], v37 offset:1792
v_mfma_f32_16x16x32_bf16 a[80:83], v[124:127], v[92:95], a[80:83]
ds_read_b64_tr_b16 v[80:81], v38 offset:0
v_mfma_f32_16x16x32_bf16 a[108:111], v[124:127], v[96:99], a[108:111]
ds_read_b64_tr_b16 v[82:83], v38 offset:1792
s_waitcnt lgkmcnt(0)
v_mfma_f32_16x16x32_bf16 a[0:3], v[56:59], v[40:43], a[0:3]
v_mfma_f32_16x16x32_bf16 a[28:31], v[56:59], v[44:47], a[28:31]
v_add_u32 v23, 0, v22
v_mfma_f32_16x16x32_bf16 a[56:59], v[56:59], v[48:51], a[56:59]
v_add_u32 v32, 0, v25
v_mfma_f32_16x16x32_bf16 a[84:87], v[56:59], v[52:55], a[84:87]
v_add_u32 v33, 0, v26
v_mfma_f32_16x16x32_bf16 a[4:7], v[60:63], v[40:43], a[4:7]
v_add_u32 v34, 0, v27
v_mfma_f32_16x16x32_bf16 a[32:35], v[60:63], v[44:47], a[32:35]
v_add_u32 v35, 0, v28
v_mfma_f32_16x16x32_bf16 a[60:63], v[60:63], v[48:51], a[60:63]
v_add_u32 v36, 0, v29
v_mfma_f32_16x16x32_bf16 a[88:91], v[60:63], v[52:55], a[88:91]
v_add_u32 v37, 0, v30
v_mfma_f32_16x16x32_bf16 a[8:11], v[64:67], v[40:43], a[8:11]
v_add_u32 v38, 0, v31
v_mfma_f32_16x16x32_bf16 a[36:39], v[64:67], v[44:47], a[36:39]
ds_read_b128 v[84:87], v23 offset:0
v_mfma_f32_16x16x32_bf16 a[64:67], v[64:67], v[48:51], a[64:67]
ds_read_b128 v[88:91], v23 offset:2048
v_mfma_f32_16x16x32_bf16 a[92:95], v[64:67], v[52:55], a[92:95]
ds_read_b128 v[92:95], v23 offset:4096
v_mfma_f32_16x16x32_bf16 a[12:15], v[68:71], v[40:43], a[12:15]
ds_read_b128 v[96:99], v23 offset:6144
v_mfma_f32_16x16x32_bf16 a[40:43], v[68:71], v[44:47], a[40:43]
ds_read_b64_tr_b16 v[100:101], v32 offset:14336
v_mfma_f32_16x16x32_bf16 a[68:71], v[68:71], v[48:51], a[68:71]
v_mfma_f32_16x16x32_bf16 a[96:99], v[68:71], v[52:55], a[96:99]
ds_read_b64_tr_b16 v[102:103], v32 offset:16128
v_mfma_f32_16x16x32_bf16 a[16:19], v[72:75], v[40:43], a[16:19]
ds_read_b64_tr_b16 v[104:105], v33 offset:14336
v_mfma_f32_16x16x32_bf16 a[44:47], v[72:75], v[44:47], a[44:47]
ds_read_b64_tr_b16 v[106:107], v33 offset:16128
v_mfma_f32_16x16x32_bf16 a[72:75], v[72:75], v[48:51], a[72:75]
ds_read_b64_tr_b16 v[108:109], v34 offset:14336
v_mfma_f32_16x16x32_bf16 a[100:103], v[72:75], v[52:55], a[100:103]
ds_read_b64_tr_b16 v[110:111], v34 offset:16128
v_mfma_f32_16x16x32_bf16 a[20:23], v[76:79], v[40:43], a[20:23]
ds_read_b64_tr_b16 v[112:113], v35 offset:14336
v_mfma_f32_16x16x32_bf16 a[48:51], v[76:79], v[44:47], a[48:51]
ds_read_b64_tr_b16 v[114:115], v35 offset:16128
v_mfma_f32_16x16x32_bf16 a[76:79], v[76:79], v[48:51], a[76:79]
ds_read_b64_tr_b16 v[116:117], v36 offset:14336
v_mfma_f32_16x16x32_bf16 a[104:107], v[76:79], v[52:55], a[104:107]
ds_read_b64_tr_b16 v[118:119], v36 offset:16128
v_mfma_f32_16x16x32_bf16 a[24:27], v[80:83], v[40:43], a[24:27]
ds_read_b64_tr_b16 v[120:121], v37 offset:14336
v_mfma_f32_16x16x32_bf16 a[52:55], v[80:83], v[44:47], a[52:55]
ds_read_b64_tr_b16 v[122:123], v37 offset:16128
v_mfma_f32_16x16x32_bf16 a[80:83], v[80:83], v[48:51], a[80:83]
ds_read_b64_tr_b16 v[124:125], v38 offset:14336
v_mfma_f32_16x16x32_bf16 a[108:111], v[80:83], v[52:55], a[108:111]
ds_read_b64_tr_b16 v[126:127], v38 offset:16128
s_waitcnt vmcnt(0)
s_barrier
s_waitcnt lgkmcnt(0)
v_mfma_f32_16x16x32_bf16 a[0:3], v[100:103], v[84:87], a[0:3]
v_mfma_f32_16x16x32_bf16 a[28:31], v[100:103], v[88:91], a[28:31]
v_add_u32 v23, 45056, v21
v_mfma_f32_16x16x32_bf16 a[56:59], v[100:103], v[92:95], a[56:59]
v_add_u32 v32, 45056, v25
v_mfma_f32_16x16x32_bf16 a[84:87], v[100:103], v[96:99], a[84:87]
v_add_u32 v33, 45056, v26
v_mfma_f32_16x16x32_bf16 a[4:7], v[104:107], v[84:87], a[4:7]
v_add_u32 v34, 45056, v27
v_mfma_f32_16x16x32_bf16 a[32:35], v[104:107], v[88:91], a[32:35]
v_add_u32 v35, 45056, v28
v_mfma_f32_16x16x32_bf16 a[60:63], v[104:107], v[92:95], a[60:63]
v_add_u32 v36, 45056, v29
v_mfma_f32_16x16x32_bf16 a[88:91], v[104:107], v[96:99], a[88:91]
v_add_u32 v37, 45056, v30
v_mfma_f32_16x16x32_bf16 a[8:11], v[108:111], v[84:87], a[8:11]
v_add_u32 v38, 45056, v31
v_mfma_f32_16x16x32_bf16 a[36:39], v[108:111], v[88:91], a[36:39]
ds_read_b128 v[40:43], v23 offset:0
v_mfma_f32_16x16x32_bf16 a[64:67], v[108:111], v[92:95], a[64:67]
ds_read_b128 v[44:47], v23 offset:2048
v_mfma_f32_16x16x32_bf16 a[92:95], v[108:111], v[96:99], a[92:95]
ds_read_b128 v[48:51], v23 offset:4096
v_mfma_f32_16x16x32_bf16 a[12:15], v[112:115], v[84:87], a[12:15]
ds_read_b128 v[52:55], v23 offset:6144
v_mfma_f32_16x16x32_bf16 a[40:43], v[112:115], v[88:91], a[40:43]
ds_read_b64_tr_b16 v[56:57], v32 offset:0
v_mfma_f32_16x16x32_bf16 a[68:71], v[112:115], v[92:95], a[68:71]
v_mfma_f32_16x16x32_bf16 a[96:99], v[112:115], v[96:99], a[96:99]
ds_read_b64_tr_b16 v[58:59], v32 offset:1792
v_mfma_f32_16x16x32_bf16 a[16:19], v[116:119], v[84:87], a[16:19]
ds_read_b64_tr_b16 v[60:61], v33 offset:0
v_mfma_f32_16x16x32_bf16 a[44:47], v[116:119], v[88:91], a[44:47]
ds_read_b64_tr_b16 v[62:63], v33 offset:1792
v_mfma_f32_16x16x32_bf16 a[72:75], v[116:119], v[92:95], a[72:75]
ds_read_b64_tr_b16 v[64:65], v34 offset:0
v_mfma_f32_16x16x32_bf16 a[100:103], v[116:119], v[96:99], a[100:103]
ds_read_b64_tr_b16 v[66:67], v34 offset:1792
v_mfma_f32_16x16x32_bf16 a[20:23], v[120:123], v[84:87], a[20:23]
ds_read_b64_tr_b16 v[68:69], v35 offset:0
v_mfma_f32_16x16x32_bf16 a[48:51], v[120:123], v[88:91], a[48:51]
ds_read_b64_tr_b16 v[70:71], v35 offset:1792
v_mfma_f32_16x16x32_bf16 a[76:79], v[120:123], v[92:95], a[76:79]
ds_read_b64_tr_b16 v[72:73], v36 offset:0
v_mfma_f32_16x16x32_bf16 a[104:107], v[120:123], v[96:99], a[104:107]
ds_read_b64_tr_b16 v[74:75], v36 offset:1792
v_mfma_f32_16x16x32_bf16 a[24:27], v[124:127], v[84:87], a[24:27]
ds_read_b64_tr_b16 v[76:77], v37 offset:0
v_mfma_f32_16x16x32_bf16 a[52:55], v[124:127], v[88:91], a[52:55]
ds_read_b64_tr_b16 v[78:79], v37 offset:1792
v_mfma_f32_16x16x32_bf16 a[80:83], v[124:127], v[92:95], a[80:83]
ds_read_b64_tr_b16 v[80:81], v38 offset:0
v_mfma_f32_16x16x32_bf16 a[108:111], v[124:127], v[96:99], a[108:111]
ds_read_b64_tr_b16 v[82:83], v38 offset:1792
s_waitcnt vmcnt(0) lgkmcnt(0)
s_nop 15
s_nop 7
v_and_b32 v4, 15, v1
v_lshrrev_b32 v5, 4, v1
v_lshrrev_b32 v6, 1, v2
v_and_b32 v7, 1, v2
v_lshl_add_u32 v8, v6, 6, v4
s_lshl_b32 s25, s22, 7
v_add_u32 v9, s25, v8
v_xor_b32 v60, 16, v1
v_lshlrev_b32 v60, 2, v60
v_xor_b32 v61, 32, v1
v_lshlrev_b32 v61, 2, v61
v_lshlrev_b32 v3, 3, v8
v_add_u32 v3, 135168, v3
ds_read_b64 v[64:65], v3 offset:0
ds_read_b64 v[66:67], v3 offset:128
ds_read_b64 v[68:69], v3 offset:256
ds_read_b64 v[70:71], v3 offset:384
s_mul_i32 s25, s23, 224
v_mul_u32_u24 v10, 112, v7
v_add_u32 v10, s25, v10
v_lshl_add_u32 v10, v5, 2, v10
s_mov_b32 s26, 3584
v_mul_lo_u32 v11, v9, s26
v_add_u32 v11, v11, v10
v_lshlrev_b32 v11, 1, v11
s_load_dwordx2 s[12:13], s[0:1], 88
s_load_dwordx2 s[4:5], s[0:1], 88
s_waitcnt lgkmcnt(0)
s_add_u32 s12, s12, 25165824
s_addc_u32 s13, s13, 0
s_mov_b32 s14, 14680064
s_mov_b32 s15, 0x00020000
s_add_u32 s4, s4, 54542336
s_addc_u32 s5, s5, 0
s_mov_b32 s6, 106496
s_mov_b32 s7, 0x00020000
v_lshlrev_b32 v12, 2, v10
buffer_load_dwordx4 v[72:75], v12, s[4:7], 0 offen offset:0
buffer_load_dwordx4 v[76:79], v12, s[4:7], 0 offen offset:64
buffer_load_dwordx4 v[80:83], v12, s[4:7], 0 offen offset:128
buffer_load_dwordx4 v[84:87], v12, s[4:7], 0 offen offset:192
buffer_load_dwordx4 v[88:91], v12, s[4:7], 0 offen offset:256
buffer_load_dwordx4 v[92:95], v12, s[4:7], 0 offen offset:320
buffer_load_dwordx4 v[96:99], v12, s[4:7], 0 offen offset:384
v_add_u32 v13, 30720, v12
buffer_load_dwordx4 v[128:131], v13, s[4:7], 0 offen offset:0
buffer_load_dwordx4 v[132:135], v13, s[4:7], 0 offen offset:64
buffer_load_dwordx4 v[136:139], v13, s[4:7], 0 offen offset:128
buffer_load_dwordx4 v[140:143], v13, s[4:7], 0 offen offset:192
buffer_load_dwordx4 v[144:147], v13, s[4:7], 0 offen offset:256
buffer_load_dwordx4 v[148:151], v13, s[4:7], 0 offen offset:320
buffer_load_dwordx4 v[152:155], v13, s[4:7], 0 offen offset:384
v_add_u32 v13, 61440, v12
buffer_load_dwordx4 v[156:159], v13, s[4:7], 0 offen offset:0
buffer_load_dwordx4 v[160:163], v13, s[4:7], 0 offen offset:64
buffer_load_dwordx4 v[164:167], v13, s[4:7], 0 offen offset:128
buffer_load_dwordx4 v[168:171], v13, s[4:7], 0 offen offset:192
buffer_load_dwordx4 v[172:175], v13, s[4:7], 0 offen offset:256
buffer_load_dwordx4 v[176:179], v13, s[4:7], 0 offen offset:320
buffer_load_dwordx4 v[180:183], v13, s[4:7], 0 offen offset:384
v_add_u32 v13, 92160, v12
buffer_load_dwordx4 v[184:187], v13, s[4:7], 0 offen offset:0
buffer_load_dwordx4 v[188:191], v13, s[4:7], 0 offen offset:64
buffer_load_dwordx4 v[192:195], v13, s[4:7], 0 offen offset:128
buffer_load_dwordx4 v[196:199], v13, s[4:7], 0 offen offset:192
buffer_load_dwordx4 v[200:203], v13, s[4:7], 0 offen offset:256
buffer_load_dwordx4 v[204:207], v13, s[4:7], 0 offen offset:320
buffer_load_dwordx4 v[208:211], v13, s[4:7], 0 offen offset:384
s_waitcnt vmcnt(0)
v_add_f32 v72, v72, v128
v_add_f32 v73, v73, v129
v_add_f32 v74, v74, v130
v_add_f32 v75, v75, v131
v_add_f32 v76, v76, v132
v_add_f32 v77, v77, v133
v_add_f32 v78, v78, v134
v_add_f32 v79, v79, v135
v_add_f32 v80, v80, v136
v_add_f32 v81, v81, v137
v_add_f32 v82, v82, v138
v_add_f32 v83, v83, v139
v_add_f32 v84, v84, v140
v_add_f32 v85, v85, v141
v_add_f32 v86, v86, v142
v_add_f32 v87, v87, v143
v_add_f32 v88, v88, v144
v_add_f32 v89, v89, v145
v_add_f32 v90, v90, v146
v_add_f32 v91, v91, v147
v_add_f32 v92, v92, v148
v_add_f32 v93, v93, v149
v_add_f32 v94, v94, v150
v_add_f32 v95, v95, v151
v_add_f32 v96, v96, v152
v_add_f32 v97, v97, v153
v_add_f32 v98, v98, v154
v_add_f32 v99, v99, v155
v_add_f32 v72, v72, v156
v_add_f32 v73, v73, v157
v_add_f32 v74, v74, v158
v_add_f32 v75, v75, v159
v_add_f32 v76, v76, v160
v_add_f32 v77, v77, v161
v_add_f32 v78, v78, v162
v_add_f32 v79, v79, v163
v_add_f32 v80, v80, v164
v_add_f32 v81, v81, v165
v_add_f32 v82, v82, v166
v_add_f32 v83, v83, v167
v_add_f32 v84, v84, v168
v_add_f32 v85, v85, v169
v_add_f32 v86, v86, v170
v_add_f32 v87, v87, v171
v_add_f32 v88, v88, v172
v_add_f32 v89, v89, v173
v_add_f32 v90, v90, v174
v_add_f32 v91, v91, v175
v_add_f32 v92, v92, v176
v_add_f32 v93, v93, v177
v_add_f32 v94, v94, v178
v_add_f32 v95, v95, v179
v_add_f32 v96, v96, v180
v_add_f32 v97, v97, v181
v_add_f32 v98, v98, v182
v_add_f32 v99, v99, v183
v_add_f32 v72, v72, v184
v_add_f32 v73, v73, v185
v_add_f32 v74, v74, v186
v_add_f32 v75, v75, v187
v_add_f32 v76, v76, v188
v_add_f32 v77, v77, v189
v_add_f32 v78, v78, v190
v_add_f32 v79, v79, v191
v_add_f32 v80, v80, v192
v_add_f32 v81, v81, v193
v_add_f32 v82, v82, v194
v_add_f32 v83, v83, v195
v_add_f32 v84, v84, v196
v_add_f32 v85, v85, v197
v_add_f32 v86, v86, v198
v_add_f32 v87, v87, v199
v_add_f32 v88, v88, v200
v_add_f32 v89, v89, v201
v_add_f32 v90, v90, v202
v_add_f32 v91, v91, v203
v_add_f32 v92, v92, v204
v_add_f32 v93, v93, v205
v_add_f32 v94, v94, v206
v_add_f32 v95, v95, v207
v_add_f32 v96, v96, v208
v_add_f32 v97, v97, v209
v_add_f32 v98, v98, v210
v_add_f32 v99, v99, v211
v_add_u32 v13, 0, v11
s_waitcnt vmcnt(0) lgkmcnt(0)
v_accvgpr_read_b32 v104, a0
v_accvgpr_read_b32 v105, a1
v_accvgpr_read_b32 v106, a2
v_accvgpr_read_b32 v107, a3
v_fma_f32 v104, -v64, v72, v104
v_mul_f32 v104, v104, v65
v_fma_f32 v105, -v64, v73, v105
v_mul_f32 v105, v105, v65
v_fma_f32 v106, -v64, v74, v106
v_mul_f32 v106, v106, v65
v_fma_f32 v107, -v64, v75, v107
v_mul_f32 v107, v107, v65
v_cvt_pk_bf16_f32 v110, v104, v105
v_lshlrev_b32 v104, 16, v110
v_and_b32 v105, 0xffff0000, v110
v_cvt_pk_bf16_f32 v110, v106, v107
v_lshlrev_b32 v106, 16, v110
v_and_b32 v107, 0xffff0000, v110
v_mul_f32 v111, v104, v104
v_mul_f32 v111, 0x3d372713, v111
v_add_f32 v111, 1.0, v111
v_mul_f32 v111, v111, v104
v_mul_f32 v111, 0xc01362dc, v111
v_exp_f32 v111, v111
s_nop 0
v_add_f32 v111, 1.0, v111
v_rcp_f32 v111, v111
s_nop 0
v_mul_f32 v104, v104, v111
v_mul_f32 v111, v105, v105
v_mul_f32 v111, 0x3d372713, v111
v_add_f32 v111, 1.0, v111
v_mul_f32 v111, v111, v105
v_mul_f32 v111, 0xc01362dc, v111
v_exp_f32 v111, v111
s_nop 0
v_add_f32 v111, 1.0, v111
v_rcp_f32 v111, v111
s_nop 0
v_mul_f32 v105, v105, v111
v_mul_f32 v111, v106, v106
v_mul_f32 v111, 0x3d372713, v111
v_add_f32 v111, 1.0, v111
v_mul_f32 v111, v111, v106
v_mul_f32 v111, 0xc01362dc, v111
v_exp_f32 v111, v111
s_nop 0
v_add_f32 v111, 1.0, v111
v_rcp_f32 v111, v111
s_nop 0
v_mul_f32 v106, v106, v111
v_mul_f32 v111, v107, v107
v_mul_f32 v111, 0x3d372713, v111
v_add_f32 v111, 1.0, v111
v_mul_f32 v111, v111, v107
v_mul_f32 v111, 0xc01362dc, v111
v_exp_f32 v111, v111
s_nop 0
v_add_f32 v111, 1.0, v111
v_rcp_f32 v111, v111
s_nop 0
v_mul_f32 v107, v107, v111
v_cvt_pk_bf16_f32 v108, v104, v105
v_cvt_pk_bf16_f32 v109, v106, v107
buffer_store_dwordx2 v[108:109], v13, s[12:15], 0 offen offset:0
s_nop 1
v_accvgpr_read_b32 v104, a4
v_accvgpr_read_b32 v105, a5
v_accvgpr_read_b32 v106, a6
v_accvgpr_read_b32 v107, a7
v_fma_f32 v104, -v64, v76, v104
v_mul_f32 v104, v104, v65
v_fma_f32 v105, -v64, v77, v105
v_mul_f32 v105, v105, v65
v_fma_f32 v106, -v64, v78, v106
v_mul_f32 v106, v106, v65
v_fma_f32 v107, -v64, v79, v107
v_mul_f32 v107, v107, v65
v_cvt_pk_bf16_f32 v110, v104, v105
v_lshlrev_b32 v104, 16, v110
v_and_b32 v105, 0xffff0000, v110
v_cvt_pk_bf16_f32 v110, v106, v107
v_lshlrev_b32 v106, 16, v110
v_and_b32 v107, 0xffff0000, v110
v_mul_f32 v111, v104, v104
v_mul_f32 v111, 0x3d372713, v111
v_add_f32 v111, 1.0, v111
v_mul_f32 v111, v111, v104
v_mul_f32 v111, 0xc01362dc, v111
v_exp_f32 v111, v111
s_nop 0
v_add_f32 v111, 1.0, v111
v_rcp_f32 v111, v111
s_nop 0
v_mul_f32 v104, v104, v111
v_mul_f32 v111, v105, v105
v_mul_f32 v111, 0x3d372713, v111
v_add_f32 v111, 1.0, v111
v_mul_f32 v111, v111, v105
v_mul_f32 v111, 0xc01362dc, v111
v_exp_f32 v111, v111
s_nop 0
v_add_f32 v111, 1.0, v111
v_rcp_f32 v111, v111
s_nop 0
v_mul_f32 v105, v105, v111
v_mul_f32 v111, v106, v106
v_mul_f32 v111, 0x3d372713, v111
v_add_f32 v111, 1.0, v111
v_mul_f32 v111, v111, v106
v_mul_f32 v111, 0xc01362dc, v111
v_exp_f32 v111, v111
s_nop 0
v_add_f32 v111, 1.0, v111
v_rcp_f32 v111, v111
s_nop 0
v_mul_f32 v106, v106, v111
v_mul_f32 v111, v107, v107
v_mul_f32 v111, 0x3d372713, v111
v_add_f32 v111, 1.0, v111
v_mul_f32 v111, v111, v107
v_mul_f32 v111, 0xc01362dc, v111
v_exp_f32 v111, v111
s_nop 0
v_add_f32 v111, 1.0, v111
v_rcp_f32 v111, v111
s_nop 0
v_mul_f32 v107, v107, v111
v_cvt_pk_bf16_f32 v108, v104, v105
v_cvt_pk_bf16_f32 v109, v106, v107
buffer_store_dwordx2 v[108:109], v13, s[12:15], 0 offen offset:32
s_nop 1
v_accvgpr_read_b32 v104, a8
v_accvgpr_read_b32 v105, a9
v_accvgpr_read_b32 v106, a10
v_accvgpr_read_b32 v107, a11
v_fma_f32 v104, -v64, v80, v104
v_mul_f32 v104, v104, v65
v_fma_f32 v105, -v64, v81, v105
v_mul_f32 v105, v105, v65
v_fma_f32 v106, -v64, v82, v106
v_mul_f32 v106, v106, v65
v_fma_f32 v107, -v64, v83, v107
v_mul_f32 v107, v107, v65
v_cvt_pk_bf16_f32 v110, v104, v105
v_lshlrev_b32 v104, 16, v110
v_and_b32 v105, 0xffff0000, v110
v_cvt_pk_bf16_f32 v110, v106, v107
v_lshlrev_b32 v106, 16, v110
v_and_b32 v107, 0xffff0000, v110
v_mul_f32 v111, v104, v104
v_mul_f32 v111, 0x3d372713, v111
v_add_f32 v111, 1.0, v111
v_mul_f32 v111, v111, v104
v_mul_f32 v111, 0xc01362dc, v111
v_exp_f32 v111, v111
s_nop 0
v_add_f32 v111, 1.0, v111
v_rcp_f32 v111, v111
s_nop 0
v_mul_f32 v104, v104, v111
v_mul_f32 v111, v105, v105
v_mul_f32 v111, 0x3d372713, v111
v_add_f32 v111, 1.0, v111
v_mul_f32 v111, v111, v105
v_mul_f32 v111, 0xc01362dc, v111
v_exp_f32 v111, v111
s_nop 0
v_add_f32 v111, 1.0, v111
v_rcp_f32 v111, v111
s_nop 0
v_mul_f32 v105, v105, v111
v_mul_f32 v111, v106, v106
v_mul_f32 v111, 0x3d372713, v111
v_add_f32 v111, 1.0, v111
v_mul_f32 v111, v111, v106
v_mul_f32 v111, 0xc01362dc, v111
v_exp_f32 v111, v111
s_nop 0
v_add_f32 v111, 1.0, v111
v_rcp_f32 v111, v111
s_nop 0
v_mul_f32 v106, v106, v111
v_mul_f32 v111, v107, v107
v_mul_f32 v111, 0x3d372713, v111
v_add_f32 v111, 1.0, v111
v_mul_f32 v111, v111, v107
v_mul_f32 v111, 0xc01362dc, v111
v_exp_f32 v111, v111
s_nop 0
v_add_f32 v111, 1.0, v111
v_rcp_f32 v111, v111
s_nop 0
v_mul_f32 v107, v107, v111
v_cvt_pk_bf16_f32 v108, v104, v105
v_cvt_pk_bf16_f32 v109, v106, v107
buffer_store_dwordx2 v[108:109], v13, s[12:15], 0 offen offset:64
s_nop 1
v_accvgpr_read_b32 v104, a12
v_accvgpr_read_b32 v105, a13
v_accvgpr_read_b32 v106, a14
v_accvgpr_read_b32 v107, a15
v_fma_f32 v104, -v64, v84, v104
v_mul_f32 v104, v104, v65
v_fma_f32 v105, -v64, v85, v105
v_mul_f32 v105, v105, v65
v_fma_f32 v106, -v64, v86, v106
v_mul_f32 v106, v106, v65
v_fma_f32 v107, -v64, v87, v107
v_mul_f32 v107, v107, v65
v_cvt_pk_bf16_f32 v110, v104, v105
v_lshlrev_b32 v104, 16, v110
v_and_b32 v105, 0xffff0000, v110
v_cvt_pk_bf16_f32 v110, v106, v107
v_lshlrev_b32 v106, 16, v110
v_and_b32 v107, 0xffff0000, v110
v_mul_f32 v111, v104, v104
v_mul_f32 v111, 0x3d372713, v111
v_add_f32 v111, 1.0, v111
v_mul_f32 v111, v111, v104
v_mul_f32 v111, 0xc01362dc, v111
v_exp_f32 v111, v111
s_nop 0
v_add_f32 v111, 1.0, v111
v_rcp_f32 v111, v111
s_nop 0
v_mul_f32 v104, v104, v111
v_mul_f32 v111, v105, v105
v_mul_f32 v111, 0x3d372713, v111
v_add_f32 v111, 1.0, v111
v_mul_f32 v111, v111, v105
v_mul_f32 v111, 0xc01362dc, v111
v_exp_f32 v111, v111
s_nop 0
v_add_f32 v111, 1.0, v111
v_rcp_f32 v111, v111
s_nop 0
v_mul_f32 v105, v105, v111
v_mul_f32 v111, v106, v106
v_mul_f32 v111, 0x3d372713, v111
v_add_f32 v111, 1.0, v111
v_mul_f32 v111, v111, v106
v_mul_f32 v111, 0xc01362dc, v111
v_exp_f32 v111, v111
s_nop 0
v_add_f32 v111, 1.0, v111
v_rcp_f32 v111, v111
s_nop 0
v_mul_f32 v106, v106, v111
v_mul_f32 v111, v107, v107
v_mul_f32 v111, 0x3d372713, v111
v_add_f32 v111, 1.0, v111
v_mul_f32 v111, v111, v107
v_mul_f32 v111, 0xc01362dc, v111
v_exp_f32 v111, v111
s_nop 0
v_add_f32 v111, 1.0, v111
v_rcp_f32 v111, v111
s_nop 0
v_mul_f32 v107, v107, v111
v_cvt_pk_bf16_f32 v108, v104, v105
v_cvt_pk_bf16_f32 v109, v106, v107
buffer_store_dwordx2 v[108:109], v13, s[12:15], 0 offen offset:96
s_nop 1
v_accvgpr_read_b32 v104, a16
v_accvgpr_read_b32 v105, a17
v_accvgpr_read_b32 v106, a18
v_accvgpr_read_b32 v107, a19
v_fma_f32 v104, -v64, v88, v104
v_mul_f32 v104, v104, v65
v_fma_f32 v105, -v64, v89, v105
v_mul_f32 v105, v105, v65
v_fma_f32 v106, -v64, v90, v106
v_mul_f32 v106, v106, v65
v_fma_f32 v107, -v64, v91, v107
v_mul_f32 v107, v107, v65
v_cvt_pk_bf16_f32 v110, v104, v105
v_lshlrev_b32 v104, 16, v110
v_and_b32 v105, 0xffff0000, v110
v_cvt_pk_bf16_f32 v110, v106, v107
v_lshlrev_b32 v106, 16, v110
v_and_b32 v107, 0xffff0000, v110
v_mul_f32 v111, v104, v104
v_mul_f32 v111, 0x3d372713, v111
v_add_f32 v111, 1.0, v111
v_mul_f32 v111, v111, v104
v_mul_f32 v111, 0xc01362dc, v111
v_exp_f32 v111, v111
s_nop 0
v_add_f32 v111, 1.0, v111
v_rcp_f32 v111, v111
s_nop 0
v_mul_f32 v104, v104, v111
v_mul_f32 v111, v105, v105
v_mul_f32 v111, 0x3d372713, v111
v_add_f32 v111, 1.0, v111
v_mul_f32 v111, v111, v105
v_mul_f32 v111, 0xc01362dc, v111
v_exp_f32 v111, v111
s_nop 0
v_add_f32 v111, 1.0, v111
v_rcp_f32 v111, v111
s_nop 0
v_mul_f32 v105, v105, v111
v_mul_f32 v111, v106, v106
v_mul_f32 v111, 0x3d372713, v111
v_add_f32 v111, 1.0, v111
v_mul_f32 v111, v111, v106
v_mul_f32 v111, 0xc01362dc, v111
v_exp_f32 v111, v111
s_nop 0
v_add_f32 v111, 1.0, v111
v_rcp_f32 v111, v111
s_nop 0
v_mul_f32 v106, v106, v111
v_mul_f32 v111, v107, v107
v_mul_f32 v111, 0x3d372713, v111
v_add_f32 v111, 1.0, v111
v_mul_f32 v111, v111, v107
v_mul_f32 v111, 0xc01362dc, v111
v_exp_f32 v111, v111
s_nop 0
v_add_f32 v111, 1.0, v111
v_rcp_f32 v111, v111
s_nop 0
v_mul_f32 v107, v107, v111
v_cvt_pk_bf16_f32 v108, v104, v105
v_cvt_pk_bf16_f32 v109, v106, v107
buffer_store_dwordx2 v[108:109], v13, s[12:15], 0 offen offset:128
s_nop 1
v_accvgpr_read_b32 v104, a20
v_accvgpr_read_b32 v105, a21
v_accvgpr_read_b32 v106, a22
v_accvgpr_read_b32 v107, a23
v_fma_f32 v104, -v64, v92, v104
v_mul_f32 v104, v104, v65
v_fma_f32 v105, -v64, v93, v105
v_mul_f32 v105, v105, v65
v_fma_f32 v106, -v64, v94, v106
v_mul_f32 v106, v106, v65
v_fma_f32 v107, -v64, v95, v107
v_mul_f32 v107, v107, v65
v_cvt_pk_bf16_f32 v110, v104, v105
v_lshlrev_b32 v104, 16, v110
v_and_b32 v105, 0xffff0000, v110
v_cvt_pk_bf16_f32 v110, v106, v107
v_lshlrev_b32 v106, 16, v110
v_and_b32 v107, 0xffff0000, v110
v_mul_f32 v111, v104, v104
v_mul_f32 v111, 0x3d372713, v111
v_add_f32 v111, 1.0, v111
v_mul_f32 v111, v111, v104
v_mul_f32 v111, 0xc01362dc, v111
v_exp_f32 v111, v111
s_nop 0
v_add_f32 v111, 1.0, v111
v_rcp_f32 v111, v111
s_nop 0
v_mul_f32 v104, v104, v111
v_mul_f32 v111, v105, v105
v_mul_f32 v111, 0x3d372713, v111
v_add_f32 v111, 1.0, v111
v_mul_f32 v111, v111, v105
v_mul_f32 v111, 0xc01362dc, v111
v_exp_f32 v111, v111
s_nop 0
v_add_f32 v111, 1.0, v111
v_rcp_f32 v111, v111
s_nop 0
v_mul_f32 v105, v105, v111
v_mul_f32 v111, v106, v106
v_mul_f32 v111, 0x3d372713, v111
v_add_f32 v111, 1.0, v111
v_mul_f32 v111, v111, v106
v_mul_f32 v111, 0xc01362dc, v111
v_exp_f32 v111, v111
s_nop 0
v_add_f32 v111, 1.0, v111
v_rcp_f32 v111, v111
s_nop 0
v_mul_f32 v106, v106, v111
v_mul_f32 v111, v107, v107
v_mul_f32 v111, 0x3d372713, v111
v_add_f32 v111, 1.0, v111
v_mul_f32 v111, v111, v107
v_mul_f32 v111, 0xc01362dc, v111
v_exp_f32 v111, v111
s_nop 0
v_add_f32 v111, 1.0, v111
v_rcp_f32 v111, v111
s_nop 0
v_mul_f32 v107, v107, v111
v_cvt_pk_bf16_f32 v108, v104, v105
v_cvt_pk_bf16_f32 v109, v106, v107
buffer_store_dwordx2 v[108:109], v13, s[12:15], 0 offen offset:160
s_nop 1
v_accvgpr_read_b32 v104, a24
v_accvgpr_read_b32 v105, a25
v_accvgpr_read_b32 v106, a26
v_accvgpr_read_b32 v107, a27
v_fma_f32 v104, -v64, v96, v104
v_mul_f32 v104, v104, v65
v_fma_f32 v105, -v64, v97, v105
v_mul_f32 v105, v105, v65
v_fma_f32 v106, -v64, v98, v106
v_mul_f32 v106, v106, v65
v_fma_f32 v107, -v64, v99, v107
v_mul_f32 v107, v107, v65
v_cvt_pk_bf16_f32 v110, v104, v105
v_lshlrev_b32 v104, 16, v110
v_and_b32 v105, 0xffff0000, v110
v_cvt_pk_bf16_f32 v110, v106, v107
v_lshlrev_b32 v106, 16, v110
v_and_b32 v107, 0xffff0000, v110
v_mul_f32 v111, v104, v104
v_mul_f32 v111, 0x3d372713, v111
v_add_f32 v111, 1.0, v111
v_mul_f32 v111, v111, v104
v_mul_f32 v111, 0xc01362dc, v111
v_exp_f32 v111, v111
s_nop 0
v_add_f32 v111, 1.0, v111
v_rcp_f32 v111, v111
s_nop 0
v_mul_f32 v104, v104, v111
v_mul_f32 v111, v105, v105
v_mul_f32 v111, 0x3d372713, v111
v_add_f32 v111, 1.0, v111
v_mul_f32 v111, v111, v105
v_mul_f32 v111, 0xc01362dc, v111
v_exp_f32 v111, v111
s_nop 0
v_add_f32 v111, 1.0, v111
v_rcp_f32 v111, v111
s_nop 0
v_mul_f32 v105, v105, v111
v_mul_f32 v111, v106, v106
v_mul_f32 v111, 0x3d372713, v111
v_add_f32 v111, 1.0, v111
v_mul_f32 v111, v111, v106
v_mul_f32 v111, 0xc01362dc, v111
v_exp_f32 v111, v111
s_nop 0
v_add_f32 v111, 1.0, v111
v_rcp_f32 v111, v111
s_nop 0
v_mul_f32 v106, v106, v111
v_mul_f32 v111, v107, v107
v_mul_f32 v111, 0x3d372713, v111
v_add_f32 v111, 1.0, v111
v_mul_f32 v111, v111, v107
v_mul_f32 v111, 0xc01362dc, v111
v_exp_f32 v111, v111
s_nop 0
v_add_f32 v111, 1.0, v111
v_rcp_f32 v111, v111
s_nop 0
v_mul_f32 v107, v107, v111
v_cvt_pk_bf16_f32 v108, v104, v105
v_cvt_pk_bf16_f32 v109, v106, v107
buffer_store_dwordx2 v[108:109], v13, s[12:15], 0 offen offset:192
s_nop 1
v_add_u32 v13, 114688, v11
s_waitcnt vmcnt(0) lgkmcnt(0)
v_accvgpr_read_b32 v104, a28
v_accvgpr_read_b32 v105, a29
v_accvgpr_read_b32 v106, a30
v_accvgpr_read_b32 v107, a31
v_fma_f32 v104, -v66, v72, v104
v_mul_f32 v104, v104, v67
v_fma_f32 v105, -v66, v73, v105
v_mul_f32 v105, v105, v67
v_fma_f32 v106, -v66, v74, v106
v_mul_f32 v106, v106, v67
v_fma_f32 v107, -v66, v75, v107
v_mul_f32 v107, v107, v67
v_cvt_pk_bf16_f32 v110, v104, v105
v_lshlrev_b32 v104, 16, v110
v_and_b32 v105, 0xffff0000, v110
v_cvt_pk_bf16_f32 v110, v106, v107
v_lshlrev_b32 v106, 16, v110
v_and_b32 v107, 0xffff0000, v110
v_mul_f32 v111, v104, v104
v_mul_f32 v111, 0x3d372713, v111
v_add_f32 v111, 1.0, v111
v_mul_f32 v111, v111, v104
v_mul_f32 v111, 0xc01362dc, v111
v_exp_f32 v111, v111
s_nop 0
v_add_f32 v111, 1.0, v111
v_rcp_f32 v111, v111
s_nop 0
v_mul_f32 v104, v104, v111
v_mul_f32 v111, v105, v105
v_mul_f32 v111, 0x3d372713, v111
v_add_f32 v111, 1.0, v111
v_mul_f32 v111, v111, v105
v_mul_f32 v111, 0xc01362dc, v111
v_exp_f32 v111, v111
s_nop 0
v_add_f32 v111, 1.0, v111
v_rcp_f32 v111, v111
s_nop 0
v_mul_f32 v105, v105, v111
v_mul_f32 v111, v106, v106
v_mul_f32 v111, 0x3d372713, v111
v_add_f32 v111, 1.0, v111
v_mul_f32 v111, v111, v106
v_mul_f32 v111, 0xc01362dc, v111
v_exp_f32 v111, v111
s_nop 0
v_add_f32 v111, 1.0, v111
v_rcp_f32 v111, v111
s_nop 0
v_mul_f32 v106, v106, v111
v_mul_f32 v111, v107, v107
v_mul_f32 v111, 0x3d372713, v111
v_add_f32 v111, 1.0, v111
v_mul_f32 v111, v111, v107
v_mul_f32 v111, 0xc01362dc, v111
v_exp_f32 v111, v111
s_nop 0
v_add_f32 v111, 1.0, v111
v_rcp_f32 v111, v111
s_nop 0
v_mul_f32 v107, v107, v111
v_cvt_pk_bf16_f32 v108, v104, v105
v_cvt_pk_bf16_f32 v109, v106, v107
buffer_store_dwordx2 v[108:109], v13, s[12:15], 0 offen offset:0
s_nop 1
v_accvgpr_read_b32 v104, a32
v_accvgpr_read_b32 v105, a33
v_accvgpr_read_b32 v106, a34
v_accvgpr_read_b32 v107, a35
v_fma_f32 v104, -v66, v76, v104
v_mul_f32 v104, v104, v67
v_fma_f32 v105, -v66, v77, v105
v_mul_f32 v105, v105, v67
v_fma_f32 v106, -v66, v78, v106
v_mul_f32 v106, v106, v67
v_fma_f32 v107, -v66, v79, v107
v_mul_f32 v107, v107, v67
v_cvt_pk_bf16_f32 v110, v104, v105
v_lshlrev_b32 v104, 16, v110
v_and_b32 v105, 0xffff0000, v110
v_cvt_pk_bf16_f32 v110, v106, v107
v_lshlrev_b32 v106, 16, v110
v_and_b32 v107, 0xffff0000, v110
v_mul_f32 v111, v104, v104
v_mul_f32 v111, 0x3d372713, v111
v_add_f32 v111, 1.0, v111
v_mul_f32 v111, v111, v104
v_mul_f32 v111, 0xc01362dc, v111
v_exp_f32 v111, v111
s_nop 0
v_add_f32 v111, 1.0, v111
v_rcp_f32 v111, v111
s_nop 0
v_mul_f32 v104, v104, v111
v_mul_f32 v111, v105, v105
v_mul_f32 v111, 0x3d372713, v111
v_add_f32 v111, 1.0, v111
v_mul_f32 v111, v111, v105
v_mul_f32 v111, 0xc01362dc, v111
v_exp_f32 v111, v111
s_nop 0
v_add_f32 v111, 1.0, v111
v_rcp_f32 v111, v111
s_nop 0
v_mul_f32 v105, v105, v111
v_mul_f32 v111, v106, v106
v_mul_f32 v111, 0x3d372713, v111
v_add_f32 v111, 1.0, v111
v_mul_f32 v111, v111, v106
v_mul_f32 v111, 0xc01362dc, v111
v_exp_f32 v111, v111
s_nop 0
v_add_f32 v111, 1.0, v111
v_rcp_f32 v111, v111
s_nop 0
v_mul_f32 v106, v106, v111
v_mul_f32 v111, v107, v107
v_mul_f32 v111, 0x3d372713, v111
v_add_f32 v111, 1.0, v111
v_mul_f32 v111, v111, v107
v_mul_f32 v111, 0xc01362dc, v111
v_exp_f32 v111, v111
s_nop 0
v_add_f32 v111, 1.0, v111
v_rcp_f32 v111, v111
s_nop 0
v_mul_f32 v107, v107, v111
v_cvt_pk_bf16_f32 v108, v104, v105
v_cvt_pk_bf16_f32 v109, v106, v107
buffer_store_dwordx2 v[108:109], v13, s[12:15], 0 offen offset:32
s_nop 1
v_accvgpr_read_b32 v104, a36
v_accvgpr_read_b32 v105, a37
v_accvgpr_read_b32 v106, a38
v_accvgpr_read_b32 v107, a39
v_fma_f32 v104, -v66, v80, v104
v_mul_f32 v104, v104, v67
v_fma_f32 v105, -v66, v81, v105
v_mul_f32 v105, v105, v67
v_fma_f32 v106, -v66, v82, v106
v_mul_f32 v106, v106, v67
v_fma_f32 v107, -v66, v83, v107
v_mul_f32 v107, v107, v67
v_cvt_pk_bf16_f32 v110, v104, v105
v_lshlrev_b32 v104, 16, v110
v_and_b32 v105, 0xffff0000, v110
v_cvt_pk_bf16_f32 v110, v106, v107
v_lshlrev_b32 v106, 16, v110
v_and_b32 v107, 0xffff0000, v110
v_mul_f32 v111, v104, v104
v_mul_f32 v111, 0x3d372713, v111
v_add_f32 v111, 1.0, v111
v_mul_f32 v111, v111, v104
v_mul_f32 v111, 0xc01362dc, v111
v_exp_f32 v111, v111
s_nop 0
v_add_f32 v111, 1.0, v111
v_rcp_f32 v111, v111
s_nop 0
v_mul_f32 v104, v104, v111
v_mul_f32 v111, v105, v105
v_mul_f32 v111, 0x3d372713, v111
v_add_f32 v111, 1.0, v111
v_mul_f32 v111, v111, v105
v_mul_f32 v111, 0xc01362dc, v111
v_exp_f32 v111, v111
s_nop 0
v_add_f32 v111, 1.0, v111
v_rcp_f32 v111, v111
s_nop 0
v_mul_f32 v105, v105, v111
v_mul_f32 v111, v106, v106
v_mul_f32 v111, 0x3d372713, v111
v_add_f32 v111, 1.0, v111
v_mul_f32 v111, v111, v106
v_mul_f32 v111, 0xc01362dc, v111
v_exp_f32 v111, v111
s_nop 0
v_add_f32 v111, 1.0, v111
v_rcp_f32 v111, v111
s_nop 0
v_mul_f32 v106, v106, v111
v_mul_f32 v111, v107, v107
v_mul_f32 v111, 0x3d372713, v111
v_add_f32 v111, 1.0, v111
v_mul_f32 v111, v111, v107
v_mul_f32 v111, 0xc01362dc, v111
v_exp_f32 v111, v111
s_nop 0
v_add_f32 v111, 1.0, v111
v_rcp_f32 v111, v111
s_nop 0
v_mul_f32 v107, v107, v111
v_cvt_pk_bf16_f32 v108, v104, v105
v_cvt_pk_bf16_f32 v109, v106, v107
buffer_store_dwordx2 v[108:109], v13, s[12:15], 0 offen offset:64
s_nop 1
v_accvgpr_read_b32 v104, a40
v_accvgpr_read_b32 v105, a41
v_accvgpr_read_b32 v106, a42
v_accvgpr_read_b32 v107, a43
v_fma_f32 v104, -v66, v84, v104
v_mul_f32 v104, v104, v67
v_fma_f32 v105, -v66, v85, v105
v_mul_f32 v105, v105, v67
v_fma_f32 v106, -v66, v86, v106
v_mul_f32 v106, v106, v67
v_fma_f32 v107, -v66, v87, v107
v_mul_f32 v107, v107, v67
v_cvt_pk_bf16_f32 v110, v104, v105
v_lshlrev_b32 v104, 16, v110
v_and_b32 v105, 0xffff0000, v110
v_cvt_pk_bf16_f32 v110, v106, v107
v_lshlrev_b32 v106, 16, v110
v_and_b32 v107, 0xffff0000, v110
v_mul_f32 v111, v104, v104
v_mul_f32 v111, 0x3d372713, v111
v_add_f32 v111, 1.0, v111
v_mul_f32 v111, v111, v104
v_mul_f32 v111, 0xc01362dc, v111
v_exp_f32 v111, v111
s_nop 0
v_add_f32 v111, 1.0, v111
v_rcp_f32 v111, v111
s_nop 0
v_mul_f32 v104, v104, v111
v_mul_f32 v111, v105, v105
v_mul_f32 v111, 0x3d372713, v111
v_add_f32 v111, 1.0, v111
v_mul_f32 v111, v111, v105
v_mul_f32 v111, 0xc01362dc, v111
v_exp_f32 v111, v111
s_nop 0
v_add_f32 v111, 1.0, v111
v_rcp_f32 v111, v111
s_nop 0
v_mul_f32 v105, v105, v111
v_mul_f32 v111, v106, v106
v_mul_f32 v111, 0x3d372713, v111
v_add_f32 v111, 1.0, v111
v_mul_f32 v111, v111, v106
v_mul_f32 v111, 0xc01362dc, v111
v_exp_f32 v111, v111
s_nop 0
v_add_f32 v111, 1.0, v111
v_rcp_f32 v111, v111
s_nop 0
v_mul_f32 v106, v106, v111
v_mul_f32 v111, v107, v107
v_mul_f32 v111, 0x3d372713, v111
v_add_f32 v111, 1.0, v111
v_mul_f32 v111, v111, v107
v_mul_f32 v111, 0xc01362dc, v111
v_exp_f32 v111, v111
s_nop 0
v_add_f32 v111, 1.0, v111
v_rcp_f32 v111, v111
s_nop 0
v_mul_f32 v107, v107, v111
v_cvt_pk_bf16_f32 v108, v104, v105
v_cvt_pk_bf16_f32 v109, v106, v107
buffer_store_dwordx2 v[108:109], v13, s[12:15], 0 offen offset:96
s_nop 1
v_accvgpr_read_b32 v104, a44
v_accvgpr_read_b32 v105, a45
v_accvgpr_read_b32 v106, a46
v_accvgpr_read_b32 v107, a47
v_fma_f32 v104, -v66, v88, v104
v_mul_f32 v104, v104, v67
v_fma_f32 v105, -v66, v89, v105
v_mul_f32 v105, v105, v67
v_fma_f32 v106, -v66, v90, v106
v_mul_f32 v106, v106, v67
v_fma_f32 v107, -v66, v91, v107
v_mul_f32 v107, v107, v67
v_cvt_pk_bf16_f32 v110, v104, v105
v_lshlrev_b32 v104, 16, v110
v_and_b32 v105, 0xffff0000, v110
v_cvt_pk_bf16_f32 v110, v106, v107
v_lshlrev_b32 v106, 16, v110
v_and_b32 v107, 0xffff0000, v110
v_mul_f32 v111, v104, v104
v_mul_f32 v111, 0x3d372713, v111
v_add_f32 v111, 1.0, v111
v_mul_f32 v111, v111, v104
v_mul_f32 v111, 0xc01362dc, v111
v_exp_f32 v111, v111
s_nop 0
v_add_f32 v111, 1.0, v111
v_rcp_f32 v111, v111
s_nop 0
v_mul_f32 v104, v104, v111
v_mul_f32 v111, v105, v105
v_mul_f32 v111, 0x3d372713, v111
v_add_f32 v111, 1.0, v111
v_mul_f32 v111, v111, v105
v_mul_f32 v111, 0xc01362dc, v111
v_exp_f32 v111, v111
s_nop 0
v_add_f32 v111, 1.0, v111
v_rcp_f32 v111, v111
s_nop 0
v_mul_f32 v105, v105, v111
v_mul_f32 v111, v106, v106
v_mul_f32 v111, 0x3d372713, v111
v_add_f32 v111, 1.0, v111
v_mul_f32 v111, v111, v106
v_mul_f32 v111, 0xc01362dc, v111
v_exp_f32 v111, v111
s_nop 0
v_add_f32 v111, 1.0, v111
v_rcp_f32 v111, v111
s_nop 0
v_mul_f32 v106, v106, v111
v_mul_f32 v111, v107, v107
v_mul_f32 v111, 0x3d372713, v111
v_add_f32 v111, 1.0, v111
v_mul_f32 v111, v111, v107
v_mul_f32 v111, 0xc01362dc, v111
v_exp_f32 v111, v111
s_nop 0
v_add_f32 v111, 1.0, v111
v_rcp_f32 v111, v111
s_nop 0
v_mul_f32 v107, v107, v111
v_cvt_pk_bf16_f32 v108, v104, v105
v_cvt_pk_bf16_f32 v109, v106, v107
buffer_store_dwordx2 v[108:109], v13, s[12:15], 0 offen offset:128
s_nop 1
v_accvgpr_read_b32 v104, a48
v_accvgpr_read_b32 v105, a49
v_accvgpr_read_b32 v106, a50
v_accvgpr_read_b32 v107, a51
v_fma_f32 v104, -v66, v92, v104
v_mul_f32 v104, v104, v67
v_fma_f32 v105, -v66, v93, v105
v_mul_f32 v105, v105, v67
v_fma_f32 v106, -v66, v94, v106
v_mul_f32 v106, v106, v67
v_fma_f32 v107, -v66, v95, v107
v_mul_f32 v107, v107, v67
v_cvt_pk_bf16_f32 v110, v104, v105
v_lshlrev_b32 v104, 16, v110
v_and_b32 v105, 0xffff0000, v110
v_cvt_pk_bf16_f32 v110, v106, v107
v_lshlrev_b32 v106, 16, v110
v_and_b32 v107, 0xffff0000, v110
v_mul_f32 v111, v104, v104
v_mul_f32 v111, 0x3d372713, v111
v_add_f32 v111, 1.0, v111
v_mul_f32 v111, v111, v104
v_mul_f32 v111, 0xc01362dc, v111
v_exp_f32 v111, v111
s_nop 0
v_add_f32 v111, 1.0, v111
v_rcp_f32 v111, v111
s_nop 0
v_mul_f32 v104, v104, v111
v_mul_f32 v111, v105, v105
v_mul_f32 v111, 0x3d372713, v111
v_add_f32 v111, 1.0, v111
v_mul_f32 v111, v111, v105
v_mul_f32 v111, 0xc01362dc, v111
v_exp_f32 v111, v111
s_nop 0
v_add_f32 v111, 1.0, v111
v_rcp_f32 v111, v111
s_nop 0
v_mul_f32 v105, v105, v111
v_mul_f32 v111, v106, v106
v_mul_f32 v111, 0x3d372713, v111
v_add_f32 v111, 1.0, v111
v_mul_f32 v111, v111, v106
v_mul_f32 v111, 0xc01362dc, v111
v_exp_f32 v111, v111
s_nop 0
v_add_f32 v111, 1.0, v111
v_rcp_f32 v111, v111
s_nop 0
v_mul_f32 v106, v106, v111
v_mul_f32 v111, v107, v107
v_mul_f32 v111, 0x3d372713, v111
v_add_f32 v111, 1.0, v111
v_mul_f32 v111, v111, v107
v_mul_f32 v111, 0xc01362dc, v111
v_exp_f32 v111, v111
s_nop 0
v_add_f32 v111, 1.0, v111
v_rcp_f32 v111, v111
s_nop 0
v_mul_f32 v107, v107, v111
v_cvt_pk_bf16_f32 v108, v104, v105
v_cvt_pk_bf16_f32 v109, v106, v107
buffer_store_dwordx2 v[108:109], v13, s[12:15], 0 offen offset:160
s_nop 1
v_accvgpr_read_b32 v104, a52
v_accvgpr_read_b32 v105, a53
v_accvgpr_read_b32 v106, a54
v_accvgpr_read_b32 v107, a55
v_fma_f32 v104, -v66, v96, v104
v_mul_f32 v104, v104, v67
v_fma_f32 v105, -v66, v97, v105
v_mul_f32 v105, v105, v67
v_fma_f32 v106, -v66, v98, v106
v_mul_f32 v106, v106, v67
v_fma_f32 v107, -v66, v99, v107
v_mul_f32 v107, v107, v67
v_cvt_pk_bf16_f32 v110, v104, v105
v_lshlrev_b32 v104, 16, v110
v_and_b32 v105, 0xffff0000, v110
v_cvt_pk_bf16_f32 v110, v106, v107
v_lshlrev_b32 v106, 16, v110
v_and_b32 v107, 0xffff0000, v110
v_mul_f32 v111, v104, v104
v_mul_f32 v111, 0x3d372713, v111
v_add_f32 v111, 1.0, v111
v_mul_f32 v111, v111, v104
v_mul_f32 v111, 0xc01362dc, v111
v_exp_f32 v111, v111
s_nop 0
v_add_f32 v111, 1.0, v111
v_rcp_f32 v111, v111
s_nop 0
v_mul_f32 v104, v104, v111
v_mul_f32 v111, v105, v105
v_mul_f32 v111, 0x3d372713, v111
v_add_f32 v111, 1.0, v111
v_mul_f32 v111, v111, v105
v_mul_f32 v111, 0xc01362dc, v111
v_exp_f32 v111, v111
s_nop 0
v_add_f32 v111, 1.0, v111
v_rcp_f32 v111, v111
s_nop 0
v_mul_f32 v105, v105, v111
v_mul_f32 v111, v106, v106
v_mul_f32 v111, 0x3d372713, v111
v_add_f32 v111, 1.0, v111
v_mul_f32 v111, v111, v106
v_mul_f32 v111, 0xc01362dc, v111
v_exp_f32 v111, v111
s_nop 0
v_add_f32 v111, 1.0, v111
v_rcp_f32 v111, v111
s_nop 0
v_mul_f32 v106, v106, v111
v_mul_f32 v111, v107, v107
v_mul_f32 v111, 0x3d372713, v111
v_add_f32 v111, 1.0, v111
v_mul_f32 v111, v111, v107
v_mul_f32 v111, 0xc01362dc, v111
v_exp_f32 v111, v111
s_nop 0
v_add_f32 v111, 1.0, v111
v_rcp_f32 v111, v111
s_nop 0
v_mul_f32 v107, v107, v111
v_cvt_pk_bf16_f32 v108, v104, v105
v_cvt_pk_bf16_f32 v109, v106, v107
buffer_store_dwordx2 v[108:109], v13, s[12:15], 0 offen offset:192
s_nop 1
v_add_u32 v13, 229376, v11
s_waitcnt vmcnt(0) lgkmcnt(0)
v_accvgpr_read_b32 v104, a56
v_accvgpr_read_b32 v105, a57
v_accvgpr_read_b32 v106, a58
v_accvgpr_read_b32 v107, a59
v_fma_f32 v104, -v68, v72, v104
v_mul_f32 v104, v104, v69
v_fma_f32 v105, -v68, v73, v105
v_mul_f32 v105, v105, v69
v_fma_f32 v106, -v68, v74, v106
v_mul_f32 v106, v106, v69
v_fma_f32 v107, -v68, v75, v107
v_mul_f32 v107, v107, v69
v_cvt_pk_bf16_f32 v110, v104, v105
v_lshlrev_b32 v104, 16, v110
v_and_b32 v105, 0xffff0000, v110
v_cvt_pk_bf16_f32 v110, v106, v107
v_lshlrev_b32 v106, 16, v110
v_and_b32 v107, 0xffff0000, v110
v_mul_f32 v111, v104, v104
v_mul_f32 v111, 0x3d372713, v111
v_add_f32 v111, 1.0, v111
v_mul_f32 v111, v111, v104
v_mul_f32 v111, 0xc01362dc, v111
v_exp_f32 v111, v111
s_nop 0
v_add_f32 v111, 1.0, v111
v_rcp_f32 v111, v111
s_nop 0
v_mul_f32 v104, v104, v111
v_mul_f32 v111, v105, v105
v_mul_f32 v111, 0x3d372713, v111
v_add_f32 v111, 1.0, v111
v_mul_f32 v111, v111, v105
v_mul_f32 v111, 0xc01362dc, v111
v_exp_f32 v111, v111
s_nop 0
v_add_f32 v111, 1.0, v111
v_rcp_f32 v111, v111
s_nop 0
v_mul_f32 v105, v105, v111
v_mul_f32 v111, v106, v106
v_mul_f32 v111, 0x3d372713, v111
v_add_f32 v111, 1.0, v111
v_mul_f32 v111, v111, v106
v_mul_f32 v111, 0xc01362dc, v111
v_exp_f32 v111, v111
s_nop 0
v_add_f32 v111, 1.0, v111
v_rcp_f32 v111, v111
s_nop 0
v_mul_f32 v106, v106, v111
v_mul_f32 v111, v107, v107
v_mul_f32 v111, 0x3d372713, v111
v_add_f32 v111, 1.0, v111
v_mul_f32 v111, v111, v107
v_mul_f32 v111, 0xc01362dc, v111
v_exp_f32 v111, v111
s_nop 0
v_add_f32 v111, 1.0, v111
v_rcp_f32 v111, v111
s_nop 0
v_mul_f32 v107, v107, v111
v_cvt_pk_bf16_f32 v108, v104, v105
v_cvt_pk_bf16_f32 v109, v106, v107
buffer_store_dwordx2 v[108:109], v13, s[12:15], 0 offen offset:0
s_nop 1
v_accvgpr_read_b32 v104, a60
v_accvgpr_read_b32 v105, a61
v_accvgpr_read_b32 v106, a62
v_accvgpr_read_b32 v107, a63
v_fma_f32 v104, -v68, v76, v104
v_mul_f32 v104, v104, v69
v_fma_f32 v105, -v68, v77, v105
v_mul_f32 v105, v105, v69
v_fma_f32 v106, -v68, v78, v106
v_mul_f32 v106, v106, v69
v_fma_f32 v107, -v68, v79, v107
v_mul_f32 v107, v107, v69
v_cvt_pk_bf16_f32 v110, v104, v105
v_lshlrev_b32 v104, 16, v110
v_and_b32 v105, 0xffff0000, v110
v_cvt_pk_bf16_f32 v110, v106, v107
v_lshlrev_b32 v106, 16, v110
v_and_b32 v107, 0xffff0000, v110
v_mul_f32 v111, v104, v104
v_mul_f32 v111, 0x3d372713, v111
v_add_f32 v111, 1.0, v111
v_mul_f32 v111, v111, v104
v_mul_f32 v111, 0xc01362dc, v111
v_exp_f32 v111, v111
s_nop 0
v_add_f32 v111, 1.0, v111
v_rcp_f32 v111, v111
s_nop 0
v_mul_f32 v104, v104, v111
v_mul_f32 v111, v105, v105
v_mul_f32 v111, 0x3d372713, v111
v_add_f32 v111, 1.0, v111
v_mul_f32 v111, v111, v105
v_mul_f32 v111, 0xc01362dc, v111
v_exp_f32 v111, v111
s_nop 0
v_add_f32 v111, 1.0, v111
v_rcp_f32 v111, v111
s_nop 0
v_mul_f32 v105, v105, v111
v_mul_f32 v111, v106, v106
v_mul_f32 v111, 0x3d372713, v111
v_add_f32 v111, 1.0, v111
v_mul_f32 v111, v111, v106
v_mul_f32 v111, 0xc01362dc, v111
v_exp_f32 v111, v111
s_nop 0
v_add_f32 v111, 1.0, v111
v_rcp_f32 v111, v111
s_nop 0
v_mul_f32 v106, v106, v111
v_mul_f32 v111, v107, v107
v_mul_f32 v111, 0x3d372713, v111
v_add_f32 v111, 1.0, v111
v_mul_f32 v111, v111, v107
v_mul_f32 v111, 0xc01362dc, v111
v_exp_f32 v111, v111
s_nop 0
v_add_f32 v111, 1.0, v111
v_rcp_f32 v111, v111
s_nop 0
v_mul_f32 v107, v107, v111
v_cvt_pk_bf16_f32 v108, v104, v105
v_cvt_pk_bf16_f32 v109, v106, v107
buffer_store_dwordx2 v[108:109], v13, s[12:15], 0 offen offset:32
s_nop 1
v_accvgpr_read_b32 v104, a64
v_accvgpr_read_b32 v105, a65
v_accvgpr_read_b32 v106, a66
v_accvgpr_read_b32 v107, a67
v_fma_f32 v104, -v68, v80, v104
v_mul_f32 v104, v104, v69
v_fma_f32 v105, -v68, v81, v105
v_mul_f32 v105, v105, v69
v_fma_f32 v106, -v68, v82, v106
v_mul_f32 v106, v106, v69
v_fma_f32 v107, -v68, v83, v107
v_mul_f32 v107, v107, v69
v_cvt_pk_bf16_f32 v110, v104, v105
v_lshlrev_b32 v104, 16, v110
v_and_b32 v105, 0xffff0000, v110
v_cvt_pk_bf16_f32 v110, v106, v107
v_lshlrev_b32 v106, 16, v110
v_and_b32 v107, 0xffff0000, v110
v_mul_f32 v111, v104, v104
v_mul_f32 v111, 0x3d372713, v111
v_add_f32 v111, 1.0, v111
v_mul_f32 v111, v111, v104
v_mul_f32 v111, 0xc01362dc, v111
v_exp_f32 v111, v111
s_nop 0
v_add_f32 v111, 1.0, v111
v_rcp_f32 v111, v111
s_nop 0
v_mul_f32 v104, v104, v111
v_mul_f32 v111, v105, v105
v_mul_f32 v111, 0x3d372713, v111
v_add_f32 v111, 1.0, v111
v_mul_f32 v111, v111, v105
v_mul_f32 v111, 0xc01362dc, v111
v_exp_f32 v111, v111
s_nop 0
v_add_f32 v111, 1.0, v111
v_rcp_f32 v111, v111
s_nop 0
v_mul_f32 v105, v105, v111
v_mul_f32 v111, v106, v106
v_mul_f32 v111, 0x3d372713, v111
v_add_f32 v111, 1.0, v111
v_mul_f32 v111, v111, v106
v_mul_f32 v111, 0xc01362dc, v111
v_exp_f32 v111, v111
s_nop 0
v_add_f32 v111, 1.0, v111
v_rcp_f32 v111, v111
s_nop 0
v_mul_f32 v106, v106, v111
v_mul_f32 v111, v107, v107
v_mul_f32 v111, 0x3d372713, v111
v_add_f32 v111, 1.0, v111
v_mul_f32 v111, v111, v107
v_mul_f32 v111, 0xc01362dc, v111
v_exp_f32 v111, v111
s_nop 0
v_add_f32 v111, 1.0, v111
v_rcp_f32 v111, v111
s_nop 0
v_mul_f32 v107, v107, v111
v_cvt_pk_bf16_f32 v108, v104, v105
v_cvt_pk_bf16_f32 v109, v106, v107
buffer_store_dwordx2 v[108:109], v13, s[12:15], 0 offen offset:64
s_nop 1
v_accvgpr_read_b32 v104, a68
v_accvgpr_read_b32 v105, a69
v_accvgpr_read_b32 v106, a70
v_accvgpr_read_b32 v107, a71
v_fma_f32 v104, -v68, v84, v104
v_mul_f32 v104, v104, v69
v_fma_f32 v105, -v68, v85, v105
v_mul_f32 v105, v105, v69
v_fma_f32 v106, -v68, v86, v106
v_mul_f32 v106, v106, v69
v_fma_f32 v107, -v68, v87, v107
v_mul_f32 v107, v107, v69
v_cvt_pk_bf16_f32 v110, v104, v105
v_lshlrev_b32 v104, 16, v110
v_and_b32 v105, 0xffff0000, v110
v_cvt_pk_bf16_f32 v110, v106, v107
v_lshlrev_b32 v106, 16, v110
v_and_b32 v107, 0xffff0000, v110
v_mul_f32 v111, v104, v104
v_mul_f32 v111, 0x3d372713, v111
v_add_f32 v111, 1.0, v111
v_mul_f32 v111, v111, v104
v_mul_f32 v111, 0xc01362dc, v111
v_exp_f32 v111, v111
s_nop 0
v_add_f32 v111, 1.0, v111
v_rcp_f32 v111, v111
s_nop 0
v_mul_f32 v104, v104, v111
v_mul_f32 v111, v105, v105
v_mul_f32 v111, 0x3d372713, v111
v_add_f32 v111, 1.0, v111
v_mul_f32 v111, v111, v105
v_mul_f32 v111, 0xc01362dc, v111
v_exp_f32 v111, v111
s_nop 0
v_add_f32 v111, 1.0, v111
v_rcp_f32 v111, v111
s_nop 0
v_mul_f32 v105, v105, v111
v_mul_f32 v111, v106, v106
v_mul_f32 v111, 0x3d372713, v111
v_add_f32 v111, 1.0, v111
v_mul_f32 v111, v111, v106
v_mul_f32 v111, 0xc01362dc, v111
v_exp_f32 v111, v111
s_nop 0
v_add_f32 v111, 1.0, v111
v_rcp_f32 v111, v111
s_nop 0
v_mul_f32 v106, v106, v111
v_mul_f32 v111, v107, v107
v_mul_f32 v111, 0x3d372713, v111
v_add_f32 v111, 1.0, v111
v_mul_f32 v111, v111, v107
v_mul_f32 v111, 0xc01362dc, v111
v_exp_f32 v111, v111
s_nop 0
v_add_f32 v111, 1.0, v111
v_rcp_f32 v111, v111
s_nop 0
v_mul_f32 v107, v107, v111
v_cvt_pk_bf16_f32 v108, v104, v105
v_cvt_pk_bf16_f32 v109, v106, v107
buffer_store_dwordx2 v[108:109], v13, s[12:15], 0 offen offset:96
s_nop 1
v_accvgpr_read_b32 v104, a72
v_accvgpr_read_b32 v105, a73
v_accvgpr_read_b32 v106, a74
v_accvgpr_read_b32 v107, a75
v_fma_f32 v104, -v68, v88, v104
v_mul_f32 v104, v104, v69
v_fma_f32 v105, -v68, v89, v105
v_mul_f32 v105, v105, v69
v_fma_f32 v106, -v68, v90, v106
v_mul_f32 v106, v106, v69
v_fma_f32 v107, -v68, v91, v107
v_mul_f32 v107, v107, v69
v_cvt_pk_bf16_f32 v110, v104, v105
v_lshlrev_b32 v104, 16, v110
v_and_b32 v105, 0xffff0000, v110
v_cvt_pk_bf16_f32 v110, v106, v107
v_lshlrev_b32 v106, 16, v110
v_and_b32 v107, 0xffff0000, v110
v_mul_f32 v111, v104, v104
v_mul_f32 v111, 0x3d372713, v111
v_add_f32 v111, 1.0, v111
v_mul_f32 v111, v111, v104
v_mul_f32 v111, 0xc01362dc, v111
v_exp_f32 v111, v111
s_nop 0
v_add_f32 v111, 1.0, v111
v_rcp_f32 v111, v111
s_nop 0
v_mul_f32 v104, v104, v111
v_mul_f32 v111, v105, v105
v_mul_f32 v111, 0x3d372713, v111
v_add_f32 v111, 1.0, v111
v_mul_f32 v111, v111, v105
v_mul_f32 v111, 0xc01362dc, v111
v_exp_f32 v111, v111
s_nop 0
v_add_f32 v111, 1.0, v111
v_rcp_f32 v111, v111
s_nop 0
v_mul_f32 v105, v105, v111
v_mul_f32 v111, v106, v106
v_mul_f32 v111, 0x3d372713, v111
v_add_f32 v111, 1.0, v111
v_mul_f32 v111, v111, v106
v_mul_f32 v111, 0xc01362dc, v111
v_exp_f32 v111, v111
s_nop 0
v_add_f32 v111, 1.0, v111
v_rcp_f32 v111, v111
s_nop 0
v_mul_f32 v106, v106, v111
v_mul_f32 v111, v107, v107
v_mul_f32 v111, 0x3d372713, v111
v_add_f32 v111, 1.0, v111
v_mul_f32 v111, v111, v107
v_mul_f32 v111, 0xc01362dc, v111
v_exp_f32 v111, v111
s_nop 0
v_add_f32 v111, 1.0, v111
v_rcp_f32 v111, v111
s_nop 0
v_mul_f32 v107, v107, v111
v_cvt_pk_bf16_f32 v108, v104, v105
v_cvt_pk_bf16_f32 v109, v106, v107
buffer_store_dwordx2 v[108:109], v13, s[12:15], 0 offen offset:128
s_nop 1
v_accvgpr_read_b32 v104, a76
v_accvgpr_read_b32 v105, a77
v_accvgpr_read_b32 v106, a78
v_accvgpr_read_b32 v107, a79
v_fma_f32 v104, -v68, v92, v104
v_mul_f32 v104, v104, v69
v_fma_f32 v105, -v68, v93, v105
v_mul_f32 v105, v105, v69
v_fma_f32 v106, -v68, v94, v106
v_mul_f32 v106, v106, v69
v_fma_f32 v107, -v68, v95, v107
v_mul_f32 v107, v107, v69
v_cvt_pk_bf16_f32 v110, v104, v105
v_lshlrev_b32 v104, 16, v110
v_and_b32 v105, 0xffff0000, v110
v_cvt_pk_bf16_f32 v110, v106, v107
v_lshlrev_b32 v106, 16, v110
v_and_b32 v107, 0xffff0000, v110
v_mul_f32 v111, v104, v104
v_mul_f32 v111, 0x3d372713, v111
v_add_f32 v111, 1.0, v111
v_mul_f32 v111, v111, v104
v_mul_f32 v111, 0xc01362dc, v111
v_exp_f32 v111, v111
s_nop 0
v_add_f32 v111, 1.0, v111
v_rcp_f32 v111, v111
s_nop 0
v_mul_f32 v104, v104, v111
v_mul_f32 v111, v105, v105
v_mul_f32 v111, 0x3d372713, v111
v_add_f32 v111, 1.0, v111
v_mul_f32 v111, v111, v105
v_mul_f32 v111, 0xc01362dc, v111
v_exp_f32 v111, v111
s_nop 0
v_add_f32 v111, 1.0, v111
v_rcp_f32 v111, v111
s_nop 0
v_mul_f32 v105, v105, v111
v_mul_f32 v111, v106, v106
v_mul_f32 v111, 0x3d372713, v111
v_add_f32 v111, 1.0, v111
v_mul_f32 v111, v111, v106
v_mul_f32 v111, 0xc01362dc, v111
v_exp_f32 v111, v111
s_nop 0
v_add_f32 v111, 1.0, v111
v_rcp_f32 v111, v111
s_nop 0
v_mul_f32 v106, v106, v111
v_mul_f32 v111, v107, v107
v_mul_f32 v111, 0x3d372713, v111
v_add_f32 v111, 1.0, v111
v_mul_f32 v111, v111, v107
v_mul_f32 v111, 0xc01362dc, v111
v_exp_f32 v111, v111
s_nop 0
v_add_f32 v111, 1.0, v111
v_rcp_f32 v111, v111
s_nop 0
v_mul_f32 v107, v107, v111
v_cvt_pk_bf16_f32 v108, v104, v105
v_cvt_pk_bf16_f32 v109, v106, v107
buffer_store_dwordx2 v[108:109], v13, s[12:15], 0 offen offset:160
s_nop 1
v_accvgpr_read_b32 v104, a80
v_accvgpr_read_b32 v105, a81
v_accvgpr_read_b32 v106, a82
v_accvgpr_read_b32 v107, a83
v_fma_f32 v104, -v68, v96, v104
v_mul_f32 v104, v104, v69
v_fma_f32 v105, -v68, v97, v105
v_mul_f32 v105, v105, v69
v_fma_f32 v106, -v68, v98, v106
v_mul_f32 v106, v106, v69
v_fma_f32 v107, -v68, v99, v107
v_mul_f32 v107, v107, v69
v_cvt_pk_bf16_f32 v110, v104, v105
v_lshlrev_b32 v104, 16, v110
v_and_b32 v105, 0xffff0000, v110
v_cvt_pk_bf16_f32 v110, v106, v107
v_lshlrev_b32 v106, 16, v110
v_and_b32 v107, 0xffff0000, v110
v_mul_f32 v111, v104, v104
v_mul_f32 v111, 0x3d372713, v111
v_add_f32 v111, 1.0, v111
v_mul_f32 v111, v111, v104
v_mul_f32 v111, 0xc01362dc, v111
v_exp_f32 v111, v111
s_nop 0
v_add_f32 v111, 1.0, v111
v_rcp_f32 v111, v111
s_nop 0
v_mul_f32 v104, v104, v111
v_mul_f32 v111, v105, v105
v_mul_f32 v111, 0x3d372713, v111
v_add_f32 v111, 1.0, v111
v_mul_f32 v111, v111, v105
v_mul_f32 v111, 0xc01362dc, v111
v_exp_f32 v111, v111
s_nop 0
v_add_f32 v111, 1.0, v111
v_rcp_f32 v111, v111
s_nop 0
v_mul_f32 v105, v105, v111
v_mul_f32 v111, v106, v106
v_mul_f32 v111, 0x3d372713, v111
v_add_f32 v111, 1.0, v111
v_mul_f32 v111, v111, v106
v_mul_f32 v111, 0xc01362dc, v111
v_exp_f32 v111, v111
s_nop 0
v_add_f32 v111, 1.0, v111
v_rcp_f32 v111, v111
s_nop 0
v_mul_f32 v106, v106, v111
v_mul_f32 v111, v107, v107
v_mul_f32 v111, 0x3d372713, v111
v_add_f32 v111, 1.0, v111
v_mul_f32 v111, v111, v107
v_mul_f32 v111, 0xc01362dc, v111
v_exp_f32 v111, v111
s_nop 0
v_add_f32 v111, 1.0, v111
v_rcp_f32 v111, v111
s_nop 0
v_mul_f32 v107, v107, v111
v_cvt_pk_bf16_f32 v108, v104, v105
v_cvt_pk_bf16_f32 v109, v106, v107
buffer_store_dwordx2 v[108:109], v13, s[12:15], 0 offen offset:192
s_nop 1
v_add_u32 v13, 344064, v11
s_waitcnt vmcnt(0) lgkmcnt(0)
v_accvgpr_read_b32 v104, a84
v_accvgpr_read_b32 v105, a85
v_accvgpr_read_b32 v106, a86
v_accvgpr_read_b32 v107, a87
v_fma_f32 v104, -v70, v72, v104
v_mul_f32 v104, v104, v71
v_fma_f32 v105, -v70, v73, v105
v_mul_f32 v105, v105, v71
v_fma_f32 v106, -v70, v74, v106
v_mul_f32 v106, v106, v71
v_fma_f32 v107, -v70, v75, v107
v_mul_f32 v107, v107, v71
v_cvt_pk_bf16_f32 v110, v104, v105
v_lshlrev_b32 v104, 16, v110
v_and_b32 v105, 0xffff0000, v110
v_cvt_pk_bf16_f32 v110, v106, v107
v_lshlrev_b32 v106, 16, v110
v_and_b32 v107, 0xffff0000, v110
v_mul_f32 v111, v104, v104
v_mul_f32 v111, 0x3d372713, v111
v_add_f32 v111, 1.0, v111
v_mul_f32 v111, v111, v104
v_mul_f32 v111, 0xc01362dc, v111
v_exp_f32 v111, v111
s_nop 0
v_add_f32 v111, 1.0, v111
v_rcp_f32 v111, v111
s_nop 0
v_mul_f32 v104, v104, v111
v_mul_f32 v111, v105, v105
v_mul_f32 v111, 0x3d372713, v111
v_add_f32 v111, 1.0, v111
v_mul_f32 v111, v111, v105
v_mul_f32 v111, 0xc01362dc, v111
v_exp_f32 v111, v111
s_nop 0
v_add_f32 v111, 1.0, v111
v_rcp_f32 v111, v111
s_nop 0
v_mul_f32 v105, v105, v111
v_mul_f32 v111, v106, v106
v_mul_f32 v111, 0x3d372713, v111
v_add_f32 v111, 1.0, v111
v_mul_f32 v111, v111, v106
v_mul_f32 v111, 0xc01362dc, v111
v_exp_f32 v111, v111
s_nop 0
v_add_f32 v111, 1.0, v111
v_rcp_f32 v111, v111
s_nop 0
v_mul_f32 v106, v106, v111
v_mul_f32 v111, v107, v107
v_mul_f32 v111, 0x3d372713, v111
v_add_f32 v111, 1.0, v111
v_mul_f32 v111, v111, v107
v_mul_f32 v111, 0xc01362dc, v111
v_exp_f32 v111, v111
s_nop 0
v_add_f32 v111, 1.0, v111
v_rcp_f32 v111, v111
s_nop 0
v_mul_f32 v107, v107, v111
v_cvt_pk_bf16_f32 v108, v104, v105
v_cvt_pk_bf16_f32 v109, v106, v107
buffer_store_dwordx2 v[108:109], v13, s[12:15], 0 offen offset:0
s_nop 1
v_accvgpr_read_b32 v104, a88
v_accvgpr_read_b32 v105, a89
v_accvgpr_read_b32 v106, a90
v_accvgpr_read_b32 v107, a91
v_fma_f32 v104, -v70, v76, v104
v_mul_f32 v104, v104, v71
v_fma_f32 v105, -v70, v77, v105
v_mul_f32 v105, v105, v71
v_fma_f32 v106, -v70, v78, v106
v_mul_f32 v106, v106, v71
v_fma_f32 v107, -v70, v79, v107
v_mul_f32 v107, v107, v71
v_cvt_pk_bf16_f32 v110, v104, v105
v_lshlrev_b32 v104, 16, v110
v_and_b32 v105, 0xffff0000, v110
v_cvt_pk_bf16_f32 v110, v106, v107
v_lshlrev_b32 v106, 16, v110
v_and_b32 v107, 0xffff0000, v110
v_mul_f32 v111, v104, v104
v_mul_f32 v111, 0x3d372713, v111
v_add_f32 v111, 1.0, v111
v_mul_f32 v111, v111, v104
v_mul_f32 v111, 0xc01362dc, v111
v_exp_f32 v111, v111
s_nop 0
v_add_f32 v111, 1.0, v111
v_rcp_f32 v111, v111
s_nop 0
v_mul_f32 v104, v104, v111
v_mul_f32 v111, v105, v105
v_mul_f32 v111, 0x3d372713, v111
v_add_f32 v111, 1.0, v111
v_mul_f32 v111, v111, v105
v_mul_f32 v111, 0xc01362dc, v111
v_exp_f32 v111, v111
s_nop 0
v_add_f32 v111, 1.0, v111
v_rcp_f32 v111, v111
s_nop 0
v_mul_f32 v105, v105, v111
v_mul_f32 v111, v106, v106
v_mul_f32 v111, 0x3d372713, v111
v_add_f32 v111, 1.0, v111
v_mul_f32 v111, v111, v106
v_mul_f32 v111, 0xc01362dc, v111
v_exp_f32 v111, v111
s_nop 0
v_add_f32 v111, 1.0, v111
v_rcp_f32 v111, v111
s_nop 0
v_mul_f32 v106, v106, v111
v_mul_f32 v111, v107, v107
v_mul_f32 v111, 0x3d372713, v111
v_add_f32 v111, 1.0, v111
v_mul_f32 v111, v111, v107
v_mul_f32 v111, 0xc01362dc, v111
v_exp_f32 v111, v111
s_nop 0
v_add_f32 v111, 1.0, v111
v_rcp_f32 v111, v111
s_nop 0
v_mul_f32 v107, v107, v111
v_cvt_pk_bf16_f32 v108, v104, v105
v_cvt_pk_bf16_f32 v109, v106, v107
buffer_store_dwordx2 v[108:109], v13, s[12:15], 0 offen offset:32
s_nop 1
v_accvgpr_read_b32 v104, a92
v_accvgpr_read_b32 v105, a93
v_accvgpr_read_b32 v106, a94
v_accvgpr_read_b32 v107, a95
v_fma_f32 v104, -v70, v80, v104
v_mul_f32 v104, v104, v71
v_fma_f32 v105, -v70, v81, v105
v_mul_f32 v105, v105, v71
v_fma_f32 v106, -v70, v82, v106
v_mul_f32 v106, v106, v71
v_fma_f32 v107, -v70, v83, v107
v_mul_f32 v107, v107, v71
v_cvt_pk_bf16_f32 v110, v104, v105
v_lshlrev_b32 v104, 16, v110
v_and_b32 v105, 0xffff0000, v110
v_cvt_pk_bf16_f32 v110, v106, v107
v_lshlrev_b32 v106, 16, v110
v_and_b32 v107, 0xffff0000, v110
v_mul_f32 v111, v104, v104
v_mul_f32 v111, 0x3d372713, v111
v_add_f32 v111, 1.0, v111
v_mul_f32 v111, v111, v104
v_mul_f32 v111, 0xc01362dc, v111
v_exp_f32 v111, v111
s_nop 0
v_add_f32 v111, 1.0, v111
v_rcp_f32 v111, v111
s_nop 0
v_mul_f32 v104, v104, v111
v_mul_f32 v111, v105, v105
v_mul_f32 v111, 0x3d372713, v111
v_add_f32 v111, 1.0, v111
v_mul_f32 v111, v111, v105
v_mul_f32 v111, 0xc01362dc, v111
v_exp_f32 v111, v111
s_nop 0
v_add_f32 v111, 1.0, v111
v_rcp_f32 v111, v111
s_nop 0
v_mul_f32 v105, v105, v111
v_mul_f32 v111, v106, v106
v_mul_f32 v111, 0x3d372713, v111
v_add_f32 v111, 1.0, v111
v_mul_f32 v111, v111, v106
v_mul_f32 v111, 0xc01362dc, v111
v_exp_f32 v111, v111
s_nop 0
v_add_f32 v111, 1.0, v111
v_rcp_f32 v111, v111
s_nop 0
v_mul_f32 v106, v106, v111
v_mul_f32 v111, v107, v107
v_mul_f32 v111, 0x3d372713, v111
v_add_f32 v111, 1.0, v111
v_mul_f32 v111, v111, v107
v_mul_f32 v111, 0xc01362dc, v111
v_exp_f32 v111, v111
s_nop 0
v_add_f32 v111, 1.0, v111
v_rcp_f32 v111, v111
s_nop 0
v_mul_f32 v107, v107, v111
v_cvt_pk_bf16_f32 v108, v104, v105
v_cvt_pk_bf16_f32 v109, v106, v107
buffer_store_dwordx2 v[108:109], v13, s[12:15], 0 offen offset:64
s_nop 1
v_accvgpr_read_b32 v104, a96
v_accvgpr_read_b32 v105, a97
v_accvgpr_read_b32 v106, a98
v_accvgpr_read_b32 v107, a99
v_fma_f32 v104, -v70, v84, v104
v_mul_f32 v104, v104, v71
v_fma_f32 v105, -v70, v85, v105
v_mul_f32 v105, v105, v71
v_fma_f32 v106, -v70, v86, v106
v_mul_f32 v106, v106, v71
v_fma_f32 v107, -v70, v87, v107
v_mul_f32 v107, v107, v71
v_cvt_pk_bf16_f32 v110, v104, v105
v_lshlrev_b32 v104, 16, v110
v_and_b32 v105, 0xffff0000, v110
v_cvt_pk_bf16_f32 v110, v106, v107
v_lshlrev_b32 v106, 16, v110
v_and_b32 v107, 0xffff0000, v110
v_mul_f32 v111, v104, v104
v_mul_f32 v111, 0x3d372713, v111
v_add_f32 v111, 1.0, v111
v_mul_f32 v111, v111, v104
v_mul_f32 v111, 0xc01362dc, v111
v_exp_f32 v111, v111
s_nop 0
v_add_f32 v111, 1.0, v111
v_rcp_f32 v111, v111
s_nop 0
v_mul_f32 v104, v104, v111
v_mul_f32 v111, v105, v105
v_mul_f32 v111, 0x3d372713, v111
v_add_f32 v111, 1.0, v111
v_mul_f32 v111, v111, v105
v_mul_f32 v111, 0xc01362dc, v111
v_exp_f32 v111, v111
s_nop 0
v_add_f32 v111, 1.0, v111
v_rcp_f32 v111, v111
s_nop 0
v_mul_f32 v105, v105, v111
v_mul_f32 v111, v106, v106
v_mul_f32 v111, 0x3d372713, v111
v_add_f32 v111, 1.0, v111
v_mul_f32 v111, v111, v106
v_mul_f32 v111, 0xc01362dc, v111
v_exp_f32 v111, v111
s_nop 0
v_add_f32 v111, 1.0, v111
v_rcp_f32 v111, v111
s_nop 0
v_mul_f32 v106, v106, v111
v_mul_f32 v111, v107, v107
v_mul_f32 v111, 0x3d372713, v111
v_add_f32 v111, 1.0, v111
v_mul_f32 v111, v111, v107
v_mul_f32 v111, 0xc01362dc, v111
v_exp_f32 v111, v111
s_nop 0
v_add_f32 v111, 1.0, v111
v_rcp_f32 v111, v111
s_nop 0
v_mul_f32 v107, v107, v111
v_cvt_pk_bf16_f32 v108, v104, v105
v_cvt_pk_bf16_f32 v109, v106, v107
buffer_store_dwordx2 v[108:109], v13, s[12:15], 0 offen offset:96
s_nop 1
v_accvgpr_read_b32 v104, a100
v_accvgpr_read_b32 v105, a101
v_accvgpr_read_b32 v106, a102
v_accvgpr_read_b32 v107, a103
v_fma_f32 v104, -v70, v88, v104
v_mul_f32 v104, v104, v71
v_fma_f32 v105, -v70, v89, v105
v_mul_f32 v105, v105, v71
v_fma_f32 v106, -v70, v90, v106
v_mul_f32 v106, v106, v71
v_fma_f32 v107, -v70, v91, v107
v_mul_f32 v107, v107, v71
v_cvt_pk_bf16_f32 v110, v104, v105
v_lshlrev_b32 v104, 16, v110
v_and_b32 v105, 0xffff0000, v110
v_cvt_pk_bf16_f32 v110, v106, v107
v_lshlrev_b32 v106, 16, v110
v_and_b32 v107, 0xffff0000, v110
v_mul_f32 v111, v104, v104
v_mul_f32 v111, 0x3d372713, v111
v_add_f32 v111, 1.0, v111
v_mul_f32 v111, v111, v104
v_mul_f32 v111, 0xc01362dc, v111
v_exp_f32 v111, v111
s_nop 0
v_add_f32 v111, 1.0, v111
v_rcp_f32 v111, v111
s_nop 0
v_mul_f32 v104, v104, v111
v_mul_f32 v111, v105, v105
v_mul_f32 v111, 0x3d372713, v111
v_add_f32 v111, 1.0, v111
v_mul_f32 v111, v111, v105
v_mul_f32 v111, 0xc01362dc, v111
v_exp_f32 v111, v111
s_nop 0
v_add_f32 v111, 1.0, v111
v_rcp_f32 v111, v111
s_nop 0
v_mul_f32 v105, v105, v111
v_mul_f32 v111, v106, v106
v_mul_f32 v111, 0x3d372713, v111
v_add_f32 v111, 1.0, v111
v_mul_f32 v111, v111, v106
v_mul_f32 v111, 0xc01362dc, v111
v_exp_f32 v111, v111
s_nop 0
v_add_f32 v111, 1.0, v111
v_rcp_f32 v111, v111
s_nop 0
v_mul_f32 v106, v106, v111
v_mul_f32 v111, v107, v107
v_mul_f32 v111, 0x3d372713, v111
v_add_f32 v111, 1.0, v111
v_mul_f32 v111, v111, v107
v_mul_f32 v111, 0xc01362dc, v111
v_exp_f32 v111, v111
s_nop 0
v_add_f32 v111, 1.0, v111
v_rcp_f32 v111, v111
s_nop 0
v_mul_f32 v107, v107, v111
v_cvt_pk_bf16_f32 v108, v104, v105
v_cvt_pk_bf16_f32 v109, v106, v107
buffer_store_dwordx2 v[108:109], v13, s[12:15], 0 offen offset:128
s_nop 1
v_accvgpr_read_b32 v104, a104
v_accvgpr_read_b32 v105, a105
v_accvgpr_read_b32 v106, a106
v_accvgpr_read_b32 v107, a107
v_fma_f32 v104, -v70, v92, v104
v_mul_f32 v104, v104, v71
v_fma_f32 v105, -v70, v93, v105
v_mul_f32 v105, v105, v71
v_fma_f32 v106, -v70, v94, v106
v_mul_f32 v106, v106, v71
v_fma_f32 v107, -v70, v95, v107
v_mul_f32 v107, v107, v71
v_cvt_pk_bf16_f32 v110, v104, v105
v_lshlrev_b32 v104, 16, v110
v_and_b32 v105, 0xffff0000, v110
v_cvt_pk_bf16_f32 v110, v106, v107
v_lshlrev_b32 v106, 16, v110
v_and_b32 v107, 0xffff0000, v110
v_mul_f32 v111, v104, v104
v_mul_f32 v111, 0x3d372713, v111
v_add_f32 v111, 1.0, v111
v_mul_f32 v111, v111, v104
v_mul_f32 v111, 0xc01362dc, v111
v_exp_f32 v111, v111
s_nop 0
v_add_f32 v111, 1.0, v111
v_rcp_f32 v111, v111
s_nop 0
v_mul_f32 v104, v104, v111
v_mul_f32 v111, v105, v105
v_mul_f32 v111, 0x3d372713, v111
v_add_f32 v111, 1.0, v111
v_mul_f32 v111, v111, v105
v_mul_f32 v111, 0xc01362dc, v111
v_exp_f32 v111, v111
s_nop 0
v_add_f32 v111, 1.0, v111
v_rcp_f32 v111, v111
s_nop 0
v_mul_f32 v105, v105, v111
v_mul_f32 v111, v106, v106
v_mul_f32 v111, 0x3d372713, v111
v_add_f32 v111, 1.0, v111
v_mul_f32 v111, v111, v106
v_mul_f32 v111, 0xc01362dc, v111
v_exp_f32 v111, v111
s_nop 0
v_add_f32 v111, 1.0, v111
v_rcp_f32 v111, v111
s_nop 0
v_mul_f32 v106, v106, v111
v_mul_f32 v111, v107, v107
v_mul_f32 v111, 0x3d372713, v111
v_add_f32 v111, 1.0, v111
v_mul_f32 v111, v111, v107
v_mul_f32 v111, 0xc01362dc, v111
v_exp_f32 v111, v111
s_nop 0
v_add_f32 v111, 1.0, v111
v_rcp_f32 v111, v111
s_nop 0
v_mul_f32 v107, v107, v111
v_cvt_pk_bf16_f32 v108, v104, v105
v_cvt_pk_bf16_f32 v109, v106, v107
buffer_store_dwordx2 v[108:109], v13, s[12:15], 0 offen offset:160
s_nop 1
v_accvgpr_read_b32 v104, a108
v_accvgpr_read_b32 v105, a109
v_accvgpr_read_b32 v106, a110
v_accvgpr_read_b32 v107, a111
v_fma_f32 v104, -v70, v96, v104
v_mul_f32 v104, v104, v71
v_fma_f32 v105, -v70, v97, v105
v_mul_f32 v105, v105, v71
v_fma_f32 v106, -v70, v98, v106
v_mul_f32 v106, v106, v71
v_fma_f32 v107, -v70, v99, v107
v_mul_f32 v107, v107, v71
v_cvt_pk_bf16_f32 v110, v104, v105
v_lshlrev_b32 v104, 16, v110
v_and_b32 v105, 0xffff0000, v110
v_cvt_pk_bf16_f32 v110, v106, v107
v_lshlrev_b32 v106, 16, v110
v_and_b32 v107, 0xffff0000, v110
v_mul_f32 v111, v104, v104
v_mul_f32 v111, 0x3d372713, v111
v_add_f32 v111, 1.0, v111
v_mul_f32 v111, v111, v104
v_mul_f32 v111, 0xc01362dc, v111
v_exp_f32 v111, v111
s_nop 0
v_add_f32 v111, 1.0, v111
v_rcp_f32 v111, v111
s_nop 0
v_mul_f32 v104, v104, v111
v_mul_f32 v111, v105, v105
v_mul_f32 v111, 0x3d372713, v111
v_add_f32 v111, 1.0, v111
v_mul_f32 v111, v111, v105
v_mul_f32 v111, 0xc01362dc, v111
v_exp_f32 v111, v111
s_nop 0
v_add_f32 v111, 1.0, v111
v_rcp_f32 v111, v111
s_nop 0
v_mul_f32 v105, v105, v111
v_mul_f32 v111, v106, v106
v_mul_f32 v111, 0x3d372713, v111
v_add_f32 v111, 1.0, v111
v_mul_f32 v111, v111, v106
v_mul_f32 v111, 0xc01362dc, v111
v_exp_f32 v111, v111
s_nop 0
v_add_f32 v111, 1.0, v111
v_rcp_f32 v111, v111
s_nop 0
v_mul_f32 v106, v106, v111
v_mul_f32 v111, v107, v107
v_mul_f32 v111, 0x3d372713, v111
v_add_f32 v111, 1.0, v111
v_mul_f32 v111, v111, v107
v_mul_f32 v111, 0xc01362dc, v111
v_exp_f32 v111, v111
s_nop 0
v_add_f32 v111, 1.0, v111
v_rcp_f32 v111, v111
s_nop 0
v_mul_f32 v107, v107, v111
v_cvt_pk_bf16_f32 v108, v104, v105
v_cvt_pk_bf16_f32 v109, v106, v107
buffer_store_dwordx2 v[108:109], v13, s[12:15], 0 offen offset:192
s_nop 1
w3_kernel_end:
s_endpgm
.globl w4a_kernel
.p2align 8
.type w4a_kernel,@function
w4a_kernel:
s_cmp_ge_u32 s2, 256
s_cbranch_scc1 w4a_kernel_end
s_load_dwordx2 s[4:5], s[0:1], 88
s_load_dwordx2 s[8:9], s[0:1], 64
s_and_b32 s20, s2, 7
s_lshr_b32 s21, s2, 3
s_lshr_b32 s22, s20, 1
s_lshl_b32 s22, s22, 2
s_and_b32 s23, s21, 3
s_add_u32 s22, s22, s23
s_and_b32 s23, s20, 1
s_lshl_b32 s23, s23, 3
s_lshr_b32 s24, s21, 2
s_add_u32 s23, s23, s24
v_and_b32 v1, 63, v0
v_lshrrev_b32 v2, 6, v0
s_waitcnt lgkmcnt(0)
s_add_u32 s4, s4, 25165824
s_addc_u32 s5, s5, 0
s_mov_b32 s6, 14680064
s_mov_b32 s7, 0x00020000
s_mov_b32 s10, 7340032
s_mov_b32 s11, 0x00020000
v_lshrrev_b32 v3, 3, v1
v_and_b32 v4, 7, v1
v_xor_b32 v4, v4, v3
v_lshlrev_b32 v4, 4, v4
s_lshl_b32 s25, s22, 7
v_lshlrev_b32 v5, 5, v2
v_add_u32 v5, s25, v5
v_add_u32 v5, v5, v3
s_mov_b32 s26, 7168
v_mul_lo_u32 v5, v5, s26
v_add_u32 v10, v5, v4
v_add_u32 v11, 57344, v10
v_add_u32 v12, 114688, v10
v_add_u32 v13, 172032, v10
v_mul_u32_u24 v3, 128, v2
v_add_u32 v3, 0, v3
v_add_u32 v3, v3, v1
v_mul_u32_u24 v4, 8192, v3
v_lshrrev_b32 v4, 16, v4
v_mul_u32_u24 v5, 8, v4
v_sub_u32 v5, v3, v5
v_bfe_u32 v6, v4, 3, 1
v_bfe_u32 v7, v4, 1, 1
v_lshl_or_b32 v6, v7, 1, v6
v_lshlrev_b32 v6, 1, v6
v_xor_b32 v5, v5, v6
s_mul_i32 s25, s23, 128
v_lshlrev_b32 v9, 4, v5
v_add_u32 v9, s25, v9
v_mul_u32_u24 v4, 2048, v4
v_add_u32 v14, v4, v9
v_mul_u32_u24 v3, 128, v2
v_add_u32 v3, 64, v3
v_add_u32 v3, v3, v1
v_mul_u32_u24 v4, 8192, v3
v_lshrrev_b32 v4, 16, v4
v_mul_u32_u24 v5, 8, v4
v_sub_u32 v5, v3, v5
v_bfe_u32 v6, v4, 3, 1
v_bfe_u32 v7, v4, 1, 1
v_lshl_or_b32 v6, v7, 1, v6
v_lshlrev_b32 v6, 1, v6
v_xor_b32 v5, v5, v6
s_mul_i32 s25, s23, 128
v_lshlrev_b32 v9, 4, v5
v_add_u32 v9, s25, v9
v_mul_u32_u24 v4, 2048, v4
v_add_u32 v15, v4, v9
v_lshrrev_b32 v3, 1, v2
v_lshlrev_b32 v3, 6, v3
v_and_b32 v4, 15, v1
v_add_u32 v3, v3, v4
v_lshlrev_b32 v3, 7, v3
v_lshrrev_b32 v5, 4, v1
v_and_b32 v6, 7, v1
v_xor_b32 v5, v5, v6
v_lshlrev_b32 v5, 4, v5
v_add_u32 v21, v3, v5
v_xor_b32 v22, 64, v21
v_lshrrev_b32 v3, 4, v1
v_bfe_u32 v4, v1, 2, 2
v_lshl_add_u32 v5, v3, 3, v4
v_mul_u32_u24 v5, 128, v5
v_and_b32 v6, 3, v1
v_lshl_add_u32 v5, v6, 3, v5
v_add_u32 v5, 16384, v5
v_and_b32 v6, 1, v3
v_bfe_u32 v7, v1, 3, 1
v_lshl_or_b32 v6, v7, 1, v6
v_and_b32 v7, 1, v2
v_mul_u32_u24 v7, 2, v7
v_add_u32 v8, 0, v7
v_xor_b32 v8, v8, v6
v_lshl_add_u32 v25, v8, 5, v5
v_add_u32 v8, 1, v7
v_xor_b32 v8, v8, v6
v_lshl_add_u32 v26, v8, 5, v5
v_accvgpr_write_b32 a0, 0
v_accvgpr_write_b32 a1, 0
v_accvgpr_write_b32 a2, 0
v_accvgpr_write_b32 a3, 0
v_accvgpr_write_b32 a4, 0
v_accvgpr_write_b32 a5, 0
v_accvgpr_write_b32 a6, 0
v_accvgpr_write_b32 a7, 0
v_accvgpr_write_b32 a8, 0
v_accvgpr_write_b32 a9, 0
v_accvgpr_write_b32 a10, 0
v_accvgpr_write_b32 a11, 0
v_accvgpr_write_b32 a12, 0
v_accvgpr_write_b32 a13, 0
v_accvgpr_write_b32 a14, 0
v_accvgpr_write_b32 a15, 0
v_accvgpr_write_b32 a16, 0
v_accvgpr_write_b32 a17, 0
v_accvgpr_write_b32 a18, 0
v_accvgpr_write_b32 a19, 0
v_accvgpr_write_b32 a20, 0
v_accvgpr_write_b32 a21, 0
v_accvgpr_write_b32 a22, 0
v_accvgpr_write_b32 a23, 0
v_accvgpr_write_b32 a24, 0
v_accvgpr_write_b32 a25, 0
v_accvgpr_write_b32 a26, 0
v_accvgpr_write_b32 a27, 0
v_accvgpr_write_b32 a28, 0
v_accvgpr_write_b32 a29, 0
v_accvgpr_write_b32 a30, 0
v_accvgpr_write_b32 a31, 0
v_readfirstlane_b32 s27, v2
s_nop 3
s_mul_i32 s28, s27, 2048
s_lshl_b32 s27, s27, 12
s_mov_b32 s16, 0
s_mov_b32 s17, 0
s_add_u32 m0, s27, 0
s_nop 0
buffer_load_dwordx4 v10, s[4:7], s16 offen lds
s_add_u32 m0, s27, 1024
s_nop 0
buffer_load_dwordx4 v11, s[4:7], s16 offen lds
s_add_u32 m0, s27, 2048
s_nop 0
buffer_load_dwordx4 v12, s[4:7], s16 offen lds
s_add_u32 m0, s27, 3072
s_nop 0
buffer_load_dwordx4 v13, s[4:7], s16 offen lds
s_add_u32 m0, s28, 16384
s_nop 0
buffer_load_dwordx4 v14, s[8:11], s17 offen lds
s_add_u32 m0, s28, 17408
s_nop 0
buffer_load_dwordx4 v15, s[8:11], s17 offen lds
s_add_u32 s16, s16, 128
s_add_u32 s17, s17, 131072
s_add_u32 m0, s27, 24576
s_nop 0
buffer_load_dwordx4 v10, s[4:7], s16 offen lds
s_add_u32 m0, s27, 25600
s_nop 0
buffer_load_dwordx4 v11, s[4:7], s16 offen lds
s_add_u32 m0, s27, 26624
s_nop 0
buffer_load_dwordx4 v12, s[4:7], s16 offen lds
s_add_u32 m0, s27, 27648
s_nop 0
buffer_load_dwordx4 v13, s[4:7], s16 offen lds
s_add_u32 m0, s28, 40960
s_nop 0
buffer_load_dwordx4 v14, s[8:11], s17 offen lds
s_add_u32 m0, s28, 41984
s_nop 0
buffer_load_dwordx4 v15, s[8:11], s17 offen lds
s_add_u32 s16, s16, 128
s_add_u32 s17, s17, 131072
s_add_u32 m0, s27, 49152
s_nop 0
buffer_load_dwordx4 v10, s[4:7], s16 offen lds
s_add_u32 m0, s27, 50176
s_nop 0
buffer_load_dwordx4 v11, s[4:7], s16 offen lds
s_add_u32 m0, s27, 51200
s_nop 0
buffer_load_dwordx4 v12, s[4:7], s16 offen lds
s_add_u32 m0, s27, 52224
s_nop 0
buffer_load_dwordx4 v13, s[4:7], s16 offen lds
s_add_u32 m0, s28, 65536
s_nop 0
buffer_load_dwordx4 v14, s[8:11], s17 offen lds
s_add_u32 m0, s28, 66560
s_nop 0
buffer_load_dwordx4 v15, s[8:11], s17 offen lds
s_add_u32 s16, s16, 128
s_add_u32 s17, s17, 131072
s_waitcnt vmcnt(12) lgkmcnt(0)
s_barrier
v_add_u32 v23, 0, v21
v_add_u32 v32, 0, v25
v_add_u32 v33, 0, v26
ds_read_b128 v[40:43], v23 offset:0
ds_read_b128 v[44:47], v23 offset:2048
ds_read_b128 v[48:51], v23 offset:4096
ds_read_b128 v[52:55], v23 offset:6144
ds_read_b64_tr_b16 v[56:57], v32 offset:0
ds_read_b64_tr_b16 v[58:59], v32 offset:512
ds_read_b64_tr_b16 v[60:61], v33 offset:0
ds_read_b64_tr_b16 v[62:63], v33 offset:512
s_mov_b32 s18, 14
w4a_kernel_loop:
s_waitcnt lgkmcnt(0)
v_mfma_f32_16x16x32_bf16 a[0:3], v[56:59], v[40:43], a[0:3]
v_add_u32 v23, 0, v22
v_mfma_f32_16x16x32_bf16 a[8:11], v[56:59], v[44:47], a[8:11]
v_add_u32 v32, 0, v25
v_mfma_f32_16x16x32_bf16 a[16:19], v[56:59], v[48:51], a[16:19]
v_add_u32 v33, 0, v26
ds_read_b128 v[84:87], v23 offset:0
v_mfma_f32_16x16x32_bf16 a[24:27], v[56:59], v[52:55], a[24:27]
ds_read_b128 v[88:91], v23 offset:2048
v_mfma_f32_16x16x32_bf16 a[4:7], v[60:63], v[40:43], a[4:7]
ds_read_b128 v[92:95], v23 offset:4096
v_mfma_f32_16x16x32_bf16 a[12:15], v[60:63], v[44:47], a[12:15]
ds_read_b128 v[96:99], v23 offset:6144
ds_read_b64_tr_b16 v[100:101], v32 offset:4096
v_mfma_f32_16x16x32_bf16 a[20:23], v[60:63], v[48:51], a[20:23]
ds_read_b64_tr_b16 v[102:103], v32 offset:4608
v_mfma_f32_16x16x32_bf16 a[28:31], v[60:63], v[52:55], a[28:31]
ds_read_b64_tr_b16 v[104:105], v33 offset:4096
ds_read_b64_tr_b16 v[106:107], v33 offset:4608
s_waitcnt vmcnt(6)
s_barrier
s_waitcnt lgkmcnt(0)
v_mfma_f32_16x16x32_bf16 a[0:3], v[100:103], v[84:87], a[0:3]
s_add_u32 m0, s27, 73728
s_nop 0
buffer_load_dwordx4 v10, s[4:7], s16 offen lds
v_mfma_f32_16x16x32_bf16 a[8:11], v[100:103], v[88:91], a[8:11]
s_add_u32 m0, s27, 74752
s_nop 0
buffer_load_dwordx4 v11, s[4:7], s16 offen lds
s_add_u32 m0, s27, 75776
v_mfma_f32_16x16x32_bf16 a[16:19], v[100:103], v[92:95], a[16:19]
s_nop 0
buffer_load_dwordx4 v12, s[4:7], s16 offen lds
s_add_u32 m0, s27, 76800
s_nop 0
v_mfma_f32_16x16x32_bf16 a[24:27], v[100:103], v[96:99], a[24:27]
buffer_load_dwordx4 v13, s[4:7], s16 offen lds
s_add_u32 m0, s28, 90112
s_nop 0
buffer_load_dwordx4 v14, s[8:11], s17 offen lds
v_mfma_f32_16x16x32_bf16 a[4:7], v[104:107], v[84:87], a[4:7]
s_add_u32 m0, s28, 91136
s_nop 0
buffer_load_dwordx4 v15, s[8:11], s17 offen lds
s_add_u32 s16, s16, 128
v_mfma_f32_16x16x32_bf16 a[12:15], v[104:107], v[88:91], a[12:15]
s_add_u32 s17, s17, 131072
v_add_u32 v23, 24576, v21
v_add_u32 v32, 24576, v25
v_add_u32 v33, 24576, v26
v_mfma_f32_16x16x32_bf16 a[20:23], v[104:107], v[92:95], a[20:23]
ds_read_b128 v[40:43], v23 offset:0
ds_read_b128 v[44:47], v23 offset:2048
ds_read_b128 v[48:51], v23 offset:4096
ds_read_b128 v[52:55], v23 offset:6144
v_mfma_f32_16x16x32_bf16 a[28:31], v[104:107], v[96:99], a[28:31]
ds_read_b64_tr_b16 v[56:57], v32 offset:0
ds_read_b64_tr_b16 v[58:59], v32 offset:512
ds_read_b64_tr_b16 v[60:61], v33 offset:0
ds_read_b64_tr_b16 v[62:63], v33 offset:512
s_waitcnt lgkmcnt(0)
v_mfma_f32_16x16x32_bf16 a[0:3], v[56:59], v[40:43], a[0:3]
v_add_u32 v23, 24576, v22
v_mfma_f32_16x16x32_bf16 a[8:11], v[56:59], v[44:47], a[8:11]
v_add_u32 v32, 24576, v25
v_mfma_f32_16x16x32_bf16 a[16:19], v[56:59], v[48:51], a[16:19]
v_add_u32 v33, 24576, v26
ds_read_b128 v[84:87], v23 offset:0
v_mfma_f32_16x16x32_bf16 a[24:27], v[56:59], v[52:55], a[24:27]
ds_read_b128 v[88:91], v23 offset:2048
v_mfma_f32_16x16x32_bf16 a[4:7], v[60:63], v[40:43], a[4:7]
ds_read_b128 v[92:95], v23 offset:4096
v_mfma_f32_16x16x32_bf16 a[12:15], v[60:63], v[44:47], a[12:15]
ds_read_b128 v[96:99], v23 offset:6144
ds_read_b64_tr_b16 v[100:101], v32 offset:4096
v_mfma_f32_16x16x32_bf16 a[20:23], v[60:63], v[48:51], a[20:23]
ds_read_b64_tr_b16 v[102:103], v32 offset:4608
v_mfma_f32_16x16x32_bf16 a[28:31], v[60:63], v[52:55], a[28:31]
ds_read_b64_tr_b16 v[104:105], v33 offset:4096
ds_read_b64_tr_b16 v[106:107], v33 offset:4608
s_waitcnt vmcnt(6)
s_barrier
s_waitcnt lgkmcnt(0)
v_mfma_f32_16x16x32_bf16 a[0:3], v[100:103], v[84:87], a[0:3]
s_add_u32 m0, s27, 0
s_nop 0
buffer_load_dwordx4 v10, s[4:7], s16 offen lds
v_mfma_f32_16x16x32_bf16 a[8:11], v[100:103], v[88:91], a[8:11]
s_add_u32 m0, s27, 1024
s_nop 0
buffer_load_dwordx4 v11, s[4:7], s16 offen lds
s_add_u32 m0, s27, 2048
v_mfma_f32_16x16x32_bf16 a[16:19], v[100:103], v[92:95], a[16:19]
s_nop 0
buffer_load_dwordx4 v12, s[4:7], s16 offen lds
s_add_u32 m0, s27, 3072
s_nop 0
v_mfma_f32_16x16x32_bf16 a[24:27], v[100:103], v[96:99], a[24:27]
buffer_load_dwordx4 v13, s[4:7], s16 offen lds
s_add_u32 m0, s28, 16384
s_nop 0
buffer_load_dwordx4 v14, s[8:11], s17 offen lds
v_mfma_f32_16x16x32_bf16 a[4:7], v[104:107], v[84:87], a[4:7]
s_add_u32 m0, s28, 17408
s_nop 0
buffer_load_dwordx4 v15, s[8:11], s17 offen lds
s_add_u32 s16, s16, 128
v_mfma_f32_16x16x32_bf16 a[12:15], v[104:107], v[88:91], a[12:15]
s_add_u32 s17, s17, 131072
v_add_u32 v23, 49152, v21
v_add_u32 v32, 49152, v25
v_add_u32 v33, 49152, v26
v_mfma_f32_16x16x32_bf16 a[20:23], v[104:107], v[92:95], a[20:23]
ds_read_b128 v[40:43], v23 offset:0
ds_read_b128 v[44:47], v23 offset:2048
ds_read_b128 v[48:51], v23 offset:4096
ds_read_b128 v[52:55], v23 offset:6144
v_mfma_f32_16x16x32_bf16 a[28:31], v[104:107], v[96:99], a[28:31]
ds_read_b64_tr_b16 v[56:57], v32 offset:0
ds_read_b64_tr_b16 v[58:59], v32 offset:512
ds_read_b64_tr_b16 v[60:61], v33 offset:0
ds_read_b64_tr_b16 v[62:63], v33 offset:512
s_waitcnt lgkmcnt(0)
v_mfma_f32_16x16x32_bf16 a[0:3], v[56:59], v[40:43], a[0:3]
v_add_u32 v23, 49152, v22
v_mfma_f32_16x16x32_bf16 a[8:11], v[56:59], v[44:47], a[8:11]
v_add_u32 v32, 49152, v25
v_mfma_f32_16x16x32_bf16 a[16:19], v[56:59], v[48:51], a[16:19]
v_add_u32 v33, 49152, v26
ds_read_b128 v[84:87], v23 offset:0
v_mfma_f32_16x16x32_bf16 a[24:27], v[56:59], v[52:55], a[24:27]
ds_read_b128 v[88:91], v23 offset:2048
v_mfma_f32_16x16x32_bf16 a[4:7], v[60:63], v[40:43], a[4:7]
ds_read_b128 v[92:95], v23 offset:4096
v_mfma_f32_16x16x32_bf16 a[12:15], v[60:63], v[44:47], a[12:15]
ds_read_b128 v[96:99], v23 offset:6144
ds_read_b64_tr_b16 v[100:101], v32 offset:4096
v_mfma_f32_16x16x32_bf16 a[20:23], v[60:63], v[48:51], a[20:23]
ds_read_b64_tr_b16 v[102:103], v32 offset:4608
v_mfma_f32_16x16x32_bf16 a[28:31], v[60:63], v[52:55], a[28:31]
ds_read_b64_tr_b16 v[104:105], v33 offset:4096
ds_read_b64_tr_b16 v[106:107], v33 offset:4608
s_waitcnt vmcnt(6)
s_barrier
s_waitcnt lgkmcnt(0)
v_mfma_f32_16x16x32_bf16 a[0:3], v[100:103], v[84:87], a[0:3]
s_add_u32 m0, s27, 24576
s_nop 0
buffer_load_dwordx4 v10, s[4:7], s16 offen lds
v_mfma_f32_16x16x32_bf16 a[8:11], v[100:103], v[88:91], a[8:11]
s_add_u32 m0, s27, 25600
s_nop 0
buffer_load_dwordx4 v11, s[4:7], s16 offen lds
s_add_u32 m0, s27, 26624
v_mfma_f32_16x16x32_bf16 a[16:19], v[100:103], v[92:95], a[16:19]
s_nop 0
buffer_load_dwordx4 v12, s[4:7], s16 offen lds
s_add_u32 m0, s27, 27648
s_nop 0
v_mfma_f32_16x16x32_bf16 a[24:27], v[100:103], v[96:99], a[24:27]
buffer_load_dwordx4 v13, s[4:7], s16 offen lds
s_add_u32 m0, s28, 40960
s_nop 0
buffer_load_dwordx4 v14, s[8:11], s17 offen lds
v_mfma_f32_16x16x32_bf16 a[4:7], v[104:107], v[84:87], a[4:7]
s_add_u32 m0, s28, 41984
s_nop 0
buffer_load_dwordx4 v15, s[8:11], s17 offen lds
s_add_u32 s16, s16, 128
v_mfma_f32_16x16x32_bf16 a[12:15], v[104:107], v[88:91], a[12:15]
s_add_u32 s17, s17, 131072
v_add_u32 v23, 73728, v21
v_add_u32 v32, 73728, v25
v_add_u32 v33, 73728, v26
v_mfma_f32_16x16x32_bf16 a[20:23], v[104:107], v[92:95], a[20:23]
ds_read_b128 v[40:43], v23 offset:0
ds_read_b128 v[44:47], v23 offset:2048
ds_read_b128 v[48:51], v23 offset:4096
ds_read_b128 v[52:55], v23 offset:6144
v_mfma_f32_16x16x32_bf16 a[28:31], v[104:107], v[96:99], a[28:31]
ds_read_b64_tr_b16 v[56:57], v32 offset:0
ds_read_b64_tr_b16 v[58:59], v32 offset:512
ds_read_b64_tr_b16 v[60:61], v33 offset:0
ds_read_b64_tr_b16 v[62:63], v33 offset:512
s_waitcnt lgkmcnt(0)
v_mfma_f32_16x16x32_bf16 a[0:3], v[56:59], v[40:43], a[0:3]
v_add_u32 v23, 73728, v22
v_mfma_f32_16x16x32_bf16 a[8:11], v[56:59], v[44:47], a[8:11]
v_add_u32 v32, 73728, v25
v_mfma_f32_16x16x32_bf16 a[16:19], v[56:59], v[48:51], a[16:19]
v_add_u32 v33, 73728, v26
ds_read_b128 v[84:87], v23 offset:0
v_mfma_f32_16x16x32_bf16 a[24:27], v[56:59], v[52:55], a[24:27]
ds_read_b128 v[88:91], v23 offset:2048
v_mfma_f32_16x16x32_bf16 a[4:7], v[60:63], v[40:43], a[4:7]
ds_read_b128 v[92:95], v23 offset:4096
v_mfma_f32_16x16x32_bf16 a[12:15], v[60:63], v[44:47], a[12:15]
ds_read_b128 v[96:99], v23 offset:6144
ds_read_b64_tr_b16 v[100:101], v32 offset:4096
v_mfma_f32_16x16x32_bf16 a[20:23], v[60:63], v[48:51], a[20:23]
ds_read_b64_tr_b16 v[102:103], v32 offset:4608
v_mfma_f32_16x16x32_bf16 a[28:31], v[60:63], v[52:55], a[28:31]
ds_read_b64_tr_b16 v[104:105], v33 offset:4096
ds_read_b64_tr_b16 v[106:107], v33 offset:4608
s_waitcnt vmcnt(6)
s_barrier
s_waitcnt lgkmcnt(0)
v_mfma_f32_16x16x32_bf16 a[0:3], v[100:103], v[84:87], a[0:3]
s_add_u32 m0, s27, 49152
s_nop 0
buffer_load_dwordx4 v10, s[4:7], s16 offen lds
v_mfma_f32_16x16x32_bf16 a[8:11], v[100:103], v[88:91], a[8:11]
s_add_u32 m0, s27, 50176
s_nop 0
buffer_load_dwordx4 v11, s[4:7], s16 offen lds
s_add_u32 m0, s27, 51200
v_mfma_f32_16x16x32_bf16 a[16:19], v[100:103], v[92:95], a[16:19]
s_nop 0
buffer_load_dwordx4 v12, s[4:7], s16 offen lds
s_add_u32 m0, s27, 52224
s_nop 0
v_mfma_f32_16x16x32_bf16 a[24:27], v[100:103], v[96:99], a[24:27]
buffer_load_dwordx4 v13, s[4:7], s16 offen lds
s_add_u32 m0, s28, 65536
s_nop 0
buffer_load_dwordx4 v14, s[8:11], s17 offen lds
v_mfma_f32_16x16x32_bf16 a[4:7], v[104:107], v[84:87], a[4:7]
s_add_u32 m0, s28, 66560
s_nop 0
buffer_load_dwordx4 v15, s[8:11], s17 offen lds
s_add_u32 s16, s16, 128
v_mfma_f32_16x16x32_bf16 a[12:15], v[104:107], v[88:91], a[12:15]
s_add_u32 s17, s17, 131072
v_add_u32 v23, 0, v21
v_add_u32 v32, 0, v25
v_add_u32 v33, 0, v26
v_mfma_f32_16x16x32_bf16 a[20:23], v[104:107], v[92:95], a[20:23]
ds_read_b128 v[40:43], v23 offset:0
ds_read_b128 v[44:47], v23 offset:2048
ds_read_b128 v[48:51], v23 offset:4096
ds_read_b128 v[52:55], v23 offset:6144
v_mfma_f32_16x16x32_bf16 a[28:31], v[104:107], v[96:99], a[28:31]
ds_read_b64_tr_b16 v[56:57], v32 offset:0
ds_read_b64_tr_b16 v[58:59], v32 offset:512
ds_read_b64_tr_b16 v[60:61], v33 offset:0
ds_read_b64_tr_b16 v[62:63], v33 offset:512
s_sub_u32 s18, s18, 1
s_cmp_lg_u32 s18, 0
s_cbranch_scc1 w4a_kernel_loop
s_waitcnt vmcnt(0) lgkmcnt(0)
s_nop 15
s_nop 7
v_and_b32 v4, 15, v1
v_lshrrev_b32 v5, 4, v1
v_lshrrev_b32 v6, 1, v2
v_and_b32 v7, 1, v2
v_lshl_add_u32 v8, v6, 6, v4
s_lshl_b32 s25, s22, 7
v_add_u32 v9, s25, v8
v_xor_b32 v60, 16, v1
v_lshlrev_b32 v60, 2, v60
v_xor_b32 v61, 32, v1
v_lshlrev_b32 v61, 2, v61
s_mul_i32 s25, s23, 64
v_mul_u32_u24 v10, 32, v7
v_add_u32 v10, s25, v10
v_lshl_add_u32 v10, v5, 2, v10
s_mov_b32 s26, 1024
v_mul_lo_u32 v11, v9, s26
v_add_u32 v11, v11, v10
v_lshlrev_b32 v11, 1, v11
s_load_dwordx2 s[12:13], s[0:1], 88
s_load_dwordx2 s[4:5], s[0:1], 88
s_load_dwordx2 s[8:9], s[0:1], 88
s_load_dwordx2 s[16:17], s[0:1], 88
s_waitcnt lgkmcnt(0)
s_mov_b32 s14, 4194304
s_mov_b32 s15, 0x00020000
s_mov_b32 s6, 4194304
s_mov_b32 s7, 0x00020000
s_add_u32 s8, s8, 20971520
s_addc_u32 s9, s9, 0
s_mov_b32 s10, 4194304
s_mov_b32 s11, 0x00020000
s_add_u32 s16, s16, 52428800
s_addc_u32 s17, s17, 0
s_mov_b32 s18, 524288
s_mov_b32 s19, 0x00020000
v_add_u32 v13, 0, v11
buffer_load_dwordx2 v[72:73], v13, s[4:7], 0 offen offset:0
buffer_load_dwordx2 v[80:81], v13, s[8:11], 0 offen offset:0
buffer_load_dwordx2 v[74:75], v13, s[4:7], 0 offen offset:32
buffer_load_dwordx2 v[82:83], v13, s[8:11], 0 offen offset:32
v_mov_b32 v14, 0
v_mov_b32 v15, 0
s_waitcnt vmcnt(0) lgkmcnt(0)
v_accvgpr_read_b32 v104, a0
v_accvgpr_read_b32 v105, a1
v_accvgpr_read_b32 v106, a2
v_accvgpr_read_b32 v107, a3
v_cvt_pk_bf16_f32 v110, v104, v105
v_lshlrev_b32 v104, 16, v110
v_and_b32 v105, 0xffff0000, v110
v_cvt_pk_bf16_f32 v110, v106, v107
v_lshlrev_b32 v106, 16, v110
v_and_b32 v107, 0xffff0000, v110
v_lshlrev_b32 v112, 16, v72
v_and_b32 v113, 0xffff0000, v72
v_lshlrev_b32 v114, 16, v73
v_and_b32 v115, 0xffff0000, v73
v_lshlrev_b32 v116, 16, v80
v_and_b32 v117, 0xffff0000, v80
v_lshlrev_b32 v118, 16, v81
v_and_b32 v119, 0xffff0000, v81
v_add_f32 v104, v104, v116
v_add_f32 v105, v105, v117
v_add_f32 v106, v106, v118
v_add_f32 v107, v107, v119
v_cvt_pk_bf16_f32 v110, v104, v105
v_lshlrev_b32 v104, 16, v110
v_and_b32 v105, 0xffff0000, v110
v_cvt_pk_bf16_f32 v110, v106, v107
v_lshlrev_b32 v106, 16, v110
v_and_b32 v107, 0xffff0000, v110
v_add_f32 v104, v104, v112
v_add_f32 v105, v105, v113
v_add_f32 v106, v106, v114
v_add_f32 v107, v107, v115
v_cvt_pk_bf16_f32 v108, v104, v105
v_lshlrev_b32 v104, 16, v108
v_and_b32 v105, 0xffff0000, v108
v_cvt_pk_bf16_f32 v109, v106, v107
v_lshlrev_b32 v106, 16, v109
v_and_b32 v107, 0xffff0000, v109
v_add_f32 v14, v14, v104
v_fmac_f32 v15, v104, v104
v_add_f32 v14, v14, v105
v_fmac_f32 v15, v105, v105
v_add_f32 v14, v14, v106
v_fmac_f32 v15, v106, v106
v_add_f32 v14, v14, v107
v_fmac_f32 v15, v107, v107
buffer_store_dwordx2 v[108:109], v13, s[12:15], 0 offen offset:0
s_nop 1
v_accvgpr_read_b32 v104, a4
v_accvgpr_read_b32 v105, a5
v_accvgpr_read_b32 v106, a6
v_accvgpr_read_b32 v107, a7
v_cvt_pk_bf16_f32 v110, v104, v105
v_lshlrev_b32 v104, 16, v110
v_and_b32 v105, 0xffff0000, v110
v_cvt_pk_bf16_f32 v110, v106, v107
v_lshlrev_b32 v106, 16, v110
v_and_b32 v107, 0xffff0000, v110
v_lshlrev_b32 v112, 16, v74
v_and_b32 v113, 0xffff0000, v74
v_lshlrev_b32 v114, 16, v75
v_and_b32 v115, 0xffff0000, v75
v_lshlrev_b32 v116, 16, v82
v_and_b32 v117, 0xffff0000, v82
v_lshlrev_b32 v118, 16, v83
v_and_b32 v119, 0xffff0000, v83
v_add_f32 v104, v104, v116
v_add_f32 v105, v105, v117
v_add_f32 v106, v106, v118
v_add_f32 v107, v107, v119
v_cvt_pk_bf16_f32 v110, v104, v105
v_lshlrev_b32 v104, 16, v110
v_and_b32 v105, 0xffff0000, v110
v_cvt_pk_bf16_f32 v110, v106, v107
v_lshlrev_b32 v106, 16, v110
v_and_b32 v107, 0xffff0000, v110
v_add_f32 v104, v104, v112
v_add_f32 v105, v105, v113
v_add_f32 v106, v106, v114
v_add_f32 v107, v107, v115
v_cvt_pk_bf16_f32 v108, v104, v105
v_lshlrev_b32 v104, 16, v108
v_and_b32 v105, 0xffff0000, v108
v_cvt_pk_bf16_f32 v109, v106, v107
v_lshlrev_b32 v106, 16, v109
v_and_b32 v107, 0xffff0000, v109
v_add_f32 v14, v14, v104
v_fmac_f32 v15, v104, v104
v_add_f32 v14, v14, v105
v_fmac_f32 v15, v105, v105
v_add_f32 v14, v14, v106
v_fmac_f32 v15, v106, v106
v_add_f32 v14, v14, v107
v_fmac_f32 v15, v107, v107
buffer_store_dwordx2 v[108:109], v13, s[12:15], 0 offen offset:32
s_nop 1
ds_bpermute_b32 v16, v60, v14
ds_bpermute_b32 v17, v60, v15
s_waitcnt lgkmcnt(0)
v_add_f32 v14, v14, v16
v_add_f32 v15, v15, v17
ds_bpermute_b32 v16, v61, v14
ds_bpermute_b32 v17, v61, v15
s_waitcnt lgkmcnt(0)
v_add_f32 v14, v14, v16
v_add_f32 v15, v15, v17
v_add_u32 v16, 0, v9
v_lshlrev_b32 v16, 8, v16
s_lshl_b32 s25, s23, 4
v_add_u32 v16, s25, v16
v_lshl_add_u32 v16, v7, 3, v16
v_cmp_gt_u32 vcc, 16, v1
s_and_saveexec_b64 s[30:31], vcc
buffer_store_dwordx2 v[14:15], v16, s[16:19], 0 offen
s_mov_b64 exec, s[30:31]
s_nop 1
v_add_u32 v13, 32768, v11
buffer_load_dwordx2 v[72:73], v13, s[4:7], 0 offen offset:0
buffer_load_dwordx2 v[80:81], v13, s[8:11], 0 offen offset:0
buffer_load_dwordx2 v[74:75], v13, s[4:7], 0 offen offset:32
buffer_load_dwordx2 v[82:83], v13, s[8:11], 0 offen offset:32
v_mov_b32 v14, 0
v_mov_b32 v15, 0
s_waitcnt vmcnt(0) lgkmcnt(0)
v_accvgpr_read_b32 v104, a8
v_accvgpr_read_b32 v105, a9
v_accvgpr_read_b32 v106, a10
v_accvgpr_read_b32 v107, a11
v_cvt_pk_bf16_f32 v110, v104, v105
v_lshlrev_b32 v104, 16, v110
v_and_b32 v105, 0xffff0000, v110
v_cvt_pk_bf16_f32 v110, v106, v107
v_lshlrev_b32 v106, 16, v110
v_and_b32 v107, 0xffff0000, v110
v_lshlrev_b32 v112, 16, v72
v_and_b32 v113, 0xffff0000, v72
v_lshlrev_b32 v114, 16, v73
v_and_b32 v115, 0xffff0000, v73
v_lshlrev_b32 v116, 16, v80
v_and_b32 v117, 0xffff0000, v80
v_lshlrev_b32 v118, 16, v81
v_and_b32 v119, 0xffff0000, v81
v_add_f32 v104, v104, v116
v_add_f32 v105, v105, v117
v_add_f32 v106, v106, v118
v_add_f32 v107, v107, v119
v_cvt_pk_bf16_f32 v110, v104, v105
v_lshlrev_b32 v104, 16, v110
v_and_b32 v105, 0xffff0000, v110
v_cvt_pk_bf16_f32 v110, v106, v107
v_lshlrev_b32 v106, 16, v110
v_and_b32 v107, 0xffff0000, v110
v_add_f32 v104, v104, v112
v_add_f32 v105, v105, v113
v_add_f32 v106, v106, v114
v_add_f32 v107, v107, v115
v_cvt_pk_bf16_f32 v108, v104, v105
v_lshlrev_b32 v104, 16, v108
v_and_b32 v105, 0xffff0000, v108
v_cvt_pk_bf16_f32 v109, v106, v107
v_lshlrev_b32 v106, 16, v109
v_and_b32 v107, 0xffff0000, v109
v_add_f32 v14, v14, v104
v_fmac_f32 v15, v104, v104
v_add_f32 v14, v14, v105
v_fmac_f32 v15, v105, v105
v_add_f32 v14, v14, v106
v_fmac_f32 v15, v106, v106
v_add_f32 v14, v14, v107
v_fmac_f32 v15, v107, v107
buffer_store_dwordx2 v[108:109], v13, s[12:15], 0 offen offset:0
s_nop 1
v_accvgpr_read_b32 v104, a12
v_accvgpr_read_b32 v105, a13
v_accvgpr_read_b32 v106, a14
v_accvgpr_read_b32 v107, a15
v_cvt_pk_bf16_f32 v110, v104, v105
v_lshlrev_b32 v104, 16, v110
v_and_b32 v105, 0xffff0000, v110
v_cvt_pk_bf16_f32 v110, v106, v107
v_lshlrev_b32 v106, 16, v110
v_and_b32 v107, 0xffff0000, v110
v_lshlrev_b32 v112, 16, v74
v_and_b32 v113, 0xffff0000, v74
v_lshlrev_b32 v114, 16, v75
v_and_b32 v115, 0xffff0000, v75
v_lshlrev_b32 v116, 16, v82
v_and_b32 v117, 0xffff0000, v82
v_lshlrev_b32 v118, 16, v83
v_and_b32 v119, 0xffff0000, v83
v_add_f32 v104, v104, v116
v_add_f32 v105, v105, v117
v_add_f32 v106, v106, v118
v_add_f32 v107, v107, v119
v_cvt_pk_bf16_f32 v110, v104, v105
v_lshlrev_b32 v104, 16, v110
v_and_b32 v105, 0xffff0000, v110
v_cvt_pk_bf16_f32 v110, v106, v107
v_lshlrev_b32 v106, 16, v110
v_and_b32 v107, 0xffff0000, v110
v_add_f32 v104, v104, v112
v_add_f32 v105, v105, v113
v_add_f32 v106, v106, v114
v_add_f32 v107, v107, v115
v_cvt_pk_bf16_f32 v108, v104, v105
v_lshlrev_b32 v104, 16, v108
v_and_b32 v105, 0xffff0000, v108
v_cvt_pk_bf16_f32 v109, v106, v107
v_lshlrev_b32 v106, 16, v109
v_and_b32 v107, 0xffff0000, v109
v_add_f32 v14, v14, v104
v_fmac_f32 v15, v104, v104
v_add_f32 v14, v14, v105
v_fmac_f32 v15, v105, v105
v_add_f32 v14, v14, v106
v_fmac_f32 v15, v106, v106
v_add_f32 v14, v14, v107
v_fmac_f32 v15, v107, v107
buffer_store_dwordx2 v[108:109], v13, s[12:15], 0 offen offset:32
s_nop 1
ds_bpermute_b32 v16, v60, v14
ds_bpermute_b32 v17, v60, v15
s_waitcnt lgkmcnt(0)
v_add_f32 v14, v14, v16
v_add_f32 v15, v15, v17
ds_bpermute_b32 v16, v61, v14
ds_bpermute_b32 v17, v61, v15
s_waitcnt lgkmcnt(0)
v_add_f32 v14, v14, v16
v_add_f32 v15, v15, v17
v_add_u32 v16, 16, v9
v_lshlrev_b32 v16, 8, v16
s_lshl_b32 s25, s23, 4
v_add_u32 v16, s25, v16
v_lshl_add_u32 v16, v7, 3, v16
v_cmp_gt_u32 vcc, 16, v1
s_and_saveexec_b64 s[30:31], vcc
buffer_store_dwordx2 v[14:15], v16, s[16:19], 0 offen
s_mov_b64 exec, s[30:31]
s_nop 1
v_add_u32 v13, 65536, v11
buffer_load_dwordx2 v[72:73], v13, s[4:7], 0 offen offset:0
buffer_load_dwordx2 v[80:81], v13, s[8:11], 0 offen offset:0
buffer_load_dwordx2 v[74:75], v13, s[4:7], 0 offen offset:32
buffer_load_dwordx2 v[82:83], v13, s[8:11], 0 offen offset:32
v_mov_b32 v14, 0
v_mov_b32 v15, 0
s_waitcnt vmcnt(0) lgkmcnt(0)
v_accvgpr_read_b32 v104, a16
v_accvgpr_read_b32 v105, a17
v_accvgpr_read_b32 v106, a18
v_accvgpr_read_b32 v107, a19
v_cvt_pk_bf16_f32 v110, v104, v105
v_lshlrev_b32 v104, 16, v110
v_and_b32 v105, 0xffff0000, v110
v_cvt_pk_bf16_f32 v110, v106, v107
v_lshlrev_b32 v106, 16, v110
v_and_b32 v107, 0xffff0000, v110
v_lshlrev_b32 v112, 16, v72
v_and_b32 v113, 0xffff0000, v72
v_lshlrev_b32 v114, 16, v73
v_and_b32 v115, 0xffff0000, v73
v_lshlrev_b32 v116, 16, v80
v_and_b32 v117, 0xffff0000, v80
v_lshlrev_b32 v118, 16, v81
v_and_b32 v119, 0xffff0000, v81
v_add_f32 v104, v104, v116
v_add_f32 v105, v105, v117
v_add_f32 v106, v106, v118
v_add_f32 v107, v107, v119
v_cvt_pk_bf16_f32 v110, v104, v105
v_lshlrev_b32 v104, 16, v110
v_and_b32 v105, 0xffff0000, v110
v_cvt_pk_bf16_f32 v110, v106, v107
v_lshlrev_b32 v106, 16, v110
v_and_b32 v107, 0xffff0000, v110
v_add_f32 v104, v104, v112
v_add_f32 v105, v105, v113
v_add_f32 v106, v106, v114
v_add_f32 v107, v107, v115
v_cvt_pk_bf16_f32 v108, v104, v105
v_lshlrev_b32 v104, 16, v108
v_and_b32 v105, 0xffff0000, v108
v_cvt_pk_bf16_f32 v109, v106, v107
v_lshlrev_b32 v106, 16, v109
v_and_b32 v107, 0xffff0000, v109
v_add_f32 v14, v14, v104
v_fmac_f32 v15, v104, v104
v_add_f32 v14, v14, v105
v_fmac_f32 v15, v105, v105
v_add_f32 v14, v14, v106
v_fmac_f32 v15, v106, v106
v_add_f32 v14, v14, v107
v_fmac_f32 v15, v107, v107
buffer_store_dwordx2 v[108:109], v13, s[12:15], 0 offen offset:0
s_nop 1
v_accvgpr_read_b32 v104, a20
v_accvgpr_read_b32 v105, a21
v_accvgpr_read_b32 v106, a22
v_accvgpr_read_b32 v107, a23
v_cvt_pk_bf16_f32 v110, v104, v105
v_lshlrev_b32 v104, 16, v110
v_and_b32 v105, 0xffff0000, v110
v_cvt_pk_bf16_f32 v110, v106, v107
v_lshlrev_b32 v106, 16, v110
v_and_b32 v107, 0xffff0000, v110
v_lshlrev_b32 v112, 16, v74
v_and_b32 v113, 0xffff0000, v74
v_lshlrev_b32 v114, 16, v75
v_and_b32 v115, 0xffff0000, v75
v_lshlrev_b32 v116, 16, v82
v_and_b32 v117, 0xffff0000, v82
v_lshlrev_b32 v118, 16, v83
v_and_b32 v119, 0xffff0000, v83
v_add_f32 v104, v104, v116
v_add_f32 v105, v105, v117
v_add_f32 v106, v106, v118
v_add_f32 v107, v107, v119
v_cvt_pk_bf16_f32 v110, v104, v105
v_lshlrev_b32 v104, 16, v110
v_and_b32 v105, 0xffff0000, v110
v_cvt_pk_bf16_f32 v110, v106, v107
v_lshlrev_b32 v106, 16, v110
v_and_b32 v107, 0xffff0000, v110
v_add_f32 v104, v104, v112
v_add_f32 v105, v105, v113
v_add_f32 v106, v106, v114
v_add_f32 v107, v107, v115
v_cvt_pk_bf16_f32 v108, v104, v105
v_lshlrev_b32 v104, 16, v108
v_and_b32 v105, 0xffff0000, v108
v_cvt_pk_bf16_f32 v109, v106, v107
v_lshlrev_b32 v106, 16, v109
v_and_b32 v107, 0xffff0000, v109
v_add_f32 v14, v14, v104
v_fmac_f32 v15, v104, v104
v_add_f32 v14, v14, v105
v_fmac_f32 v15, v105, v105
v_add_f32 v14, v14, v106
v_fmac_f32 v15, v106, v106
v_add_f32 v14, v14, v107
v_fmac_f32 v15, v107, v107
buffer_store_dwordx2 v[108:109], v13, s[12:15], 0 offen offset:32
s_nop 1
ds_bpermute_b32 v16, v60, v14
ds_bpermute_b32 v17, v60, v15
s_waitcnt lgkmcnt(0)
v_add_f32 v14, v14, v16
v_add_f32 v15, v15, v17
ds_bpermute_b32 v16, v61, v14
ds_bpermute_b32 v17, v61, v15
s_waitcnt lgkmcnt(0)
v_add_f32 v14, v14, v16
v_add_f32 v15, v15, v17
v_add_u32 v16, 32, v9
v_lshlrev_b32 v16, 8, v16
s_lshl_b32 s25, s23, 4
v_add_u32 v16, s25, v16
v_lshl_add_u32 v16, v7, 3, v16
v_cmp_gt_u32 vcc, 16, v1
s_and_saveexec_b64 s[30:31], vcc
buffer_store_dwordx2 v[14:15], v16, s[16:19], 0 offen
s_mov_b64 exec, s[30:31]
s_nop 1
v_add_u32 v13, 98304, v11
buffer_load_dwordx2 v[72:73], v13, s[4:7], 0 offen offset:0
buffer_load_dwordx2 v[80:81], v13, s[8:11], 0 offen offset:0
buffer_load_dwordx2 v[74:75], v13, s[4:7], 0 offen offset:32
buffer_load_dwordx2 v[82:83], v13, s[8:11], 0 offen offset:32
v_mov_b32 v14, 0
v_mov_b32 v15, 0
s_waitcnt vmcnt(0) lgkmcnt(0)
v_accvgpr_read_b32 v104, a24
v_accvgpr_read_b32 v105, a25
v_accvgpr_read_b32 v106, a26
v_accvgpr_read_b32 v107, a27
v_cvt_pk_bf16_f32 v110, v104, v105
v_lshlrev_b32 v104, 16, v110
v_and_b32 v105, 0xffff0000, v110
v_cvt_pk_bf16_f32 v110, v106, v107
v_lshlrev_b32 v106, 16, v110
v_and_b32 v107, 0xffff0000, v110
v_lshlrev_b32 v112, 16, v72
v_and_b32 v113, 0xffff0000, v72
v_lshlrev_b32 v114, 16, v73
v_and_b32 v115, 0xffff0000, v73
v_lshlrev_b32 v116, 16, v80
v_and_b32 v117, 0xffff0000, v80
v_lshlrev_b32 v118, 16, v81
v_and_b32 v119, 0xffff0000, v81
v_add_f32 v104, v104, v116
v_add_f32 v105, v105, v117
v_add_f32 v106, v106, v118
v_add_f32 v107, v107, v119
v_cvt_pk_bf16_f32 v110, v104, v105
v_lshlrev_b32 v104, 16, v110
v_and_b32 v105, 0xffff0000, v110
v_cvt_pk_bf16_f32 v110, v106, v107
v_lshlrev_b32 v106, 16, v110
v_and_b32 v107, 0xffff0000, v110
v_add_f32 v104, v104, v112
v_add_f32 v105, v105, v113
v_add_f32 v106, v106, v114
v_add_f32 v107, v107, v115
v_cvt_pk_bf16_f32 v108, v104, v105
v_lshlrev_b32 v104, 16, v108
v_and_b32 v105, 0xffff0000, v108
v_cvt_pk_bf16_f32 v109, v106, v107
v_lshlrev_b32 v106, 16, v109
v_and_b32 v107, 0xffff0000, v109
v_add_f32 v14, v14, v104
v_fmac_f32 v15, v104, v104
v_add_f32 v14, v14, v105
v_fmac_f32 v15, v105, v105
v_add_f32 v14, v14, v106
v_fmac_f32 v15, v106, v106
v_add_f32 v14, v14, v107
v_fmac_f32 v15, v107, v107
buffer_store_dwordx2 v[108:109], v13, s[12:15], 0 offen offset:0
s_nop 1
v_accvgpr_read_b32 v104, a28
v_accvgpr_read_b32 v105, a29
v_accvgpr_read_b32 v106, a30
v_accvgpr_read_b32 v107, a31
v_cvt_pk_bf16_f32 v110, v104, v105
v_lshlrev_b32 v104, 16, v110
v_and_b32 v105, 0xffff0000, v110
v_cvt_pk_bf16_f32 v110, v106, v107
v_lshlrev_b32 v106, 16, v110
v_and_b32 v107, 0xffff0000, v110
v_lshlrev_b32 v112, 16, v74
v_and_b32 v113, 0xffff0000, v74
v_lshlrev_b32 v114, 16, v75
v_and_b32 v115, 0xffff0000, v75
v_lshlrev_b32 v116, 16, v82
v_and_b32 v117, 0xffff0000, v82
v_lshlrev_b32 v118, 16, v83
v_and_b32 v119, 0xffff0000, v83
v_add_f32 v104, v104, v116
v_add_f32 v105, v105, v117
v_add_f32 v106, v106, v118
v_add_f32 v107, v107, v119
v_cvt_pk_bf16_f32 v110, v104, v105
v_lshlrev_b32 v104, 16, v110
v_and_b32 v105, 0xffff0000, v110
v_cvt_pk_bf16_f32 v110, v106, v107
v_lshlrev_b32 v106, 16, v110
v_and_b32 v107, 0xffff0000, v110
v_add_f32 v104, v104, v112
v_add_f32 v105, v105, v113
v_add_f32 v106, v106, v114
v_add_f32 v107, v107, v115
v_cvt_pk_bf16_f32 v108, v104, v105
v_lshlrev_b32 v104, 16, v108
v_and_b32 v105, 0xffff0000, v108
v_cvt_pk_bf16_f32 v109, v106, v107
v_lshlrev_b32 v106, 16, v109
v_and_b32 v107, 0xffff0000, v109
v_add_f32 v14, v14, v104
v_fmac_f32 v15, v104, v104
v_add_f32 v14, v14, v105
v_fmac_f32 v15, v105, v105
v_add_f32 v14, v14, v106
v_fmac_f32 v15, v106, v106
v_add_f32 v14, v14, v107
v_fmac_f32 v15, v107, v107
buffer_store_dwordx2 v[108:109], v13, s[12:15], 0 offen offset:32
s_nop 1
ds_bpermute_b32 v16, v60, v14
ds_bpermute_b32 v17, v60, v15
s_waitcnt lgkmcnt(0)
v_add_f32 v14, v14, v16
v_add_f32 v15, v15, v17
ds_bpermute_b32 v16, v61, v14
ds_bpermute_b32 v17, v61, v15
s_waitcnt lgkmcnt(0)
v_add_f32 v14, v14, v16
v_add_f32 v15, v15, v17
v_add_u32 v16, 48, v9
v_lshlrev_b32 v16, 8, v16
s_lshl_b32 s25, s23, 4
v_add_u32 v16, s25, v16
v_lshl_add_u32 v16, v7, 3, v16
v_cmp_gt_u32 vcc, 16, v1
s_and_saveexec_b64 s[30:31], vcc
buffer_store_dwordx2 v[14:15], v16, s[16:19], 0 offen
s_mov_b64 exec, s[30:31]
s_nop 1
w4a_kernel_end:
s_endpgm
.globl w4b_kernel
.p2align 8
.type w4b_kernel,@function
w4b_kernel:
s_cmp_ge_u32 s2, 256
s_cbranch_scc1 w4b_kernel_end
s_load_dwordx2 s[4:5], s[0:1], 88
s_load_dwordx2 s[8:9], s[0:1], 64
s_and_b32 s20, s2, 7
s_lshr_b32 s21, s2, 3
s_lshr_b32 s22, s20, 1
s_lshl_b32 s22, s22, 2
s_and_b32 s23, s21, 3
s_add_u32 s22, s22, s23
s_and_b32 s23, s20, 1
s_lshl_b32 s23, s23, 3
s_lshr_b32 s24, s21, 2
s_add_u32 s23, s23, s24
v_and_b32 v1, 63, v0
v_lshrrev_b32 v2, 6, v0
s_waitcnt lgkmcnt(0)
s_add_u32 s4, s4, 25165824
s_addc_u32 s5, s5, 0
s_mov_b32 s6, 14680064
s_mov_b32 s7, 0x00020000
s_mov_b32 s10, 7340032
s_mov_b32 s11, 0x00020000
v_lshrrev_b32 v3, 3, v1
v_and_b32 v4, 7, v1
v_xor_b32 v4, v4, v3
v_lshlrev_b32 v4, 4, v4
s_lshl_b32 s25, s22, 7
v_lshlrev_b32 v5, 5, v2
v_add_u32 v5, s25, v5
v_add_u32 v5, v5, v3
s_mov_b32 s26, 7168
v_mul_lo_u32 v5, v5, s26
v_add_u32 v10, v5, v4
v_add_u32 v11, 57344, v10
v_add_u32 v12, 114688, v10
v_add_u32 v13, 172032, v10
v_mul_u32_u24 v3, 128, v2
v_add_u32 v3, 0, v3
v_add_u32 v3, v3, v1
v_mul_u32_u24 v4, 8192, v3
v_lshrrev_b32 v4, 16, v4
v_mul_u32_u24 v5, 8, v4
v_sub_u32 v5, v3, v5
v_bfe_u32 v6, v4, 3, 1
v_bfe_u32 v7, v4, 1, 1
v_lshl_or_b32 v6, v7, 1, v6
v_lshlrev_b32 v6, 1, v6
v_xor_b32 v5, v5, v6
s_mul_i32 s25, s23, 128
v_lshlrev_b32 v9, 4, v5
v_add_u32 v9, s25, v9
v_mul_u32_u24 v4, 2048, v4
v_add_u32 v14, v4, v9
v_mul_u32_u24 v3, 128, v2
v_add_u32 v3, 64, v3
v_add_u32 v3, v3, v1
v_mul_u32_u24 v4, 8192, v3
v_lshrrev_b32 v4, 16, v4
v_mul_u32_u24 v5, 8, v4
v_sub_u32 v5, v3, v5
v_bfe_u32 v6, v4, 3, 1
v_bfe_u32 v7, v4, 1, 1
v_lshl_or_b32 v6, v7, 1, v6
v_lshlrev_b32 v6, 1, v6
v_xor_b32 v5, v5, v6
s_mul_i32 s25, s23, 128
v_lshlrev_b32 v9, 4, v5
v_add_u32 v9, s25, v9
v_mul_u32_u24 v4, 2048, v4
v_add_u32 v15, v4, v9
v_lshrrev_b32 v3, 1, v2
v_lshlrev_b32 v3, 6, v3
v_and_b32 v4, 15, v1
v_add_u32 v3, v3, v4
v_lshlrev_b32 v3, 7, v3
v_lshrrev_b32 v5, 4, v1
v_and_b32 v6, 7, v1
v_xor_b32 v5, v5, v6
v_lshlrev_b32 v5, 4, v5
v_add_u32 v21, v3, v5
v_xor_b32 v22, 64, v21
v_lshrrev_b32 v3, 4, v1
v_bfe_u32 v4, v1, 2, 2
v_lshl_add_u32 v5, v3, 3, v4
v_mul_u32_u24 v5, 128, v5
v_and_b32 v6, 3, v1
v_lshl_add_u32 v5, v6, 3, v5
v_add_u32 v5, 16384, v5
v_and_b32 v6, 1, v3
v_bfe_u32 v7, v1, 3, 1
v_lshl_or_b32 v6, v7, 1, v6
v_and_b32 v7, 1, v2
v_mul_u32_u24 v7, 2, v7
v_add_u32 v8, 0, v7
v_xor_b32 v8, v8, v6
v_lshl_add_u32 v25, v8, 5, v5
v_add_u32 v8, 1, v7
v_xor_b32 v8, v8, v6
v_lshl_add_u32 v26, v8, 5, v5
v_accvgpr_write_b32 a0, 0
v_accvgpr_write_b32 a1, 0
v_accvgpr_write_b32 a2, 0
v_accvgpr_write_b32 a3, 0
v_accvgpr_write_b32 a4, 0
v_accvgpr_write_b32 a5, 0
v_accvgpr_write_b32 a6, 0
v_accvgpr_write_b32 a7, 0
v_accvgpr_write_b32 a8, 0
v_accvgpr_write_b32 a9, 0
v_accvgpr_write_b32 a10, 0
v_accvgpr_write_b32 a11, 0
v_accvgpr_write_b32 a12, 0
v_accvgpr_write_b32 a13, 0
v_accvgpr_write_b32 a14, 0
v_accvgpr_write_b32 a15, 0
v_accvgpr_write_b32 a16, 0
v_accvgpr_write_b32 a17, 0
v_accvgpr_write_b32 a18, 0
v_accvgpr_write_b32 a19, 0
v_accvgpr_write_b32 a20, 0
v_accvgpr_write_b32 a21, 0
v_accvgpr_write_b32 a22, 0
v_accvgpr_write_b32 a23, 0
v_accvgpr_write_b32 a24, 0
v_accvgpr_write_b32 a25, 0
v_accvgpr_write_b32 a26, 0
v_accvgpr_write_b32 a27, 0
v_accvgpr_write_b32 a28, 0
v_accvgpr_write_b32 a29, 0
v_accvgpr_write_b32 a30, 0
v_accvgpr_write_b32 a31, 0
v_readfirstlane_b32 s27, v2
s_nop 3
s_mul_i32 s28, s27, 2048
s_lshl_b32 s27, s27, 12
s_mov_b32 s16, 0
s_mov_b32 s17, 0
s_add_u32 m0, s27, 0
s_nop 0
buffer_load_dwordx4 v10, s[4:7], s16 offen lds
s_add_u32 m0, s27, 1024
s_nop 0
buffer_load_dwordx4 v11, s[4:7], s16 offen lds
s_add_u32 m0, s27, 2048
s_nop 0
buffer_load_dwordx4 v12, s[4:7], s16 offen lds
s_add_u32 m0, s27, 3072
s_nop 0
buffer_load_dwordx4 v13, s[4:7], s16 offen lds
s_add_u32 m0, s28, 16384
s_nop 0
buffer_load_dwordx4 v14, s[8:11], s17 offen lds
s_add_u32 m0, s28, 17408
s_nop 0
buffer_load_dwordx4 v15, s[8:11], s17 offen lds
s_add_u32 s16, s16, 128
s_add_u32 s17, s17, 131072
s_add_u32 m0, s27, 24576
s_nop 0
buffer_load_dwordx4 v10, s[4:7], s16 offen lds
s_add_u32 m0, s27, 25600
s_nop 0
buffer_load_dwordx4 v11, s[4:7], s16 offen lds
s_add_u32 m0, s27, 26624
s_nop 0
buffer_load_dwordx4 v12, s[4:7], s16 offen lds
s_add_u32 m0, s27, 27648
s_nop 0
buffer_load_dwordx4 v13, s[4:7], s16 offen lds
s_add_u32 m0, s28, 40960
s_nop 0
buffer_load_dwordx4 v14, s[8:11], s17 offen lds
s_add_u32 m0, s28, 41984
s_nop 0
buffer_load_dwordx4 v15, s[8:11], s17 offen lds
s_add_u32 s16, s16, 128
s_add_u32 s17, s17, 131072
s_add_u32 m0, s27, 49152
s_nop 0
buffer_load_dwordx4 v10, s[4:7], s16 offen lds
s_add_u32 m0, s27, 50176
s_nop 0
buffer_load_dwordx4 v11, s[4:7], s16 offen lds
s_add_u32 m0, s27, 51200
s_nop 0
buffer_load_dwordx4 v12, s[4:7], s16 offen lds
s_add_u32 m0, s27, 52224
s_nop 0
buffer_load_dwordx4 v13, s[4:7], s16 offen lds
s_add_u32 m0, s28, 65536
s_nop 0
buffer_load_dwordx4 v14, s[8:11], s17 offen lds
s_add_u32 m0, s28, 66560
s_nop 0
buffer_load_dwordx4 v15, s[8:11], s17 offen lds
s_add_u32 s16, s16, 128
s_add_u32 s17, s17, 131072
s_waitcnt vmcnt(12) lgkmcnt(0)
s_barrier
v_add_u32 v23, 0, v21
v_add_u32 v32, 0, v25
v_add_u32 v33, 0, v26
ds_read_b128 v[40:43], v23 offset:0
ds_read_b128 v[44:47], v23 offset:2048
ds_read_b128 v[48:51], v23 offset:4096
ds_read_b128 v[52:55], v23 offset:6144
ds_read_b64_tr_b16 v[56:57], v32 offset:0
ds_read_b64_tr_b16 v[58:59], v32 offset:512
ds_read_b64_tr_b16 v[60:61], v33 offset:0
ds_read_b64_tr_b16 v[62:63], v33 offset:512
s_mov_b32 s18, 14
w4b_kernel_loop:
s_waitcnt lgkmcnt(0)
v_mfma_f32_16x16x32_bf16 a[0:3], v[56:59], v[40:43], a[0:3]
v_add_u32 v23, 0, v22
v_mfma_f32_16x16x32_bf16 a[8:11], v[56:59], v[44:47], a[8:11]
v_add_u32 v32, 0, v25
v_mfma_f32_16x16x32_bf16 a[16:19], v[56:59], v[48:51], a[16:19]
v_add_u32 v33, 0, v26
ds_read_b128 v[84:87], v23 offset:0
v_mfma_f32_16x16x32_bf16 a[24:27], v[56:59], v[52:55], a[24:27]
ds_read_b128 v[88:91], v23 offset:2048
v_mfma_f32_16x16x32_bf16 a[4:7], v[60:63], v[40:43], a[4:7]
ds_read_b128 v[92:95], v23 offset:4096
v_mfma_f32_16x16x32_bf16 a[12:15], v[60:63], v[44:47], a[12:15]
ds_read_b128 v[96:99], v23 offset:6144
ds_read_b64_tr_b16 v[100:101], v32 offset:4096
v_mfma_f32_16x16x32_bf16 a[20:23], v[60:63], v[48:51], a[20:23]
ds_read_b64_tr_b16 v[102:103], v32 offset:4608
v_mfma_f32_16x16x32_bf16 a[28:31], v[60:63], v[52:55], a[28:31]
ds_read_b64_tr_b16 v[104:105], v33 offset:4096
ds_read_b64_tr_b16 v[106:107], v33 offset:4608
s_waitcnt vmcnt(6)
s_barrier
s_waitcnt lgkmcnt(0)
v_mfma_f32_16x16x32_bf16 a[0:3], v[100:103], v[84:87], a[0:3]
s_add_u32 m0, s27, 73728
s_nop 0
buffer_load_dwordx4 v10, s[4:7], s16 offen lds
v_mfma_f32_16x16x32_bf16 a[8:11], v[100:103], v[88:91], a[8:11]
s_add_u32 m0, s27, 74752
s_nop 0
buffer_load_dwordx4 v11, s[4:7], s16 offen lds
s_add_u32 m0, s27, 75776
v_mfma_f32_16x16x32_bf16 a[16:19], v[100:103], v[92:95], a[16:19]
s_nop 0
buffer_load_dwordx4 v12, s[4:7], s16 offen lds
s_add_u32 m0, s27, 76800
s_nop 0
v_mfma_f32_16x16x32_bf16 a[24:27], v[100:103], v[96:99], a[24:27]
buffer_load_dwordx4 v13, s[4:7], s16 offen lds
s_add_u32 m0, s28, 90112
s_nop 0
buffer_load_dwordx4 v14, s[8:11], s17 offen lds
v_mfma_f32_16x16x32_bf16 a[4:7], v[104:107], v[84:87], a[4:7]
s_add_u32 m0, s28, 91136
s_nop 0
buffer_load_dwordx4 v15, s[8:11], s17 offen lds
s_add_u32 s16, s16, 128
v_mfma_f32_16x16x32_bf16 a[12:15], v[104:107], v[88:91], a[12:15]
s_add_u32 s17, s17, 131072
v_add_u32 v23, 24576, v21
v_add_u32 v32, 24576, v25
v_add_u32 v33, 24576, v26
v_mfma_f32_16x16x32_bf16 a[20:23], v[104:107], v[92:95], a[20:23]
ds_read_b128 v[40:43], v23 offset:0
ds_read_b128 v[44:47], v23 offset:2048
ds_read_b128 v[48:51], v23 offset:4096
ds_read_b128 v[52:55], v23 offset:6144
v_mfma_f32_16x16x32_bf16 a[28:31], v[104:107], v[96:99], a[28:31]
ds_read_b64_tr_b16 v[56:57], v32 offset:0
ds_read_b64_tr_b16 v[58:59], v32 offset:512
ds_read_b64_tr_b16 v[60:61], v33 offset:0
ds_read_b64_tr_b16 v[62:63], v33 offset:512
s_waitcnt lgkmcnt(0)
v_mfma_f32_16x16x32_bf16 a[0:3], v[56:59], v[40:43], a[0:3]
v_add_u32 v23, 24576, v22
v_mfma_f32_16x16x32_bf16 a[8:11], v[56:59], v[44:47], a[8:11]
v_add_u32 v32, 24576, v25
v_mfma_f32_16x16x32_bf16 a[16:19], v[56:59], v[48:51], a[16:19]
v_add_u32 v33, 24576, v26
ds_read_b128 v[84:87], v23 offset:0
v_mfma_f32_16x16x32_bf16 a[24:27], v[56:59], v[52:55], a[24:27]
ds_read_b128 v[88:91], v23 offset:2048
v_mfma_f32_16x16x32_bf16 a[4:7], v[60:63], v[40:43], a[4:7]
ds_read_b128 v[92:95], v23 offset:4096
v_mfma_f32_16x16x32_bf16 a[12:15], v[60:63], v[44:47], a[12:15]
ds_read_b128 v[96:99], v23 offset:6144
ds_read_b64_tr_b16 v[100:101], v32 offset:4096
v_mfma_f32_16x16x32_bf16 a[20:23], v[60:63], v[48:51], a[20:23]
ds_read_b64_tr_b16 v[102:103], v32 offset:4608
v_mfma_f32_16x16x32_bf16 a[28:31], v[60:63], v[52:55], a[28:31]
ds_read_b64_tr_b16 v[104:105], v33 offset:4096
ds_read_b64_tr_b16 v[106:107], v33 offset:4608
s_waitcnt vmcnt(6)
s_barrier
s_waitcnt lgkmcnt(0)
v_mfma_f32_16x16x32_bf16 a[0:3], v[100:103], v[84:87], a[0:3]
s_add_u32 m0, s27, 0
s_nop 0
buffer_load_dwordx4 v10, s[4:7], s16 offen lds
v_mfma_f32_16x16x32_bf16 a[8:11], v[100:103], v[88:91], a[8:11]
s_add_u32 m0, s27, 1024
s_nop 0
buffer_load_dwordx4 v11, s[4:7], s16 offen lds
s_add_u32 m0, s27, 2048
v_mfma_f32_16x16x32_bf16 a[16:19], v[100:103], v[92:95], a[16:19]
s_nop 0
buffer_load_dwordx4 v12, s[4:7], s16 offen lds
s_add_u32 m0, s27, 3072
s_nop 0
v_mfma_f32_16x16x32_bf16 a[24:27], v[100:103], v[96:99], a[24:27]
buffer_load_dwordx4 v13, s[4:7], s16 offen lds
s_add_u32 m0, s28, 16384
s_nop 0
buffer_load_dwordx4 v14, s[8:11], s17 offen lds
v_mfma_f32_16x16x32_bf16 a[4:7], v[104:107], v[84:87], a[4:7]
s_add_u32 m0, s28, 17408
s_nop 0
buffer_load_dwordx4 v15, s[8:11], s17 offen lds
s_add_u32 s16, s16, 128
v_mfma_f32_16x16x32_bf16 a[12:15], v[104:107], v[88:91], a[12:15]
s_add_u32 s17, s17, 131072
v_add_u32 v23, 49152, v21
v_add_u32 v32, 49152, v25
v_add_u32 v33, 49152, v26
v_mfma_f32_16x16x32_bf16 a[20:23], v[104:107], v[92:95], a[20:23]
ds_read_b128 v[40:43], v23 offset:0
ds_read_b128 v[44:47], v23 offset:2048
ds_read_b128 v[48:51], v23 offset:4096
ds_read_b128 v[52:55], v23 offset:6144
v_mfma_f32_16x16x32_bf16 a[28:31], v[104:107], v[96:99], a[28:31]
ds_read_b64_tr_b16 v[56:57], v32 offset:0
ds_read_b64_tr_b16 v[58:59], v32 offset:512
ds_read_b64_tr_b16 v[60:61], v33 offset:0
ds_read_b64_tr_b16 v[62:63], v33 offset:512
s_waitcnt lgkmcnt(0)
v_mfma_f32_16x16x32_bf16 a[0:3], v[56:59], v[40:43], a[0:3]
v_add_u32 v23, 49152, v22
v_mfma_f32_16x16x32_bf16 a[8:11], v[56:59], v[44:47], a[8:11]
v_add_u32 v32, 49152, v25
v_mfma_f32_16x16x32_bf16 a[16:19], v[56:59], v[48:51], a[16:19]
v_add_u32 v33, 49152, v26
ds_read_b128 v[84:87], v23 offset:0
v_mfma_f32_16x16x32_bf16 a[24:27], v[56:59], v[52:55], a[24:27]
ds_read_b128 v[88:91], v23 offset:2048
v_mfma_f32_16x16x32_bf16 a[4:7], v[60:63], v[40:43], a[4:7]
ds_read_b128 v[92:95], v23 offset:4096
v_mfma_f32_16x16x32_bf16 a[12:15], v[60:63], v[44:47], a[12:15]
ds_read_b128 v[96:99], v23 offset:6144
ds_read_b64_tr_b16 v[100:101], v32 offset:4096
v_mfma_f32_16x16x32_bf16 a[20:23], v[60:63], v[48:51], a[20:23]
ds_read_b64_tr_b16 v[102:103], v32 offset:4608
v_mfma_f32_16x16x32_bf16 a[28:31], v[60:63], v[52:55], a[28:31]
ds_read_b64_tr_b16 v[104:105], v33 offset:4096
ds_read_b64_tr_b16 v[106:107], v33 offset:4608
s_waitcnt vmcnt(6)
s_barrier
s_waitcnt lgkmcnt(0)
v_mfma_f32_16x16x32_bf16 a[0:3], v[100:103], v[84:87], a[0:3]
s_add_u32 m0, s27, 24576
s_nop 0
buffer_load_dwordx4 v10, s[4:7], s16 offen lds
v_mfma_f32_16x16x32_bf16 a[8:11], v[100:103], v[88:91], a[8:11]
s_add_u32 m0, s27, 25600
s_nop 0
buffer_load_dwordx4 v11, s[4:7], s16 offen lds
s_add_u32 m0, s27, 26624
v_mfma_f32_16x16x32_bf16 a[16:19], v[100:103], v[92:95], a[16:19]
s_nop 0
buffer_load_dwordx4 v12, s[4:7], s16 offen lds
s_add_u32 m0, s27, 27648
s_nop 0
v_mfma_f32_16x16x32_bf16 a[24:27], v[100:103], v[96:99], a[24:27]
buffer_load_dwordx4 v13, s[4:7], s16 offen lds
s_add_u32 m0, s28, 40960
s_nop 0
buffer_load_dwordx4 v14, s[8:11], s17 offen lds
v_mfma_f32_16x16x32_bf16 a[4:7], v[104:107], v[84:87], a[4:7]
s_add_u32 m0, s28, 41984
s_nop 0
buffer_load_dwordx4 v15, s[8:11], s17 offen lds
s_add_u32 s16, s16, 128
v_mfma_f32_16x16x32_bf16 a[12:15], v[104:107], v[88:91], a[12:15]
s_add_u32 s17, s17, 131072
v_add_u32 v23, 73728, v21
v_add_u32 v32, 73728, v25
v_add_u32 v33, 73728, v26
v_mfma_f32_16x16x32_bf16 a[20:23], v[104:107], v[92:95], a[20:23]
ds_read_b128 v[40:43], v23 offset:0
ds_read_b128 v[44:47], v23 offset:2048
ds_read_b128 v[48:51], v23 offset:4096
ds_read_b128 v[52:55], v23 offset:6144
v_mfma_f32_16x16x32_bf16 a[28:31], v[104:107], v[96:99], a[28:31]
ds_read_b64_tr_b16 v[56:57], v32 offset:0
ds_read_b64_tr_b16 v[58:59], v32 offset:512
ds_read_b64_tr_b16 v[60:61], v33 offset:0
ds_read_b64_tr_b16 v[62:63], v33 offset:512
s_waitcnt lgkmcnt(0)
v_mfma_f32_16x16x32_bf16 a[0:3], v[56:59], v[40:43], a[0:3]
v_add_u32 v23, 73728, v22
v_mfma_f32_16x16x32_bf16 a[8:11], v[56:59], v[44:47], a[8:11]
v_add_u32 v32, 73728, v25
v_mfma_f32_16x16x32_bf16 a[16:19], v[56:59], v[48:51], a[16:19]
v_add_u32 v33, 73728, v26
ds_read_b128 v[84:87], v23 offset:0
v_mfma_f32_16x16x32_bf16 a[24:27], v[56:59], v[52:55], a[24:27]
ds_read_b128 v[88:91], v23 offset:2048
v_mfma_f32_16x16x32_bf16 a[4:7], v[60:63], v[40:43], a[4:7]
ds_read_b128 v[92:95], v23 offset:4096
v_mfma_f32_16x16x32_bf16 a[12:15], v[60:63], v[44:47], a[12:15]
ds_read_b128 v[96:99], v23 offset:6144
ds_read_b64_tr_b16 v[100:101], v32 offset:4096
v_mfma_f32_16x16x32_bf16 a[20:23], v[60:63], v[48:51], a[20:23]
ds_read_b64_tr_b16 v[102:103], v32 offset:4608
v_mfma_f32_16x16x32_bf16 a[28:31], v[60:63], v[52:55], a[28:31]
ds_read_b64_tr_b16 v[104:105], v33 offset:4096
ds_read_b64_tr_b16 v[106:107], v33 offset:4608
s_waitcnt vmcnt(6)
s_barrier
s_waitcnt lgkmcnt(0)
v_mfma_f32_16x16x32_bf16 a[0:3], v[100:103], v[84:87], a[0:3]
s_add_u32 m0, s27, 49152
s_nop 0
buffer_load_dwordx4 v10, s[4:7], s16 offen lds
v_mfma_f32_16x16x32_bf16 a[8:11], v[100:103], v[88:91], a[8:11]
s_add_u32 m0, s27, 50176
s_nop 0
buffer_load_dwordx4 v11, s[4:7], s16 offen lds
s_add_u32 m0, s27, 51200
v_mfma_f32_16x16x32_bf16 a[16:19], v[100:103], v[92:95], a[16:19]
s_nop 0
buffer_load_dwordx4 v12, s[4:7], s16 offen lds
s_add_u32 m0, s27, 52224
s_nop 0
v_mfma_f32_16x16x32_bf16 a[24:27], v[100:103], v[96:99], a[24:27]
buffer_load_dwordx4 v13, s[4:7], s16 offen lds
s_add_u32 m0, s28, 65536
s_nop 0
buffer_load_dwordx4 v14, s[8:11], s17 offen lds
v_mfma_f32_16x16x32_bf16 a[4:7], v[104:107], v[84:87], a[4:7]
s_add_u32 m0, s28, 66560
s_nop 0
buffer_load_dwordx4 v15, s[8:11], s17 offen lds
s_add_u32 s16, s16, 128
v_mfma_f32_16x16x32_bf16 a[12:15], v[104:107], v[88:91], a[12:15]
s_add_u32 s17, s17, 131072
v_add_u32 v23, 0, v21
v_add_u32 v32, 0, v25
v_add_u32 v33, 0, v26
v_mfma_f32_16x16x32_bf16 a[20:23], v[104:107], v[92:95], a[20:23]
ds_read_b128 v[40:43], v23 offset:0
ds_read_b128 v[44:47], v23 offset:2048
ds_read_b128 v[48:51], v23 offset:4096
ds_read_b128 v[52:55], v23 offset:6144
v_mfma_f32_16x16x32_bf16 a[28:31], v[104:107], v[96:99], a[28:31]
ds_read_b64_tr_b16 v[56:57], v32 offset:0
ds_read_b64_tr_b16 v[58:59], v32 offset:512
ds_read_b64_tr_b16 v[60:61], v33 offset:0
ds_read_b64_tr_b16 v[62:63], v33 offset:512
s_sub_u32 s18, s18, 1
s_cmp_lg_u32 s18, 0
s_cbranch_scc1 w4b_kernel_loop
s_waitcnt vmcnt(0) lgkmcnt(0)
s_nop 15
s_nop 7
v_and_b32 v4, 15, v1
v_lshrrev_b32 v5, 4, v1
v_lshrrev_b32 v6, 1, v2
v_and_b32 v7, 1, v2
v_lshl_add_u32 v8, v6, 6, v4
s_lshl_b32 s25, s22, 7
v_add_u32 v9, s25, v8
v_xor_b32 v60, 16, v1
v_lshlrev_b32 v60, 2, v60
v_xor_b32 v61, 32, v1
v_lshlrev_b32 v61, 2, v61
s_mul_i32 s25, s23, 64
v_mul_u32_u24 v10, 32, v7
v_add_u32 v10, s25, v10
v_lshl_add_u32 v10, v5, 2, v10
s_mov_b32 s26, 1024
v_mul_lo_u32 v11, v9, s26
v_add_u32 v11, v11, v10
v_lshlrev_b32 v11, 1, v11
s_load_dwordx2 s[12:13], s[0:1], 72
s_load_dwordx2 s[4:5], s[0:1], 88
s_load_dwordx2 s[8:9], s[0:1], 88
s_load_dwordx2 s[16:17], s[0:1], 88
s_waitcnt lgkmcnt(0)
s_mov_b32 s14, 4194304
s_mov_b32 s15, 0x00020000
s_mov_b32 s6, 4194304
s_mov_b32 s7, 0x00020000
s_add_u32 s8, s8, 20971520
s_addc_u32 s9, s9, 0
s_mov_b32 s10, 4194304
s_mov_b32 s11, 0x00020000
s_add_u32 s16, s16, 52428800
s_addc_u32 s17, s17, 0
s_mov_b32 s18, 524288
s_mov_b32 s19, 0x00020000
v_add_u32 v13, 0, v11
buffer_load_dwordx2 v[72:73], v13, s[4:7], 0 offen offset:0
buffer_load_dwordx2 v[80:81], v13, s[8:11], 0 offen offset:0
buffer_load_dwordx2 v[74:75], v13, s[4:7], 0 offen offset:32
buffer_load_dwordx2 v[82:83], v13, s[8:11], 0 offen offset:32
v_mov_b32 v14, 0
v_mov_b32 v15, 0
s_waitcnt vmcnt(0) lgkmcnt(0)
v_accvgpr_read_b32 v104, a0
v_accvgpr_read_b32 v105, a1
v_accvgpr_read_b32 v106, a2
v_accvgpr_read_b32 v107, a3
v_cvt_pk_bf16_f32 v110, v104, v105
v_lshlrev_b32 v104, 16, v110
v_and_b32 v105, 0xffff0000, v110
v_cvt_pk_bf16_f32 v110, v106, v107
v_lshlrev_b32 v106, 16, v110
v_and_b32 v107, 0xffff0000, v110
v_lshlrev_b32 v112, 16, v72
v_and_b32 v113, 0xffff0000, v72
v_lshlrev_b32 v114, 16, v73
v_and_b32 v115, 0xffff0000, v73
v_lshlrev_b32 v116, 16, v80
v_and_b32 v117, 0xffff0000, v80
v_lshlrev_b32 v118, 16, v81
v_and_b32 v119, 0xffff0000, v81
v_add_f32 v104, v104, v116
v_add_f32 v105, v105, v117
v_add_f32 v106, v106, v118
v_add_f32 v107, v107, v119
v_cvt_pk_bf16_f32 v110, v104, v105
v_lshlrev_b32 v104, 16, v110
v_and_b32 v105, 0xffff0000, v110
v_cvt_pk_bf16_f32 v110, v106, v107
v_lshlrev_b32 v106, 16, v110
v_and_b32 v107, 0xffff0000, v110
v_add_f32 v104, v104, v112
v_add_f32 v105, v105, v113
v_add_f32 v106, v106, v114
v_add_f32 v107, v107, v115
v_cvt_pk_bf16_f32 v108, v104, v105
v_lshlrev_b32 v104, 16, v108
v_and_b32 v105, 0xffff0000, v108
v_cvt_pk_bf16_f32 v109, v106, v107
v_lshlrev_b32 v106, 16, v109
v_and_b32 v107, 0xffff0000, v109
v_add_f32 v14, v14, v104
v_fmac_f32 v15, v104, v104
v_add_f32 v14, v14, v105
v_fmac_f32 v15, v105, v105
v_add_f32 v14, v14, v106
v_fmac_f32 v15, v106, v106
v_add_f32 v14, v14, v107
v_fmac_f32 v15, v107, v107
buffer_store_dwordx2 v[108:109], v13, s[12:15], 0 offen offset:0
s_nop 1
v_accvgpr_read_b32 v104, a4
v_accvgpr_read_b32 v105, a5
v_accvgpr_read_b32 v106, a6
v_accvgpr_read_b32 v107, a7
v_cvt_pk_bf16_f32 v110, v104, v105
v_lshlrev_b32 v104, 16, v110
v_and_b32 v105, 0xffff0000, v110
v_cvt_pk_bf16_f32 v110, v106, v107
v_lshlrev_b32 v106, 16, v110
v_and_b32 v107, 0xffff0000, v110
v_lshlrev_b32 v112, 16, v74
v_and_b32 v113, 0xffff0000, v74
v_lshlrev_b32 v114, 16, v75
v_and_b32 v115, 0xffff0000, v75
v_lshlrev_b32 v116, 16, v82
v_and_b32 v117, 0xffff0000, v82
v_lshlrev_b32 v118, 16, v83
v_and_b32 v119, 0xffff0000, v83
v_add_f32 v104, v104, v116
v_add_f32 v105, v105, v117
v_add_f32 v106, v106, v118
v_add_f32 v107, v107, v119
v_cvt_pk_bf16_f32 v110, v104, v105
v_lshlrev_b32 v104, 16, v110
v_and_b32 v105, 0xffff0000, v110
v_cvt_pk_bf16_f32 v110, v106, v107
v_lshlrev_b32 v106, 16, v110
v_and_b32 v107, 0xffff0000, v110
v_add_f32 v104, v104, v112
v_add_f32 v105, v105, v113
v_add_f32 v106, v106, v114
v_add_f32 v107, v107, v115
v_cvt_pk_bf16_f32 v108, v104, v105
v_lshlrev_b32 v104, 16, v108
v_and_b32 v105, 0xffff0000, v108
v_cvt_pk_bf16_f32 v109, v106, v107
v_lshlrev_b32 v106, 16, v109
v_and_b32 v107, 0xffff0000, v109
v_add_f32 v14, v14, v104
v_fmac_f32 v15, v104, v104
v_add_f32 v14, v14, v105
v_fmac_f32 v15, v105, v105
v_add_f32 v14, v14, v106
v_fmac_f32 v15, v106, v106
v_add_f32 v14, v14, v107
v_fmac_f32 v15, v107, v107
buffer_store_dwordx2 v[108:109], v13, s[12:15], 0 offen offset:32
s_nop 1
ds_bpermute_b32 v16, v60, v14
ds_bpermute_b32 v17, v60, v15
s_waitcnt lgkmcnt(0)
v_add_f32 v14, v14, v16
v_add_f32 v15, v15, v17
ds_bpermute_b32 v16, v61, v14
ds_bpermute_b32 v17, v61, v15
s_waitcnt lgkmcnt(0)
v_add_f32 v14, v14, v16
v_add_f32 v15, v15, v17
v_add_u32 v16, 0, v9
v_lshlrev_b32 v16, 8, v16
s_lshl_b32 s25, s23, 4
v_add_u32 v16, s25, v16
v_lshl_add_u32 v16, v7, 3, v16
v_cmp_gt_u32 vcc, 16, v1
s_and_saveexec_b64 s[30:31], vcc
buffer_store_dwordx2 v[14:15], v16, s[16:19], 0 offen
s_mov_b64 exec, s[30:31]
s_nop 1
v_add_u32 v13, 32768, v11
buffer_load_dwordx2 v[72:73], v13, s[4:7], 0 offen offset:0
buffer_load_dwordx2 v[80:81], v13, s[8:11], 0 offen offset:0
buffer_load_dwordx2 v[74:75], v13, s[4:7], 0 offen offset:32
buffer_load_dwordx2 v[82:83], v13, s[8:11], 0 offen offset:32
v_mov_b32 v14, 0
v_mov_b32 v15, 0
s_waitcnt vmcnt(0) lgkmcnt(0)
v_accvgpr_read_b32 v104, a8
v_accvgpr_read_b32 v105, a9
v_accvgpr_read_b32 v106, a10
v_accvgpr_read_b32 v107, a11
v_cvt_pk_bf16_f32 v110, v104, v105
v_lshlrev_b32 v104, 16, v110
v_and_b32 v105, 0xffff0000, v110
v_cvt_pk_bf16_f32 v110, v106, v107
v_lshlrev_b32 v106, 16, v110
v_and_b32 v107, 0xffff0000, v110
v_lshlrev_b32 v112, 16, v72
v_and_b32 v113, 0xffff0000, v72
v_lshlrev_b32 v114, 16, v73
v_and_b32 v115, 0xffff0000, v73
v_lshlrev_b32 v116, 16, v80
v_and_b32 v117, 0xffff0000, v80
v_lshlrev_b32 v118, 16, v81
v_and_b32 v119, 0xffff0000, v81
v_add_f32 v104, v104, v116
v_add_f32 v105, v105, v117
v_add_f32 v106, v106, v118
v_add_f32 v107, v107, v119
v_cvt_pk_bf16_f32 v110, v104, v105
v_lshlrev_b32 v104, 16, v110
v_and_b32 v105, 0xffff0000, v110
v_cvt_pk_bf16_f32 v110, v106, v107
v_lshlrev_b32 v106, 16, v110
v_and_b32 v107, 0xffff0000, v110
v_add_f32 v104, v104, v112
v_add_f32 v105, v105, v113
v_add_f32 v106, v106, v114
v_add_f32 v107, v107, v115
v_cvt_pk_bf16_f32 v108, v104, v105
v_lshlrev_b32 v104, 16, v108
v_and_b32 v105, 0xffff0000, v108
v_cvt_pk_bf16_f32 v109, v106, v107
v_lshlrev_b32 v106, 16, v109
v_and_b32 v107, 0xffff0000, v109
v_add_f32 v14, v14, v104
v_fmac_f32 v15, v104, v104
v_add_f32 v14, v14, v105
v_fmac_f32 v15, v105, v105
v_add_f32 v14, v14, v106
v_fmac_f32 v15, v106, v106
v_add_f32 v14, v14, v107
v_fmac_f32 v15, v107, v107
buffer_store_dwordx2 v[108:109], v13, s[12:15], 0 offen offset:0
s_nop 1
v_accvgpr_read_b32 v104, a12
v_accvgpr_read_b32 v105, a13
v_accvgpr_read_b32 v106, a14
v_accvgpr_read_b32 v107, a15
v_cvt_pk_bf16_f32 v110, v104, v105
v_lshlrev_b32 v104, 16, v110
v_and_b32 v105, 0xffff0000, v110
v_cvt_pk_bf16_f32 v110, v106, v107
v_lshlrev_b32 v106, 16, v110
v_and_b32 v107, 0xffff0000, v110
v_lshlrev_b32 v112, 16, v74
v_and_b32 v113, 0xffff0000, v74
v_lshlrev_b32 v114, 16, v75
v_and_b32 v115, 0xffff0000, v75
v_lshlrev_b32 v116, 16, v82
v_and_b32 v117, 0xffff0000, v82
v_lshlrev_b32 v118, 16, v83
v_and_b32 v119, 0xffff0000, v83
v_add_f32 v104, v104, v116
v_add_f32 v105, v105, v117
v_add_f32 v106, v106, v118
v_add_f32 v107, v107, v119
v_cvt_pk_bf16_f32 v110, v104, v105
v_lshlrev_b32 v104, 16, v110
v_and_b32 v105, 0xffff0000, v110
v_cvt_pk_bf16_f32 v110, v106, v107
v_lshlrev_b32 v106, 16, v110
v_and_b32 v107, 0xffff0000, v110
v_add_f32 v104, v104, v112
v_add_f32 v105, v105, v113
v_add_f32 v106, v106, v114
v_add_f32 v107, v107, v115
v_cvt_pk_bf16_f32 v108, v104, v105
v_lshlrev_b32 v104, 16, v108
v_and_b32 v105, 0xffff0000, v108
v_cvt_pk_bf16_f32 v109, v106, v107
v_lshlrev_b32 v106, 16, v109
v_and_b32 v107, 0xffff0000, v109
v_add_f32 v14, v14, v104
v_fmac_f32 v15, v104, v104
v_add_f32 v14, v14, v105
v_fmac_f32 v15, v105, v105
v_add_f32 v14, v14, v106
v_fmac_f32 v15, v106, v106
v_add_f32 v14, v14, v107
v_fmac_f32 v15, v107, v107
buffer_store_dwordx2 v[108:109], v13, s[12:15], 0 offen offset:32
s_nop 1
ds_bpermute_b32 v16, v60, v14
ds_bpermute_b32 v17, v60, v15
s_waitcnt lgkmcnt(0)
v_add_f32 v14, v14, v16
v_add_f32 v15, v15, v17
ds_bpermute_b32 v16, v61, v14
ds_bpermute_b32 v17, v61, v15
s_waitcnt lgkmcnt(0)
v_add_f32 v14, v14, v16
v_add_f32 v15, v15, v17
v_add_u32 v16, 16, v9
v_lshlrev_b32 v16, 8, v16
s_lshl_b32 s25, s23, 4
v_add_u32 v16, s25, v16
v_lshl_add_u32 v16, v7, 3, v16
v_cmp_gt_u32 vcc, 16, v1
s_and_saveexec_b64 s[30:31], vcc
buffer_store_dwordx2 v[14:15], v16, s[16:19], 0 offen
s_mov_b64 exec, s[30:31]
s_nop 1
v_add_u32 v13, 65536, v11
buffer_load_dwordx2 v[72:73], v13, s[4:7], 0 offen offset:0
buffer_load_dwordx2 v[80:81], v13, s[8:11], 0 offen offset:0
buffer_load_dwordx2 v[74:75], v13, s[4:7], 0 offen offset:32
buffer_load_dwordx2 v[82:83], v13, s[8:11], 0 offen offset:32
v_mov_b32 v14, 0
v_mov_b32 v15, 0
s_waitcnt vmcnt(0) lgkmcnt(0)
v_accvgpr_read_b32 v104, a16
v_accvgpr_read_b32 v105, a17
v_accvgpr_read_b32 v106, a18
v_accvgpr_read_b32 v107, a19
v_cvt_pk_bf16_f32 v110, v104, v105
v_lshlrev_b32 v104, 16, v110
v_and_b32 v105, 0xffff0000, v110
v_cvt_pk_bf16_f32 v110, v106, v107
v_lshlrev_b32 v106, 16, v110
v_and_b32 v107, 0xffff0000, v110
v_lshlrev_b32 v112, 16, v72
v_and_b32 v113, 0xffff0000, v72
v_lshlrev_b32 v114, 16, v73
v_and_b32 v115, 0xffff0000, v73
v_lshlrev_b32 v116, 16, v80
v_and_b32 v117, 0xffff0000, v80
v_lshlrev_b32 v118, 16, v81
v_and_b32 v119, 0xffff0000, v81
v_add_f32 v104, v104, v116
v_add_f32 v105, v105, v117
v_add_f32 v106, v106, v118
v_add_f32 v107, v107, v119
v_cvt_pk_bf16_f32 v110, v104, v105
v_lshlrev_b32 v104, 16, v110
v_and_b32 v105, 0xffff0000, v110
v_cvt_pk_bf16_f32 v110, v106, v107
v_lshlrev_b32 v106, 16, v110
v_and_b32 v107, 0xffff0000, v110
v_add_f32 v104, v104, v112
v_add_f32 v105, v105, v113
v_add_f32 v106, v106, v114
v_add_f32 v107, v107, v115
v_cvt_pk_bf16_f32 v108, v104, v105
v_lshlrev_b32 v104, 16, v108
v_and_b32 v105, 0xffff0000, v108
v_cvt_pk_bf16_f32 v109, v106, v107
v_lshlrev_b32 v106, 16, v109
v_and_b32 v107, 0xffff0000, v109
v_add_f32 v14, v14, v104
v_fmac_f32 v15, v104, v104
v_add_f32 v14, v14, v105
v_fmac_f32 v15, v105, v105
v_add_f32 v14, v14, v106
v_fmac_f32 v15, v106, v106
v_add_f32 v14, v14, v107
v_fmac_f32 v15, v107, v107
buffer_store_dwordx2 v[108:109], v13, s[12:15], 0 offen offset:0
s_nop 1
v_accvgpr_read_b32 v104, a20
v_accvgpr_read_b32 v105, a21
v_accvgpr_read_b32 v106, a22
v_accvgpr_read_b32 v107, a23
v_cvt_pk_bf16_f32 v110, v104, v105
v_lshlrev_b32 v104, 16, v110
v_and_b32 v105, 0xffff0000, v110
v_cvt_pk_bf16_f32 v110, v106, v107
v_lshlrev_b32 v106, 16, v110
v_and_b32 v107, 0xffff0000, v110
v_lshlrev_b32 v112, 16, v74
v_and_b32 v113, 0xffff0000, v74
v_lshlrev_b32 v114, 16, v75
v_and_b32 v115, 0xffff0000, v75
v_lshlrev_b32 v116, 16, v82
v_and_b32 v117, 0xffff0000, v82
v_lshlrev_b32 v118, 16, v83
v_and_b32 v119, 0xffff0000, v83
v_add_f32 v104, v104, v116
v_add_f32 v105, v105, v117
v_add_f32 v106, v106, v118
v_add_f32 v107, v107, v119
v_cvt_pk_bf16_f32 v110, v104, v105
v_lshlrev_b32 v104, 16, v110
v_and_b32 v105, 0xffff0000, v110
v_cvt_pk_bf16_f32 v110, v106, v107
v_lshlrev_b32 v106, 16, v110
v_and_b32 v107, 0xffff0000, v110
v_add_f32 v104, v104, v112
v_add_f32 v105, v105, v113
v_add_f32 v106, v106, v114
v_add_f32 v107, v107, v115
v_cvt_pk_bf16_f32 v108, v104, v105
v_lshlrev_b32 v104, 16, v108
v_and_b32 v105, 0xffff0000, v108
v_cvt_pk_bf16_f32 v109, v106, v107
v_lshlrev_b32 v106, 16, v109
v_and_b32 v107, 0xffff0000, v109
v_add_f32 v14, v14, v104
v_fmac_f32 v15, v104, v104
v_add_f32 v14, v14, v105
v_fmac_f32 v15, v105, v105
v_add_f32 v14, v14, v106
v_fmac_f32 v15, v106, v106
v_add_f32 v14, v14, v107
v_fmac_f32 v15, v107, v107
buffer_store_dwordx2 v[108:109], v13, s[12:15], 0 offen offset:32
s_nop 1
ds_bpermute_b32 v16, v60, v14
ds_bpermute_b32 v17, v60, v15
s_waitcnt lgkmcnt(0)
v_add_f32 v14, v14, v16
v_add_f32 v15, v15, v17
ds_bpermute_b32 v16, v61, v14
ds_bpermute_b32 v17, v61, v15
s_waitcnt lgkmcnt(0)
v_add_f32 v14, v14, v16
v_add_f32 v15, v15, v17
v_add_u32 v16, 32, v9
v_lshlrev_b32 v16, 8, v16
s_lshl_b32 s25, s23, 4
v_add_u32 v16, s25, v16
v_lshl_add_u32 v16, v7, 3, v16
v_cmp_gt_u32 vcc, 16, v1
s_and_saveexec_b64 s[30:31], vcc
buffer_store_dwordx2 v[14:15], v16, s[16:19], 0 offen
s_mov_b64 exec, s[30:31]
s_nop 1
v_add_u32 v13, 98304, v11
buffer_load_dwordx2 v[72:73], v13, s[4:7], 0 offen offset:0
buffer_load_dwordx2 v[80:81], v13, s[8:11], 0 offen offset:0
buffer_load_dwordx2 v[74:75], v13, s[4:7], 0 offen offset:32
buffer_load_dwordx2 v[82:83], v13, s[8:11], 0 offen offset:32
v_mov_b32 v14, 0
v_mov_b32 v15, 0
s_waitcnt vmcnt(0) lgkmcnt(0)
v_accvgpr_read_b32 v104, a24
v_accvgpr_read_b32 v105, a25
v_accvgpr_read_b32 v106, a26
v_accvgpr_read_b32 v107, a27
v_cvt_pk_bf16_f32 v110, v104, v105
v_lshlrev_b32 v104, 16, v110
v_and_b32 v105, 0xffff0000, v110
v_cvt_pk_bf16_f32 v110, v106, v107
v_lshlrev_b32 v106, 16, v110
v_and_b32 v107, 0xffff0000, v110
v_lshlrev_b32 v112, 16, v72
v_and_b32 v113, 0xffff0000, v72
v_lshlrev_b32 v114, 16, v73
v_and_b32 v115, 0xffff0000, v73
v_lshlrev_b32 v116, 16, v80
v_and_b32 v117, 0xffff0000, v80
v_lshlrev_b32 v118, 16, v81
v_and_b32 v119, 0xffff0000, v81
v_add_f32 v104, v104, v116
v_add_f32 v105, v105, v117
v_add_f32 v106, v106, v118
v_add_f32 v107, v107, v119
v_cvt_pk_bf16_f32 v110, v104, v105
v_lshlrev_b32 v104, 16, v110
v_and_b32 v105, 0xffff0000, v110
v_cvt_pk_bf16_f32 v110, v106, v107
v_lshlrev_b32 v106, 16, v110
v_and_b32 v107, 0xffff0000, v110
v_add_f32 v104, v104, v112
v_add_f32 v105, v105, v113
v_add_f32 v106, v106, v114
v_add_f32 v107, v107, v115
v_cvt_pk_bf16_f32 v108, v104, v105
v_lshlrev_b32 v104, 16, v108
v_and_b32 v105, 0xffff0000, v108
v_cvt_pk_bf16_f32 v109, v106, v107
v_lshlrev_b32 v106, 16, v109
v_and_b32 v107, 0xffff0000, v109
v_add_f32 v14, v14, v104
v_fmac_f32 v15, v104, v104
v_add_f32 v14, v14, v105
v_fmac_f32 v15, v105, v105
v_add_f32 v14, v14, v106
v_fmac_f32 v15, v106, v106
v_add_f32 v14, v14, v107
v_fmac_f32 v15, v107, v107
buffer_store_dwordx2 v[108:109], v13, s[12:15], 0 offen offset:0
s_nop 1
v_accvgpr_read_b32 v104, a28
v_accvgpr_read_b32 v105, a29
v_accvgpr_read_b32 v106, a30
v_accvgpr_read_b32 v107, a31
v_cvt_pk_bf16_f32 v110, v104, v105
v_lshlrev_b32 v104, 16, v110
v_and_b32 v105, 0xffff0000, v110
v_cvt_pk_bf16_f32 v110, v106, v107
v_lshlrev_b32 v106, 16, v110
v_and_b32 v107, 0xffff0000, v110
v_lshlrev_b32 v112, 16, v74
v_and_b32 v113, 0xffff0000, v74
v_lshlrev_b32 v114, 16, v75
v_and_b32 v115, 0xffff0000, v75
v_lshlrev_b32 v116, 16, v82
v_and_b32 v117, 0xffff0000, v82
v_lshlrev_b32 v118, 16, v83
v_and_b32 v119, 0xffff0000, v83
v_add_f32 v104, v104, v116
v_add_f32 v105, v105, v117
v_add_f32 v106, v106, v118
v_add_f32 v107, v107, v119
v_cvt_pk_bf16_f32 v110, v104, v105
v_lshlrev_b32 v104, 16, v110
v_and_b32 v105, 0xffff0000, v110
v_cvt_pk_bf16_f32 v110, v106, v107
v_lshlrev_b32 v106, 16, v110
v_and_b32 v107, 0xffff0000, v110
v_add_f32 v104, v104, v112
v_add_f32 v105, v105, v113
v_add_f32 v106, v106, v114
v_add_f32 v107, v107, v115
v_cvt_pk_bf16_f32 v108, v104, v105
v_lshlrev_b32 v104, 16, v108
v_and_b32 v105, 0xffff0000, v108
v_cvt_pk_bf16_f32 v109, v106, v107
v_lshlrev_b32 v106, 16, v109
v_and_b32 v107, 0xffff0000, v109
v_add_f32 v14, v14, v104
v_fmac_f32 v15, v104, v104
v_add_f32 v14, v14, v105
v_fmac_f32 v15, v105, v105
v_add_f32 v14, v14, v106
v_fmac_f32 v15, v106, v106
v_add_f32 v14, v14, v107
v_fmac_f32 v15, v107, v107
buffer_store_dwordx2 v[108:109], v13, s[12:15], 0 offen offset:32
s_nop 1
ds_bpermute_b32 v16, v60, v14
ds_bpermute_b32 v17, v60, v15
s_waitcnt lgkmcnt(0)
v_add_f32 v14, v14, v16
v_add_f32 v15, v15, v17
ds_bpermute_b32 v16, v61, v14
ds_bpermute_b32 v17, v61, v15
s_waitcnt lgkmcnt(0)
v_add_f32 v14, v14, v16
v_add_f32 v15, v15, v17
v_add_u32 v16, 48, v9
v_lshlrev_b32 v16, 8, v16
s_lshl_b32 s25, s23, 4
v_add_u32 v16, s25, v16
v_lshl_add_u32 v16, v7, 3, v16
v_cmp_gt_u32 vcc, 16, v1
s_and_saveexec_b64 s[30:31], vcc
buffer_store_dwordx2 v[14:15], v16, s[16:19], 0 offen
s_mov_b64 exec, s[30:31]
s_nop 1
w4b_kernel_end:
s_endpgm
.section .rodata,"a"
.p2align 6
.amdhsa_kernel prep_kernel
  .amdhsa_next_free_vgpr 512
  .amdhsa_next_free_sgpr 102
  .amdhsa_accum_offset 256
  .amdhsa_group_segment_fixed_size 0
  .amdhsa_kernarg_size 96
  .amdhsa_user_sgpr_count 2
  .amdhsa_user_sgpr_kernarg_segment_ptr 1
  .amdhsa_system_sgpr_workgroup_id_x 1
.end_amdhsa_kernel
.p2align 6
.amdhsa_kernel qkv_kernel
  .amdhsa_next_free_vgpr 512
  .amdhsa_next_free_sgpr 102
  .amdhsa_accum_offset 256
  .amdhsa_group_segment_fixed_size 0
  .amdhsa_kernarg_size 96
  .amdhsa_user_sgpr_count 2
  .amdhsa_user_sgpr_kernarg_segment_ptr 1
  .amdhsa_system_sgpr_workgroup_id_x 1
.end_amdhsa_kernel
.p2align 6
.amdhsa_kernel a3_kernel
  .amdhsa_next_free_vgpr 512
  .amdhsa_next_free_sgpr 102
  .amdhsa_accum_offset 256
  .amdhsa_group_segment_fixed_size 0
  .amdhsa_kernarg_size 96
  .amdhsa_user_sgpr_count 2
  .amdhsa_user_sgpr_kernarg_segment_ptr 1
  .amdhsa_system_sgpr_workgroup_id_x 1
.end_amdhsa_kernel
.p2align 6
.amdhsa_kernel wo_kernel
  .amdhsa_next_free_vgpr 512
  .amdhsa_next_free_sgpr 102
  .amdhsa_accum_offset 256
  .amdhsa_group_segment_fixed_size 0
  .amdhsa_kernarg_size 96
  .amdhsa_user_sgpr_count 2
  .amdhsa_user_sgpr_kernarg_segment_ptr 1
  .amdhsa_system_sgpr_workgroup_id_x 1
.end_amdhsa_kernel
.p2align 6
.amdhsa_kernel w1_kernel
  .amdhsa_next_free_vgpr 512
  .amdhsa_next_free_sgpr 102
  .amdhsa_accum_offset 256
  .amdhsa_group_segment_fixed_size 0
  .amdhsa_kernarg_size 96
  .amdhsa_user_sgpr_count 2
  .amdhsa_user_sgpr_kernarg_segment_ptr 1
  .amdhsa_system_sgpr_workgroup_id_x 1
.end_amdhsa_kernel
.p2align 6
.amdhsa_kernel w2_kernel
  .amdhsa_next_free_vgpr 512
  .amdhsa_next_free_sgpr 102
  .amdhsa_accum_offset 256
  .amdhsa_group_segment_fixed_size 0
  .amdhsa_kernarg_size 96
  .amdhsa_user_sgpr_count 2
  .amdhsa_user_sgpr_kernarg_segment_ptr 1
  .amdhsa_system_sgpr_workgroup_id_x 1
.end_amdhsa_kernel
.p2align 6
.amdhsa_kernel w3_kernel
  .amdhsa_next_free_vgpr 512
  .amdhsa_next_free_sgpr 102
  .amdhsa_accum_offset 256
  .amdhsa_group_segment_fixed_size 0
  .amdhsa_kernarg_size 96
  .amdhsa_user_sgpr_count 2
  .amdhsa_user_sgpr_kernarg_segment_ptr 1
  .amdhsa_system_sgpr_workgroup_id_x 1
.end_amdhsa_kernel
.p2align 6
.amdhsa_kernel w4a_kernel
  .amdhsa_next_free_vgpr 512
  .amdhsa_next_free_sgpr 102
  .amdhsa_accum_offset 256
  .amdhsa_group_segment_fixed_size 0
  .amdhsa_kernarg_size 96
  .amdhsa_user_sgpr_count 2
  .amdhsa_user_sgpr_kernarg_segment_ptr 1
  .amdhsa_system_sgpr_workgroup_id_x 1
.end_amdhsa_kernel
.p2align 6
.amdhsa_kernel w4b_kernel
  .amdhsa_next_free_vgpr 512
  .amdhsa_next_free_sgpr 102
  .amdhsa_accum_offset 256
  .amdhsa_group_segment_fixed_size 0
  .amdhsa_kernarg_size 96
  .amdhsa_user_sgpr_count 2
  .amdhsa_user_sgpr_kernarg_segment_ptr 1
  .amdhsa_system_sgpr_workgroup_id_x 1
.end_amdhsa_kernel
```
